```python
import torch

def _softmax(x, axis=-1):
    return torch.softmax(x, dim=axis)
def _gelu(x):
    return torch.nn.functional.gelu(x, approximate="tanh")
def _silu(x):
    return torch.nn.functional.silu(x)
def _sigmoid(x):
    return torch.sigmoid(x)
def _layernorm(x, axis=-1, eps=1e-5):
    m = x.mean(dim=axis, keepdim=True)
    v = x.var(dim=axis, keepdim=True, unbiased=False)
    return (x - m) / torch.sqrt(v + eps)
def _scatter_add(tgt, idx, src, axis=0):
    return tgt.clone().index_add_(axis, idx, src)
def _segment_sum(src, seg, n):
    out = torch.zeros((n,) + src.shape[1:], dtype=src.dtype)
    return out.index_add_(0, seg, src)
def _pad(x, pw):
    flat = tuple(v for pair in reversed(pw) for v in pair)
    return torch.nn.functional.pad(x, flat)

kernel_name = 'concat_heads__mha_block_cached__gqa_block_cached__near_ridge'

def setup_inputs():

    _w = (lambda a: (lambda t: t.to(torch.bfloat16) if t.is_floating_point() else t)(torch.as_tensor(a)))
    def _A_setup():
        B, Sq, D = 16, 160, 512
        H, Sk, Dh = 32, 1024, 128
        return {
            "x": _w((lambda *s: torch.randn(*s, dtype=torch.bfloat16) * 0.8)(B, Sq, D)),
            "k_cache": _w((lambda *s: torch.randn(*s, dtype=torch.bfloat16) * 0.8)(B, H, Sk, Dh)),
            "v_cache": _w((lambda *s: torch.randn(*s, dtype=torch.bfloat16) * 0.05)(B, H, Sk, Dh)),
            "wq": _w((lambda *s: torch.randn(*s, dtype=torch.bfloat16) * 0.8)(D, H * Dh) * (D ** -0.5)),
            "wo": _w((lambda *s: torch.randn(*s, dtype=torch.bfloat16) * 0.05)(H * Dh, D) * ((H * Dh) ** -0.5)),
        }
    _A_in = _A_setup()

    def _B_setup():
        B, Sq, D = 16, 160, 512
        Hq, Hkv, Sk, Dh = 32, 32, 1024, 128
        assert Hq % Hkv == 0, (Hq, Hkv)
        return {
            "x": _w((lambda *s: torch.randn(*s, dtype=torch.bfloat16) * 0.8)(B, Sq, D)),
            "k_cache": _w((lambda *s: torch.randn(*s, dtype=torch.bfloat16) * 0.8)(B, Hkv, Sk, Dh)),
            "v_cache": _w((lambda *s: torch.randn(*s, dtype=torch.bfloat16) * 0.05)(B, Hkv, Sk, Dh)),
            "wq": _w((lambda *s: torch.randn(*s, dtype=torch.bfloat16) * 0.8)(D, Hq * Dh) * (D ** -0.5)),
            "wo": _w((lambda *s: torch.randn(*s, dtype=torch.bfloat16) * 0.05)(Hq * Dh, D) * ((Hq * Dh) ** -0.5)),
        }
    _B_in = _B_setup()

    return {
        "A_x": _A_in["x"],
        "A_k_cache": _A_in["k_cache"],
        "A_v_cache": _A_in["v_cache"],
        "A_wq": _A_in["wq"],
        "A_wo": _A_in["wo"],
        "B_x": _B_in["x"],
        "B_k_cache": _B_in["k_cache"],
        "B_v_cache": _B_in["v_cache"],
        "B_wq": _B_in["wq"],
        "B_wo": _B_in["wo"],
    }

def reference(A_x, A_k_cache, A_v_cache, A_wq, A_wo, B_x, B_k_cache, B_v_cache, B_wq, B_wo):
    def _A_ref(x, k_cache, v_cache, wq, wo):
        B, Sq, D = x.shape
        H, Dh = 32, 128
        q = (lambda x, *d: x.permute(*d))((x @ wq).reshape(B, Sq, H, Dh), 0, 2, 1, 3)
        scores = torch.einsum("bhqd,bhkd->bhqk", q, k_cache) * (Dh ** -0.5)
        p = _softmax(scores, axis=-1)
        o = torch.einsum("bhqk,bhkd->bhqd", p, v_cache)
        return (lambda x, *d: x.permute(*d))(o, 0, 2, 1, 3).reshape(B, Sq, H * Dh) @ wo

    def _B_ref(x, k_cache, v_cache, wq, wo):
        B, Sq, D = x.shape
        Hq, Dh = 32, 128
        Hkv = k_cache.shape[1]
        rep = Hq // Hkv
        q = (lambda x, *d: x.permute(*d))((x @ wq).reshape(B, Sq, Hq, Dh), 0, 2, 1, 3)
        k = (lambda x, n, axis: torch.repeat_interleave(x, n, dim=axis))(k_cache, rep, axis=1)
        v = (lambda x, n, axis: torch.repeat_interleave(x, n, dim=axis))(v_cache, rep, axis=1)
        scores = torch.einsum("bhqd,bhkd->bhqk", q, k) * (Dh ** -0.5)
        p = _softmax(scores, axis=-1)
        o = torch.einsum("bhqk,bhkd->bhqd", p, v)
        return (lambda x, *d: x.permute(*d))(o, 0, 2, 1, 3).reshape(B, Sq, Hq * Dh) @ wo

    a = _A_ref(A_x, A_k_cache, A_v_cache, A_wq, A_wo)
    b = _B_ref(B_x, B_k_cache, B_v_cache, B_wq, B_wo)
    return torch.concatenate([a, b], axis=-1)
```

```asm
; @launch kernel=prep_kernel grid=(1344,1,1) block=(256,1,1) lds=0
; @launch kernel=concat_heads__mha_block_cached__gqa_block_cached__near_ridge_kernel grid=(512,1,1) block=(128,1,1) lds=81920
; @launch kernel=oproj_kernel grid=(256,1,1) block=(256,1,1) lds=122880
.amdgcn_target "amdgcn-amd-amdhsa--gfx950"
.text
.globl concat_heads__mha_block_cached__gqa_block_cached__near_ridge_kernel
.p2align 8
.type concat_heads__mha_block_cached__gqa_block_cached__near_ridge_kernel,@function
concat_heads__mha_block_cached__gqa_block_cached__near_ridge_kernel:
    s_cmp_ge_u32 s2, 512
    s_cbranch_scc1 K1_END
    s_load_dwordx8 s[4:11], s[0:1], 0
    s_load_dwordx2 s[12:13], s[0:1], 32
    s_load_dwordx8 s[16:23], s[0:1], 40
    s_load_dwordx2 s[24:25], s[0:1], 72
    s_load_dwordx2 s[26:27], s[0:1], 96
    v_and_b32 v243, 63, v0
    v_lshrrev_b32 v244, 6, v0
    s_nop 1
    v_readfirstlane_b32 s35, v244
    s_nop 3
    s_lshl_b32 s30, s35, 12
    s_mul_i32 s75, s35, 80
    s_mul_i32 s84, s35, 5120
    s_and_b32 s68, s2, 7
    s_lshr_b32 s69, s2, 3
    s_lshl_b32 s74, s68, 2
    s_add_u32 s74, s74, s69
    s_and_b32 s74, s74, 31
    s_lshl_b32 s74, s74, 13
    s_add_u32 s83, s74, s30
    s_lshr_b32 s32, s69, 2
    s_and_b32 s69, s69, 3
    s_lshl_b32 s68, s68, 2
    s_add_u32 s33, s68, s69
    s_lshl_b32 s68, s32, 5
    s_add_u32 s85, s68, s33
    s_lshl_b32 s34, s85, 18
    s_mov_b32 s67, 0x3e0293ee
    s_mov_b32 s72, 0x41000000
    v_and_b32 v245, 15, v243
    v_lshrrev_b32 v246, 4, v243
    v_bfe_u32 v247, v243, 2, 2
    v_and_b32 v248, 3, v243
    v_mov_b32 v204, 0x3f803f80
    v_mov_b32 v205, 0x3f803f80
    v_mov_b32 v206, 0x3f803f80
    v_mov_b32 v207, 0x3f803f80
    v_add_u32 v249, 0, v246
    v_xor_b32 v249, v249, v245
    v_lshlrev_b32 v249, 4, v249
    v_lshl_add_u32 v218, v245, 8, v249
    v_add_u32 v249, 4, v246
    v_xor_b32 v249, v249, v245
    v_lshlrev_b32 v249, 4, v249
    v_lshl_add_u32 v219, v245, 8, v249
    v_add_u32 v249, 8, v246
    v_xor_b32 v249, v249, v245
    v_lshlrev_b32 v249, 4, v249
    v_lshl_add_u32 v220, v245, 8, v249
    v_add_u32 v249, 12, v246
    v_xor_b32 v249, v249, v245
    v_lshlrev_b32 v249, 4, v249
    v_lshl_add_u32 v221, v245, 8, v249
    v_xor_b32 v249, 0, v247
    v_lshl_add_u32 v249, v249, 2, v248
    v_lshlrev_b32 v249, 4, v249
    v_lshl_add_u32 v250, v246, 2, v247
    v_lshl_add_u32 v222, v250, 8, v249
    v_lshl_add_u32 v250, v246, 3, v247
    v_lshl_add_u32 v250, v250, 8, v249
    v_add_u32 v226, 49152, v250
    v_xor_b32 v249, 1, v247
    v_lshl_add_u32 v249, v249, 2, v248
    v_lshlrev_b32 v249, 4, v249
    v_lshl_add_u32 v250, v246, 2, v247
    v_lshl_add_u32 v223, v250, 8, v249
    v_lshl_add_u32 v250, v246, 3, v247
    v_lshl_add_u32 v250, v250, 8, v249
    v_add_u32 v227, 49152, v250
    v_xor_b32 v249, 2, v247
    v_lshl_add_u32 v249, v249, 2, v248
    v_lshlrev_b32 v249, 4, v249
    v_lshl_add_u32 v250, v246, 2, v247
    v_lshl_add_u32 v224, v250, 8, v249
    v_lshl_add_u32 v250, v246, 3, v247
    v_lshl_add_u32 v250, v250, 8, v249
    v_add_u32 v228, 49152, v250
    v_xor_b32 v249, 3, v247
    v_lshl_add_u32 v249, v249, 2, v248
    v_lshlrev_b32 v249, 4, v249
    v_lshl_add_u32 v250, v246, 2, v247
    v_lshl_add_u32 v225, v250, 8, v249
    v_lshl_add_u32 v250, v246, 3, v247
    v_lshl_add_u32 v250, v250, 8, v249
    v_add_u32 v229, 49152, v250
    v_add_u32 v249, 0, v246
    v_xor_b32 v249, v249, v245
    v_lshlrev_b32 v249, 4, v249
    v_lshl_add_u32 v230, v246, 8, v249
    v_add_u32 v249, 4, v246
    v_xor_b32 v249, v249, v245
    v_lshlrev_b32 v249, 4, v249
    v_lshl_add_u32 v231, v246, 8, v249
    v_add_u32 v249, 8, v246
    v_xor_b32 v249, v249, v245
    v_lshlrev_b32 v249, 4, v249
    v_lshl_add_u32 v232, v246, 8, v249
    v_add_u32 v249, 12, v246
    v_xor_b32 v249, v249, v245
    v_lshlrev_b32 v249, 4, v249
    v_lshl_add_u32 v233, v246, 8, v249
    v_lshlrev_b32 v249, 2, v246
    v_xor_b32 v249, v249, v245
    v_lshlrev_b32 v249, 4, v249
    v_lshl_add_u32 v234, v246, 8, v249
    v_lshl_add_u32 v235, v246, 13, v249
    v_lshlrev_b32 v241, 4, v243
    s_mul_i32 s68, s35, 81920
    v_add_u32 v249, s68, v241
    v_add_u32 v236, 0, v249
    v_add_u32 v249, s68, v241
    v_add_u32 v237, 16384, v249
    v_add_u32 v249, s68, v241
    v_add_u32 v238, 32768, v249
    v_add_u32 v249, s68, v241
    v_add_u32 v239, 49152, v249
    v_add_u32 v249, s68, v241
    v_add_u32 v240, 65536, v249
    v_lshlrev_b32 v253, 7, v243
    v_lshrrev_b32 v249, 1, v243
    v_and_b32 v250, 1, v243
    v_lshlrev_b32 v250, 7, v250
    v_lshl_add_u32 v252, v249, 13, v250
    s_waitcnt lgkmcnt(0)
    s_add_u32 s36, s6, s34
    s_addc_u32 s37, s7, 0
    s_and_b32 s37, s37, 65535
    s_mov_b32 s38, 262144
    s_mov_b32 s39, 131072
    s_add_u32 s40, s8, s34
    s_addc_u32 s41, s9, 0
    s_and_b32 s41, s41, 65535
    s_mov_b32 s42, 262144
    s_mov_b32 s43, 131072
    s_add_u32 s44, s18, s34
    s_addc_u32 s45, s19, 0
    s_and_b32 s45, s45, 65535
    s_mov_b32 s46, 262144
    s_mov_b32 s47, 131072
    s_add_u32 s48, s20, s34
    s_addc_u32 s49, s21, 0
    s_and_b32 s49, s49, 65535
    s_mov_b32 s50, 262144
    s_mov_b32 s51, 131072
    s_mov_b32 s31, 0
    s_add_u32 m0, s30, 0
    s_add_u32 s64, s83, 0
    s_and_b32 s64, s64, 262143
    buffer_load_dwordx4 v230, s[36:39], s64 offen offset:0 nt lds
    buffer_load_dwordx4 v231, s[36:39], s64 offen offset:1024 nt lds
    buffer_load_dwordx4 v232, s[36:39], s64 offen offset:2048 nt lds
    buffer_load_dwordx4 v233, s[36:39], s64 offen offset:3072 nt lds
    s_add_u32 m0, s30, 8192
    s_add_u32 s64, s83, 8192
    s_and_b32 s64, s64, 262143
    buffer_load_dwordx4 v230, s[36:39], s64 offen offset:0 nt lds
    buffer_load_dwordx4 v231, s[36:39], s64 offen offset:1024 nt lds
    buffer_load_dwordx4 v232, s[36:39], s64 offen offset:2048 nt lds
    buffer_load_dwordx4 v233, s[36:39], s64 offen offset:3072 nt lds
    s_add_u32 m0, s30, 16384
    s_add_u32 s64, s83, 16384
    s_and_b32 s64, s64, 262143
    buffer_load_dwordx4 v230, s[36:39], s64 offen offset:0 nt lds
    buffer_load_dwordx4 v231, s[36:39], s64 offen offset:1024 nt lds
    buffer_load_dwordx4 v232, s[36:39], s64 offen offset:2048 nt lds
    buffer_load_dwordx4 v233, s[36:39], s64 offen offset:3072 nt lds
    s_add_u32 m0, s30, 32768
    s_add_u32 s65, s83, 0
    s_and_b32 s65, s65, 262143
    buffer_load_dwordx4 v234, s[40:43], s65 offen offset:0 nt lds
    buffer_load_dwordx4 v234, s[40:43], s65 offen offset:1024 nt lds
    buffer_load_dwordx4 v234, s[40:43], s65 offen offset:2048 nt lds
    buffer_load_dwordx4 v234, s[40:43], s65 offen offset:3072 nt lds
    s_add_u32 m0, s30, 24576
    s_add_u32 s64, s83, 24576
    s_and_b32 s64, s64, 262143
    buffer_load_dwordx4 v230, s[36:39], s64 offen offset:0 nt lds
    buffer_load_dwordx4 v231, s[36:39], s64 offen offset:1024 nt lds
    buffer_load_dwordx4 v232, s[36:39], s64 offen offset:2048 nt lds
    buffer_load_dwordx4 v233, s[36:39], s64 offen offset:3072 nt lds
    s_add_u32 m0, s30, 40960
    s_add_u32 s65, s83, 8192
    s_and_b32 s65, s65, 262143
    buffer_load_dwordx4 v234, s[40:43], s65 offen offset:0 nt lds
    buffer_load_dwordx4 v234, s[40:43], s65 offen offset:1024 nt lds
    buffer_load_dwordx4 v234, s[40:43], s65 offen offset:2048 nt lds
    buffer_load_dwordx4 v234, s[40:43], s65 offen offset:3072 nt lds
    s_lshr_b32 s68, s2, 3
    s_lshr_b32 s69, s68, 5
    s_xor_b32 s68, s68, s69
    s_and_b32 s100, s68, 0
    s_mov_b32 s101, 0
    s_mov_b32 s87, 0
    s_mul_i32 s86, s35, 20480
    s_mul_i32 s68, s2, 40960
    s_add_u32 s68, s68, 117440512
    s_add_u32 s96, s26, s68
    s_addc_u32 s97, s27, 0
    s_and_b32 s97, s97, 65535
    s_mov_b32 s98, 40960
    s_mov_b32 s99, 131072
    s_lshl_b32 s68, s31, 4
    s_add_u32 s68, s68, s32
    s_mul_i32 s68, s68, 163840
    s_add_u32 s68, s68, 67108864
    s_add_u32 s56, s26, s68
    s_addc_u32 s57, s27, 0
    s_and_b32 s57, s57, 65535
    s_mov_b32 s58, 163840
    s_mov_b32 s59, 131072
    s_lshl_b32 s68, s31, 5
    s_add_u32 s68, s68, s33
    s_lshl_b32 s68, s68, 17
    s_add_u32 s68, s68, 83886080
    s_add_u32 s52, s26, s68
    s_addc_u32 s53, s27, 0
    s_and_b32 s53, s53, 65535
    s_mov_b32 s54, 131072
    s_mov_b32 s55, 131072
    s_mov_b32 s14, 0
K1_ROUND:
    s_lshl_b32 s69, s31, 9
    s_add_u32 s69, s69, s85
    s_mul_i32 s69, s69, 40960
    s_add_u32 s60, s26, s69
    s_addc_u32 s61, s27, 0
    s_and_b32 s61, s61, 65535
    s_mov_b32 s62, 40960
    s_mov_b32 s63, 131072
    s_add_u32 s64, s83, 32768
    s_and_b32 s64, s64, 262143
    s_add_u32 s65, s83, 16384
    s_and_b32 s65, s65, 262143
    s_and_b32 s68, s100, s31
    s_cmp_eq_u32 s68, 0
    s_cbranch_scc1 K1_DOQ
    s_add_u32 s68, s86, 0
    buffer_load_dwordx4 a[160:163], v241, s[96:99], s68 offen offset:0
    s_add_u32 s68, s86, 1024
    buffer_load_dwordx4 a[164:167], v241, s[96:99], s68 offen offset:0
    s_add_u32 s68, s86, 2048
    buffer_load_dwordx4 a[168:171], v241, s[96:99], s68 offen offset:0
    s_add_u32 s68, s86, 3072
    buffer_load_dwordx4 a[172:175], v241, s[96:99], s68 offen offset:0
    s_add_u32 s68, s86, 4096
    buffer_load_dwordx4 a[176:179], v241, s[96:99], s68 offen offset:0
    s_add_u32 s68, s86, 5120
    buffer_load_dwordx4 a[180:183], v241, s[96:99], s68 offen offset:0
    s_add_u32 s68, s86, 6144
    buffer_load_dwordx4 a[184:187], v241, s[96:99], s68 offen offset:0
    s_add_u32 s68, s86, 7168
    buffer_load_dwordx4 a[188:191], v241, s[96:99], s68 offen offset:0
    s_add_u32 s68, s86, 8192
    buffer_load_dwordx4 a[192:195], v241, s[96:99], s68 offen offset:0
    s_add_u32 s68, s86, 9216
    buffer_load_dwordx4 a[196:199], v241, s[96:99], s68 offen offset:0
    s_add_u32 s68, s86, 10240
    buffer_load_dwordx4 a[200:203], v241, s[96:99], s68 offen offset:0
    s_add_u32 s68, s86, 11264
    buffer_load_dwordx4 a[204:207], v241, s[96:99], s68 offen offset:0
    s_add_u32 s68, s86, 12288
    buffer_load_dwordx4 a[208:211], v241, s[96:99], s68 offen offset:0
    s_add_u32 s68, s86, 13312
    buffer_load_dwordx4 a[212:215], v241, s[96:99], s68 offen offset:0
    s_add_u32 s68, s86, 14336
    buffer_load_dwordx4 a[216:219], v241, s[96:99], s68 offen offset:0
    s_add_u32 s68, s86, 15360
    buffer_load_dwordx4 a[220:223], v241, s[96:99], s68 offen offset:0
    s_add_u32 s68, s86, 16384
    buffer_load_dwordx4 a[224:227], v241, s[96:99], s68 offen offset:0
    s_add_u32 s68, s86, 17408
    buffer_load_dwordx4 a[228:231], v241, s[96:99], s68 offen offset:0
    s_add_u32 s68, s86, 18432
    buffer_load_dwordx4 a[232:235], v241, s[96:99], s68 offen offset:0
    s_add_u32 s68, s86, 19456
    buffer_load_dwordx4 a[236:239], v241, s[96:99], s68 offen offset:0
    s_waitcnt vmcnt(0)
    s_branch K1_QEND
K1_DOQ:
    s_mov_b32 s101, 0
K1_QP:
    s_mov_b32 s88, 0
    s_mov_b32 s89, 4096
    s_mov_b32 s90, 8192
    s_mov_b32 s91, 12288
    s_waitcnt lgkmcnt(0)
    s_barrier
    s_add_u32 m0, s30, 49152
    s_add_u32 s73, s30, 0
    buffer_load_dwordx4 v241, s[52:55], s73 offen offset:0 lds
    buffer_load_dwordx4 v241, s[52:55], s73 offen offset:1024 lds
    buffer_load_dwordx4 v241, s[52:55], s73 offen offset:2048 lds
    buffer_load_dwordx4 v241, s[52:55], s73 offen offset:3072 lds
    s_add_u32 m0, s30, 57344
    s_add_u32 s73, s30, 8192
    buffer_load_dwordx4 v241, s[52:55], s73 offen offset:0 lds
    buffer_load_dwordx4 v241, s[52:55], s73 offen offset:1024 lds
    buffer_load_dwordx4 v241, s[52:55], s73 offen offset:2048 lds
    buffer_load_dwordx4 v241, s[52:55], s73 offen offset:3072 lds
    s_add_u32 m0, s30, 65536
    s_add_u32 s73, s30, 16384
    buffer_load_dwordx4 v241, s[52:55], s73 offen offset:0 lds
    buffer_load_dwordx4 v241, s[52:55], s73 offen offset:1024 lds
    buffer_load_dwordx4 v241, s[52:55], s73 offen offset:2048 lds
    buffer_load_dwordx4 v241, s[52:55], s73 offen offset:3072 lds
    s_add_u32 m0, s30, 73728
    s_add_u32 s73, s30, 24576
    buffer_load_dwordx4 v241, s[52:55], s73 offen offset:0 lds
    buffer_load_dwordx4 v241, s[52:55], s73 offen offset:1024 lds
    buffer_load_dwordx4 v241, s[52:55], s73 offen offset:2048 lds
    buffer_load_dwordx4 v241, s[52:55], s73 offen offset:3072 lds
    buffer_load_dwordx4 v[0:3], v236, s[56:59], s88 offen offset:0
    buffer_load_dwordx4 v[4:7], v237, s[56:59], s88 offen offset:0
    buffer_load_dwordx4 v[8:11], v238, s[56:59], s88 offen offset:0
    buffer_load_dwordx4 v[12:15], v239, s[56:59], s88 offen offset:0
    buffer_load_dwordx4 v[16:19], v240, s[56:59], s88 offen offset:0
    buffer_load_dwordx4 v[20:23], v236, s[56:59], s88 offen offset:1024
    buffer_load_dwordx4 v[24:27], v237, s[56:59], s88 offen offset:1024
    buffer_load_dwordx4 v[28:31], v238, s[56:59], s88 offen offset:1024
    buffer_load_dwordx4 v[32:35], v239, s[56:59], s88 offen offset:1024
    buffer_load_dwordx4 v[36:39], v240, s[56:59], s88 offen offset:1024
    buffer_load_dwordx4 v[40:43], v236, s[56:59], s88 offen offset:2048
    buffer_load_dwordx4 v[44:47], v237, s[56:59], s88 offen offset:2048
    buffer_load_dwordx4 v[48:51], v238, s[56:59], s88 offen offset:2048
    buffer_load_dwordx4 v[52:55], v239, s[56:59], s88 offen offset:2048
    buffer_load_dwordx4 v[56:59], v240, s[56:59], s88 offen offset:2048
    s_waitcnt vmcnt(27)
    s_waitcnt lgkmcnt(0)
    s_barrier
    ds_read_b64_tr_b16 v[132:133], v226 offset:0
    ds_read_b64_tr_b16 v[134:135], v226 offset:1024
    ds_read_b64_tr_b16 v[136:137], v226 offset:8
    ds_read_b64_tr_b16 v[138:139], v226 offset:1032
    ds_read_b64_tr_b16 v[140:141], v227 offset:0
    ds_read_b64_tr_b16 v[142:143], v227 offset:1024
    ds_read_b64_tr_b16 v[144:145], v227 offset:8
    ds_read_b64_tr_b16 v[146:147], v227 offset:1032
    ds_read_b64_tr_b16 v[148:149], v228 offset:0
    ds_read_b64_tr_b16 v[150:151], v228 offset:1024
    ds_read_b64_tr_b16 v[152:153], v228 offset:8
    ds_read_b64_tr_b16 v[154:155], v228 offset:1032
    ds_read_b64_tr_b16 v[156:157], v229 offset:0
    ds_read_b64_tr_b16 v[158:159], v229 offset:1024
    ds_read_b64_tr_b16 v[160:161], v229 offset:8
    ds_read_b64_tr_b16 v[162:163], v229 offset:1032
    s_waitcnt vmcnt(23)
    s_waitcnt lgkmcnt(0)
    s_barrier
    s_waitcnt vmcnt(14)
    v_mfma_f32_16x16x32_bf16 a[0:3], v[132:135], v[0:3], 0
    v_mfma_f32_16x16x32_bf16 a[20:23], v[136:139], v[0:3], 0
    ds_read_b64_tr_b16 v[100:101], v226 offset:8192
    v_mfma_f32_16x16x32_bf16 a[40:43], v[140:143], v[0:3], 0
    s_add_u32 m0, s30, 49152
    s_add_u32 s73, s30, 32768
    buffer_load_dwordx4 v241, s[52:55], s73 offen offset:0 lds
    v_mfma_f32_16x16x32_bf16 a[60:63], v[144:147], v[0:3], 0
    ds_read_b64_tr_b16 v[102:103], v226 offset:9216
    v_mfma_f32_16x16x32_bf16 a[80:83], v[148:151], v[0:3], 0
    v_mfma_f32_16x16x32_bf16 a[100:103], v[152:155], v[0:3], 0
    ds_read_b64_tr_b16 v[104:105], v226 offset:8200
    v_mfma_f32_16x16x32_bf16 a[120:123], v[156:159], v[0:3], 0
    buffer_load_dwordx4 v241, s[52:55], s73 offen offset:1024 lds
    v_mfma_f32_16x16x32_bf16 a[140:143], v[160:163], v[0:3], 0
    ds_read_b64_tr_b16 v[106:107], v226 offset:9224
    s_waitcnt vmcnt(15)
    v_mfma_f32_16x16x32_bf16 a[4:7], v[132:135], v[4:7], 0
    v_mfma_f32_16x16x32_bf16 a[24:27], v[136:139], v[4:7], 0
    ds_read_b64_tr_b16 v[108:109], v227 offset:8192
    v_mfma_f32_16x16x32_bf16 a[44:47], v[140:143], v[4:7], 0
    buffer_load_dwordx4 v241, s[52:55], s73 offen offset:2048 lds
    v_mfma_f32_16x16x32_bf16 a[64:67], v[144:147], v[4:7], 0
    ds_read_b64_tr_b16 v[110:111], v227 offset:9216
    v_mfma_f32_16x16x32_bf16 a[84:87], v[148:151], v[4:7], 0
    v_mfma_f32_16x16x32_bf16 a[104:107], v[152:155], v[4:7], 0
    ds_read_b64_tr_b16 v[112:113], v227 offset:8200
    v_mfma_f32_16x16x32_bf16 a[124:127], v[156:159], v[4:7], 0
    buffer_load_dwordx4 v241, s[52:55], s73 offen offset:3072 lds
    v_mfma_f32_16x16x32_bf16 a[144:147], v[160:163], v[4:7], 0
    ds_read_b64_tr_b16 v[114:115], v227 offset:9224
    s_waitcnt vmcnt(16)
    v_mfma_f32_16x16x32_bf16 a[8:11], v[132:135], v[8:11], 0
    v_mfma_f32_16x16x32_bf16 a[28:31], v[136:139], v[8:11], 0
    ds_read_b64_tr_b16 v[116:117], v228 offset:8192
    v_mfma_f32_16x16x32_bf16 a[48:51], v[140:143], v[8:11], 0
    buffer_load_dwordx4 v[60:63], v236, s[56:59], s88 offen offset:3072
    v_mfma_f32_16x16x32_bf16 a[68:71], v[144:147], v[8:11], 0
    ds_read_b64_tr_b16 v[118:119], v228 offset:9216
    v_mfma_f32_16x16x32_bf16 a[88:91], v[148:151], v[8:11], 0
    v_mfma_f32_16x16x32_bf16 a[108:111], v[152:155], v[8:11], 0
    ds_read_b64_tr_b16 v[120:121], v228 offset:8200
    v_mfma_f32_16x16x32_bf16 a[128:131], v[156:159], v[8:11], 0
    buffer_load_dwordx4 v[64:67], v237, s[56:59], s88 offen offset:3072
    v_mfma_f32_16x16x32_bf16 a[148:151], v[160:163], v[8:11], 0
    ds_read_b64_tr_b16 v[122:123], v228 offset:9224
    s_waitcnt vmcnt(17)
    v_mfma_f32_16x16x32_bf16 a[12:15], v[132:135], v[12:15], 0
    v_mfma_f32_16x16x32_bf16 a[32:35], v[136:139], v[12:15], 0
    ds_read_b64_tr_b16 v[124:125], v229 offset:8192
    v_mfma_f32_16x16x32_bf16 a[52:55], v[140:143], v[12:15], 0
    buffer_load_dwordx4 v[68:71], v238, s[56:59], s88 offen offset:3072
    v_mfma_f32_16x16x32_bf16 a[72:75], v[144:147], v[12:15], 0
    ds_read_b64_tr_b16 v[126:127], v229 offset:9216
    v_mfma_f32_16x16x32_bf16 a[92:95], v[148:151], v[12:15], 0
    v_mfma_f32_16x16x32_bf16 a[112:115], v[152:155], v[12:15], 0
    ds_read_b64_tr_b16 v[128:129], v229 offset:8200
    v_mfma_f32_16x16x32_bf16 a[132:135], v[156:159], v[12:15], 0
    buffer_load_dwordx4 v[72:75], v239, s[56:59], s88 offen offset:3072
    v_mfma_f32_16x16x32_bf16 a[152:155], v[160:163], v[12:15], 0
    ds_read_b64_tr_b16 v[130:131], v229 offset:9224
    s_waitcnt vmcnt(18)
    v_mfma_f32_16x16x32_bf16 a[16:19], v[132:135], v[16:19], 0
    v_mfma_f32_16x16x32_bf16 a[36:39], v[136:139], v[16:19], 0
    v_mfma_f32_16x16x32_bf16 a[56:59], v[140:143], v[16:19], 0
    buffer_load_dwordx4 v[76:79], v240, s[56:59], s88 offen offset:3072
    v_mfma_f32_16x16x32_bf16 a[76:79], v[144:147], v[16:19], 0
    v_mfma_f32_16x16x32_bf16 a[96:99], v[148:151], v[16:19], 0
    v_mfma_f32_16x16x32_bf16 a[116:119], v[152:155], v[16:19], 0
    v_mfma_f32_16x16x32_bf16 a[136:139], v[156:159], v[16:19], 0
    v_mfma_f32_16x16x32_bf16 a[156:159], v[160:163], v[16:19], 0
    s_waitcnt lgkmcnt(0)
    s_barrier
    s_waitcnt vmcnt(18)
    v_mfma_f32_16x16x32_bf16 a[0:3], v[100:103], v[20:23], a[0:3]
    v_mfma_f32_16x16x32_bf16 a[20:23], v[104:107], v[20:23], a[20:23]
    ds_read_b64_tr_b16 v[132:133], v226 offset:16384
    v_mfma_f32_16x16x32_bf16 a[40:43], v[108:111], v[20:23], a[40:43]
    s_add_u32 m0, s30, 57344
    s_add_u32 s73, s30, 40960
    buffer_load_dwordx4 v241, s[52:55], s73 offen offset:0 lds
    v_mfma_f32_16x16x32_bf16 a[60:63], v[112:115], v[20:23], a[60:63]
    ds_read_b64_tr_b16 v[134:135], v226 offset:17408
    v_mfma_f32_16x16x32_bf16 a[80:83], v[116:119], v[20:23], a[80:83]
    v_mfma_f32_16x16x32_bf16 a[100:103], v[120:123], v[20:23], a[100:103]
    ds_read_b64_tr_b16 v[136:137], v226 offset:16392
    v_mfma_f32_16x16x32_bf16 a[120:123], v[124:127], v[20:23], a[120:123]
    buffer_load_dwordx4 v241, s[52:55], s73 offen offset:1024 lds
    v_mfma_f32_16x16x32_bf16 a[140:143], v[128:131], v[20:23], a[140:143]
    ds_read_b64_tr_b16 v[138:139], v226 offset:17416
    s_waitcnt vmcnt(19)
    v_mfma_f32_16x16x32_bf16 a[4:7], v[100:103], v[24:27], a[4:7]
    v_mfma_f32_16x16x32_bf16 a[24:27], v[104:107], v[24:27], a[24:27]
    ds_read_b64_tr_b16 v[140:141], v227 offset:16384
    v_mfma_f32_16x16x32_bf16 a[44:47], v[108:111], v[24:27], a[44:47]
    buffer_load_dwordx4 v241, s[52:55], s73 offen offset:2048 lds
    v_mfma_f32_16x16x32_bf16 a[64:67], v[112:115], v[24:27], a[64:67]
    ds_read_b64_tr_b16 v[142:143], v227 offset:17408
    v_mfma_f32_16x16x32_bf16 a[84:87], v[116:119], v[24:27], a[84:87]
    v_mfma_f32_16x16x32_bf16 a[104:107], v[120:123], v[24:27], a[104:107]
    ds_read_b64_tr_b16 v[144:145], v227 offset:16392
    v_mfma_f32_16x16x32_bf16 a[124:127], v[124:127], v[24:27], a[124:127]
    buffer_load_dwordx4 v241, s[52:55], s73 offen offset:3072 lds
    v_mfma_f32_16x16x32_bf16 a[144:147], v[128:131], v[24:27], a[144:147]
    ds_read_b64_tr_b16 v[146:147], v227 offset:17416
    s_waitcnt vmcnt(20)
    v_mfma_f32_16x16x32_bf16 a[8:11], v[100:103], v[28:31], a[8:11]
    v_mfma_f32_16x16x32_bf16 a[28:31], v[104:107], v[28:31], a[28:31]
    ds_read_b64_tr_b16 v[148:149], v228 offset:16384
    v_mfma_f32_16x16x32_bf16 a[48:51], v[108:111], v[28:31], a[48:51]
    buffer_load_dwordx4 v[0:3], v236, s[56:59], s89 offen offset:0
    v_mfma_f32_16x16x32_bf16 a[68:71], v[112:115], v[28:31], a[68:71]
    ds_read_b64_tr_b16 v[150:151], v228 offset:17408
    v_mfma_f32_16x16x32_bf16 a[88:91], v[116:119], v[28:31], a[88:91]
    v_mfma_f32_16x16x32_bf16 a[108:111], v[120:123], v[28:31], a[108:111]
    ds_read_b64_tr_b16 v[152:153], v228 offset:16392
    v_mfma_f32_16x16x32_bf16 a[128:131], v[124:127], v[28:31], a[128:131]
    buffer_load_dwordx4 v[4:7], v237, s[56:59], s89 offen offset:0
    v_mfma_f32_16x16x32_bf16 a[148:151], v[128:131], v[28:31], a[148:151]
    ds_read_b64_tr_b16 v[154:155], v228 offset:17416
    s_waitcnt vmcnt(21)
    v_mfma_f32_16x16x32_bf16 a[12:15], v[100:103], v[32:35], a[12:15]
    v_mfma_f32_16x16x32_bf16 a[32:35], v[104:107], v[32:35], a[32:35]
    ds_read_b64_tr_b16 v[156:157], v229 offset:16384
    v_mfma_f32_16x16x32_bf16 a[52:55], v[108:111], v[32:35], a[52:55]
    buffer_load_dwordx4 v[8:11], v238, s[56:59], s89 offen offset:0
    v_mfma_f32_16x16x32_bf16 a[72:75], v[112:115], v[32:35], a[72:75]
    ds_read_b64_tr_b16 v[158:159], v229 offset:17408
    v_mfma_f32_16x16x32_bf16 a[92:95], v[116:119], v[32:35], a[92:95]
    v_mfma_f32_16x16x32_bf16 a[112:115], v[120:123], v[32:35], a[112:115]
    ds_read_b64_tr_b16 v[160:161], v229 offset:16392
    v_mfma_f32_16x16x32_bf16 a[132:135], v[124:127], v[32:35], a[132:135]
    buffer_load_dwordx4 v[12:15], v239, s[56:59], s89 offen offset:0
    v_mfma_f32_16x16x32_bf16 a[152:155], v[128:131], v[32:35], a[152:155]
    ds_read_b64_tr_b16 v[162:163], v229 offset:17416
    s_waitcnt vmcnt(22)
    v_mfma_f32_16x16x32_bf16 a[16:19], v[100:103], v[36:39], a[16:19]
    v_mfma_f32_16x16x32_bf16 a[36:39], v[104:107], v[36:39], a[36:39]
    v_mfma_f32_16x16x32_bf16 a[56:59], v[108:111], v[36:39], a[56:59]
    buffer_load_dwordx4 v[16:19], v240, s[56:59], s89 offen offset:0
    v_mfma_f32_16x16x32_bf16 a[76:79], v[112:115], v[36:39], a[76:79]
    v_mfma_f32_16x16x32_bf16 a[96:99], v[116:119], v[36:39], a[96:99]
    v_mfma_f32_16x16x32_bf16 a[116:119], v[120:123], v[36:39], a[116:119]
    v_mfma_f32_16x16x32_bf16 a[136:139], v[124:127], v[36:39], a[136:139]
    v_mfma_f32_16x16x32_bf16 a[156:159], v[128:131], v[36:39], a[156:159]
    s_waitcnt lgkmcnt(0)
    s_barrier
    s_waitcnt vmcnt(22)
    v_mfma_f32_16x16x32_bf16 a[0:3], v[132:135], v[40:43], a[0:3]
    v_mfma_f32_16x16x32_bf16 a[20:23], v[136:139], v[40:43], a[20:23]
    ds_read_b64_tr_b16 v[100:101], v226 offset:24576
    v_mfma_f32_16x16x32_bf16 a[40:43], v[140:143], v[40:43], a[40:43]
    s_add_u32 m0, s30, 65536
    s_add_u32 s73, s30, 49152
    buffer_load_dwordx4 v241, s[52:55], s73 offen offset:0 lds
    v_mfma_f32_16x16x32_bf16 a[60:63], v[144:147], v[40:43], a[60:63]
    ds_read_b64_tr_b16 v[102:103], v226 offset:25600
    v_mfma_f32_16x16x32_bf16 a[80:83], v[148:151], v[40:43], a[80:83]
    v_mfma_f32_16x16x32_bf16 a[100:103], v[152:155], v[40:43], a[100:103]
    ds_read_b64_tr_b16 v[104:105], v226 offset:24584
    v_mfma_f32_16x16x32_bf16 a[120:123], v[156:159], v[40:43], a[120:123]
    buffer_load_dwordx4 v241, s[52:55], s73 offen offset:1024 lds
    v_mfma_f32_16x16x32_bf16 a[140:143], v[160:163], v[40:43], a[140:143]
    ds_read_b64_tr_b16 v[106:107], v226 offset:25608
    s_waitcnt vmcnt(23)
    v_mfma_f32_16x16x32_bf16 a[4:7], v[132:135], v[44:47], a[4:7]
    v_mfma_f32_16x16x32_bf16 a[24:27], v[136:139], v[44:47], a[24:27]
    ds_read_b64_tr_b16 v[108:109], v227 offset:24576
    v_mfma_f32_16x16x32_bf16 a[44:47], v[140:143], v[44:47], a[44:47]
    buffer_load_dwordx4 v241, s[52:55], s73 offen offset:2048 lds
    v_mfma_f32_16x16x32_bf16 a[64:67], v[144:147], v[44:47], a[64:67]
    ds_read_b64_tr_b16 v[110:111], v227 offset:25600
    v_mfma_f32_16x16x32_bf16 a[84:87], v[148:151], v[44:47], a[84:87]
    v_mfma_f32_16x16x32_bf16 a[104:107], v[152:155], v[44:47], a[104:107]
    ds_read_b64_tr_b16 v[112:113], v227 offset:24584
    v_mfma_f32_16x16x32_bf16 a[124:127], v[156:159], v[44:47], a[124:127]
    buffer_load_dwordx4 v241, s[52:55], s73 offen offset:3072 lds
    v_mfma_f32_16x16x32_bf16 a[144:147], v[160:163], v[44:47], a[144:147]
    ds_read_b64_tr_b16 v[114:115], v227 offset:25608
    s_waitcnt vmcnt(24)
    v_mfma_f32_16x16x32_bf16 a[8:11], v[132:135], v[48:51], a[8:11]
    v_mfma_f32_16x16x32_bf16 a[28:31], v[136:139], v[48:51], a[28:31]
    ds_read_b64_tr_b16 v[116:117], v228 offset:24576
    v_mfma_f32_16x16x32_bf16 a[48:51], v[140:143], v[48:51], a[48:51]
    buffer_load_dwordx4 v[20:23], v236, s[56:59], s89 offen offset:1024
    v_mfma_f32_16x16x32_bf16 a[68:71], v[144:147], v[48:51], a[68:71]
    ds_read_b64_tr_b16 v[118:119], v228 offset:25600
    v_mfma_f32_16x16x32_bf16 a[88:91], v[148:151], v[48:51], a[88:91]
    v_mfma_f32_16x16x32_bf16 a[108:111], v[152:155], v[48:51], a[108:111]
    ds_read_b64_tr_b16 v[120:121], v228 offset:24584
    v_mfma_f32_16x16x32_bf16 a[128:131], v[156:159], v[48:51], a[128:131]
    buffer_load_dwordx4 v[24:27], v237, s[56:59], s89 offen offset:1024
    v_mfma_f32_16x16x32_bf16 a[148:151], v[160:163], v[48:51], a[148:151]
    ds_read_b64_tr_b16 v[122:123], v228 offset:25608
    s_waitcnt vmcnt(25)
    v_mfma_f32_16x16x32_bf16 a[12:15], v[132:135], v[52:55], a[12:15]
    v_mfma_f32_16x16x32_bf16 a[32:35], v[136:139], v[52:55], a[32:35]
    ds_read_b64_tr_b16 v[124:125], v229 offset:24576
    v_mfma_f32_16x16x32_bf16 a[52:55], v[140:143], v[52:55], a[52:55]
    buffer_load_dwordx4 v[28:31], v238, s[56:59], s89 offen offset:1024
    v_mfma_f32_16x16x32_bf16 a[72:75], v[144:147], v[52:55], a[72:75]
    ds_read_b64_tr_b16 v[126:127], v229 offset:25600
    v_mfma_f32_16x16x32_bf16 a[92:95], v[148:151], v[52:55], a[92:95]
    v_mfma_f32_16x16x32_bf16 a[112:115], v[152:155], v[52:55], a[112:115]
    ds_read_b64_tr_b16 v[128:129], v229 offset:24584
    v_mfma_f32_16x16x32_bf16 a[132:135], v[156:159], v[52:55], a[132:135]
    buffer_load_dwordx4 v[32:35], v239, s[56:59], s89 offen offset:1024
    v_mfma_f32_16x16x32_bf16 a[152:155], v[160:163], v[52:55], a[152:155]
    ds_read_b64_tr_b16 v[130:131], v229 offset:25608
    s_waitcnt vmcnt(26)
    v_mfma_f32_16x16x32_bf16 a[16:19], v[132:135], v[56:59], a[16:19]
    v_mfma_f32_16x16x32_bf16 a[36:39], v[136:139], v[56:59], a[36:39]
    v_mfma_f32_16x16x32_bf16 a[56:59], v[140:143], v[56:59], a[56:59]
    buffer_load_dwordx4 v[36:39], v240, s[56:59], s89 offen offset:1024
    v_mfma_f32_16x16x32_bf16 a[76:79], v[144:147], v[56:59], a[76:79]
    v_mfma_f32_16x16x32_bf16 a[96:99], v[148:151], v[56:59], a[96:99]
    v_mfma_f32_16x16x32_bf16 a[116:119], v[152:155], v[56:59], a[116:119]
    v_mfma_f32_16x16x32_bf16 a[136:139], v[156:159], v[56:59], a[136:139]
    v_mfma_f32_16x16x32_bf16 a[156:159], v[160:163], v[56:59], a[156:159]
    s_waitcnt vmcnt(23)
    s_waitcnt lgkmcnt(0)
    s_barrier
    s_waitcnt vmcnt(22)
    v_mfma_f32_16x16x32_bf16 a[0:3], v[100:103], v[60:63], a[0:3]
    v_mfma_f32_16x16x32_bf16 a[20:23], v[104:107], v[60:63], a[20:23]
    ds_read_b64_tr_b16 v[132:133], v226 offset:0
    v_mfma_f32_16x16x32_bf16 a[40:43], v[108:111], v[60:63], a[40:43]
    s_add_u32 m0, s30, 73728
    s_add_u32 s73, s30, 57344
    buffer_load_dwordx4 v241, s[52:55], s73 offen offset:0 lds
    v_mfma_f32_16x16x32_bf16 a[60:63], v[112:115], v[60:63], a[60:63]
    ds_read_b64_tr_b16 v[134:135], v226 offset:1024
    v_mfma_f32_16x16x32_bf16 a[80:83], v[116:119], v[60:63], a[80:83]
    v_mfma_f32_16x16x32_bf16 a[100:103], v[120:123], v[60:63], a[100:103]
    ds_read_b64_tr_b16 v[136:137], v226 offset:8
    v_mfma_f32_16x16x32_bf16 a[120:123], v[124:127], v[60:63], a[120:123]
    buffer_load_dwordx4 v241, s[52:55], s73 offen offset:1024 lds
    v_mfma_f32_16x16x32_bf16 a[140:143], v[128:131], v[60:63], a[140:143]
    ds_read_b64_tr_b16 v[138:139], v226 offset:1032
    s_waitcnt vmcnt(23)
    v_mfma_f32_16x16x32_bf16 a[4:7], v[100:103], v[64:67], a[4:7]
    v_mfma_f32_16x16x32_bf16 a[24:27], v[104:107], v[64:67], a[24:27]
    ds_read_b64_tr_b16 v[140:141], v227 offset:0
    v_mfma_f32_16x16x32_bf16 a[44:47], v[108:111], v[64:67], a[44:47]
    buffer_load_dwordx4 v241, s[52:55], s73 offen offset:2048 lds
    v_mfma_f32_16x16x32_bf16 a[64:67], v[112:115], v[64:67], a[64:67]
    ds_read_b64_tr_b16 v[142:143], v227 offset:1024
    v_mfma_f32_16x16x32_bf16 a[84:87], v[116:119], v[64:67], a[84:87]
    v_mfma_f32_16x16x32_bf16 a[104:107], v[120:123], v[64:67], a[104:107]
    ds_read_b64_tr_b16 v[144:145], v227 offset:8
    v_mfma_f32_16x16x32_bf16 a[124:127], v[124:127], v[64:67], a[124:127]
    buffer_load_dwordx4 v241, s[52:55], s73 offen offset:3072 lds
    v_mfma_f32_16x16x32_bf16 a[144:147], v[128:131], v[64:67], a[144:147]
    ds_read_b64_tr_b16 v[146:147], v227 offset:1032
    s_waitcnt vmcnt(24)
    v_mfma_f32_16x16x32_bf16 a[8:11], v[100:103], v[68:71], a[8:11]
    v_mfma_f32_16x16x32_bf16 a[28:31], v[104:107], v[68:71], a[28:31]
    ds_read_b64_tr_b16 v[148:149], v228 offset:0
    v_mfma_f32_16x16x32_bf16 a[48:51], v[108:111], v[68:71], a[48:51]
    buffer_load_dwordx4 v[40:43], v236, s[56:59], s89 offen offset:2048
    v_mfma_f32_16x16x32_bf16 a[68:71], v[112:115], v[68:71], a[68:71]
    ds_read_b64_tr_b16 v[150:151], v228 offset:1024
    v_mfma_f32_16x16x32_bf16 a[88:91], v[116:119], v[68:71], a[88:91]
    v_mfma_f32_16x16x32_bf16 a[108:111], v[120:123], v[68:71], a[108:111]
    ds_read_b64_tr_b16 v[152:153], v228 offset:8
    v_mfma_f32_16x16x32_bf16 a[128:131], v[124:127], v[68:71], a[128:131]
    buffer_load_dwordx4 v[44:47], v237, s[56:59], s89 offen offset:2048
    v_mfma_f32_16x16x32_bf16 a[148:151], v[128:131], v[68:71], a[148:151]
    ds_read_b64_tr_b16 v[154:155], v228 offset:1032
    s_waitcnt vmcnt(25)
    v_mfma_f32_16x16x32_bf16 a[12:15], v[100:103], v[72:75], a[12:15]
    v_mfma_f32_16x16x32_bf16 a[32:35], v[104:107], v[72:75], a[32:35]
    ds_read_b64_tr_b16 v[156:157], v229 offset:0
    v_mfma_f32_16x16x32_bf16 a[52:55], v[108:111], v[72:75], a[52:55]
    buffer_load_dwordx4 v[48:51], v238, s[56:59], s89 offen offset:2048
    v_mfma_f32_16x16x32_bf16 a[72:75], v[112:115], v[72:75], a[72:75]
    ds_read_b64_tr_b16 v[158:159], v229 offset:1024
    v_mfma_f32_16x16x32_bf16 a[92:95], v[116:119], v[72:75], a[92:95]
    v_mfma_f32_16x16x32_bf16 a[112:115], v[120:123], v[72:75], a[112:115]
    ds_read_b64_tr_b16 v[160:161], v229 offset:8
    v_mfma_f32_16x16x32_bf16 a[132:135], v[124:127], v[72:75], a[132:135]
    buffer_load_dwordx4 v[52:55], v239, s[56:59], s89 offen offset:2048
    v_mfma_f32_16x16x32_bf16 a[152:155], v[128:131], v[72:75], a[152:155]
    ds_read_b64_tr_b16 v[162:163], v229 offset:1032
    s_waitcnt vmcnt(26)
    v_mfma_f32_16x16x32_bf16 a[16:19], v[100:103], v[76:79], a[16:19]
    v_mfma_f32_16x16x32_bf16 a[36:39], v[104:107], v[76:79], a[36:39]
    v_mfma_f32_16x16x32_bf16 a[56:59], v[108:111], v[76:79], a[56:59]
    buffer_load_dwordx4 v[56:59], v240, s[56:59], s89 offen offset:2048
    v_mfma_f32_16x16x32_bf16 a[76:79], v[112:115], v[76:79], a[76:79]
    v_mfma_f32_16x16x32_bf16 a[96:99], v[116:119], v[76:79], a[96:99]
    v_mfma_f32_16x16x32_bf16 a[116:119], v[120:123], v[76:79], a[116:119]
    v_mfma_f32_16x16x32_bf16 a[136:139], v[124:127], v[76:79], a[136:139]
    v_mfma_f32_16x16x32_bf16 a[156:159], v[128:131], v[76:79], a[156:159]
    s_waitcnt vmcnt(23)
    s_waitcnt lgkmcnt(0)
    s_barrier
    s_waitcnt vmcnt(22)
    v_mfma_f32_16x16x32_bf16 a[0:3], v[132:135], v[0:3], a[0:3]
    v_mfma_f32_16x16x32_bf16 a[20:23], v[136:139], v[0:3], a[20:23]
    ds_read_b64_tr_b16 v[100:101], v226 offset:8192
    v_mfma_f32_16x16x32_bf16 a[40:43], v[140:143], v[0:3], a[40:43]
    s_add_u32 m0, s30, 49152
    s_add_u32 s73, s30, 65536
    buffer_load_dwordx4 v241, s[52:55], s73 offen offset:0 lds
    v_mfma_f32_16x16x32_bf16 a[60:63], v[144:147], v[0:3], a[60:63]
    ds_read_b64_tr_b16 v[102:103], v226 offset:9216
    v_mfma_f32_16x16x32_bf16 a[80:83], v[148:151], v[0:3], a[80:83]
    v_mfma_f32_16x16x32_bf16 a[100:103], v[152:155], v[0:3], a[100:103]
    ds_read_b64_tr_b16 v[104:105], v226 offset:8200
    v_mfma_f32_16x16x32_bf16 a[120:123], v[156:159], v[0:3], a[120:123]
    buffer_load_dwordx4 v241, s[52:55], s73 offen offset:1024 lds
    v_mfma_f32_16x16x32_bf16 a[140:143], v[160:163], v[0:3], a[140:143]
    ds_read_b64_tr_b16 v[106:107], v226 offset:9224
    s_waitcnt vmcnt(23)
    v_mfma_f32_16x16x32_bf16 a[4:7], v[132:135], v[4:7], a[4:7]
    v_mfma_f32_16x16x32_bf16 a[24:27], v[136:139], v[4:7], a[24:27]
    ds_read_b64_tr_b16 v[108:109], v227 offset:8192
    v_mfma_f32_16x16x32_bf16 a[44:47], v[140:143], v[4:7], a[44:47]
    buffer_load_dwordx4 v241, s[52:55], s73 offen offset:2048 lds
    v_mfma_f32_16x16x32_bf16 a[64:67], v[144:147], v[4:7], a[64:67]
    ds_read_b64_tr_b16 v[110:111], v227 offset:9216
    v_mfma_f32_16x16x32_bf16 a[84:87], v[148:151], v[4:7], a[84:87]
    v_mfma_f32_16x16x32_bf16 a[104:107], v[152:155], v[4:7], a[104:107]
    ds_read_b64_tr_b16 v[112:113], v227 offset:8200
    v_mfma_f32_16x16x32_bf16 a[124:127], v[156:159], v[4:7], a[124:127]
    buffer_load_dwordx4 v241, s[52:55], s73 offen offset:3072 lds
    v_mfma_f32_16x16x32_bf16 a[144:147], v[160:163], v[4:7], a[144:147]
    ds_read_b64_tr_b16 v[114:115], v227 offset:9224
    s_waitcnt vmcnt(24)
    v_mfma_f32_16x16x32_bf16 a[8:11], v[132:135], v[8:11], a[8:11]
    v_mfma_f32_16x16x32_bf16 a[28:31], v[136:139], v[8:11], a[28:31]
    ds_read_b64_tr_b16 v[116:117], v228 offset:8192
    v_mfma_f32_16x16x32_bf16 a[48:51], v[140:143], v[8:11], a[48:51]
    buffer_load_dwordx4 v[60:63], v236, s[56:59], s89 offen offset:3072
    v_mfma_f32_16x16x32_bf16 a[68:71], v[144:147], v[8:11], a[68:71]
    ds_read_b64_tr_b16 v[118:119], v228 offset:9216
    v_mfma_f32_16x16x32_bf16 a[88:91], v[148:151], v[8:11], a[88:91]
    v_mfma_f32_16x16x32_bf16 a[108:111], v[152:155], v[8:11], a[108:111]
    ds_read_b64_tr_b16 v[120:121], v228 offset:8200
    v_mfma_f32_16x16x32_bf16 a[128:131], v[156:159], v[8:11], a[128:131]
    buffer_load_dwordx4 v[64:67], v237, s[56:59], s89 offen offset:3072
    v_mfma_f32_16x16x32_bf16 a[148:151], v[160:163], v[8:11], a[148:151]
    ds_read_b64_tr_b16 v[122:123], v228 offset:9224
    s_waitcnt vmcnt(25)
    v_mfma_f32_16x16x32_bf16 a[12:15], v[132:135], v[12:15], a[12:15]
    v_mfma_f32_16x16x32_bf16 a[32:35], v[136:139], v[12:15], a[32:35]
    ds_read_b64_tr_b16 v[124:125], v229 offset:8192
    v_mfma_f32_16x16x32_bf16 a[52:55], v[140:143], v[12:15], a[52:55]
    buffer_load_dwordx4 v[68:71], v238, s[56:59], s89 offen offset:3072
    v_mfma_f32_16x16x32_bf16 a[72:75], v[144:147], v[12:15], a[72:75]
    ds_read_b64_tr_b16 v[126:127], v229 offset:9216
    v_mfma_f32_16x16x32_bf16 a[92:95], v[148:151], v[12:15], a[92:95]
    v_mfma_f32_16x16x32_bf16 a[112:115], v[152:155], v[12:15], a[112:115]
    ds_read_b64_tr_b16 v[128:129], v229 offset:8200
    v_mfma_f32_16x16x32_bf16 a[132:135], v[156:159], v[12:15], a[132:135]
    buffer_load_dwordx4 v[72:75], v239, s[56:59], s89 offen offset:3072
    v_mfma_f32_16x16x32_bf16 a[152:155], v[160:163], v[12:15], a[152:155]
    ds_read_b64_tr_b16 v[130:131], v229 offset:9224
    s_waitcnt vmcnt(26)
    v_mfma_f32_16x16x32_bf16 a[16:19], v[132:135], v[16:19], a[16:19]
    v_mfma_f32_16x16x32_bf16 a[36:39], v[136:139], v[16:19], a[36:39]
    v_mfma_f32_16x16x32_bf16 a[56:59], v[140:143], v[16:19], a[56:59]
    buffer_load_dwordx4 v[76:79], v240, s[56:59], s89 offen offset:3072
    v_mfma_f32_16x16x32_bf16 a[76:79], v[144:147], v[16:19], a[76:79]
    v_mfma_f32_16x16x32_bf16 a[96:99], v[148:151], v[16:19], a[96:99]
    v_mfma_f32_16x16x32_bf16 a[116:119], v[152:155], v[16:19], a[116:119]
    v_mfma_f32_16x16x32_bf16 a[136:139], v[156:159], v[16:19], a[136:139]
    v_mfma_f32_16x16x32_bf16 a[156:159], v[160:163], v[16:19], a[156:159]
    s_waitcnt vmcnt(23)
    s_waitcnt lgkmcnt(0)
    s_barrier
    s_waitcnt vmcnt(22)
    v_mfma_f32_16x16x32_bf16 a[0:3], v[100:103], v[20:23], a[0:3]
    v_mfma_f32_16x16x32_bf16 a[20:23], v[104:107], v[20:23], a[20:23]
    ds_read_b64_tr_b16 v[132:133], v226 offset:16384
    v_mfma_f32_16x16x32_bf16 a[40:43], v[108:111], v[20:23], a[40:43]
    s_add_u32 m0, s30, 57344
    s_add_u32 s73, s30, 73728
    buffer_load_dwordx4 v241, s[52:55], s73 offen offset:0 lds
    v_mfma_f32_16x16x32_bf16 a[60:63], v[112:115], v[20:23], a[60:63]
    ds_read_b64_tr_b16 v[134:135], v226 offset:17408
    v_mfma_f32_16x16x32_bf16 a[80:83], v[116:119], v[20:23], a[80:83]
    v_mfma_f32_16x16x32_bf16 a[100:103], v[120:123], v[20:23], a[100:103]
    ds_read_b64_tr_b16 v[136:137], v226 offset:16392
    v_mfma_f32_16x16x32_bf16 a[120:123], v[124:127], v[20:23], a[120:123]
    buffer_load_dwordx4 v241, s[52:55], s73 offen offset:1024 lds
    v_mfma_f32_16x16x32_bf16 a[140:143], v[128:131], v[20:23], a[140:143]
    ds_read_b64_tr_b16 v[138:139], v226 offset:17416
    s_waitcnt vmcnt(23)
    v_mfma_f32_16x16x32_bf16 a[4:7], v[100:103], v[24:27], a[4:7]
    v_mfma_f32_16x16x32_bf16 a[24:27], v[104:107], v[24:27], a[24:27]
    ds_read_b64_tr_b16 v[140:141], v227 offset:16384
    v_mfma_f32_16x16x32_bf16 a[44:47], v[108:111], v[24:27], a[44:47]
    buffer_load_dwordx4 v241, s[52:55], s73 offen offset:2048 lds
    v_mfma_f32_16x16x32_bf16 a[64:67], v[112:115], v[24:27], a[64:67]
    ds_read_b64_tr_b16 v[142:143], v227 offset:17408
    v_mfma_f32_16x16x32_bf16 a[84:87], v[116:119], v[24:27], a[84:87]
    v_mfma_f32_16x16x32_bf16 a[104:107], v[120:123], v[24:27], a[104:107]
    ds_read_b64_tr_b16 v[144:145], v227 offset:16392
    v_mfma_f32_16x16x32_bf16 a[124:127], v[124:127], v[24:27], a[124:127]
    buffer_load_dwordx4 v241, s[52:55], s73 offen offset:3072 lds
    v_mfma_f32_16x16x32_bf16 a[144:147], v[128:131], v[24:27], a[144:147]
    ds_read_b64_tr_b16 v[146:147], v227 offset:17416
    s_waitcnt vmcnt(24)
    v_mfma_f32_16x16x32_bf16 a[8:11], v[100:103], v[28:31], a[8:11]
    v_mfma_f32_16x16x32_bf16 a[28:31], v[104:107], v[28:31], a[28:31]
    ds_read_b64_tr_b16 v[148:149], v228 offset:16384
    v_mfma_f32_16x16x32_bf16 a[48:51], v[108:111], v[28:31], a[48:51]
    buffer_load_dwordx4 v[0:3], v236, s[56:59], s90 offen offset:0
    v_mfma_f32_16x16x32_bf16 a[68:71], v[112:115], v[28:31], a[68:71]
    ds_read_b64_tr_b16 v[150:151], v228 offset:17408
    v_mfma_f32_16x16x32_bf16 a[88:91], v[116:119], v[28:31], a[88:91]
    v_mfma_f32_16x16x32_bf16 a[108:111], v[120:123], v[28:31], a[108:111]
    ds_read_b64_tr_b16 v[152:153], v228 offset:16392
    v_mfma_f32_16x16x32_bf16 a[128:131], v[124:127], v[28:31], a[128:131]
    buffer_load_dwordx4 v[4:7], v237, s[56:59], s90 offen offset:0
    v_mfma_f32_16x16x32_bf16 a[148:151], v[128:131], v[28:31], a[148:151]
    ds_read_b64_tr_b16 v[154:155], v228 offset:17416
    s_waitcnt vmcnt(25)
    v_mfma_f32_16x16x32_bf16 a[12:15], v[100:103], v[32:35], a[12:15]
    v_mfma_f32_16x16x32_bf16 a[32:35], v[104:107], v[32:35], a[32:35]
    ds_read_b64_tr_b16 v[156:157], v229 offset:16384
    v_mfma_f32_16x16x32_bf16 a[52:55], v[108:111], v[32:35], a[52:55]
    buffer_load_dwordx4 v[8:11], v238, s[56:59], s90 offen offset:0
    v_mfma_f32_16x16x32_bf16 a[72:75], v[112:115], v[32:35], a[72:75]
    ds_read_b64_tr_b16 v[158:159], v229 offset:17408
    v_mfma_f32_16x16x32_bf16 a[92:95], v[116:119], v[32:35], a[92:95]
    v_mfma_f32_16x16x32_bf16 a[112:115], v[120:123], v[32:35], a[112:115]
    ds_read_b64_tr_b16 v[160:161], v229 offset:16392
    v_mfma_f32_16x16x32_bf16 a[132:135], v[124:127], v[32:35], a[132:135]
    buffer_load_dwordx4 v[12:15], v239, s[56:59], s90 offen offset:0
    v_mfma_f32_16x16x32_bf16 a[152:155], v[128:131], v[32:35], a[152:155]
    ds_read_b64_tr_b16 v[162:163], v229 offset:17416
    s_waitcnt vmcnt(26)
    v_mfma_f32_16x16x32_bf16 a[16:19], v[100:103], v[36:39], a[16:19]
    v_mfma_f32_16x16x32_bf16 a[36:39], v[104:107], v[36:39], a[36:39]
    v_mfma_f32_16x16x32_bf16 a[56:59], v[108:111], v[36:39], a[56:59]
    buffer_load_dwordx4 v[16:19], v240, s[56:59], s90 offen offset:0
    v_mfma_f32_16x16x32_bf16 a[76:79], v[112:115], v[36:39], a[76:79]
    v_mfma_f32_16x16x32_bf16 a[96:99], v[116:119], v[36:39], a[96:99]
    v_mfma_f32_16x16x32_bf16 a[116:119], v[120:123], v[36:39], a[116:119]
    v_mfma_f32_16x16x32_bf16 a[136:139], v[124:127], v[36:39], a[136:139]
    v_mfma_f32_16x16x32_bf16 a[156:159], v[128:131], v[36:39], a[156:159]
    s_waitcnt vmcnt(23)
    s_waitcnt lgkmcnt(0)
    s_barrier
    s_waitcnt vmcnt(22)
    v_mfma_f32_16x16x32_bf16 a[0:3], v[132:135], v[40:43], a[0:3]
    v_mfma_f32_16x16x32_bf16 a[20:23], v[136:139], v[40:43], a[20:23]
    ds_read_b64_tr_b16 v[100:101], v226 offset:24576
    v_mfma_f32_16x16x32_bf16 a[40:43], v[140:143], v[40:43], a[40:43]
    s_add_u32 m0, s30, 65536
    s_add_u32 s73, s30, 81920
    buffer_load_dwordx4 v241, s[52:55], s73 offen offset:0 lds
    v_mfma_f32_16x16x32_bf16 a[60:63], v[144:147], v[40:43], a[60:63]
    ds_read_b64_tr_b16 v[102:103], v226 offset:25600
    v_mfma_f32_16x16x32_bf16 a[80:83], v[148:151], v[40:43], a[80:83]
    v_mfma_f32_16x16x32_bf16 a[100:103], v[152:155], v[40:43], a[100:103]
    ds_read_b64_tr_b16 v[104:105], v226 offset:24584
    v_mfma_f32_16x16x32_bf16 a[120:123], v[156:159], v[40:43], a[120:123]
    buffer_load_dwordx4 v241, s[52:55], s73 offen offset:1024 lds
    v_mfma_f32_16x16x32_bf16 a[140:143], v[160:163], v[40:43], a[140:143]
    ds_read_b64_tr_b16 v[106:107], v226 offset:25608
    s_waitcnt vmcnt(23)
    v_mfma_f32_16x16x32_bf16 a[4:7], v[132:135], v[44:47], a[4:7]
    v_mfma_f32_16x16x32_bf16 a[24:27], v[136:139], v[44:47], a[24:27]
    ds_read_b64_tr_b16 v[108:109], v227 offset:24576
    v_mfma_f32_16x16x32_bf16 a[44:47], v[140:143], v[44:47], a[44:47]
    buffer_load_dwordx4 v241, s[52:55], s73 offen offset:2048 lds
    v_mfma_f32_16x16x32_bf16 a[64:67], v[144:147], v[44:47], a[64:67]
    ds_read_b64_tr_b16 v[110:111], v227 offset:25600
    v_mfma_f32_16x16x32_bf16 a[84:87], v[148:151], v[44:47], a[84:87]
    v_mfma_f32_16x16x32_bf16 a[104:107], v[152:155], v[44:47], a[104:107]
    ds_read_b64_tr_b16 v[112:113], v227 offset:24584
    v_mfma_f32_16x16x32_bf16 a[124:127], v[156:159], v[44:47], a[124:127]
    buffer_load_dwordx4 v241, s[52:55], s73 offen offset:3072 lds
    v_mfma_f32_16x16x32_bf16 a[144:147], v[160:163], v[44:47], a[144:147]
    ds_read_b64_tr_b16 v[114:115], v227 offset:25608
    s_waitcnt vmcnt(24)
    v_mfma_f32_16x16x32_bf16 a[8:11], v[132:135], v[48:51], a[8:11]
    v_mfma_f32_16x16x32_bf16 a[28:31], v[136:139], v[48:51], a[28:31]
    ds_read_b64_tr_b16 v[116:117], v228 offset:24576
    v_mfma_f32_16x16x32_bf16 a[48:51], v[140:143], v[48:51], a[48:51]
    buffer_load_dwordx4 v[20:23], v236, s[56:59], s90 offen offset:1024
    v_mfma_f32_16x16x32_bf16 a[68:71], v[144:147], v[48:51], a[68:71]
    ds_read_b64_tr_b16 v[118:119], v228 offset:25600
    v_mfma_f32_16x16x32_bf16 a[88:91], v[148:151], v[48:51], a[88:91]
    v_mfma_f32_16x16x32_bf16 a[108:111], v[152:155], v[48:51], a[108:111]
    ds_read_b64_tr_b16 v[120:121], v228 offset:24584
    v_mfma_f32_16x16x32_bf16 a[128:131], v[156:159], v[48:51], a[128:131]
    buffer_load_dwordx4 v[24:27], v237, s[56:59], s90 offen offset:1024
    v_mfma_f32_16x16x32_bf16 a[148:151], v[160:163], v[48:51], a[148:151]
    ds_read_b64_tr_b16 v[122:123], v228 offset:25608
    s_waitcnt vmcnt(25)
    v_mfma_f32_16x16x32_bf16 a[12:15], v[132:135], v[52:55], a[12:15]
    v_mfma_f32_16x16x32_bf16 a[32:35], v[136:139], v[52:55], a[32:35]
    ds_read_b64_tr_b16 v[124:125], v229 offset:24576
    v_mfma_f32_16x16x32_bf16 a[52:55], v[140:143], v[52:55], a[52:55]
    buffer_load_dwordx4 v[28:31], v238, s[56:59], s90 offen offset:1024
    v_mfma_f32_16x16x32_bf16 a[72:75], v[144:147], v[52:55], a[72:75]
    ds_read_b64_tr_b16 v[126:127], v229 offset:25600
    v_mfma_f32_16x16x32_bf16 a[92:95], v[148:151], v[52:55], a[92:95]
    v_mfma_f32_16x16x32_bf16 a[112:115], v[152:155], v[52:55], a[112:115]
    ds_read_b64_tr_b16 v[128:129], v229 offset:24584
    v_mfma_f32_16x16x32_bf16 a[132:135], v[156:159], v[52:55], a[132:135]
    buffer_load_dwordx4 v[32:35], v239, s[56:59], s90 offen offset:1024
    v_mfma_f32_16x16x32_bf16 a[152:155], v[160:163], v[52:55], a[152:155]
    ds_read_b64_tr_b16 v[130:131], v229 offset:25608
    s_waitcnt vmcnt(26)
    v_mfma_f32_16x16x32_bf16 a[16:19], v[132:135], v[56:59], a[16:19]
    v_mfma_f32_16x16x32_bf16 a[36:39], v[136:139], v[56:59], a[36:39]
    v_mfma_f32_16x16x32_bf16 a[56:59], v[140:143], v[56:59], a[56:59]
    buffer_load_dwordx4 v[36:39], v240, s[56:59], s90 offen offset:1024
    v_mfma_f32_16x16x32_bf16 a[76:79], v[144:147], v[56:59], a[76:79]
    v_mfma_f32_16x16x32_bf16 a[96:99], v[148:151], v[56:59], a[96:99]
    v_mfma_f32_16x16x32_bf16 a[116:119], v[152:155], v[56:59], a[116:119]
    v_mfma_f32_16x16x32_bf16 a[136:139], v[156:159], v[56:59], a[136:139]
    v_mfma_f32_16x16x32_bf16 a[156:159], v[160:163], v[56:59], a[156:159]
    s_waitcnt vmcnt(23)
    s_waitcnt lgkmcnt(0)
    s_barrier
    s_waitcnt vmcnt(22)
    v_mfma_f32_16x16x32_bf16 a[0:3], v[100:103], v[60:63], a[0:3]
    v_mfma_f32_16x16x32_bf16 a[20:23], v[104:107], v[60:63], a[20:23]
    ds_read_b64_tr_b16 v[132:133], v226 offset:0
    v_mfma_f32_16x16x32_bf16 a[40:43], v[108:111], v[60:63], a[40:43]
    s_add_u32 m0, s30, 73728
    s_add_u32 s73, s30, 90112
    buffer_load_dwordx4 v241, s[52:55], s73 offen offset:0 lds
    v_mfma_f32_16x16x32_bf16 a[60:63], v[112:115], v[60:63], a[60:63]
    ds_read_b64_tr_b16 v[134:135], v226 offset:1024
    v_mfma_f32_16x16x32_bf16 a[80:83], v[116:119], v[60:63], a[80:83]
    v_mfma_f32_16x16x32_bf16 a[100:103], v[120:123], v[60:63], a[100:103]
    ds_read_b64_tr_b16 v[136:137], v226 offset:8
    v_mfma_f32_16x16x32_bf16 a[120:123], v[124:127], v[60:63], a[120:123]
    buffer_load_dwordx4 v241, s[52:55], s73 offen offset:1024 lds
    v_mfma_f32_16x16x32_bf16 a[140:143], v[128:131], v[60:63], a[140:143]
    ds_read_b64_tr_b16 v[138:139], v226 offset:1032
    s_waitcnt vmcnt(23)
    v_mfma_f32_16x16x32_bf16 a[4:7], v[100:103], v[64:67], a[4:7]
    v_mfma_f32_16x16x32_bf16 a[24:27], v[104:107], v[64:67], a[24:27]
    ds_read_b64_tr_b16 v[140:141], v227 offset:0
    v_mfma_f32_16x16x32_bf16 a[44:47], v[108:111], v[64:67], a[44:47]
    buffer_load_dwordx4 v241, s[52:55], s73 offen offset:2048 lds
    v_mfma_f32_16x16x32_bf16 a[64:67], v[112:115], v[64:67], a[64:67]
    ds_read_b64_tr_b16 v[142:143], v227 offset:1024
    v_mfma_f32_16x16x32_bf16 a[84:87], v[116:119], v[64:67], a[84:87]
    v_mfma_f32_16x16x32_bf16 a[104:107], v[120:123], v[64:67], a[104:107]
    ds_read_b64_tr_b16 v[144:145], v227 offset:8
    v_mfma_f32_16x16x32_bf16 a[124:127], v[124:127], v[64:67], a[124:127]
    buffer_load_dwordx4 v241, s[52:55], s73 offen offset:3072 lds
    v_mfma_f32_16x16x32_bf16 a[144:147], v[128:131], v[64:67], a[144:147]
    ds_read_b64_tr_b16 v[146:147], v227 offset:1032
    s_waitcnt vmcnt(24)
    v_mfma_f32_16x16x32_bf16 a[8:11], v[100:103], v[68:71], a[8:11]
    v_mfma_f32_16x16x32_bf16 a[28:31], v[104:107], v[68:71], a[28:31]
    ds_read_b64_tr_b16 v[148:149], v228 offset:0
    v_mfma_f32_16x16x32_bf16 a[48:51], v[108:111], v[68:71], a[48:51]
    buffer_load_dwordx4 v[40:43], v236, s[56:59], s90 offen offset:2048
    v_mfma_f32_16x16x32_bf16 a[68:71], v[112:115], v[68:71], a[68:71]
    ds_read_b64_tr_b16 v[150:151], v228 offset:1024
    v_mfma_f32_16x16x32_bf16 a[88:91], v[116:119], v[68:71], a[88:91]
    v_mfma_f32_16x16x32_bf16 a[108:111], v[120:123], v[68:71], a[108:111]
    ds_read_b64_tr_b16 v[152:153], v228 offset:8
    v_mfma_f32_16x16x32_bf16 a[128:131], v[124:127], v[68:71], a[128:131]
    buffer_load_dwordx4 v[44:47], v237, s[56:59], s90 offen offset:2048
    v_mfma_f32_16x16x32_bf16 a[148:151], v[128:131], v[68:71], a[148:151]
    ds_read_b64_tr_b16 v[154:155], v228 offset:1032
    s_waitcnt vmcnt(25)
    v_mfma_f32_16x16x32_bf16 a[12:15], v[100:103], v[72:75], a[12:15]
    v_mfma_f32_16x16x32_bf16 a[32:35], v[104:107], v[72:75], a[32:35]
    ds_read_b64_tr_b16 v[156:157], v229 offset:0
    v_mfma_f32_16x16x32_bf16 a[52:55], v[108:111], v[72:75], a[52:55]
    buffer_load_dwordx4 v[48:51], v238, s[56:59], s90 offen offset:2048
    v_mfma_f32_16x16x32_bf16 a[72:75], v[112:115], v[72:75], a[72:75]
    ds_read_b64_tr_b16 v[158:159], v229 offset:1024
    v_mfma_f32_16x16x32_bf16 a[92:95], v[116:119], v[72:75], a[92:95]
    v_mfma_f32_16x16x32_bf16 a[112:115], v[120:123], v[72:75], a[112:115]
    ds_read_b64_tr_b16 v[160:161], v229 offset:8
    v_mfma_f32_16x16x32_bf16 a[132:135], v[124:127], v[72:75], a[132:135]
    buffer_load_dwordx4 v[52:55], v239, s[56:59], s90 offen offset:2048
    v_mfma_f32_16x16x32_bf16 a[152:155], v[128:131], v[72:75], a[152:155]
    ds_read_b64_tr_b16 v[162:163], v229 offset:1032
    s_waitcnt vmcnt(26)
    v_mfma_f32_16x16x32_bf16 a[16:19], v[100:103], v[76:79], a[16:19]
    v_mfma_f32_16x16x32_bf16 a[36:39], v[104:107], v[76:79], a[36:39]
    v_mfma_f32_16x16x32_bf16 a[56:59], v[108:111], v[76:79], a[56:59]
    buffer_load_dwordx4 v[56:59], v240, s[56:59], s90 offen offset:2048
    v_mfma_f32_16x16x32_bf16 a[76:79], v[112:115], v[76:79], a[76:79]
    v_mfma_f32_16x16x32_bf16 a[96:99], v[116:119], v[76:79], a[96:99]
    v_mfma_f32_16x16x32_bf16 a[116:119], v[120:123], v[76:79], a[116:119]
    v_mfma_f32_16x16x32_bf16 a[136:139], v[124:127], v[76:79], a[136:139]
    v_mfma_f32_16x16x32_bf16 a[156:159], v[128:131], v[76:79], a[156:159]
    s_waitcnt vmcnt(23)
    s_waitcnt lgkmcnt(0)
    s_barrier
    s_waitcnt vmcnt(22)
    v_mfma_f32_16x16x32_bf16 a[0:3], v[132:135], v[0:3], a[0:3]
    v_mfma_f32_16x16x32_bf16 a[20:23], v[136:139], v[0:3], a[20:23]
    ds_read_b64_tr_b16 v[100:101], v226 offset:8192
    v_mfma_f32_16x16x32_bf16 a[40:43], v[140:143], v[0:3], a[40:43]
    s_add_u32 m0, s30, 49152
    s_add_u32 s73, s30, 98304
    buffer_load_dwordx4 v241, s[52:55], s73 offen offset:0 lds
    v_mfma_f32_16x16x32_bf16 a[60:63], v[144:147], v[0:3], a[60:63]
    ds_read_b64_tr_b16 v[102:103], v226 offset:9216
    v_mfma_f32_16x16x32_bf16 a[80:83], v[148:151], v[0:3], a[80:83]
    v_mfma_f32_16x16x32_bf16 a[100:103], v[152:155], v[0:3], a[100:103]
    ds_read_b64_tr_b16 v[104:105], v226 offset:8200
    v_mfma_f32_16x16x32_bf16 a[120:123], v[156:159], v[0:3], a[120:123]
    buffer_load_dwordx4 v241, s[52:55], s73 offen offset:1024 lds
    v_mfma_f32_16x16x32_bf16 a[140:143], v[160:163], v[0:3], a[140:143]
    ds_read_b64_tr_b16 v[106:107], v226 offset:9224
    s_waitcnt vmcnt(23)
    v_mfma_f32_16x16x32_bf16 a[4:7], v[132:135], v[4:7], a[4:7]
    v_mfma_f32_16x16x32_bf16 a[24:27], v[136:139], v[4:7], a[24:27]
    ds_read_b64_tr_b16 v[108:109], v227 offset:8192
    v_mfma_f32_16x16x32_bf16 a[44:47], v[140:143], v[4:7], a[44:47]
    buffer_load_dwordx4 v241, s[52:55], s73 offen offset:2048 lds
    v_mfma_f32_16x16x32_bf16 a[64:67], v[144:147], v[4:7], a[64:67]
    ds_read_b64_tr_b16 v[110:111], v227 offset:9216
    v_mfma_f32_16x16x32_bf16 a[84:87], v[148:151], v[4:7], a[84:87]
    v_mfma_f32_16x16x32_bf16 a[104:107], v[152:155], v[4:7], a[104:107]
    ds_read_b64_tr_b16 v[112:113], v227 offset:8200
    v_mfma_f32_16x16x32_bf16 a[124:127], v[156:159], v[4:7], a[124:127]
    buffer_load_dwordx4 v241, s[52:55], s73 offen offset:3072 lds
    v_mfma_f32_16x16x32_bf16 a[144:147], v[160:163], v[4:7], a[144:147]
    ds_read_b64_tr_b16 v[114:115], v227 offset:9224
    s_waitcnt vmcnt(24)
    v_mfma_f32_16x16x32_bf16 a[8:11], v[132:135], v[8:11], a[8:11]
    v_mfma_f32_16x16x32_bf16 a[28:31], v[136:139], v[8:11], a[28:31]
    ds_read_b64_tr_b16 v[116:117], v228 offset:8192
    v_mfma_f32_16x16x32_bf16 a[48:51], v[140:143], v[8:11], a[48:51]
    buffer_load_dwordx4 v[60:63], v236, s[56:59], s90 offen offset:3072
    v_mfma_f32_16x16x32_bf16 a[68:71], v[144:147], v[8:11], a[68:71]
    ds_read_b64_tr_b16 v[118:119], v228 offset:9216
    v_mfma_f32_16x16x32_bf16 a[88:91], v[148:151], v[8:11], a[88:91]
    v_mfma_f32_16x16x32_bf16 a[108:111], v[152:155], v[8:11], a[108:111]
    ds_read_b64_tr_b16 v[120:121], v228 offset:8200
    v_mfma_f32_16x16x32_bf16 a[128:131], v[156:159], v[8:11], a[128:131]
    buffer_load_dwordx4 v[64:67], v237, s[56:59], s90 offen offset:3072
    v_mfma_f32_16x16x32_bf16 a[148:151], v[160:163], v[8:11], a[148:151]
    ds_read_b64_tr_b16 v[122:123], v228 offset:9224
    s_waitcnt vmcnt(25)
    v_mfma_f32_16x16x32_bf16 a[12:15], v[132:135], v[12:15], a[12:15]
    v_mfma_f32_16x16x32_bf16 a[32:35], v[136:139], v[12:15], a[32:35]
    ds_read_b64_tr_b16 v[124:125], v229 offset:8192
    v_mfma_f32_16x16x32_bf16 a[52:55], v[140:143], v[12:15], a[52:55]
    buffer_load_dwordx4 v[68:71], v238, s[56:59], s90 offen offset:3072
    v_mfma_f32_16x16x32_bf16 a[72:75], v[144:147], v[12:15], a[72:75]
    ds_read_b64_tr_b16 v[126:127], v229 offset:9216
    v_mfma_f32_16x16x32_bf16 a[92:95], v[148:151], v[12:15], a[92:95]
    v_mfma_f32_16x16x32_bf16 a[112:115], v[152:155], v[12:15], a[112:115]
    ds_read_b64_tr_b16 v[128:129], v229 offset:8200
    v_mfma_f32_16x16x32_bf16 a[132:135], v[156:159], v[12:15], a[132:135]
    buffer_load_dwordx4 v[72:75], v239, s[56:59], s90 offen offset:3072
    v_mfma_f32_16x16x32_bf16 a[152:155], v[160:163], v[12:15], a[152:155]
    ds_read_b64_tr_b16 v[130:131], v229 offset:9224
    s_waitcnt vmcnt(26)
    v_mfma_f32_16x16x32_bf16 a[16:19], v[132:135], v[16:19], a[16:19]
    v_mfma_f32_16x16x32_bf16 a[36:39], v[136:139], v[16:19], a[36:39]
    v_mfma_f32_16x16x32_bf16 a[56:59], v[140:143], v[16:19], a[56:59]
    buffer_load_dwordx4 v[76:79], v240, s[56:59], s90 offen offset:3072
    v_mfma_f32_16x16x32_bf16 a[76:79], v[144:147], v[16:19], a[76:79]
    v_mfma_f32_16x16x32_bf16 a[96:99], v[148:151], v[16:19], a[96:99]
    v_mfma_f32_16x16x32_bf16 a[116:119], v[152:155], v[16:19], a[116:119]
    v_mfma_f32_16x16x32_bf16 a[136:139], v[156:159], v[16:19], a[136:139]
    v_mfma_f32_16x16x32_bf16 a[156:159], v[160:163], v[16:19], a[156:159]
    s_waitcnt vmcnt(23)
    s_waitcnt lgkmcnt(0)
    s_barrier
    s_waitcnt vmcnt(22)
    v_mfma_f32_16x16x32_bf16 a[0:3], v[100:103], v[20:23], a[0:3]
    v_mfma_f32_16x16x32_bf16 a[20:23], v[104:107], v[20:23], a[20:23]
    ds_read_b64_tr_b16 v[132:133], v226 offset:16384
    v_mfma_f32_16x16x32_bf16 a[40:43], v[108:111], v[20:23], a[40:43]
    s_add_u32 m0, s30, 57344
    s_add_u32 s73, s30, 106496
    buffer_load_dwordx4 v241, s[52:55], s73 offen offset:0 lds
    v_mfma_f32_16x16x32_bf16 a[60:63], v[112:115], v[20:23], a[60:63]
    ds_read_b64_tr_b16 v[134:135], v226 offset:17408
    v_mfma_f32_16x16x32_bf16 a[80:83], v[116:119], v[20:23], a[80:83]
    v_mfma_f32_16x16x32_bf16 a[100:103], v[120:123], v[20:23], a[100:103]
    ds_read_b64_tr_b16 v[136:137], v226 offset:16392
    v_mfma_f32_16x16x32_bf16 a[120:123], v[124:127], v[20:23], a[120:123]
    buffer_load_dwordx4 v241, s[52:55], s73 offen offset:1024 lds
    v_mfma_f32_16x16x32_bf16 a[140:143], v[128:131], v[20:23], a[140:143]
    ds_read_b64_tr_b16 v[138:139], v226 offset:17416
    s_waitcnt vmcnt(23)
    v_mfma_f32_16x16x32_bf16 a[4:7], v[100:103], v[24:27], a[4:7]
    v_mfma_f32_16x16x32_bf16 a[24:27], v[104:107], v[24:27], a[24:27]
    ds_read_b64_tr_b16 v[140:141], v227 offset:16384
    v_mfma_f32_16x16x32_bf16 a[44:47], v[108:111], v[24:27], a[44:47]
    buffer_load_dwordx4 v241, s[52:55], s73 offen offset:2048 lds
    v_mfma_f32_16x16x32_bf16 a[64:67], v[112:115], v[24:27], a[64:67]
    ds_read_b64_tr_b16 v[142:143], v227 offset:17408
    v_mfma_f32_16x16x32_bf16 a[84:87], v[116:119], v[24:27], a[84:87]
    v_mfma_f32_16x16x32_bf16 a[104:107], v[120:123], v[24:27], a[104:107]
    ds_read_b64_tr_b16 v[144:145], v227 offset:16392
    v_mfma_f32_16x16x32_bf16 a[124:127], v[124:127], v[24:27], a[124:127]
    buffer_load_dwordx4 v241, s[52:55], s73 offen offset:3072 lds
    v_mfma_f32_16x16x32_bf16 a[144:147], v[128:131], v[24:27], a[144:147]
    ds_read_b64_tr_b16 v[146:147], v227 offset:17416
    s_waitcnt vmcnt(24)
    v_mfma_f32_16x16x32_bf16 a[8:11], v[100:103], v[28:31], a[8:11]
    v_mfma_f32_16x16x32_bf16 a[28:31], v[104:107], v[28:31], a[28:31]
    ds_read_b64_tr_b16 v[148:149], v228 offset:16384
    v_mfma_f32_16x16x32_bf16 a[48:51], v[108:111], v[28:31], a[48:51]
    buffer_load_dwordx4 v[0:3], v236, s[56:59], s91 offen offset:0
    v_mfma_f32_16x16x32_bf16 a[68:71], v[112:115], v[28:31], a[68:71]
    ds_read_b64_tr_b16 v[150:151], v228 offset:17408
    v_mfma_f32_16x16x32_bf16 a[88:91], v[116:119], v[28:31], a[88:91]
    v_mfma_f32_16x16x32_bf16 a[108:111], v[120:123], v[28:31], a[108:111]
    ds_read_b64_tr_b16 v[152:153], v228 offset:16392
    v_mfma_f32_16x16x32_bf16 a[128:131], v[124:127], v[28:31], a[128:131]
    buffer_load_dwordx4 v[4:7], v237, s[56:59], s91 offen offset:0
    v_mfma_f32_16x16x32_bf16 a[148:151], v[128:131], v[28:31], a[148:151]
    ds_read_b64_tr_b16 v[154:155], v228 offset:17416
    s_waitcnt vmcnt(25)
    v_mfma_f32_16x16x32_bf16 a[12:15], v[100:103], v[32:35], a[12:15]
    v_mfma_f32_16x16x32_bf16 a[32:35], v[104:107], v[32:35], a[32:35]
    ds_read_b64_tr_b16 v[156:157], v229 offset:16384
    v_mfma_f32_16x16x32_bf16 a[52:55], v[108:111], v[32:35], a[52:55]
    buffer_load_dwordx4 v[8:11], v238, s[56:59], s91 offen offset:0
    v_mfma_f32_16x16x32_bf16 a[72:75], v[112:115], v[32:35], a[72:75]
    ds_read_b64_tr_b16 v[158:159], v229 offset:17408
    v_mfma_f32_16x16x32_bf16 a[92:95], v[116:119], v[32:35], a[92:95]
    v_mfma_f32_16x16x32_bf16 a[112:115], v[120:123], v[32:35], a[112:115]
    ds_read_b64_tr_b16 v[160:161], v229 offset:16392
    v_mfma_f32_16x16x32_bf16 a[132:135], v[124:127], v[32:35], a[132:135]
    buffer_load_dwordx4 v[12:15], v239, s[56:59], s91 offen offset:0
    v_mfma_f32_16x16x32_bf16 a[152:155], v[128:131], v[32:35], a[152:155]
    ds_read_b64_tr_b16 v[162:163], v229 offset:17416
    s_waitcnt vmcnt(26)
    v_mfma_f32_16x16x32_bf16 a[16:19], v[100:103], v[36:39], a[16:19]
    v_mfma_f32_16x16x32_bf16 a[36:39], v[104:107], v[36:39], a[36:39]
    v_mfma_f32_16x16x32_bf16 a[56:59], v[108:111], v[36:39], a[56:59]
    buffer_load_dwordx4 v[16:19], v240, s[56:59], s91 offen offset:0
    v_mfma_f32_16x16x32_bf16 a[76:79], v[112:115], v[36:39], a[76:79]
    v_mfma_f32_16x16x32_bf16 a[96:99], v[116:119], v[36:39], a[96:99]
    v_mfma_f32_16x16x32_bf16 a[116:119], v[120:123], v[36:39], a[116:119]
    v_mfma_f32_16x16x32_bf16 a[136:139], v[124:127], v[36:39], a[136:139]
    v_mfma_f32_16x16x32_bf16 a[156:159], v[128:131], v[36:39], a[156:159]
    s_waitcnt vmcnt(23)
    s_waitcnt lgkmcnt(0)
    s_barrier
    s_waitcnt vmcnt(22)
    v_mfma_f32_16x16x32_bf16 a[0:3], v[132:135], v[40:43], a[0:3]
    v_mfma_f32_16x16x32_bf16 a[20:23], v[136:139], v[40:43], a[20:23]
    ds_read_b64_tr_b16 v[100:101], v226 offset:24576
    v_mfma_f32_16x16x32_bf16 a[40:43], v[140:143], v[40:43], a[40:43]
    s_add_u32 m0, s30, 65536
    s_add_u32 s73, s30, 114688
    buffer_load_dwordx4 v241, s[52:55], s73 offen offset:0 lds
    v_mfma_f32_16x16x32_bf16 a[60:63], v[144:147], v[40:43], a[60:63]
    ds_read_b64_tr_b16 v[102:103], v226 offset:25600
    v_mfma_f32_16x16x32_bf16 a[80:83], v[148:151], v[40:43], a[80:83]
    v_mfma_f32_16x16x32_bf16 a[100:103], v[152:155], v[40:43], a[100:103]
    ds_read_b64_tr_b16 v[104:105], v226 offset:24584
    v_mfma_f32_16x16x32_bf16 a[120:123], v[156:159], v[40:43], a[120:123]
    buffer_load_dwordx4 v241, s[52:55], s73 offen offset:1024 lds
    v_mfma_f32_16x16x32_bf16 a[140:143], v[160:163], v[40:43], a[140:143]
    ds_read_b64_tr_b16 v[106:107], v226 offset:25608
    s_waitcnt vmcnt(23)
    v_mfma_f32_16x16x32_bf16 a[4:7], v[132:135], v[44:47], a[4:7]
    v_mfma_f32_16x16x32_bf16 a[24:27], v[136:139], v[44:47], a[24:27]
    ds_read_b64_tr_b16 v[108:109], v227 offset:24576
    v_mfma_f32_16x16x32_bf16 a[44:47], v[140:143], v[44:47], a[44:47]
    buffer_load_dwordx4 v241, s[52:55], s73 offen offset:2048 lds
    v_mfma_f32_16x16x32_bf16 a[64:67], v[144:147], v[44:47], a[64:67]
    ds_read_b64_tr_b16 v[110:111], v227 offset:25600
    v_mfma_f32_16x16x32_bf16 a[84:87], v[148:151], v[44:47], a[84:87]
    v_mfma_f32_16x16x32_bf16 a[104:107], v[152:155], v[44:47], a[104:107]
    ds_read_b64_tr_b16 v[112:113], v227 offset:24584
    v_mfma_f32_16x16x32_bf16 a[124:127], v[156:159], v[44:47], a[124:127]
    buffer_load_dwordx4 v241, s[52:55], s73 offen offset:3072 lds
    v_mfma_f32_16x16x32_bf16 a[144:147], v[160:163], v[44:47], a[144:147]
    ds_read_b64_tr_b16 v[114:115], v227 offset:25608
    s_waitcnt vmcnt(24)
    v_mfma_f32_16x16x32_bf16 a[8:11], v[132:135], v[48:51], a[8:11]
    v_mfma_f32_16x16x32_bf16 a[28:31], v[136:139], v[48:51], a[28:31]
    ds_read_b64_tr_b16 v[116:117], v228 offset:24576
    v_mfma_f32_16x16x32_bf16 a[48:51], v[140:143], v[48:51], a[48:51]
    buffer_load_dwordx4 v[20:23], v236, s[56:59], s91 offen offset:1024
    v_mfma_f32_16x16x32_bf16 a[68:71], v[144:147], v[48:51], a[68:71]
    ds_read_b64_tr_b16 v[118:119], v228 offset:25600
    v_mfma_f32_16x16x32_bf16 a[88:91], v[148:151], v[48:51], a[88:91]
    v_mfma_f32_16x16x32_bf16 a[108:111], v[152:155], v[48:51], a[108:111]
    ds_read_b64_tr_b16 v[120:121], v228 offset:24584
    v_mfma_f32_16x16x32_bf16 a[128:131], v[156:159], v[48:51], a[128:131]
    buffer_load_dwordx4 v[24:27], v237, s[56:59], s91 offen offset:1024
    v_mfma_f32_16x16x32_bf16 a[148:151], v[160:163], v[48:51], a[148:151]
    ds_read_b64_tr_b16 v[122:123], v228 offset:25608
    s_waitcnt vmcnt(25)
    v_mfma_f32_16x16x32_bf16 a[12:15], v[132:135], v[52:55], a[12:15]
    v_mfma_f32_16x16x32_bf16 a[32:35], v[136:139], v[52:55], a[32:35]
    ds_read_b64_tr_b16 v[124:125], v229 offset:24576
    v_mfma_f32_16x16x32_bf16 a[52:55], v[140:143], v[52:55], a[52:55]
    buffer_load_dwordx4 v[28:31], v238, s[56:59], s91 offen offset:1024
    v_mfma_f32_16x16x32_bf16 a[72:75], v[144:147], v[52:55], a[72:75]
    ds_read_b64_tr_b16 v[126:127], v229 offset:25600
    v_mfma_f32_16x16x32_bf16 a[92:95], v[148:151], v[52:55], a[92:95]
    v_mfma_f32_16x16x32_bf16 a[112:115], v[152:155], v[52:55], a[112:115]
    ds_read_b64_tr_b16 v[128:129], v229 offset:24584
    v_mfma_f32_16x16x32_bf16 a[132:135], v[156:159], v[52:55], a[132:135]
    buffer_load_dwordx4 v[32:35], v239, s[56:59], s91 offen offset:1024
    v_mfma_f32_16x16x32_bf16 a[152:155], v[160:163], v[52:55], a[152:155]
    ds_read_b64_tr_b16 v[130:131], v229 offset:25608
    s_waitcnt vmcnt(26)
    v_mfma_f32_16x16x32_bf16 a[16:19], v[132:135], v[56:59], a[16:19]
    v_mfma_f32_16x16x32_bf16 a[36:39], v[136:139], v[56:59], a[36:39]
    v_mfma_f32_16x16x32_bf16 a[56:59], v[140:143], v[56:59], a[56:59]
    buffer_load_dwordx4 v[36:39], v240, s[56:59], s91 offen offset:1024
    v_mfma_f32_16x16x32_bf16 a[76:79], v[144:147], v[56:59], a[76:79]
    v_mfma_f32_16x16x32_bf16 a[96:99], v[148:151], v[56:59], a[96:99]
    v_mfma_f32_16x16x32_bf16 a[116:119], v[152:155], v[56:59], a[116:119]
    v_mfma_f32_16x16x32_bf16 a[136:139], v[156:159], v[56:59], a[136:139]
    v_mfma_f32_16x16x32_bf16 a[156:159], v[160:163], v[56:59], a[156:159]
    s_waitcnt vmcnt(23)
    s_waitcnt lgkmcnt(0)
    s_barrier
    s_waitcnt vmcnt(22)
    v_mfma_f32_16x16x32_bf16 a[0:3], v[100:103], v[60:63], a[0:3]
    v_mfma_f32_16x16x32_bf16 a[20:23], v[104:107], v[60:63], a[20:23]
    ds_read_b64_tr_b16 v[132:133], v226 offset:0
    v_mfma_f32_16x16x32_bf16 a[40:43], v[108:111], v[60:63], a[40:43]
    s_add_u32 m0, s30, 73728
    s_add_u32 s73, s30, 122880
    buffer_load_dwordx4 v241, s[52:55], s73 offen offset:0 lds
    v_mfma_f32_16x16x32_bf16 a[60:63], v[112:115], v[60:63], a[60:63]
    ds_read_b64_tr_b16 v[134:135], v226 offset:1024
    v_mfma_f32_16x16x32_bf16 a[80:83], v[116:119], v[60:63], a[80:83]
    v_mfma_f32_16x16x32_bf16 a[100:103], v[120:123], v[60:63], a[100:103]
    ds_read_b64_tr_b16 v[136:137], v226 offset:8
    v_mfma_f32_16x16x32_bf16 a[120:123], v[124:127], v[60:63], a[120:123]
    buffer_load_dwordx4 v241, s[52:55], s73 offen offset:1024 lds
    v_mfma_f32_16x16x32_bf16 a[140:143], v[128:131], v[60:63], a[140:143]
    ds_read_b64_tr_b16 v[138:139], v226 offset:1032
    s_waitcnt vmcnt(23)
    v_mfma_f32_16x16x32_bf16 a[4:7], v[100:103], v[64:67], a[4:7]
    v_mfma_f32_16x16x32_bf16 a[24:27], v[104:107], v[64:67], a[24:27]
    ds_read_b64_tr_b16 v[140:141], v227 offset:0
    v_mfma_f32_16x16x32_bf16 a[44:47], v[108:111], v[64:67], a[44:47]
    buffer_load_dwordx4 v241, s[52:55], s73 offen offset:2048 lds
    v_mfma_f32_16x16x32_bf16 a[64:67], v[112:115], v[64:67], a[64:67]
    ds_read_b64_tr_b16 v[142:143], v227 offset:1024
    v_mfma_f32_16x16x32_bf16 a[84:87], v[116:119], v[64:67], a[84:87]
    v_mfma_f32_16x16x32_bf16 a[104:107], v[120:123], v[64:67], a[104:107]
    ds_read_b64_tr_b16 v[144:145], v227 offset:8
    v_mfma_f32_16x16x32_bf16 a[124:127], v[124:127], v[64:67], a[124:127]
    buffer_load_dwordx4 v241, s[52:55], s73 offen offset:3072 lds
    v_mfma_f32_16x16x32_bf16 a[144:147], v[128:131], v[64:67], a[144:147]
    ds_read_b64_tr_b16 v[146:147], v227 offset:1032
    s_waitcnt vmcnt(24)
    v_mfma_f32_16x16x32_bf16 a[8:11], v[100:103], v[68:71], a[8:11]
    v_mfma_f32_16x16x32_bf16 a[28:31], v[104:107], v[68:71], a[28:31]
    ds_read_b64_tr_b16 v[148:149], v228 offset:0
    v_mfma_f32_16x16x32_bf16 a[48:51], v[108:111], v[68:71], a[48:51]
    buffer_load_dwordx4 v[40:43], v236, s[56:59], s91 offen offset:2048
    v_mfma_f32_16x16x32_bf16 a[68:71], v[112:115], v[68:71], a[68:71]
    ds_read_b64_tr_b16 v[150:151], v228 offset:1024
    v_mfma_f32_16x16x32_bf16 a[88:91], v[116:119], v[68:71], a[88:91]
    v_mfma_f32_16x16x32_bf16 a[108:111], v[120:123], v[68:71], a[108:111]
    ds_read_b64_tr_b16 v[152:153], v228 offset:8
    v_mfma_f32_16x16x32_bf16 a[128:131], v[124:127], v[68:71], a[128:131]
    buffer_load_dwordx4 v[44:47], v237, s[56:59], s91 offen offset:2048
    v_mfma_f32_16x16x32_bf16 a[148:151], v[128:131], v[68:71], a[148:151]
    ds_read_b64_tr_b16 v[154:155], v228 offset:1032
    s_waitcnt vmcnt(25)
    v_mfma_f32_16x16x32_bf16 a[12:15], v[100:103], v[72:75], a[12:15]
    v_mfma_f32_16x16x32_bf16 a[32:35], v[104:107], v[72:75], a[32:35]
    ds_read_b64_tr_b16 v[156:157], v229 offset:0
    v_mfma_f32_16x16x32_bf16 a[52:55], v[108:111], v[72:75], a[52:55]
    buffer_load_dwordx4 v[48:51], v238, s[56:59], s91 offen offset:2048
    v_mfma_f32_16x16x32_bf16 a[72:75], v[112:115], v[72:75], a[72:75]
    ds_read_b64_tr_b16 v[158:159], v229 offset:1024
    v_mfma_f32_16x16x32_bf16 a[92:95], v[116:119], v[72:75], a[92:95]
    v_mfma_f32_16x16x32_bf16 a[112:115], v[120:123], v[72:75], a[112:115]
    ds_read_b64_tr_b16 v[160:161], v229 offset:8
    v_mfma_f32_16x16x32_bf16 a[132:135], v[124:127], v[72:75], a[132:135]
    buffer_load_dwordx4 v[52:55], v239, s[56:59], s91 offen offset:2048
    v_mfma_f32_16x16x32_bf16 a[152:155], v[128:131], v[72:75], a[152:155]
    ds_read_b64_tr_b16 v[162:163], v229 offset:1032
    s_waitcnt vmcnt(26)
    v_mfma_f32_16x16x32_bf16 a[16:19], v[100:103], v[76:79], a[16:19]
    v_mfma_f32_16x16x32_bf16 a[36:39], v[104:107], v[76:79], a[36:39]
    v_mfma_f32_16x16x32_bf16 a[56:59], v[108:111], v[76:79], a[56:59]
    buffer_load_dwordx4 v[56:59], v240, s[56:59], s91 offen offset:2048
    v_mfma_f32_16x16x32_bf16 a[76:79], v[112:115], v[76:79], a[76:79]
    v_mfma_f32_16x16x32_bf16 a[96:99], v[116:119], v[76:79], a[96:99]
    v_mfma_f32_16x16x32_bf16 a[116:119], v[120:123], v[76:79], a[116:119]
    v_mfma_f32_16x16x32_bf16 a[136:139], v[124:127], v[76:79], a[136:139]
    v_mfma_f32_16x16x32_bf16 a[156:159], v[128:131], v[76:79], a[156:159]
    s_waitcnt vmcnt(23)
    s_waitcnt lgkmcnt(0)
    s_barrier
    s_waitcnt vmcnt(22)
    v_mfma_f32_16x16x32_bf16 a[0:3], v[132:135], v[0:3], a[0:3]
    v_mfma_f32_16x16x32_bf16 a[20:23], v[136:139], v[0:3], a[20:23]
    ds_read_b64_tr_b16 v[100:101], v226 offset:8192
    v_mfma_f32_16x16x32_bf16 a[40:43], v[140:143], v[0:3], a[40:43]
    buffer_load_dwordx4 v[60:63], v236, s[56:59], s91 offen offset:3072
    v_mfma_f32_16x16x32_bf16 a[60:63], v[144:147], v[0:3], a[60:63]
    ds_read_b64_tr_b16 v[102:103], v226 offset:9216
    v_mfma_f32_16x16x32_bf16 a[80:83], v[148:151], v[0:3], a[80:83]
    v_mfma_f32_16x16x32_bf16 a[100:103], v[152:155], v[0:3], a[100:103]
    ds_read_b64_tr_b16 v[104:105], v226 offset:8200
    v_mfma_f32_16x16x32_bf16 a[120:123], v[156:159], v[0:3], a[120:123]
    v_mfma_f32_16x16x32_bf16 a[140:143], v[160:163], v[0:3], a[140:143]
    ds_read_b64_tr_b16 v[106:107], v226 offset:9224
    s_waitcnt vmcnt(22)
    v_mfma_f32_16x16x32_bf16 a[4:7], v[132:135], v[4:7], a[4:7]
    v_mfma_f32_16x16x32_bf16 a[24:27], v[136:139], v[4:7], a[24:27]
    buffer_load_dwordx4 v[64:67], v237, s[56:59], s91 offen offset:3072
    ds_read_b64_tr_b16 v[108:109], v227 offset:8192
    v_mfma_f32_16x16x32_bf16 a[44:47], v[140:143], v[4:7], a[44:47]
    v_mfma_f32_16x16x32_bf16 a[64:67], v[144:147], v[4:7], a[64:67]
    ds_read_b64_tr_b16 v[110:111], v227 offset:9216
    v_mfma_f32_16x16x32_bf16 a[84:87], v[148:151], v[4:7], a[84:87]
    v_mfma_f32_16x16x32_bf16 a[104:107], v[152:155], v[4:7], a[104:107]
    ds_read_b64_tr_b16 v[112:113], v227 offset:8200
    v_mfma_f32_16x16x32_bf16 a[124:127], v[156:159], v[4:7], a[124:127]
    v_mfma_f32_16x16x32_bf16 a[144:147], v[160:163], v[4:7], a[144:147]
    ds_read_b64_tr_b16 v[114:115], v227 offset:9224
    s_waitcnt vmcnt(22)
    v_mfma_f32_16x16x32_bf16 a[8:11], v[132:135], v[8:11], a[8:11]
    buffer_load_dwordx4 v[68:71], v238, s[56:59], s91 offen offset:3072
    v_mfma_f32_16x16x32_bf16 a[28:31], v[136:139], v[8:11], a[28:31]
    ds_read_b64_tr_b16 v[116:117], v228 offset:8192
    v_mfma_f32_16x16x32_bf16 a[48:51], v[140:143], v[8:11], a[48:51]
    v_mfma_f32_16x16x32_bf16 a[68:71], v[144:147], v[8:11], a[68:71]
    ds_read_b64_tr_b16 v[118:119], v228 offset:9216
    v_mfma_f32_16x16x32_bf16 a[88:91], v[148:151], v[8:11], a[88:91]
    v_mfma_f32_16x16x32_bf16 a[108:111], v[152:155], v[8:11], a[108:111]
    ds_read_b64_tr_b16 v[120:121], v228 offset:8200
    v_mfma_f32_16x16x32_bf16 a[128:131], v[156:159], v[8:11], a[128:131]
    v_mfma_f32_16x16x32_bf16 a[148:151], v[160:163], v[8:11], a[148:151]
    buffer_load_dwordx4 v[72:75], v239, s[56:59], s91 offen offset:3072
    ds_read_b64_tr_b16 v[122:123], v228 offset:9224
    s_waitcnt vmcnt(23)
    v_mfma_f32_16x16x32_bf16 a[12:15], v[132:135], v[12:15], a[12:15]
    v_mfma_f32_16x16x32_bf16 a[32:35], v[136:139], v[12:15], a[32:35]
    ds_read_b64_tr_b16 v[124:125], v229 offset:8192
    v_mfma_f32_16x16x32_bf16 a[52:55], v[140:143], v[12:15], a[52:55]
    v_mfma_f32_16x16x32_bf16 a[72:75], v[144:147], v[12:15], a[72:75]
    ds_read_b64_tr_b16 v[126:127], v229 offset:9216
    v_mfma_f32_16x16x32_bf16 a[92:95], v[148:151], v[12:15], a[92:95]
    v_mfma_f32_16x16x32_bf16 a[112:115], v[152:155], v[12:15], a[112:115]
    ds_read_b64_tr_b16 v[128:129], v229 offset:8200
    v_mfma_f32_16x16x32_bf16 a[132:135], v[156:159], v[12:15], a[132:135]
    buffer_load_dwordx4 v[76:79], v240, s[56:59], s91 offen offset:3072
    v_mfma_f32_16x16x32_bf16 a[152:155], v[160:163], v[12:15], a[152:155]
    ds_read_b64_tr_b16 v[130:131], v229 offset:9224
    s_waitcnt vmcnt(23)
    v_mfma_f32_16x16x32_bf16 a[16:19], v[132:135], v[16:19], a[16:19]
    v_mfma_f32_16x16x32_bf16 a[36:39], v[136:139], v[16:19], a[36:39]
    v_mfma_f32_16x16x32_bf16 a[56:59], v[140:143], v[16:19], a[56:59]
    v_mfma_f32_16x16x32_bf16 a[76:79], v[144:147], v[16:19], a[76:79]
    v_mfma_f32_16x16x32_bf16 a[96:99], v[148:151], v[16:19], a[96:99]
    v_mfma_f32_16x16x32_bf16 a[116:119], v[152:155], v[16:19], a[116:119]
    v_mfma_f32_16x16x32_bf16 a[136:139], v[156:159], v[16:19], a[136:139]
    v_mfma_f32_16x16x32_bf16 a[156:159], v[160:163], v[16:19], a[156:159]
    s_waitcnt vmcnt(19)
    s_waitcnt lgkmcnt(0)
    s_barrier
    s_waitcnt vmcnt(18)
    v_mfma_f32_16x16x32_bf16 a[0:3], v[100:103], v[20:23], a[0:3]
    v_mfma_f32_16x16x32_bf16 a[20:23], v[104:107], v[20:23], a[20:23]
    ds_read_b64_tr_b16 v[132:133], v226 offset:16384
    v_mfma_f32_16x16x32_bf16 a[40:43], v[108:111], v[20:23], a[40:43]
    v_mfma_f32_16x16x32_bf16 a[60:63], v[112:115], v[20:23], a[60:63]
    ds_read_b64_tr_b16 v[134:135], v226 offset:17408
    v_mfma_f32_16x16x32_bf16 a[80:83], v[116:119], v[20:23], a[80:83]
    v_mfma_f32_16x16x32_bf16 a[100:103], v[120:123], v[20:23], a[100:103]
    ds_read_b64_tr_b16 v[136:137], v226 offset:16392
    v_mfma_f32_16x16x32_bf16 a[120:123], v[124:127], v[20:23], a[120:123]
    v_mfma_f32_16x16x32_bf16 a[140:143], v[128:131], v[20:23], a[140:143]
    ds_read_b64_tr_b16 v[138:139], v226 offset:17416
    s_waitcnt vmcnt(17)
    v_mfma_f32_16x16x32_bf16 a[4:7], v[100:103], v[24:27], a[4:7]
    v_mfma_f32_16x16x32_bf16 a[24:27], v[104:107], v[24:27], a[24:27]
    ds_read_b64_tr_b16 v[140:141], v227 offset:16384
    v_mfma_f32_16x16x32_bf16 a[44:47], v[108:111], v[24:27], a[44:47]
    v_mfma_f32_16x16x32_bf16 a[64:67], v[112:115], v[24:27], a[64:67]
    ds_read_b64_tr_b16 v[142:143], v227 offset:17408
    v_mfma_f32_16x16x32_bf16 a[84:87], v[116:119], v[24:27], a[84:87]
    v_mfma_f32_16x16x32_bf16 a[104:107], v[120:123], v[24:27], a[104:107]
    ds_read_b64_tr_b16 v[144:145], v227 offset:16392
    v_mfma_f32_16x16x32_bf16 a[124:127], v[124:127], v[24:27], a[124:127]
    v_mfma_f32_16x16x32_bf16 a[144:147], v[128:131], v[24:27], a[144:147]
    ds_read_b64_tr_b16 v[146:147], v227 offset:17416
    s_waitcnt vmcnt(16)
    v_mfma_f32_16x16x32_bf16 a[8:11], v[100:103], v[28:31], a[8:11]
    v_mfma_f32_16x16x32_bf16 a[28:31], v[104:107], v[28:31], a[28:31]
    ds_read_b64_tr_b16 v[148:149], v228 offset:16384
    v_mfma_f32_16x16x32_bf16 a[48:51], v[108:111], v[28:31], a[48:51]
    v_mfma_f32_16x16x32_bf16 a[68:71], v[112:115], v[28:31], a[68:71]
    ds_read_b64_tr_b16 v[150:151], v228 offset:17408
    v_mfma_f32_16x16x32_bf16 a[88:91], v[116:119], v[28:31], a[88:91]
    v_mfma_f32_16x16x32_bf16 a[108:111], v[120:123], v[28:31], a[108:111]
    ds_read_b64_tr_b16 v[152:153], v228 offset:16392
    v_mfma_f32_16x16x32_bf16 a[128:131], v[124:127], v[28:31], a[128:131]
    v_mfma_f32_16x16x32_bf16 a[148:151], v[128:131], v[28:31], a[148:151]
    ds_read_b64_tr_b16 v[154:155], v228 offset:17416
    s_waitcnt vmcnt(15)
    v_mfma_f32_16x16x32_bf16 a[12:15], v[100:103], v[32:35], a[12:15]
    v_mfma_f32_16x16x32_bf16 a[32:35], v[104:107], v[32:35], a[32:35]
    ds_read_b64_tr_b16 v[156:157], v229 offset:16384
    v_mfma_f32_16x16x32_bf16 a[52:55], v[108:111], v[32:35], a[52:55]
    v_mfma_f32_16x16x32_bf16 a[72:75], v[112:115], v[32:35], a[72:75]
    ds_read_b64_tr_b16 v[158:159], v229 offset:17408
    v_mfma_f32_16x16x32_bf16 a[92:95], v[116:119], v[32:35], a[92:95]
    v_mfma_f32_16x16x32_bf16 a[112:115], v[120:123], v[32:35], a[112:115]
    ds_read_b64_tr_b16 v[160:161], v229 offset:16392
    v_mfma_f32_16x16x32_bf16 a[132:135], v[124:127], v[32:35], a[132:135]
    v_mfma_f32_16x16x32_bf16 a[152:155], v[128:131], v[32:35], a[152:155]
    ds_read_b64_tr_b16 v[162:163], v229 offset:17416
    s_waitcnt vmcnt(14)
    v_mfma_f32_16x16x32_bf16 a[16:19], v[100:103], v[36:39], a[16:19]
    v_mfma_f32_16x16x32_bf16 a[36:39], v[104:107], v[36:39], a[36:39]
    v_mfma_f32_16x16x32_bf16 a[56:59], v[108:111], v[36:39], a[56:59]
    v_mfma_f32_16x16x32_bf16 a[76:79], v[112:115], v[36:39], a[76:79]
    v_mfma_f32_16x16x32_bf16 a[96:99], v[116:119], v[36:39], a[96:99]
    v_mfma_f32_16x16x32_bf16 a[116:119], v[120:123], v[36:39], a[116:119]
    v_mfma_f32_16x16x32_bf16 a[136:139], v[124:127], v[36:39], a[136:139]
    v_mfma_f32_16x16x32_bf16 a[156:159], v[128:131], v[36:39], a[156:159]
    s_waitcnt vmcnt(10)
    s_waitcnt lgkmcnt(0)
    s_barrier
    s_waitcnt vmcnt(9)
    v_mfma_f32_16x16x32_bf16 a[0:3], v[132:135], v[40:43], a[0:3]
    v_mfma_f32_16x16x32_bf16 a[20:23], v[136:139], v[40:43], a[20:23]
    ds_read_b64_tr_b16 v[100:101], v226 offset:24576
    v_mfma_f32_16x16x32_bf16 a[40:43], v[140:143], v[40:43], a[40:43]
    v_mfma_f32_16x16x32_bf16 a[60:63], v[144:147], v[40:43], a[60:63]
    ds_read_b64_tr_b16 v[102:103], v226 offset:25600
    v_mfma_f32_16x16x32_bf16 a[80:83], v[148:151], v[40:43], a[80:83]
    v_mfma_f32_16x16x32_bf16 a[100:103], v[152:155], v[40:43], a[100:103]
    ds_read_b64_tr_b16 v[104:105], v226 offset:24584
    v_mfma_f32_16x16x32_bf16 a[120:123], v[156:159], v[40:43], a[120:123]
    v_mfma_f32_16x16x32_bf16 a[140:143], v[160:163], v[40:43], a[140:143]
    ds_read_b64_tr_b16 v[106:107], v226 offset:25608
    s_waitcnt vmcnt(8)
    v_mfma_f32_16x16x32_bf16 a[4:7], v[132:135], v[44:47], a[4:7]
    v_mfma_f32_16x16x32_bf16 a[24:27], v[136:139], v[44:47], a[24:27]
    ds_read_b64_tr_b16 v[108:109], v227 offset:24576
    v_mfma_f32_16x16x32_bf16 a[44:47], v[140:143], v[44:47], a[44:47]
    v_mfma_f32_16x16x32_bf16 a[64:67], v[144:147], v[44:47], a[64:67]
    ds_read_b64_tr_b16 v[110:111], v227 offset:25600
    v_mfma_f32_16x16x32_bf16 a[84:87], v[148:151], v[44:47], a[84:87]
    v_mfma_f32_16x16x32_bf16 a[104:107], v[152:155], v[44:47], a[104:107]
    ds_read_b64_tr_b16 v[112:113], v227 offset:24584
    v_mfma_f32_16x16x32_bf16 a[124:127], v[156:159], v[44:47], a[124:127]
    v_mfma_f32_16x16x32_bf16 a[144:147], v[160:163], v[44:47], a[144:147]
    ds_read_b64_tr_b16 v[114:115], v227 offset:25608
    s_waitcnt vmcnt(7)
    v_mfma_f32_16x16x32_bf16 a[8:11], v[132:135], v[48:51], a[8:11]
    v_mfma_f32_16x16x32_bf16 a[28:31], v[136:139], v[48:51], a[28:31]
    ds_read_b64_tr_b16 v[116:117], v228 offset:24576
    v_mfma_f32_16x16x32_bf16 a[48:51], v[140:143], v[48:51], a[48:51]
    v_mfma_f32_16x16x32_bf16 a[68:71], v[144:147], v[48:51], a[68:71]
    ds_read_b64_tr_b16 v[118:119], v228 offset:25600
    v_mfma_f32_16x16x32_bf16 a[88:91], v[148:151], v[48:51], a[88:91]
    v_mfma_f32_16x16x32_bf16 a[108:111], v[152:155], v[48:51], a[108:111]
    ds_read_b64_tr_b16 v[120:121], v228 offset:24584
    v_mfma_f32_16x16x32_bf16 a[128:131], v[156:159], v[48:51], a[128:131]
    v_mfma_f32_16x16x32_bf16 a[148:151], v[160:163], v[48:51], a[148:151]
    ds_read_b64_tr_b16 v[122:123], v228 offset:25608
    s_waitcnt vmcnt(6)
    v_mfma_f32_16x16x32_bf16 a[12:15], v[132:135], v[52:55], a[12:15]
    v_mfma_f32_16x16x32_bf16 a[32:35], v[136:139], v[52:55], a[32:35]
    ds_read_b64_tr_b16 v[124:125], v229 offset:24576
    v_mfma_f32_16x16x32_bf16 a[52:55], v[140:143], v[52:55], a[52:55]
    v_mfma_f32_16x16x32_bf16 a[72:75], v[144:147], v[52:55], a[72:75]
    ds_read_b64_tr_b16 v[126:127], v229 offset:25600
    v_mfma_f32_16x16x32_bf16 a[92:95], v[148:151], v[52:55], a[92:95]
    v_mfma_f32_16x16x32_bf16 a[112:115], v[152:155], v[52:55], a[112:115]
    ds_read_b64_tr_b16 v[128:129], v229 offset:24584
    v_mfma_f32_16x16x32_bf16 a[132:135], v[156:159], v[52:55], a[132:135]
    v_mfma_f32_16x16x32_bf16 a[152:155], v[160:163], v[52:55], a[152:155]
    ds_read_b64_tr_b16 v[130:131], v229 offset:25608
    s_waitcnt vmcnt(5)
    v_mfma_f32_16x16x32_bf16 a[16:19], v[132:135], v[56:59], a[16:19]
    v_mfma_f32_16x16x32_bf16 a[36:39], v[136:139], v[56:59], a[36:39]
    v_mfma_f32_16x16x32_bf16 a[56:59], v[140:143], v[56:59], a[56:59]
    v_mfma_f32_16x16x32_bf16 a[76:79], v[144:147], v[56:59], a[76:79]
    v_mfma_f32_16x16x32_bf16 a[96:99], v[148:151], v[56:59], a[96:99]
    v_mfma_f32_16x16x32_bf16 a[116:119], v[152:155], v[56:59], a[116:119]
    v_mfma_f32_16x16x32_bf16 a[136:139], v[156:159], v[56:59], a[136:139]
    v_mfma_f32_16x16x32_bf16 a[156:159], v[160:163], v[56:59], a[156:159]
    s_waitcnt lgkmcnt(0)
    s_barrier
    s_waitcnt vmcnt(4)
    v_mfma_f32_16x16x32_bf16 a[0:3], v[100:103], v[60:63], a[0:3]
    v_mfma_f32_16x16x32_bf16 a[20:23], v[104:107], v[60:63], a[20:23]
    v_mfma_f32_16x16x32_bf16 a[40:43], v[108:111], v[60:63], a[40:43]
    v_mfma_f32_16x16x32_bf16 a[60:63], v[112:115], v[60:63], a[60:63]
    v_mfma_f32_16x16x32_bf16 a[80:83], v[116:119], v[60:63], a[80:83]
    v_mfma_f32_16x16x32_bf16 a[100:103], v[120:123], v[60:63], a[100:103]
    v_mfma_f32_16x16x32_bf16 a[120:123], v[124:127], v[60:63], a[120:123]
    v_mfma_f32_16x16x32_bf16 a[140:143], v[128:131], v[60:63], a[140:143]
    s_waitcnt vmcnt(3)
    v_mfma_f32_16x16x32_bf16 a[4:7], v[100:103], v[64:67], a[4:7]
    v_mfma_f32_16x16x32_bf16 a[24:27], v[104:107], v[64:67], a[24:27]
    v_mfma_f32_16x16x32_bf16 a[44:47], v[108:111], v[64:67], a[44:47]
    v_mfma_f32_16x16x32_bf16 a[64:67], v[112:115], v[64:67], a[64:67]
    v_mfma_f32_16x16x32_bf16 a[84:87], v[116:119], v[64:67], a[84:87]
    v_mfma_f32_16x16x32_bf16 a[104:107], v[120:123], v[64:67], a[104:107]
    v_mfma_f32_16x16x32_bf16 a[124:127], v[124:127], v[64:67], a[124:127]
    v_mfma_f32_16x16x32_bf16 a[144:147], v[128:131], v[64:67], a[144:147]
    s_waitcnt vmcnt(2)
    v_mfma_f32_16x16x32_bf16 a[8:11], v[100:103], v[68:71], a[8:11]
    v_mfma_f32_16x16x32_bf16 a[28:31], v[104:107], v[68:71], a[28:31]
    v_mfma_f32_16x16x32_bf16 a[48:51], v[108:111], v[68:71], a[48:51]
    v_mfma_f32_16x16x32_bf16 a[68:71], v[112:115], v[68:71], a[68:71]
    v_mfma_f32_16x16x32_bf16 a[88:91], v[116:119], v[68:71], a[88:91]
    v_mfma_f32_16x16x32_bf16 a[108:111], v[120:123], v[68:71], a[108:111]
    v_mfma_f32_16x16x32_bf16 a[128:131], v[124:127], v[68:71], a[128:131]
    v_mfma_f32_16x16x32_bf16 a[148:151], v[128:131], v[68:71], a[148:151]
    s_waitcnt vmcnt(1)
    v_mfma_f32_16x16x32_bf16 a[12:15], v[100:103], v[72:75], a[12:15]
    v_mfma_f32_16x16x32_bf16 a[32:35], v[104:107], v[72:75], a[32:35]
    v_mfma_f32_16x16x32_bf16 a[52:55], v[108:111], v[72:75], a[52:55]
    v_mfma_f32_16x16x32_bf16 a[72:75], v[112:115], v[72:75], a[72:75]
    v_mfma_f32_16x16x32_bf16 a[92:95], v[116:119], v[72:75], a[92:95]
    v_mfma_f32_16x16x32_bf16 a[112:115], v[120:123], v[72:75], a[112:115]
    v_mfma_f32_16x16x32_bf16 a[132:135], v[124:127], v[72:75], a[132:135]
    v_mfma_f32_16x16x32_bf16 a[152:155], v[128:131], v[72:75], a[152:155]
    s_waitcnt vmcnt(0)
    v_mfma_f32_16x16x32_bf16 a[16:19], v[100:103], v[76:79], a[16:19]
    v_mfma_f32_16x16x32_bf16 a[36:39], v[104:107], v[76:79], a[36:39]
    v_mfma_f32_16x16x32_bf16 a[56:59], v[108:111], v[76:79], a[56:59]
    v_mfma_f32_16x16x32_bf16 a[76:79], v[112:115], v[76:79], a[76:79]
    v_mfma_f32_16x16x32_bf16 a[96:99], v[116:119], v[76:79], a[96:99]
    v_mfma_f32_16x16x32_bf16 a[116:119], v[120:123], v[76:79], a[116:119]
    v_mfma_f32_16x16x32_bf16 a[136:139], v[124:127], v[76:79], a[136:139]
    v_mfma_f32_16x16x32_bf16 a[156:159], v[128:131], v[76:79], a[156:159]
    s_cmp_lg_u32 s101, 0
    s_cbranch_scc1 K1_QSTASH
    v_accvgpr_read_b32 v0, a0
    v_accvgpr_read_b32 v1, a1
    v_accvgpr_read_b32 v2, a2
    v_accvgpr_read_b32 v3, a3
    v_mul_f32 v0, s67, v0
    v_mul_f32 v1, s67, v1
    v_mul_f32 v2, s67, v2
    v_mul_f32 v3, s67, v3
    v_cvt_pk_bf16_f32 v4, v0, v1
    v_cvt_pk_bf16_f32 v5, v2, v3
    v_accvgpr_write_b32 a160, v4
    v_accvgpr_write_b32 a161, v5
    v_accvgpr_read_b32 v8, a20
    v_accvgpr_read_b32 v9, a21
    v_accvgpr_read_b32 v10, a22
    v_accvgpr_read_b32 v11, a23
    v_mul_f32 v8, s67, v8
    v_mul_f32 v9, s67, v9
    v_mul_f32 v10, s67, v10
    v_mul_f32 v11, s67, v11
    v_cvt_pk_bf16_f32 v12, v8, v9
    v_cvt_pk_bf16_f32 v13, v10, v11
    v_accvgpr_write_b32 a162, v12
    v_accvgpr_write_b32 a163, v13
    v_accvgpr_read_b32 v16, a40
    v_accvgpr_read_b32 v17, a41
    v_accvgpr_read_b32 v18, a42
    v_accvgpr_read_b32 v19, a43
    v_mul_f32 v16, s67, v16
    v_mul_f32 v17, s67, v17
    v_mul_f32 v18, s67, v18
    v_mul_f32 v19, s67, v19
    v_cvt_pk_bf16_f32 v20, v16, v17
    v_cvt_pk_bf16_f32 v21, v18, v19
    v_accvgpr_write_b32 a164, v20
    v_accvgpr_write_b32 a165, v21
    v_accvgpr_read_b32 v24, a60
    v_accvgpr_read_b32 v25, a61
    v_accvgpr_read_b32 v26, a62
    v_accvgpr_read_b32 v27, a63
    v_mul_f32 v24, s67, v24
    v_mul_f32 v25, s67, v25
    v_mul_f32 v26, s67, v26
    v_mul_f32 v27, s67, v27
    v_cvt_pk_bf16_f32 v28, v24, v25
    v_cvt_pk_bf16_f32 v29, v26, v27
    v_accvgpr_write_b32 a166, v28
    v_accvgpr_write_b32 a167, v29
    v_accvgpr_read_b32 v0, a80
    v_accvgpr_read_b32 v1, a81
    v_accvgpr_read_b32 v2, a82
    v_accvgpr_read_b32 v3, a83
    v_mul_f32 v0, s67, v0
    v_mul_f32 v1, s67, v1
    v_mul_f32 v2, s67, v2
    v_mul_f32 v3, s67, v3
    v_cvt_pk_bf16_f32 v4, v0, v1
    v_cvt_pk_bf16_f32 v5, v2, v3
    v_accvgpr_write_b32 a168, v4
    v_accvgpr_write_b32 a169, v5
    v_accvgpr_read_b32 v8, a100
    v_accvgpr_read_b32 v9, a101
    v_accvgpr_read_b32 v10, a102
    v_accvgpr_read_b32 v11, a103
    v_mul_f32 v8, s67, v8
    v_mul_f32 v9, s67, v9
    v_mul_f32 v10, s67, v10
    v_mul_f32 v11, s67, v11
    v_cvt_pk_bf16_f32 v12, v8, v9
    v_cvt_pk_bf16_f32 v13, v10, v11
    v_accvgpr_write_b32 a170, v12
    v_accvgpr_write_b32 a171, v13
    v_accvgpr_read_b32 v16, a120
    v_accvgpr_read_b32 v17, a121
    v_accvgpr_read_b32 v18, a122
    v_accvgpr_read_b32 v19, a123
    v_mul_f32 v16, s67, v16
    v_mul_f32 v17, s67, v17
    v_mul_f32 v18, s67, v18
    v_mul_f32 v19, s67, v19
    v_cvt_pk_bf16_f32 v20, v16, v17
    v_cvt_pk_bf16_f32 v21, v18, v19
    v_accvgpr_write_b32 a172, v20
    v_accvgpr_write_b32 a173, v21
    v_accvgpr_read_b32 v24, a140
    v_accvgpr_read_b32 v25, a141
    v_accvgpr_read_b32 v26, a142
    v_accvgpr_read_b32 v27, a143
    v_mul_f32 v24, s67, v24
    v_mul_f32 v25, s67, v25
    v_mul_f32 v26, s67, v26
    v_mul_f32 v27, s67, v27
    v_cvt_pk_bf16_f32 v28, v24, v25
    v_cvt_pk_bf16_f32 v29, v26, v27
    v_accvgpr_write_b32 a174, v28
    v_accvgpr_write_b32 a175, v29
    v_accvgpr_read_b32 v0, a4
    v_accvgpr_read_b32 v1, a5
    v_accvgpr_read_b32 v2, a6
    v_accvgpr_read_b32 v3, a7
    v_mul_f32 v0, s67, v0
    v_mul_f32 v1, s67, v1
    v_mul_f32 v2, s67, v2
    v_mul_f32 v3, s67, v3
    v_cvt_pk_bf16_f32 v4, v0, v1
    v_cvt_pk_bf16_f32 v5, v2, v3
    v_accvgpr_write_b32 a176, v4
    v_accvgpr_write_b32 a177, v5
    v_accvgpr_read_b32 v8, a24
    v_accvgpr_read_b32 v9, a25
    v_accvgpr_read_b32 v10, a26
    v_accvgpr_read_b32 v11, a27
    v_mul_f32 v8, s67, v8
    v_mul_f32 v9, s67, v9
    v_mul_f32 v10, s67, v10
    v_mul_f32 v11, s67, v11
    v_cvt_pk_bf16_f32 v12, v8, v9
    v_cvt_pk_bf16_f32 v13, v10, v11
    v_accvgpr_write_b32 a178, v12
    v_accvgpr_write_b32 a179, v13
    v_accvgpr_read_b32 v16, a44
    v_accvgpr_read_b32 v17, a45
    v_accvgpr_read_b32 v18, a46
    v_accvgpr_read_b32 v19, a47
    v_mul_f32 v16, s67, v16
    v_mul_f32 v17, s67, v17
    v_mul_f32 v18, s67, v18
    v_mul_f32 v19, s67, v19
    v_cvt_pk_bf16_f32 v20, v16, v17
    v_cvt_pk_bf16_f32 v21, v18, v19
    v_accvgpr_write_b32 a180, v20
    v_accvgpr_write_b32 a181, v21
    v_accvgpr_read_b32 v24, a64
    v_accvgpr_read_b32 v25, a65
    v_accvgpr_read_b32 v26, a66
    v_accvgpr_read_b32 v27, a67
    v_mul_f32 v24, s67, v24
    v_mul_f32 v25, s67, v25
    v_mul_f32 v26, s67, v26
    v_mul_f32 v27, s67, v27
    v_cvt_pk_bf16_f32 v28, v24, v25
    v_cvt_pk_bf16_f32 v29, v26, v27
    v_accvgpr_write_b32 a182, v28
    v_accvgpr_write_b32 a183, v29
    v_accvgpr_read_b32 v0, a84
    v_accvgpr_read_b32 v1, a85
    v_accvgpr_read_b32 v2, a86
    v_accvgpr_read_b32 v3, a87
    v_mul_f32 v0, s67, v0
    v_mul_f32 v1, s67, v1
    v_mul_f32 v2, s67, v2
    v_mul_f32 v3, s67, v3
    v_cvt_pk_bf16_f32 v4, v0, v1
    v_cvt_pk_bf16_f32 v5, v2, v3
    v_accvgpr_write_b32 a184, v4
    v_accvgpr_write_b32 a185, v5
    v_accvgpr_read_b32 v8, a104
    v_accvgpr_read_b32 v9, a105
    v_accvgpr_read_b32 v10, a106
    v_accvgpr_read_b32 v11, a107
    v_mul_f32 v8, s67, v8
    v_mul_f32 v9, s67, v9
    v_mul_f32 v10, s67, v10
    v_mul_f32 v11, s67, v11
    v_cvt_pk_bf16_f32 v12, v8, v9
    v_cvt_pk_bf16_f32 v13, v10, v11
    v_accvgpr_write_b32 a186, v12
    v_accvgpr_write_b32 a187, v13
    v_accvgpr_read_b32 v16, a124
    v_accvgpr_read_b32 v17, a125
    v_accvgpr_read_b32 v18, a126
    v_accvgpr_read_b32 v19, a127
    v_mul_f32 v16, s67, v16
    v_mul_f32 v17, s67, v17
    v_mul_f32 v18, s67, v18
    v_mul_f32 v19, s67, v19
    v_cvt_pk_bf16_f32 v20, v16, v17
    v_cvt_pk_bf16_f32 v21, v18, v19
    v_accvgpr_write_b32 a188, v20
    v_accvgpr_write_b32 a189, v21
    v_accvgpr_read_b32 v24, a144
    v_accvgpr_read_b32 v25, a145
    v_accvgpr_read_b32 v26, a146
    v_accvgpr_read_b32 v27, a147
    v_mul_f32 v24, s67, v24
    v_mul_f32 v25, s67, v25
    v_mul_f32 v26, s67, v26
    v_mul_f32 v27, s67, v27
    v_cvt_pk_bf16_f32 v28, v24, v25
    v_cvt_pk_bf16_f32 v29, v26, v27
    v_accvgpr_write_b32 a190, v28
    v_accvgpr_write_b32 a191, v29
    v_accvgpr_read_b32 v0, a8
    v_accvgpr_read_b32 v1, a9
    v_accvgpr_read_b32 v2, a10
    v_accvgpr_read_b32 v3, a11
    v_mul_f32 v0, s67, v0
    v_mul_f32 v1, s67, v1
    v_mul_f32 v2, s67, v2
    v_mul_f32 v3, s67, v3
    v_cvt_pk_bf16_f32 v4, v0, v1
    v_cvt_pk_bf16_f32 v5, v2, v3
    v_accvgpr_write_b32 a192, v4
    v_accvgpr_write_b32 a193, v5
    v_accvgpr_read_b32 v8, a28
    v_accvgpr_read_b32 v9, a29
    v_accvgpr_read_b32 v10, a30
    v_accvgpr_read_b32 v11, a31
    v_mul_f32 v8, s67, v8
    v_mul_f32 v9, s67, v9
    v_mul_f32 v10, s67, v10
    v_mul_f32 v11, s67, v11
    v_cvt_pk_bf16_f32 v12, v8, v9
    v_cvt_pk_bf16_f32 v13, v10, v11
    v_accvgpr_write_b32 a194, v12
    v_accvgpr_write_b32 a195, v13
    v_accvgpr_read_b32 v16, a48
    v_accvgpr_read_b32 v17, a49
    v_accvgpr_read_b32 v18, a50
    v_accvgpr_read_b32 v19, a51
    v_mul_f32 v16, s67, v16
    v_mul_f32 v17, s67, v17
    v_mul_f32 v18, s67, v18
    v_mul_f32 v19, s67, v19
    v_cvt_pk_bf16_f32 v20, v16, v17
    v_cvt_pk_bf16_f32 v21, v18, v19
    v_accvgpr_write_b32 a196, v20
    v_accvgpr_write_b32 a197, v21
    v_accvgpr_read_b32 v24, a68
    v_accvgpr_read_b32 v25, a69
    v_accvgpr_read_b32 v26, a70
    v_accvgpr_read_b32 v27, a71
    v_mul_f32 v24, s67, v24
    v_mul_f32 v25, s67, v25
    v_mul_f32 v26, s67, v26
    v_mul_f32 v27, s67, v27
    v_cvt_pk_bf16_f32 v28, v24, v25
    v_cvt_pk_bf16_f32 v29, v26, v27
    v_accvgpr_write_b32 a198, v28
    v_accvgpr_write_b32 a199, v29
    v_accvgpr_read_b32 v0, a88
    v_accvgpr_read_b32 v1, a89
    v_accvgpr_read_b32 v2, a90
    v_accvgpr_read_b32 v3, a91
    v_mul_f32 v0, s67, v0
    v_mul_f32 v1, s67, v1
    v_mul_f32 v2, s67, v2
    v_mul_f32 v3, s67, v3
    v_cvt_pk_bf16_f32 v4, v0, v1
    v_cvt_pk_bf16_f32 v5, v2, v3
    v_accvgpr_write_b32 a200, v4
    v_accvgpr_write_b32 a201, v5
    v_accvgpr_read_b32 v8, a108
    v_accvgpr_read_b32 v9, a109
    v_accvgpr_read_b32 v10, a110
    v_accvgpr_read_b32 v11, a111
    v_mul_f32 v8, s67, v8
    v_mul_f32 v9, s67, v9
    v_mul_f32 v10, s67, v10
    v_mul_f32 v11, s67, v11
    v_cvt_pk_bf16_f32 v12, v8, v9
    v_cvt_pk_bf16_f32 v13, v10, v11
    v_accvgpr_write_b32 a202, v12
    v_accvgpr_write_b32 a203, v13
    v_accvgpr_read_b32 v16, a128
    v_accvgpr_read_b32 v17, a129
    v_accvgpr_read_b32 v18, a130
    v_accvgpr_read_b32 v19, a131
    v_mul_f32 v16, s67, v16
    v_mul_f32 v17, s67, v17
    v_mul_f32 v18, s67, v18
    v_mul_f32 v19, s67, v19
    v_cvt_pk_bf16_f32 v20, v16, v17
    v_cvt_pk_bf16_f32 v21, v18, v19
    v_accvgpr_write_b32 a204, v20
    v_accvgpr_write_b32 a205, v21
    v_accvgpr_read_b32 v24, a148
    v_accvgpr_read_b32 v25, a149
    v_accvgpr_read_b32 v26, a150
    v_accvgpr_read_b32 v27, a151
    v_mul_f32 v24, s67, v24
    v_mul_f32 v25, s67, v25
    v_mul_f32 v26, s67, v26
    v_mul_f32 v27, s67, v27
    v_cvt_pk_bf16_f32 v28, v24, v25
    v_cvt_pk_bf16_f32 v29, v26, v27
    v_accvgpr_write_b32 a206, v28
    v_accvgpr_write_b32 a207, v29
    v_accvgpr_read_b32 v0, a12
    v_accvgpr_read_b32 v1, a13
    v_accvgpr_read_b32 v2, a14
    v_accvgpr_read_b32 v3, a15
    v_mul_f32 v0, s67, v0
    v_mul_f32 v1, s67, v1
    v_mul_f32 v2, s67, v2
    v_mul_f32 v3, s67, v3
    v_cvt_pk_bf16_f32 v4, v0, v1
    v_cvt_pk_bf16_f32 v5, v2, v3
    v_accvgpr_write_b32 a208, v4
    v_accvgpr_write_b32 a209, v5
    v_accvgpr_read_b32 v8, a32
    v_accvgpr_read_b32 v9, a33
    v_accvgpr_read_b32 v10, a34
    v_accvgpr_read_b32 v11, a35
    v_mul_f32 v8, s67, v8
    v_mul_f32 v9, s67, v9
    v_mul_f32 v10, s67, v10
    v_mul_f32 v11, s67, v11
    v_cvt_pk_bf16_f32 v12, v8, v9
    v_cvt_pk_bf16_f32 v13, v10, v11
    v_accvgpr_write_b32 a210, v12
    v_accvgpr_write_b32 a211, v13
    v_accvgpr_read_b32 v16, a52
    v_accvgpr_read_b32 v17, a53
    v_accvgpr_read_b32 v18, a54
    v_accvgpr_read_b32 v19, a55
    v_mul_f32 v16, s67, v16
    v_mul_f32 v17, s67, v17
    v_mul_f32 v18, s67, v18
    v_mul_f32 v19, s67, v19
    v_cvt_pk_bf16_f32 v20, v16, v17
    v_cvt_pk_bf16_f32 v21, v18, v19
    v_accvgpr_write_b32 a212, v20
    v_accvgpr_write_b32 a213, v21
    v_accvgpr_read_b32 v24, a72
    v_accvgpr_read_b32 v25, a73
    v_accvgpr_read_b32 v26, a74
    v_accvgpr_read_b32 v27, a75
    v_mul_f32 v24, s67, v24
    v_mul_f32 v25, s67, v25
    v_mul_f32 v26, s67, v26
    v_mul_f32 v27, s67, v27
    v_cvt_pk_bf16_f32 v28, v24, v25
    v_cvt_pk_bf16_f32 v29, v26, v27
    v_accvgpr_write_b32 a214, v28
    v_accvgpr_write_b32 a215, v29
    v_accvgpr_read_b32 v0, a92
    v_accvgpr_read_b32 v1, a93
    v_accvgpr_read_b32 v2, a94
    v_accvgpr_read_b32 v3, a95
    v_mul_f32 v0, s67, v0
    v_mul_f32 v1, s67, v1
    v_mul_f32 v2, s67, v2
    v_mul_f32 v3, s67, v3
    v_cvt_pk_bf16_f32 v4, v0, v1
    v_cvt_pk_bf16_f32 v5, v2, v3
    v_accvgpr_write_b32 a216, v4
    v_accvgpr_write_b32 a217, v5
    v_accvgpr_read_b32 v8, a112
    v_accvgpr_read_b32 v9, a113
    v_accvgpr_read_b32 v10, a114
    v_accvgpr_read_b32 v11, a115
    v_mul_f32 v8, s67, v8
    v_mul_f32 v9, s67, v9
    v_mul_f32 v10, s67, v10
    v_mul_f32 v11, s67, v11
    v_cvt_pk_bf16_f32 v12, v8, v9
    v_cvt_pk_bf16_f32 v13, v10, v11
    v_accvgpr_write_b32 a218, v12
    v_accvgpr_write_b32 a219, v13
    v_accvgpr_read_b32 v16, a132
    v_accvgpr_read_b32 v17, a133
    v_accvgpr_read_b32 v18, a134
    v_accvgpr_read_b32 v19, a135
    v_mul_f32 v16, s67, v16
    v_mul_f32 v17, s67, v17
    v_mul_f32 v18, s67, v18
    v_mul_f32 v19, s67, v19
    v_cvt_pk_bf16_f32 v20, v16, v17
    v_cvt_pk_bf16_f32 v21, v18, v19
    v_accvgpr_write_b32 a220, v20
    v_accvgpr_write_b32 a221, v21
    v_accvgpr_read_b32 v24, a152
    v_accvgpr_read_b32 v25, a153
    v_accvgpr_read_b32 v26, a154
    v_accvgpr_read_b32 v27, a155
    v_mul_f32 v24, s67, v24
    v_mul_f32 v25, s67, v25
    v_mul_f32 v26, s67, v26
    v_mul_f32 v27, s67, v27
    v_cvt_pk_bf16_f32 v28, v24, v25
    v_cvt_pk_bf16_f32 v29, v26, v27
    v_accvgpr_write_b32 a222, v28
    v_accvgpr_write_b32 a223, v29
    v_accvgpr_read_b32 v0, a16
    v_accvgpr_read_b32 v1, a17
    v_accvgpr_read_b32 v2, a18
    v_accvgpr_read_b32 v3, a19
    v_mul_f32 v0, s67, v0
    v_mul_f32 v1, s67, v1
    v_mul_f32 v2, s67, v2
    v_mul_f32 v3, s67, v3
    v_cvt_pk_bf16_f32 v4, v0, v1
    v_cvt_pk_bf16_f32 v5, v2, v3
    v_accvgpr_write_b32 a224, v4
    v_accvgpr_write_b32 a225, v5
    v_accvgpr_read_b32 v8, a36
    v_accvgpr_read_b32 v9, a37
    v_accvgpr_read_b32 v10, a38
    v_accvgpr_read_b32 v11, a39
    v_mul_f32 v8, s67, v8
    v_mul_f32 v9, s67, v9
    v_mul_f32 v10, s67, v10
    v_mul_f32 v11, s67, v11
    v_cvt_pk_bf16_f32 v12, v8, v9
    v_cvt_pk_bf16_f32 v13, v10, v11
    v_accvgpr_write_b32 a226, v12
    v_accvgpr_write_b32 a227, v13
    v_accvgpr_read_b32 v16, a56
    v_accvgpr_read_b32 v17, a57
    v_accvgpr_read_b32 v18, a58
    v_accvgpr_read_b32 v19, a59
    v_mul_f32 v16, s67, v16
    v_mul_f32 v17, s67, v17
    v_mul_f32 v18, s67, v18
    v_mul_f32 v19, s67, v19
    v_cvt_pk_bf16_f32 v20, v16, v17
    v_cvt_pk_bf16_f32 v21, v18, v19
    v_accvgpr_write_b32 a228, v20
    v_accvgpr_write_b32 a229, v21
    v_accvgpr_read_b32 v24, a76
    v_accvgpr_read_b32 v25, a77
    v_accvgpr_read_b32 v26, a78
    v_accvgpr_read_b32 v27, a79
    v_mul_f32 v24, s67, v24
    v_mul_f32 v25, s67, v25
    v_mul_f32 v26, s67, v26
    v_mul_f32 v27, s67, v27
    v_cvt_pk_bf16_f32 v28, v24, v25
    v_cvt_pk_bf16_f32 v29, v26, v27
    v_accvgpr_write_b32 a230, v28
    v_accvgpr_write_b32 a231, v29
    v_accvgpr_read_b32 v0, a96
    v_accvgpr_read_b32 v1, a97
    v_accvgpr_read_b32 v2, a98
    v_accvgpr_read_b32 v3, a99
    v_mul_f32 v0, s67, v0
    v_mul_f32 v1, s67, v1
    v_mul_f32 v2, s67, v2
    v_mul_f32 v3, s67, v3
    v_cvt_pk_bf16_f32 v4, v0, v1
    v_cvt_pk_bf16_f32 v5, v2, v3
    v_accvgpr_write_b32 a232, v4
    v_accvgpr_write_b32 a233, v5
    v_accvgpr_read_b32 v8, a116
    v_accvgpr_read_b32 v9, a117
    v_accvgpr_read_b32 v10, a118
    v_accvgpr_read_b32 v11, a119
    v_mul_f32 v8, s67, v8
    v_mul_f32 v9, s67, v9
    v_mul_f32 v10, s67, v10
    v_mul_f32 v11, s67, v11
    v_cvt_pk_bf16_f32 v12, v8, v9
    v_cvt_pk_bf16_f32 v13, v10, v11
    v_accvgpr_write_b32 a234, v12
    v_accvgpr_write_b32 a235, v13
    v_accvgpr_read_b32 v16, a136
    v_accvgpr_read_b32 v17, a137
    v_accvgpr_read_b32 v18, a138
    v_accvgpr_read_b32 v19, a139
    v_mul_f32 v16, s67, v16
    v_mul_f32 v17, s67, v17
    v_mul_f32 v18, s67, v18
    v_mul_f32 v19, s67, v19
    v_cvt_pk_bf16_f32 v20, v16, v17
    v_cvt_pk_bf16_f32 v21, v18, v19
    v_accvgpr_write_b32 a236, v20
    v_accvgpr_write_b32 a237, v21
    v_accvgpr_read_b32 v24, a156
    v_accvgpr_read_b32 v25, a157
    v_accvgpr_read_b32 v26, a158
    v_accvgpr_read_b32 v27, a159
    v_mul_f32 v24, s67, v24
    v_mul_f32 v25, s67, v25
    v_mul_f32 v26, s67, v26
    v_mul_f32 v27, s67, v27
    v_cvt_pk_bf16_f32 v28, v24, v25
    v_cvt_pk_bf16_f32 v29, v26, v27
    v_accvgpr_write_b32 a238, v28
    v_accvgpr_write_b32 a239, v29
    s_cmp_eq_u32 s100, 0
    s_cbranch_scc1 K1_QDONE
    s_mov_b32 s101, 1
    s_mov_b32 s74, 1
    s_lshl_b32 s68, s74, 4
    s_add_u32 s68, s68, s32
    s_mul_i32 s68, s68, 163840
    s_add_u32 s68, s68, 67108864
    s_add_u32 s56, s26, s68
    s_addc_u32 s57, s27, 0
    s_and_b32 s57, s57, 65535
    s_mov_b32 s58, 163840
    s_mov_b32 s59, 131072
    s_lshl_b32 s68, s74, 5
    s_add_u32 s68, s68, s33
    s_lshl_b32 s68, s68, 17
    s_add_u32 s68, s68, 83886080
    s_add_u32 s52, s26, s68
    s_addc_u32 s53, s27, 0
    s_and_b32 s53, s53, 65535
    s_mov_b32 s54, 131072
    s_mov_b32 s55, 131072
    s_branch K1_QP
K1_QSTASH:
    v_accvgpr_read_b32 v0, a0
    v_accvgpr_read_b32 v1, a1
    v_accvgpr_read_b32 v2, a2
    v_accvgpr_read_b32 v3, a3
    v_accvgpr_read_b32 v4, a20
    v_accvgpr_read_b32 v5, a21
    v_accvgpr_read_b32 v6, a22
    v_accvgpr_read_b32 v7, a23
    v_mul_f32 v0, s67, v0
    v_mul_f32 v1, s67, v1
    v_mul_f32 v2, s67, v2
    v_mul_f32 v3, s67, v3
    v_mul_f32 v4, s67, v4
    v_mul_f32 v5, s67, v5
    v_mul_f32 v6, s67, v6
    v_mul_f32 v7, s67, v7
    v_cvt_pk_bf16_f32 v8, v0, v1
    v_cvt_pk_bf16_f32 v9, v2, v3
    v_cvt_pk_bf16_f32 v10, v4, v5
    v_cvt_pk_bf16_f32 v11, v6, v7
    s_add_u32 s68, s86, 0
    buffer_store_dwordx4 v[8:11], v241, s[96:99], s68 offen offset:0
    v_accvgpr_read_b32 v12, a40
    v_accvgpr_read_b32 v13, a41
    v_accvgpr_read_b32 v14, a42
    v_accvgpr_read_b32 v15, a43
    v_accvgpr_read_b32 v16, a60
    v_accvgpr_read_b32 v17, a61
    v_accvgpr_read_b32 v18, a62
    v_accvgpr_read_b32 v19, a63
    v_mul_f32 v12, s67, v12
    v_mul_f32 v13, s67, v13
    v_mul_f32 v14, s67, v14
    v_mul_f32 v15, s67, v15
    v_mul_f32 v16, s67, v16
    v_mul_f32 v17, s67, v17
    v_mul_f32 v18, s67, v18
    v_mul_f32 v19, s67, v19
    v_cvt_pk_bf16_f32 v20, v12, v13
    v_cvt_pk_bf16_f32 v21, v14, v15
    v_cvt_pk_bf16_f32 v22, v16, v17
    v_cvt_pk_bf16_f32 v23, v18, v19
    s_add_u32 s68, s86, 1024
    buffer_store_dwordx4 v[20:23], v241, s[96:99], s68 offen offset:0
    v_accvgpr_read_b32 v24, a80
    v_accvgpr_read_b32 v25, a81
    v_accvgpr_read_b32 v26, a82
    v_accvgpr_read_b32 v27, a83
    v_accvgpr_read_b32 v28, a100
    v_accvgpr_read_b32 v29, a101
    v_accvgpr_read_b32 v30, a102
    v_accvgpr_read_b32 v31, a103
    v_mul_f32 v24, s67, v24
    v_mul_f32 v25, s67, v25
    v_mul_f32 v26, s67, v26
    v_mul_f32 v27, s67, v27
    v_mul_f32 v28, s67, v28
    v_mul_f32 v29, s67, v29
    v_mul_f32 v30, s67, v30
    v_mul_f32 v31, s67, v31
    v_cvt_pk_bf16_f32 v32, v24, v25
    v_cvt_pk_bf16_f32 v33, v26, v27
    v_cvt_pk_bf16_f32 v34, v28, v29
    v_cvt_pk_bf16_f32 v35, v30, v31
    s_add_u32 s68, s86, 2048
    buffer_store_dwordx4 v[32:35], v241, s[96:99], s68 offen offset:0
    v_accvgpr_read_b32 v36, a120
    v_accvgpr_read_b32 v37, a121
    v_accvgpr_read_b32 v38, a122
    v_accvgpr_read_b32 v39, a123
    v_accvgpr_read_b32 v40, a140
    v_accvgpr_read_b32 v41, a141
    v_accvgpr_read_b32 v42, a142
    v_accvgpr_read_b32 v43, a143
    v_mul_f32 v36, s67, v36
    v_mul_f32 v37, s67, v37
    v_mul_f32 v38, s67, v38
    v_mul_f32 v39, s67, v39
    v_mul_f32 v40, s67, v40
    v_mul_f32 v41, s67, v41
    v_mul_f32 v42, s67, v42
    v_mul_f32 v43, s67, v43
    v_cvt_pk_bf16_f32 v44, v36, v37
    v_cvt_pk_bf16_f32 v45, v38, v39
    v_cvt_pk_bf16_f32 v46, v40, v41
    v_cvt_pk_bf16_f32 v47, v42, v43
    s_add_u32 s68, s86, 3072
    buffer_store_dwordx4 v[44:47], v241, s[96:99], s68 offen offset:0
    v_accvgpr_read_b32 v0, a4
    v_accvgpr_read_b32 v1, a5
    v_accvgpr_read_b32 v2, a6
    v_accvgpr_read_b32 v3, a7
    v_accvgpr_read_b32 v4, a24
    v_accvgpr_read_b32 v5, a25
    v_accvgpr_read_b32 v6, a26
    v_accvgpr_read_b32 v7, a27
    v_mul_f32 v0, s67, v0
    v_mul_f32 v1, s67, v1
    v_mul_f32 v2, s67, v2
    v_mul_f32 v3, s67, v3
    v_mul_f32 v4, s67, v4
    v_mul_f32 v5, s67, v5
    v_mul_f32 v6, s67, v6
    v_mul_f32 v7, s67, v7
    v_cvt_pk_bf16_f32 v8, v0, v1
    v_cvt_pk_bf16_f32 v9, v2, v3
    v_cvt_pk_bf16_f32 v10, v4, v5
    v_cvt_pk_bf16_f32 v11, v6, v7
    s_add_u32 s68, s86, 4096
    buffer_store_dwordx4 v[8:11], v241, s[96:99], s68 offen offset:0
    v_accvgpr_read_b32 v12, a44
    v_accvgpr_read_b32 v13, a45
    v_accvgpr_read_b32 v14, a46
    v_accvgpr_read_b32 v15, a47
    v_accvgpr_read_b32 v16, a64
    v_accvgpr_read_b32 v17, a65
    v_accvgpr_read_b32 v18, a66
    v_accvgpr_read_b32 v19, a67
    v_mul_f32 v12, s67, v12
    v_mul_f32 v13, s67, v13
    v_mul_f32 v14, s67, v14
    v_mul_f32 v15, s67, v15
    v_mul_f32 v16, s67, v16
    v_mul_f32 v17, s67, v17
    v_mul_f32 v18, s67, v18
    v_mul_f32 v19, s67, v19
    v_cvt_pk_bf16_f32 v20, v12, v13
    v_cvt_pk_bf16_f32 v21, v14, v15
    v_cvt_pk_bf16_f32 v22, v16, v17
    v_cvt_pk_bf16_f32 v23, v18, v19
    s_add_u32 s68, s86, 5120
    buffer_store_dwordx4 v[20:23], v241, s[96:99], s68 offen offset:0
    v_accvgpr_read_b32 v24, a84
    v_accvgpr_read_b32 v25, a85
    v_accvgpr_read_b32 v26, a86
    v_accvgpr_read_b32 v27, a87
    v_accvgpr_read_b32 v28, a104
    v_accvgpr_read_b32 v29, a105
    v_accvgpr_read_b32 v30, a106
    v_accvgpr_read_b32 v31, a107
    v_mul_f32 v24, s67, v24
    v_mul_f32 v25, s67, v25
    v_mul_f32 v26, s67, v26
    v_mul_f32 v27, s67, v27
    v_mul_f32 v28, s67, v28
    v_mul_f32 v29, s67, v29
    v_mul_f32 v30, s67, v30
    v_mul_f32 v31, s67, v31
    v_cvt_pk_bf16_f32 v32, v24, v25
    v_cvt_pk_bf16_f32 v33, v26, v27
    v_cvt_pk_bf16_f32 v34, v28, v29
    v_cvt_pk_bf16_f32 v35, v30, v31
    s_add_u32 s68, s86, 6144
    buffer_store_dwordx4 v[32:35], v241, s[96:99], s68 offen offset:0
    v_accvgpr_read_b32 v36, a124
    v_accvgpr_read_b32 v37, a125
    v_accvgpr_read_b32 v38, a126
    v_accvgpr_read_b32 v39, a127
    v_accvgpr_read_b32 v40, a144
    v_accvgpr_read_b32 v41, a145
    v_accvgpr_read_b32 v42, a146
    v_accvgpr_read_b32 v43, a147
    v_mul_f32 v36, s67, v36
    v_mul_f32 v37, s67, v37
    v_mul_f32 v38, s67, v38
    v_mul_f32 v39, s67, v39
    v_mul_f32 v40, s67, v40
    v_mul_f32 v41, s67, v41
    v_mul_f32 v42, s67, v42
    v_mul_f32 v43, s67, v43
    v_cvt_pk_bf16_f32 v44, v36, v37
    v_cvt_pk_bf16_f32 v45, v38, v39
    v_cvt_pk_bf16_f32 v46, v40, v41
    v_cvt_pk_bf16_f32 v47, v42, v43
    s_add_u32 s68, s86, 7168
    buffer_store_dwordx4 v[44:47], v241, s[96:99], s68 offen offset:0
    v_accvgpr_read_b32 v0, a8
    v_accvgpr_read_b32 v1, a9
    v_accvgpr_read_b32 v2, a10
    v_accvgpr_read_b32 v3, a11
    v_accvgpr_read_b32 v4, a28
    v_accvgpr_read_b32 v5, a29
    v_accvgpr_read_b32 v6, a30
    v_accvgpr_read_b32 v7, a31
    v_mul_f32 v0, s67, v0
    v_mul_f32 v1, s67, v1
    v_mul_f32 v2, s67, v2
    v_mul_f32 v3, s67, v3
    v_mul_f32 v4, s67, v4
    v_mul_f32 v5, s67, v5
    v_mul_f32 v6, s67, v6
    v_mul_f32 v7, s67, v7
    v_cvt_pk_bf16_f32 v8, v0, v1
    v_cvt_pk_bf16_f32 v9, v2, v3
    v_cvt_pk_bf16_f32 v10, v4, v5
    v_cvt_pk_bf16_f32 v11, v6, v7
    s_add_u32 s68, s86, 8192
    buffer_store_dwordx4 v[8:11], v241, s[96:99], s68 offen offset:0
    v_accvgpr_read_b32 v12, a48
    v_accvgpr_read_b32 v13, a49
    v_accvgpr_read_b32 v14, a50
    v_accvgpr_read_b32 v15, a51
    v_accvgpr_read_b32 v16, a68
    v_accvgpr_read_b32 v17, a69
    v_accvgpr_read_b32 v18, a70
    v_accvgpr_read_b32 v19, a71
    v_mul_f32 v12, s67, v12
    v_mul_f32 v13, s67, v13
    v_mul_f32 v14, s67, v14
    v_mul_f32 v15, s67, v15
    v_mul_f32 v16, s67, v16
    v_mul_f32 v17, s67, v17
    v_mul_f32 v18, s67, v18
    v_mul_f32 v19, s67, v19
    v_cvt_pk_bf16_f32 v20, v12, v13
    v_cvt_pk_bf16_f32 v21, v14, v15
    v_cvt_pk_bf16_f32 v22, v16, v17
    v_cvt_pk_bf16_f32 v23, v18, v19
    s_add_u32 s68, s86, 9216
    buffer_store_dwordx4 v[20:23], v241, s[96:99], s68 offen offset:0
    v_accvgpr_read_b32 v24, a88
    v_accvgpr_read_b32 v25, a89
    v_accvgpr_read_b32 v26, a90
    v_accvgpr_read_b32 v27, a91
    v_accvgpr_read_b32 v28, a108
    v_accvgpr_read_b32 v29, a109
    v_accvgpr_read_b32 v30, a110
    v_accvgpr_read_b32 v31, a111
    v_mul_f32 v24, s67, v24
    v_mul_f32 v25, s67, v25
    v_mul_f32 v26, s67, v26
    v_mul_f32 v27, s67, v27
    v_mul_f32 v28, s67, v28
    v_mul_f32 v29, s67, v29
    v_mul_f32 v30, s67, v30
    v_mul_f32 v31, s67, v31
    v_cvt_pk_bf16_f32 v32, v24, v25
    v_cvt_pk_bf16_f32 v33, v26, v27
    v_cvt_pk_bf16_f32 v34, v28, v29
    v_cvt_pk_bf16_f32 v35, v30, v31
    s_add_u32 s68, s86, 10240
    buffer_store_dwordx4 v[32:35], v241, s[96:99], s68 offen offset:0
    v_accvgpr_read_b32 v36, a128
    v_accvgpr_read_b32 v37, a129
    v_accvgpr_read_b32 v38, a130
    v_accvgpr_read_b32 v39, a131
    v_accvgpr_read_b32 v40, a148
    v_accvgpr_read_b32 v41, a149
    v_accvgpr_read_b32 v42, a150
    v_accvgpr_read_b32 v43, a151
    v_mul_f32 v36, s67, v36
    v_mul_f32 v37, s67, v37
    v_mul_f32 v38, s67, v38
    v_mul_f32 v39, s67, v39
    v_mul_f32 v40, s67, v40
    v_mul_f32 v41, s67, v41
    v_mul_f32 v42, s67, v42
    v_mul_f32 v43, s67, v43
    v_cvt_pk_bf16_f32 v44, v36, v37
    v_cvt_pk_bf16_f32 v45, v38, v39
    v_cvt_pk_bf16_f32 v46, v40, v41
    v_cvt_pk_bf16_f32 v47, v42, v43
    s_add_u32 s68, s86, 11264
    buffer_store_dwordx4 v[44:47], v241, s[96:99], s68 offen offset:0
    v_accvgpr_read_b32 v0, a12
    v_accvgpr_read_b32 v1, a13
    v_accvgpr_read_b32 v2, a14
    v_accvgpr_read_b32 v3, a15
    v_accvgpr_read_b32 v4, a32
    v_accvgpr_read_b32 v5, a33
    v_accvgpr_read_b32 v6, a34
    v_accvgpr_read_b32 v7, a35
    v_mul_f32 v0, s67, v0
    v_mul_f32 v1, s67, v1
    v_mul_f32 v2, s67, v2
    v_mul_f32 v3, s67, v3
    v_mul_f32 v4, s67, v4
    v_mul_f32 v5, s67, v5
    v_mul_f32 v6, s67, v6
    v_mul_f32 v7, s67, v7
    v_cvt_pk_bf16_f32 v8, v0, v1
    v_cvt_pk_bf16_f32 v9, v2, v3
    v_cvt_pk_bf16_f32 v10, v4, v5
    v_cvt_pk_bf16_f32 v11, v6, v7
    s_add_u32 s68, s86, 12288
    buffer_store_dwordx4 v[8:11], v241, s[96:99], s68 offen offset:0
    v_accvgpr_read_b32 v12, a52
    v_accvgpr_read_b32 v13, a53
    v_accvgpr_read_b32 v14, a54
    v_accvgpr_read_b32 v15, a55
    v_accvgpr_read_b32 v16, a72
    v_accvgpr_read_b32 v17, a73
    v_accvgpr_read_b32 v18, a74
    v_accvgpr_read_b32 v19, a75
    v_mul_f32 v12, s67, v12
    v_mul_f32 v13, s67, v13
    v_mul_f32 v14, s67, v14
    v_mul_f32 v15, s67, v15
    v_mul_f32 v16, s67, v16
    v_mul_f32 v17, s67, v17
    v_mul_f32 v18, s67, v18
    v_mul_f32 v19, s67, v19
    v_cvt_pk_bf16_f32 v20, v12, v13
    v_cvt_pk_bf16_f32 v21, v14, v15
    v_cvt_pk_bf16_f32 v22, v16, v17
    v_cvt_pk_bf16_f32 v23, v18, v19
    s_add_u32 s68, s86, 13312
    buffer_store_dwordx4 v[20:23], v241, s[96:99], s68 offen offset:0
    v_accvgpr_read_b32 v24, a92
    v_accvgpr_read_b32 v25, a93
    v_accvgpr_read_b32 v26, a94
    v_accvgpr_read_b32 v27, a95
    v_accvgpr_read_b32 v28, a112
    v_accvgpr_read_b32 v29, a113
    v_accvgpr_read_b32 v30, a114
    v_accvgpr_read_b32 v31, a115
    v_mul_f32 v24, s67, v24
    v_mul_f32 v25, s67, v25
    v_mul_f32 v26, s67, v26
    v_mul_f32 v27, s67, v27
    v_mul_f32 v28, s67, v28
    v_mul_f32 v29, s67, v29
    v_mul_f32 v30, s67, v30
    v_mul_f32 v31, s67, v31
    v_cvt_pk_bf16_f32 v32, v24, v25
    v_cvt_pk_bf16_f32 v33, v26, v27
    v_cvt_pk_bf16_f32 v34, v28, v29
    v_cvt_pk_bf16_f32 v35, v30, v31
    s_add_u32 s68, s86, 14336
    buffer_store_dwordx4 v[32:35], v241, s[96:99], s68 offen offset:0
    v_accvgpr_read_b32 v36, a132
    v_accvgpr_read_b32 v37, a133
    v_accvgpr_read_b32 v38, a134
    v_accvgpr_read_b32 v39, a135
    v_accvgpr_read_b32 v40, a152
    v_accvgpr_read_b32 v41, a153
    v_accvgpr_read_b32 v42, a154
    v_accvgpr_read_b32 v43, a155
    v_mul_f32 v36, s67, v36
    v_mul_f32 v37, s67, v37
    v_mul_f32 v38, s67, v38
    v_mul_f32 v39, s67, v39
    v_mul_f32 v40, s67, v40
    v_mul_f32 v41, s67, v41
    v_mul_f32 v42, s67, v42
    v_mul_f32 v43, s67, v43
    v_cvt_pk_bf16_f32 v44, v36, v37
    v_cvt_pk_bf16_f32 v45, v38, v39
    v_cvt_pk_bf16_f32 v46, v40, v41
    v_cvt_pk_bf16_f32 v47, v42, v43
    s_add_u32 s68, s86, 15360
    buffer_store_dwordx4 v[44:47], v241, s[96:99], s68 offen offset:0
    v_accvgpr_read_b32 v0, a16
    v_accvgpr_read_b32 v1, a17
    v_accvgpr_read_b32 v2, a18
    v_accvgpr_read_b32 v3, a19
    v_accvgpr_read_b32 v4, a36
    v_accvgpr_read_b32 v5, a37
    v_accvgpr_read_b32 v6, a38
    v_accvgpr_read_b32 v7, a39
    v_mul_f32 v0, s67, v0
    v_mul_f32 v1, s67, v1
    v_mul_f32 v2, s67, v2
    v_mul_f32 v3, s67, v3
    v_mul_f32 v4, s67, v4
    v_mul_f32 v5, s67, v5
    v_mul_f32 v6, s67, v6
    v_mul_f32 v7, s67, v7
    v_cvt_pk_bf16_f32 v8, v0, v1
    v_cvt_pk_bf16_f32 v9, v2, v3
    v_cvt_pk_bf16_f32 v10, v4, v5
    v_cvt_pk_bf16_f32 v11, v6, v7
    s_add_u32 s68, s86, 16384
    buffer_store_dwordx4 v[8:11], v241, s[96:99], s68 offen offset:0
    v_accvgpr_read_b32 v12, a56
    v_accvgpr_read_b32 v13, a57
    v_accvgpr_read_b32 v14, a58
    v_accvgpr_read_b32 v15, a59
    v_accvgpr_read_b32 v16, a76
    v_accvgpr_read_b32 v17, a77
    v_accvgpr_read_b32 v18, a78
    v_accvgpr_read_b32 v19, a79
    v_mul_f32 v12, s67, v12
    v_mul_f32 v13, s67, v13
    v_mul_f32 v14, s67, v14
    v_mul_f32 v15, s67, v15
    v_mul_f32 v16, s67, v16
    v_mul_f32 v17, s67, v17
    v_mul_f32 v18, s67, v18
    v_mul_f32 v19, s67, v19
    v_cvt_pk_bf16_f32 v20, v12, v13
    v_cvt_pk_bf16_f32 v21, v14, v15
    v_cvt_pk_bf16_f32 v22, v16, v17
    v_cvt_pk_bf16_f32 v23, v18, v19
    s_add_u32 s68, s86, 17408
    buffer_store_dwordx4 v[20:23], v241, s[96:99], s68 offen offset:0
    v_accvgpr_read_b32 v24, a96
    v_accvgpr_read_b32 v25, a97
    v_accvgpr_read_b32 v26, a98
    v_accvgpr_read_b32 v27, a99
    v_accvgpr_read_b32 v28, a116
    v_accvgpr_read_b32 v29, a117
    v_accvgpr_read_b32 v30, a118
    v_accvgpr_read_b32 v31, a119
    v_mul_f32 v24, s67, v24
    v_mul_f32 v25, s67, v25
    v_mul_f32 v26, s67, v26
    v_mul_f32 v27, s67, v27
    v_mul_f32 v28, s67, v28
    v_mul_f32 v29, s67, v29
    v_mul_f32 v30, s67, v30
    v_mul_f32 v31, s67, v31
    v_cvt_pk_bf16_f32 v32, v24, v25
    v_cvt_pk_bf16_f32 v33, v26, v27
    v_cvt_pk_bf16_f32 v34, v28, v29
    v_cvt_pk_bf16_f32 v35, v30, v31
    s_add_u32 s68, s86, 18432
    buffer_store_dwordx4 v[32:35], v241, s[96:99], s68 offen offset:0
    v_accvgpr_read_b32 v36, a136
    v_accvgpr_read_b32 v37, a137
    v_accvgpr_read_b32 v38, a138
    v_accvgpr_read_b32 v39, a139
    v_accvgpr_read_b32 v40, a156
    v_accvgpr_read_b32 v41, a157
    v_accvgpr_read_b32 v42, a158
    v_accvgpr_read_b32 v43, a159
    v_mul_f32 v36, s67, v36
    v_mul_f32 v37, s67, v37
    v_mul_f32 v38, s67, v38
    v_mul_f32 v39, s67, v39
    v_mul_f32 v40, s67, v40
    v_mul_f32 v41, s67, v41
    v_mul_f32 v42, s67, v42
    v_mul_f32 v43, s67, v43
    v_cvt_pk_bf16_f32 v44, v36, v37
    v_cvt_pk_bf16_f32 v45, v38, v39
    v_cvt_pk_bf16_f32 v46, v40, v41
    v_cvt_pk_bf16_f32 v47, v42, v43
    s_add_u32 s68, s86, 19456
    buffer_store_dwordx4 v[44:47], v241, s[96:99], s68 offen offset:0
K1_QDONE:
K1_QEND:
    v_accvgpr_write_b32 a0, 0
    v_accvgpr_write_b32 a1, 0
    v_accvgpr_write_b32 a2, 0
    v_accvgpr_write_b32 a3, 0
    v_accvgpr_write_b32 a4, 0
    v_accvgpr_write_b32 a5, 0
    v_accvgpr_write_b32 a6, 0
    v_accvgpr_write_b32 a7, 0
    v_accvgpr_write_b32 a8, 0
    v_accvgpr_write_b32 a9, 0
    v_accvgpr_write_b32 a10, 0
    v_accvgpr_write_b32 a11, 0
    v_accvgpr_write_b32 a12, 0
    v_accvgpr_write_b32 a13, 0
    v_accvgpr_write_b32 a14, 0
    v_accvgpr_write_b32 a15, 0
    v_accvgpr_write_b32 a16, 0
    v_accvgpr_write_b32 a17, 0
    v_accvgpr_write_b32 a18, 0
    v_accvgpr_write_b32 a19, 0
    v_accvgpr_write_b32 a20, 0
    v_accvgpr_write_b32 a21, 0
    v_accvgpr_write_b32 a22, 0
    v_accvgpr_write_b32 a23, 0
    v_accvgpr_write_b32 a24, 0
    v_accvgpr_write_b32 a25, 0
    v_accvgpr_write_b32 a26, 0
    v_accvgpr_write_b32 a27, 0
    v_accvgpr_write_b32 a28, 0
    v_accvgpr_write_b32 a29, 0
    v_accvgpr_write_b32 a30, 0
    v_accvgpr_write_b32 a31, 0
    v_accvgpr_write_b32 a32, 0
    v_accvgpr_write_b32 a33, 0
    v_accvgpr_write_b32 a34, 0
    v_accvgpr_write_b32 a35, 0
    v_accvgpr_write_b32 a36, 0
    v_accvgpr_write_b32 a37, 0
    v_accvgpr_write_b32 a38, 0
    v_accvgpr_write_b32 a39, 0
    v_accvgpr_write_b32 a40, 0
    v_accvgpr_write_b32 a41, 0
    v_accvgpr_write_b32 a42, 0
    v_accvgpr_write_b32 a43, 0
    v_accvgpr_write_b32 a44, 0
    v_accvgpr_write_b32 a45, 0
    v_accvgpr_write_b32 a46, 0
    v_accvgpr_write_b32 a47, 0
    v_accvgpr_write_b32 a48, 0
    v_accvgpr_write_b32 a49, 0
    v_accvgpr_write_b32 a50, 0
    v_accvgpr_write_b32 a51, 0
    v_accvgpr_write_b32 a52, 0
    v_accvgpr_write_b32 a53, 0
    v_accvgpr_write_b32 a54, 0
    v_accvgpr_write_b32 a55, 0
    v_accvgpr_write_b32 a56, 0
    v_accvgpr_write_b32 a57, 0
    v_accvgpr_write_b32 a58, 0
    v_accvgpr_write_b32 a59, 0
    v_accvgpr_write_b32 a60, 0
    v_accvgpr_write_b32 a61, 0
    v_accvgpr_write_b32 a62, 0
    v_accvgpr_write_b32 a63, 0
    v_accvgpr_write_b32 a64, 0
    v_accvgpr_write_b32 a65, 0
    v_accvgpr_write_b32 a66, 0
    v_accvgpr_write_b32 a67, 0
    v_accvgpr_write_b32 a68, 0
    v_accvgpr_write_b32 a69, 0
    v_accvgpr_write_b32 a70, 0
    v_accvgpr_write_b32 a71, 0
    v_accvgpr_write_b32 a72, 0
    v_accvgpr_write_b32 a73, 0
    v_accvgpr_write_b32 a74, 0
    v_accvgpr_write_b32 a75, 0
    v_accvgpr_write_b32 a76, 0
    v_accvgpr_write_b32 a77, 0
    v_accvgpr_write_b32 a78, 0
    v_accvgpr_write_b32 a79, 0
    v_accvgpr_write_b32 a80, 0
    v_accvgpr_write_b32 a81, 0
    v_accvgpr_write_b32 a82, 0
    v_accvgpr_write_b32 a83, 0
    v_accvgpr_write_b32 a84, 0
    v_accvgpr_write_b32 a85, 0
    v_accvgpr_write_b32 a86, 0
    v_accvgpr_write_b32 a87, 0
    v_accvgpr_write_b32 a88, 0
    v_accvgpr_write_b32 a89, 0
    v_accvgpr_write_b32 a90, 0
    v_accvgpr_write_b32 a91, 0
    v_accvgpr_write_b32 a92, 0
    v_accvgpr_write_b32 a93, 0
    v_accvgpr_write_b32 a94, 0
    v_accvgpr_write_b32 a95, 0
    v_accvgpr_write_b32 a96, 0
    v_accvgpr_write_b32 a97, 0
    v_accvgpr_write_b32 a98, 0
    v_accvgpr_write_b32 a99, 0
    v_accvgpr_write_b32 a100, 0
    v_accvgpr_write_b32 a101, 0
    v_accvgpr_write_b32 a102, 0
    v_accvgpr_write_b32 a103, 0
    v_accvgpr_write_b32 a104, 0
    v_accvgpr_write_b32 a105, 0
    v_accvgpr_write_b32 a106, 0
    v_accvgpr_write_b32 a107, 0
    v_accvgpr_write_b32 a108, 0
    v_accvgpr_write_b32 a109, 0
    v_accvgpr_write_b32 a110, 0
    v_accvgpr_write_b32 a111, 0
    v_accvgpr_write_b32 a112, 0
    v_accvgpr_write_b32 a113, 0
    v_accvgpr_write_b32 a114, 0
    v_accvgpr_write_b32 a115, 0
    v_accvgpr_write_b32 a116, 0
    v_accvgpr_write_b32 a117, 0
    v_accvgpr_write_b32 a118, 0
    v_accvgpr_write_b32 a119, 0
    v_accvgpr_write_b32 a120, 0
    v_accvgpr_write_b32 a121, 0
    v_accvgpr_write_b32 a122, 0
    v_accvgpr_write_b32 a123, 0
    v_accvgpr_write_b32 a124, 0
    v_accvgpr_write_b32 a125, 0
    v_accvgpr_write_b32 a126, 0
    v_accvgpr_write_b32 a127, 0
    v_accvgpr_write_b32 a128, 0
    v_accvgpr_write_b32 a129, 0
    v_accvgpr_write_b32 a130, 0
    v_accvgpr_write_b32 a131, 0
    v_accvgpr_write_b32 a132, 0
    v_accvgpr_write_b32 a133, 0
    v_accvgpr_write_b32 a134, 0
    v_accvgpr_write_b32 a135, 0
    v_accvgpr_write_b32 a136, 0
    v_accvgpr_write_b32 a137, 0
    v_accvgpr_write_b32 a138, 0
    v_accvgpr_write_b32 a139, 0
    v_accvgpr_write_b32 a140, 0
    v_accvgpr_write_b32 a141, 0
    v_accvgpr_write_b32 a142, 0
    v_accvgpr_write_b32 a143, 0
    v_accvgpr_write_b32 a144, 0
    v_accvgpr_write_b32 a145, 0
    v_accvgpr_write_b32 a146, 0
    v_accvgpr_write_b32 a147, 0
    v_accvgpr_write_b32 a148, 0
    v_accvgpr_write_b32 a149, 0
    v_accvgpr_write_b32 a150, 0
    v_accvgpr_write_b32 a151, 0
    v_accvgpr_write_b32 a152, 0
    v_accvgpr_write_b32 a153, 0
    v_accvgpr_write_b32 a154, 0
    v_accvgpr_write_b32 a155, 0
    v_accvgpr_write_b32 a156, 0
    v_accvgpr_write_b32 a157, 0
    v_accvgpr_write_b32 a158, 0
    v_accvgpr_write_b32 a159, 0
    v_mov_b32 v184, 0
    v_mov_b32 v164, 0
    v_mov_b32 v185, 0
    v_mov_b32 v165, 0
    v_mov_b32 v186, 0
    v_mov_b32 v166, 0
    v_mov_b32 v187, 0
    v_mov_b32 v167, 0
    v_mov_b32 v188, 0
    v_mov_b32 v168, 0
    v_mov_b32 v189, 0
    v_mov_b32 v169, 0
    v_mov_b32 v190, 0
    v_mov_b32 v170, 0
    v_mov_b32 v191, 0
    v_mov_b32 v171, 0
    v_mov_b32 v192, 0
    v_mov_b32 v172, 0
    v_mov_b32 v193, 0
    v_mov_b32 v173, 0
    v_mov_b32 v194, 0
    v_mov_b32 v174, 0
    v_mov_b32 v195, 0
    v_mov_b32 v175, 0
    v_mov_b32 v196, 0
    v_mov_b32 v176, 0
    v_mov_b32 v197, 0
    v_mov_b32 v177, 0
    v_mov_b32 v198, 0
    v_mov_b32 v178, 0
    v_mov_b32 v199, 0
    v_mov_b32 v179, 0
    v_mov_b32 v200, 0
    v_mov_b32 v180, 0
    v_mov_b32 v201, 0
    v_mov_b32 v181, 0
    v_mov_b32 v202, 0
    v_mov_b32 v182, 0
    v_mov_b32 v203, 0
    v_mov_b32 v183, 0
    ds_read_b128 v[100:103], v218 offset:0
    ds_read_b128 v[104:107], v219 offset:0
    ds_read_b128 v[108:111], v220 offset:0
    ds_read_b128 v[112:115], v221 offset:0
    ds_read_b128 v[116:119], v218 offset:4096
    ds_read_b128 v[120:123], v219 offset:4096
    ds_read_b128 v[124:127], v220 offset:4096
    ds_read_b128 v[128:131], v221 offset:4096
    s_waitcnt vmcnt(16) lgkmcnt(0)
    s_barrier
    v_mfma_f32_16x16x32_bf16 v[0:3], v[100:103], a[160:163], v[164:167]
    v_mfma_f32_16x16x32_bf16 v[20:23], v[116:119], a[160:163], v[164:167]
    v_mfma_f32_16x16x32_bf16 v[0:3], v[104:107], a[164:167], v[0:3]
    v_mfma_f32_16x16x32_bf16 v[20:23], v[120:123], a[164:167], v[20:23]
    v_mfma_f32_16x16x32_bf16 v[0:3], v[108:111], a[168:171], v[0:3]
    v_mfma_f32_16x16x32_bf16 v[20:23], v[124:127], a[168:171], v[20:23]
    v_mfma_f32_16x16x32_bf16 v[0:3], v[112:115], a[172:175], v[0:3]
    v_mfma_f32_16x16x32_bf16 v[20:23], v[128:131], a[172:175], v[20:23]
    v_mfma_f32_16x16x32_bf16 v[4:7], v[100:103], a[176:179], v[168:171]
    v_mfma_f32_16x16x32_bf16 v[24:27], v[116:119], a[176:179], v[168:171]
    v_mfma_f32_16x16x32_bf16 v[4:7], v[104:107], a[180:183], v[4:7]
    v_mfma_f32_16x16x32_bf16 v[24:27], v[120:123], a[180:183], v[24:27]
    v_mfma_f32_16x16x32_bf16 v[4:7], v[108:111], a[184:187], v[4:7]
    v_mfma_f32_16x16x32_bf16 v[24:27], v[124:127], a[184:187], v[24:27]
    v_mfma_f32_16x16x32_bf16 v[4:7], v[112:115], a[188:191], v[4:7]
    v_mfma_f32_16x16x32_bf16 v[24:27], v[128:131], a[188:191], v[24:27]
    s_add_u32 m0, s30, 0
    s_nop 0
    buffer_load_dwordx4 v230, s[36:39], s64 offen offset:0 nt lds
    buffer_load_dwordx4 v231, s[36:39], s64 offen offset:1024 nt lds
    v_mfma_f32_16x16x32_bf16 v[8:11], v[100:103], a[192:195], v[172:175]
    v_mfma_f32_16x16x32_bf16 v[28:31], v[116:119], a[192:195], v[172:175]
    v_mfma_f32_16x16x32_bf16 v[8:11], v[104:107], a[196:199], v[8:11]
    v_mfma_f32_16x16x32_bf16 v[28:31], v[120:123], a[196:199], v[28:31]
    v_mfma_f32_16x16x32_bf16 v[8:11], v[108:111], a[200:203], v[8:11]
    v_mfma_f32_16x16x32_bf16 v[28:31], v[124:127], a[200:203], v[28:31]
    v_mfma_f32_16x16x32_bf16 v[8:11], v[112:115], a[204:207], v[8:11]
    v_mfma_f32_16x16x32_bf16 v[28:31], v[128:131], a[204:207], v[28:31]
    buffer_load_dwordx4 v232, s[36:39], s64 offen offset:2048 nt lds
    buffer_load_dwordx4 v233, s[36:39], s64 offen offset:3072 nt lds
    s_add_u32 s64, s64, 8192
    s_and_b32 s64, s64, 262143
    v_mfma_f32_16x16x32_bf16 v[12:15], v[100:103], a[208:211], v[176:179]
    v_mfma_f32_16x16x32_bf16 v[32:35], v[116:119], a[208:211], v[176:179]
    s_add_u32 m0, s30, 49152
    s_nop 0
    buffer_load_dwordx4 v234, s[40:43], s65 offen offset:0 nt lds
    v_mfma_f32_16x16x32_bf16 v[12:15], v[104:107], a[212:215], v[12:15]
    v_mfma_f32_16x16x32_bf16 v[32:35], v[120:123], a[212:215], v[32:35]
    v_max3_f32 v208, v0, v1, v2
    v_mfma_f32_16x16x32_bf16 v[12:15], v[108:111], a[216:219], v[12:15]
    v_max3_f32 v208, v208, v3, v20
    v_mfma_f32_16x16x32_bf16 v[32:35], v[124:127], a[216:219], v[32:35]
    v_mfma_f32_16x16x32_bf16 v[12:15], v[112:115], a[220:223], v[12:15]
    v_max3_f32 v208, v208, v21, v22
    v_mfma_f32_16x16x32_bf16 v[32:35], v[128:131], a[220:223], v[32:35]
    v_max_f32 v208, v208, v23
    buffer_load_dwordx4 v234, s[40:43], s65 offen offset:1024 nt lds
    v_max3_f32 v209, v4, v5, v6
    v_max3_f32 v209, v209, v7, v24
    v_max3_f32 v209, v209, v25, v26
    v_max_f32 v209, v209, v27
    v_mfma_f32_16x16x32_bf16 v[16:19], v[100:103], a[224:227], v[180:183]
    v_mfma_f32_16x16x32_bf16 v[36:39], v[116:119], a[224:227], v[180:183]
    buffer_load_dwordx4 v234, s[40:43], s65 offen offset:2048 nt lds
    v_mfma_f32_16x16x32_bf16 v[16:19], v[104:107], a[228:231], v[16:19]
    v_mfma_f32_16x16x32_bf16 v[36:39], v[120:123], a[228:231], v[36:39]
    v_max3_f32 v210, v8, v9, v10
    v_mfma_f32_16x16x32_bf16 v[16:19], v[108:111], a[232:235], v[16:19]
    v_max3_f32 v210, v210, v11, v28
    v_mfma_f32_16x16x32_bf16 v[36:39], v[124:127], a[232:235], v[36:39]
    v_mfma_f32_16x16x32_bf16 v[16:19], v[112:115], a[236:239], v[16:19]
    v_max3_f32 v210, v210, v29, v30
    v_mfma_f32_16x16x32_bf16 v[36:39], v[128:131], a[236:239], v[36:39]
    v_max_f32 v210, v210, v31
    buffer_load_dwordx4 v234, s[40:43], s65 offen offset:3072 nt lds
    s_add_u32 s65, s65, 8192
    s_and_b32 s65, s65, 262143
    ds_read_b128 v[100:103], v218 offset:8192
    ds_read_b128 v[104:107], v219 offset:8192
    ds_read_b128 v[108:111], v220 offset:8192
    ds_read_b128 v[112:115], v221 offset:8192
    ds_read_b128 v[116:119], v218 offset:12288
    ds_read_b128 v[120:123], v219 offset:12288
    ds_read_b128 v[124:127], v220 offset:12288
    ds_read_b128 v[128:131], v221 offset:12288
    v_max3_f32 v211, v12, v13, v14
    v_max3_f32 v211, v211, v15, v32
    v_max3_f32 v211, v211, v33, v34
    v_max_f32 v211, v211, v35
    v_max3_f32 v212, v16, v17, v18
    v_max3_f32 v212, v212, v19, v36
    v_max3_f32 v212, v212, v37, v38
    v_max_f32 v212, v212, v39
    v_mov_b32 v213, v208
    s_nop 1
    v_permlane32_swap_b32 v213, v208
    v_max_f32 v208, v208, v213
    v_mov_b32 v213, v208
    s_nop 1
    v_permlane16_swap_b32 v213, v208
    v_max_f32 v208, v208, v213
    v_mov_b32 v214, v209
    s_nop 1
    v_permlane32_swap_b32 v214, v209
    v_max_f32 v209, v209, v214
    v_mov_b32 v214, v209
    s_nop 1
    v_permlane16_swap_b32 v214, v209
    v_max_f32 v209, v209, v214
    v_mov_b32 v215, v210
    s_nop 1
    v_permlane32_swap_b32 v215, v210
    v_max_f32 v210, v210, v215
    v_mov_b32 v215, v210
    s_nop 1
    v_permlane16_swap_b32 v215, v210
    v_max_f32 v210, v210, v215
    v_mov_b32 v216, v211
    s_nop 1
    v_permlane32_swap_b32 v216, v211
    v_max_f32 v211, v211, v216
    v_mov_b32 v216, v211
    s_nop 1
    v_permlane16_swap_b32 v216, v211
    v_max_f32 v211, v211, v216
    v_mov_b32 v217, v212
    s_nop 1
    v_permlane32_swap_b32 v217, v212
    v_max_f32 v212, v212, v217
    v_mov_b32 v217, v212
    s_nop 1
    v_permlane16_swap_b32 v217, v212
    v_max_f32 v212, v212, v217
    v_sub_f32 v164, 0, v208
    v_sub_f32 v165, 0, v208
    v_sub_f32 v166, 0, v208
    v_sub_f32 v167, 0, v208
    v_sub_f32 v0, v0, v208
    v_sub_f32 v1, v1, v208
    v_sub_f32 v2, v2, v208
    v_sub_f32 v3, v3, v208
    v_sub_f32 v20, v20, v208
    v_sub_f32 v21, v21, v208
    v_sub_f32 v22, v22, v208
    v_sub_f32 v23, v23, v208
    v_sub_f32 v168, 0, v209
    v_sub_f32 v169, 0, v209
    v_sub_f32 v170, 0, v209
    v_sub_f32 v171, 0, v209
    v_sub_f32 v4, v4, v209
    v_sub_f32 v5, v5, v209
    v_sub_f32 v6, v6, v209
    v_sub_f32 v7, v7, v209
    v_sub_f32 v24, v24, v209
    v_sub_f32 v25, v25, v209
    v_sub_f32 v26, v26, v209
    v_sub_f32 v27, v27, v209
    v_sub_f32 v172, 0, v210
    v_sub_f32 v173, 0, v210
    v_sub_f32 v174, 0, v210
    v_sub_f32 v175, 0, v210
    v_sub_f32 v8, v8, v210
    v_sub_f32 v9, v9, v210
    v_sub_f32 v10, v10, v210
    v_sub_f32 v11, v11, v210
    v_sub_f32 v28, v28, v210
    v_sub_f32 v29, v29, v210
    v_sub_f32 v30, v30, v210
    v_sub_f32 v31, v31, v210
    v_sub_f32 v176, 0, v211
    v_sub_f32 v177, 0, v211
    v_sub_f32 v178, 0, v211
    v_sub_f32 v179, 0, v211
    v_sub_f32 v12, v12, v211
    v_sub_f32 v13, v13, v211
    v_sub_f32 v14, v14, v211
    v_sub_f32 v15, v15, v211
    v_sub_f32 v32, v32, v211
    v_sub_f32 v33, v33, v211
    v_sub_f32 v34, v34, v211
    v_sub_f32 v35, v35, v211
    v_sub_f32 v180, 0, v212
    v_sub_f32 v181, 0, v212
    v_sub_f32 v182, 0, v212
    v_sub_f32 v183, 0, v212
    v_sub_f32 v16, v16, v212
    v_sub_f32 v17, v17, v212
    v_sub_f32 v18, v18, v212
    v_sub_f32 v19, v19, v212
    v_sub_f32 v36, v36, v212
    v_sub_f32 v37, v37, v212
    v_sub_f32 v38, v38, v212
    v_sub_f32 v39, v39, v212
    s_mov_b32 s66, 0
K1_LOOP:
    s_waitcnt vmcnt(16) lgkmcnt(0)
    s_barrier
    v_mfma_f32_16x16x32_bf16 v[40:43], v[100:103], a[160:163], v[164:167]
    ds_read_b64_tr_b16 v[132:133], v222 offset:32768
    ds_read_b64_tr_b16 v[134:135], v222 offset:36864
    v_mfma_f32_16x16x32_bf16 v[60:63], v[116:119], a[160:163], v[164:167]
    ds_read_b64_tr_b16 v[136:137], v222 offset:32776
    ds_read_b64_tr_b16 v[138:139], v222 offset:36872
    ds_read_b64_tr_b16 v[140:141], v223 offset:32768
    v_mfma_f32_16x16x32_bf16 v[40:43], v[104:107], a[164:167], v[40:43]
    ds_read_b64_tr_b16 v[142:143], v223 offset:36864
    ds_read_b64_tr_b16 v[144:145], v223 offset:32776
    v_mfma_f32_16x16x32_bf16 v[60:63], v[120:123], a[164:167], v[60:63]
    ds_read_b64_tr_b16 v[146:147], v223 offset:36872
    v_exp_f32 v0, v0
    v_exp_f32 v1, v1
    v_mfma_f32_16x16x32_bf16 v[40:43], v[108:111], a[168:171], v[40:43]
    v_exp_f32 v2, v2
    v_exp_f32 v3, v3
    v_mfma_f32_16x16x32_bf16 v[60:63], v[124:127], a[168:171], v[60:63]
    v_exp_f32 v20, v20
    v_exp_f32 v21, v21
    v_exp_f32 v22, v22
    v_mfma_f32_16x16x32_bf16 v[40:43], v[112:115], a[172:175], v[40:43]
    v_exp_f32 v23, v23
    v_cvt_pk_bf16_f32 v80, v0, v1
    v_mfma_f32_16x16x32_bf16 v[60:63], v[128:131], a[172:175], v[60:63]
    v_cvt_pk_bf16_f32 v81, v2, v3
    v_cvt_pk_bf16_f32 v82, v20, v21
    v_cvt_pk_bf16_f32 v83, v22, v23
    v_mfma_f32_16x16x32_bf16 v[44:47], v[100:103], a[176:179], v[168:171]
    s_add_u32 m0, s30, 8192
    s_nop 0
    buffer_load_dwordx4 v230, s[36:39], s64 offen offset:0 nt lds
    ds_read_b64_tr_b16 v[148:149], v224 offset:32768
    v_mfma_f32_16x16x32_bf16 v[64:67], v[116:119], a[176:179], v[168:171]
    ds_read_b64_tr_b16 v[150:151], v224 offset:36864
    ds_read_b64_tr_b16 v[152:153], v224 offset:32776
    ds_read_b64_tr_b16 v[154:155], v224 offset:36872
    v_mfma_f32_16x16x32_bf16 v[44:47], v[104:107], a[180:183], v[44:47]
    ds_read_b64_tr_b16 v[156:157], v225 offset:32768
    ds_read_b64_tr_b16 v[158:159], v225 offset:36864
    v_mfma_f32_16x16x32_bf16 v[64:67], v[120:123], a[180:183], v[64:67]
    ds_read_b64_tr_b16 v[160:161], v225 offset:32776
    ds_read_b64_tr_b16 v[162:163], v225 offset:36872
    v_exp_f32 v4, v4
    v_mfma_f32_16x16x32_bf16 v[44:47], v[108:111], a[184:187], v[44:47]
    v_exp_f32 v5, v5
    v_exp_f32 v6, v6
    v_exp_f32 v7, v7
    v_mfma_f32_16x16x32_bf16 v[64:67], v[124:127], a[184:187], v[64:67]
    v_exp_f32 v24, v24
    v_exp_f32 v25, v25
    v_mfma_f32_16x16x32_bf16 v[44:47], v[112:115], a[188:191], v[44:47]
    v_exp_f32 v26, v26
    v_exp_f32 v27, v27
    v_cvt_pk_bf16_f32 v84, v4, v5
    v_mfma_f32_16x16x32_bf16 v[64:67], v[128:131], a[188:191], v[64:67]
    v_cvt_pk_bf16_f32 v85, v6, v7
    v_cvt_pk_bf16_f32 v86, v24, v25
    v_cvt_pk_bf16_f32 v87, v26, v27
    s_waitcnt lgkmcnt(14)
    v_mfma_f32_16x16x32_bf16 a[0:3], v[132:135], v[80:83], a[0:3]
    buffer_load_dwordx4 v231, s[36:39], s64 offen offset:1024 nt lds
    s_waitcnt lgkmcnt(12)
    v_mfma_f32_16x16x32_bf16 a[20:23], v[136:139], v[80:83], a[20:23]
    v_exp_f32 v8, v8
    s_waitcnt lgkmcnt(10)
    v_mfma_f32_16x16x32_bf16 a[40:43], v[140:143], v[80:83], a[40:43]
    v_exp_f32 v9, v9
    v_exp_f32 v10, v10
    s_waitcnt lgkmcnt(8)
    v_mfma_f32_16x16x32_bf16 a[60:63], v[144:147], v[80:83], a[60:63]
    v_exp_f32 v11, v11
    s_waitcnt lgkmcnt(6)
    v_mfma_f32_16x16x32_bf16 a[80:83], v[148:151], v[80:83], a[80:83]
    v_exp_f32 v28, v28
    v_exp_f32 v29, v29
    s_waitcnt lgkmcnt(4)
    v_mfma_f32_16x16x32_bf16 a[100:103], v[152:155], v[80:83], a[100:103]
    v_exp_f32 v30, v30
    s_waitcnt lgkmcnt(2)
    v_mfma_f32_16x16x32_bf16 a[120:123], v[156:159], v[80:83], a[120:123]
    v_exp_f32 v31, v31
    v_cvt_pk_bf16_f32 v88, v8, v9
    s_waitcnt lgkmcnt(0)
    v_mfma_f32_16x16x32_bf16 a[140:143], v[160:163], v[80:83], a[140:143]
    v_cvt_pk_bf16_f32 v89, v10, v11
    v_mfma_f32_16x16x32_bf16 v[184:187], v[204:207], v[80:83], v[184:187]
    v_cvt_pk_bf16_f32 v90, v28, v29
    v_cvt_pk_bf16_f32 v91, v30, v31
    v_mfma_f32_16x16x32_bf16 v[48:51], v[100:103], a[192:195], v[172:175]
    buffer_load_dwordx4 v232, s[36:39], s64 offen offset:2048 nt lds
    v_mfma_f32_16x16x32_bf16 v[68:71], v[116:119], a[192:195], v[172:175]
    v_exp_f32 v12, v12
    v_exp_f32 v13, v13
    v_mfma_f32_16x16x32_bf16 v[48:51], v[104:107], a[196:199], v[48:51]
    v_exp_f32 v14, v14
    v_mfma_f32_16x16x32_bf16 v[68:71], v[120:123], a[196:199], v[68:71]
    v_exp_f32 v15, v15
    v_exp_f32 v32, v32
    v_mfma_f32_16x16x32_bf16 v[48:51], v[108:111], a[200:203], v[48:51]
    v_exp_f32 v33, v33
    v_exp_f32 v34, v34
    v_mfma_f32_16x16x32_bf16 v[68:71], v[124:127], a[200:203], v[68:71]
    v_exp_f32 v35, v35
    v_mfma_f32_16x16x32_bf16 v[48:51], v[112:115], a[204:207], v[48:51]
    v_cvt_pk_bf16_f32 v92, v12, v13
    v_cvt_pk_bf16_f32 v93, v14, v15
    v_mfma_f32_16x16x32_bf16 v[68:71], v[128:131], a[204:207], v[68:71]
    v_cvt_pk_bf16_f32 v94, v32, v33
    v_cvt_pk_bf16_f32 v95, v34, v35
    v_mfma_f32_16x16x32_bf16 a[4:7], v[132:135], v[84:87], a[4:7]
    buffer_load_dwordx4 v233, s[36:39], s64 offen offset:3072 nt lds
    s_add_u32 s64, s64, 8192
    s_and_b32 s64, s64, 262143
    v_mfma_f32_16x16x32_bf16 a[24:27], v[136:139], v[84:87], a[24:27]
    v_exp_f32 v16, v16
    v_mfma_f32_16x16x32_bf16 a[44:47], v[140:143], v[84:87], a[44:47]
    v_exp_f32 v17, v17
    v_exp_f32 v18, v18
    v_mfma_f32_16x16x32_bf16 a[64:67], v[144:147], v[84:87], a[64:67]
    v_exp_f32 v19, v19
    v_mfma_f32_16x16x32_bf16 a[84:87], v[148:151], v[84:87], a[84:87]
    v_exp_f32 v36, v36
    v_exp_f32 v37, v37
    v_mfma_f32_16x16x32_bf16 a[104:107], v[152:155], v[84:87], a[104:107]
    v_exp_f32 v38, v38
    v_mfma_f32_16x16x32_bf16 a[124:127], v[156:159], v[84:87], a[124:127]
    v_exp_f32 v39, v39
    v_cvt_pk_bf16_f32 v96, v16, v17
    v_mfma_f32_16x16x32_bf16 a[144:147], v[160:163], v[84:87], a[144:147]
    v_cvt_pk_bf16_f32 v97, v18, v19
    v_mfma_f32_16x16x32_bf16 v[188:191], v[204:207], v[84:87], v[188:191]
    v_cvt_pk_bf16_f32 v98, v36, v37
    v_cvt_pk_bf16_f32 v99, v38, v39
    v_mfma_f32_16x16x32_bf16 v[52:55], v[100:103], a[208:211], v[176:179]
    v_mfma_f32_16x16x32_bf16 v[72:75], v[116:119], a[208:211], v[176:179]
    s_add_u32 m0, s30, 57344
    s_nop 0
    buffer_load_dwordx4 v234, s[40:43], s65 offen offset:0 nt lds
    v_mfma_f32_16x16x32_bf16 v[52:55], v[104:107], a[212:215], v[52:55]
    v_mfma_f32_16x16x32_bf16 v[72:75], v[120:123], a[212:215], v[72:75]
    v_max3_f32 v208, v40, v41, v42
    v_mfma_f32_16x16x32_bf16 v[52:55], v[108:111], a[216:219], v[52:55]
    v_max3_f32 v208, v208, v43, v60
    v_mfma_f32_16x16x32_bf16 v[72:75], v[124:127], a[216:219], v[72:75]
    v_mfma_f32_16x16x32_bf16 v[52:55], v[112:115], a[220:223], v[52:55]
    v_max3_f32 v208, v208, v61, v62
    v_mfma_f32_16x16x32_bf16 v[72:75], v[128:131], a[220:223], v[72:75]
    v_max_f32 v208, v208, v63
    v_mfma_f32_16x16x32_bf16 a[8:11], v[132:135], v[88:91], a[8:11]
    v_mfma_f32_16x16x32_bf16 a[28:31], v[136:139], v[88:91], a[28:31]
    buffer_load_dwordx4 v234, s[40:43], s65 offen offset:1024 nt lds
    v_mfma_f32_16x16x32_bf16 a[48:51], v[140:143], v[88:91], a[48:51]
    v_mfma_f32_16x16x32_bf16 a[68:71], v[144:147], v[88:91], a[68:71]
    v_max3_f32 v209, v44, v45, v46
    v_mfma_f32_16x16x32_bf16 a[88:91], v[148:151], v[88:91], a[88:91]
    v_mfma_f32_16x16x32_bf16 a[108:111], v[152:155], v[88:91], a[108:111]
    v_max3_f32 v209, v209, v47, v64
    v_mfma_f32_16x16x32_bf16 a[128:131], v[156:159], v[88:91], a[128:131]
    v_mfma_f32_16x16x32_bf16 a[148:151], v[160:163], v[88:91], a[148:151]
    v_max3_f32 v209, v209, v65, v66
    v_mfma_f32_16x16x32_bf16 v[192:195], v[204:207], v[88:91], v[192:195]
    v_max_f32 v209, v209, v67
    v_mfma_f32_16x16x32_bf16 v[56:59], v[100:103], a[224:227], v[180:183]
    v_mfma_f32_16x16x32_bf16 v[76:79], v[116:119], a[224:227], v[180:183]
    buffer_load_dwordx4 v234, s[40:43], s65 offen offset:2048 nt lds
    v_mfma_f32_16x16x32_bf16 v[56:59], v[104:107], a[228:231], v[56:59]
    v_mfma_f32_16x16x32_bf16 v[76:79], v[120:123], a[228:231], v[76:79]
    v_max3_f32 v210, v48, v49, v50
    v_mfma_f32_16x16x32_bf16 v[56:59], v[108:111], a[232:235], v[56:59]
    v_max3_f32 v210, v210, v51, v68
    v_mfma_f32_16x16x32_bf16 v[76:79], v[124:127], a[232:235], v[76:79]
    v_mfma_f32_16x16x32_bf16 v[56:59], v[112:115], a[236:239], v[56:59]
    v_max3_f32 v210, v210, v69, v70
    v_mfma_f32_16x16x32_bf16 v[76:79], v[128:131], a[236:239], v[76:79]
    v_max_f32 v210, v210, v71
    v_mfma_f32_16x16x32_bf16 a[12:15], v[132:135], v[92:95], a[12:15]
    buffer_load_dwordx4 v234, s[40:43], s65 offen offset:3072 nt lds
    s_add_u32 s65, s65, 8192
    s_and_b32 s65, s65, 262143
    v_mfma_f32_16x16x32_bf16 a[32:35], v[136:139], v[92:95], a[32:35]
    ds_read_b128 v[100:103], v218 offset:16384
    v_mfma_f32_16x16x32_bf16 a[52:55], v[140:143], v[92:95], a[52:55]
    ds_read_b128 v[104:107], v219 offset:16384
    v_mfma_f32_16x16x32_bf16 a[72:75], v[144:147], v[92:95], a[72:75]
    ds_read_b128 v[108:111], v220 offset:16384
    v_mfma_f32_16x16x32_bf16 a[92:95], v[148:151], v[92:95], a[92:95]
    ds_read_b128 v[112:115], v221 offset:16384
    v_mfma_f32_16x16x32_bf16 a[112:115], v[152:155], v[92:95], a[112:115]
    ds_read_b128 v[116:119], v218 offset:20480
    v_mfma_f32_16x16x32_bf16 a[132:135], v[156:159], v[92:95], a[132:135]
    ds_read_b128 v[120:123], v219 offset:20480
    v_mfma_f32_16x16x32_bf16 a[152:155], v[160:163], v[92:95], a[152:155]
    ds_read_b128 v[124:127], v220 offset:20480
    v_mfma_f32_16x16x32_bf16 v[196:199], v[204:207], v[92:95], v[196:199]
    ds_read_b128 v[128:131], v221 offset:20480
    v_mfma_f32_16x16x32_bf16 a[16:19], v[132:135], v[96:99], a[16:19]
    v_mfma_f32_16x16x32_bf16 a[36:39], v[136:139], v[96:99], a[36:39]
    v_max3_f32 v211, v52, v53, v54
    v_mfma_f32_16x16x32_bf16 a[56:59], v[140:143], v[96:99], a[56:59]
    v_max3_f32 v211, v211, v55, v72
    v_mfma_f32_16x16x32_bf16 a[76:79], v[144:147], v[96:99], a[76:79]
    v_max3_f32 v211, v211, v73, v74
    v_mfma_f32_16x16x32_bf16 a[96:99], v[148:151], v[96:99], a[96:99]
    v_max_f32 v211, v211, v75
    v_mfma_f32_16x16x32_bf16 a[116:119], v[152:155], v[96:99], a[116:119]
    v_max3_f32 v212, v56, v57, v58
    v_mfma_f32_16x16x32_bf16 a[136:139], v[156:159], v[96:99], a[136:139]
    v_max3_f32 v212, v212, v59, v76
    v_mfma_f32_16x16x32_bf16 a[156:159], v[160:163], v[96:99], a[156:159]
    v_max3_f32 v212, v212, v77, v78
    v_mfma_f32_16x16x32_bf16 v[200:203], v[204:207], v[96:99], v[200:203]
    v_max_f32 v212, v212, v79
    v_max3_f32 v242, v208, v209, v210
    v_max3_f32 v242, v242, v211, v212
    v_cmp_gt_f32 s[70:71], v242, s72
    s_nop 3
    s_cmp_lg_u64 s[70:71], 0
    s_cbranch_scc1 K1_RESC0
K1_RESC0_RET:
    s_waitcnt vmcnt(16) lgkmcnt(0)
    s_barrier
    v_mfma_f32_16x16x32_bf16 v[0:3], v[100:103], a[160:163], v[164:167]
    ds_read_b64_tr_b16 v[132:133], v222 offset:40960
    ds_read_b64_tr_b16 v[134:135], v222 offset:45056
    v_mfma_f32_16x16x32_bf16 v[20:23], v[116:119], a[160:163], v[164:167]
    ds_read_b64_tr_b16 v[136:137], v222 offset:40968
    ds_read_b64_tr_b16 v[138:139], v222 offset:45064
    ds_read_b64_tr_b16 v[140:141], v223 offset:40960
    v_mfma_f32_16x16x32_bf16 v[0:3], v[104:107], a[164:167], v[0:3]
    ds_read_b64_tr_b16 v[142:143], v223 offset:45056
    ds_read_b64_tr_b16 v[144:145], v223 offset:40968
    v_mfma_f32_16x16x32_bf16 v[20:23], v[120:123], a[164:167], v[20:23]
    ds_read_b64_tr_b16 v[146:147], v223 offset:45064
    v_exp_f32 v40, v40
    v_exp_f32 v41, v41
    v_mfma_f32_16x16x32_bf16 v[0:3], v[108:111], a[168:171], v[0:3]
    v_exp_f32 v42, v42
    v_exp_f32 v43, v43
    v_mfma_f32_16x16x32_bf16 v[20:23], v[124:127], a[168:171], v[20:23]
    v_exp_f32 v60, v60
    v_exp_f32 v61, v61
    v_exp_f32 v62, v62
    v_mfma_f32_16x16x32_bf16 v[0:3], v[112:115], a[172:175], v[0:3]
    v_exp_f32 v63, v63
    v_cvt_pk_bf16_f32 v80, v40, v41
    v_mfma_f32_16x16x32_bf16 v[20:23], v[128:131], a[172:175], v[20:23]
    v_cvt_pk_bf16_f32 v81, v42, v43
    v_cvt_pk_bf16_f32 v82, v60, v61
    v_cvt_pk_bf16_f32 v83, v62, v63
    v_mfma_f32_16x16x32_bf16 v[4:7], v[100:103], a[176:179], v[168:171]
    s_add_u32 m0, s30, 16384
    s_nop 0
    buffer_load_dwordx4 v230, s[36:39], s64 offen offset:0 nt lds
    ds_read_b64_tr_b16 v[148:149], v224 offset:40960
    v_mfma_f32_16x16x32_bf16 v[24:27], v[116:119], a[176:179], v[168:171]
    ds_read_b64_tr_b16 v[150:151], v224 offset:45056
    ds_read_b64_tr_b16 v[152:153], v224 offset:40968
    ds_read_b64_tr_b16 v[154:155], v224 offset:45064
    v_mfma_f32_16x16x32_bf16 v[4:7], v[104:107], a[180:183], v[4:7]
    ds_read_b64_tr_b16 v[156:157], v225 offset:40960
    ds_read_b64_tr_b16 v[158:159], v225 offset:45056
    v_mfma_f32_16x16x32_bf16 v[24:27], v[120:123], a[180:183], v[24:27]
    ds_read_b64_tr_b16 v[160:161], v225 offset:40968
    ds_read_b64_tr_b16 v[162:163], v225 offset:45064
    v_exp_f32 v44, v44
    v_mfma_f32_16x16x32_bf16 v[4:7], v[108:111], a[184:187], v[4:7]
    v_exp_f32 v45, v45
    v_exp_f32 v46, v46
    v_exp_f32 v47, v47
    v_mfma_f32_16x16x32_bf16 v[24:27], v[124:127], a[184:187], v[24:27]
    v_exp_f32 v64, v64
    v_exp_f32 v65, v65
    v_mfma_f32_16x16x32_bf16 v[4:7], v[112:115], a[188:191], v[4:7]
    v_exp_f32 v66, v66
    v_exp_f32 v67, v67
    v_cvt_pk_bf16_f32 v84, v44, v45
    v_mfma_f32_16x16x32_bf16 v[24:27], v[128:131], a[188:191], v[24:27]
    v_cvt_pk_bf16_f32 v85, v46, v47
    v_cvt_pk_bf16_f32 v86, v64, v65
    v_cvt_pk_bf16_f32 v87, v66, v67
    s_waitcnt lgkmcnt(14)
    v_mfma_f32_16x16x32_bf16 a[0:3], v[132:135], v[80:83], a[0:3]
    buffer_load_dwordx4 v231, s[36:39], s64 offen offset:1024 nt lds
    s_waitcnt lgkmcnt(12)
    v_mfma_f32_16x16x32_bf16 a[20:23], v[136:139], v[80:83], a[20:23]
    v_exp_f32 v48, v48
    s_waitcnt lgkmcnt(10)
    v_mfma_f32_16x16x32_bf16 a[40:43], v[140:143], v[80:83], a[40:43]
    v_exp_f32 v49, v49
    v_exp_f32 v50, v50
    s_waitcnt lgkmcnt(8)
    v_mfma_f32_16x16x32_bf16 a[60:63], v[144:147], v[80:83], a[60:63]
    v_exp_f32 v51, v51
    s_waitcnt lgkmcnt(6)
    v_mfma_f32_16x16x32_bf16 a[80:83], v[148:151], v[80:83], a[80:83]
    v_exp_f32 v68, v68
    v_exp_f32 v69, v69
    s_waitcnt lgkmcnt(4)
    v_mfma_f32_16x16x32_bf16 a[100:103], v[152:155], v[80:83], a[100:103]
    v_exp_f32 v70, v70
    s_waitcnt lgkmcnt(2)
    v_mfma_f32_16x16x32_bf16 a[120:123], v[156:159], v[80:83], a[120:123]
    v_exp_f32 v71, v71
    v_cvt_pk_bf16_f32 v88, v48, v49
    s_waitcnt lgkmcnt(0)
    v_mfma_f32_16x16x32_bf16 a[140:143], v[160:163], v[80:83], a[140:143]
    v_cvt_pk_bf16_f32 v89, v50, v51
    v_mfma_f32_16x16x32_bf16 v[184:187], v[204:207], v[80:83], v[184:187]
    v_cvt_pk_bf16_f32 v90, v68, v69
    v_cvt_pk_bf16_f32 v91, v70, v71
    v_mfma_f32_16x16x32_bf16 v[8:11], v[100:103], a[192:195], v[172:175]
    buffer_load_dwordx4 v232, s[36:39], s64 offen offset:2048 nt lds
    v_mfma_f32_16x16x32_bf16 v[28:31], v[116:119], a[192:195], v[172:175]
    v_exp_f32 v52, v52
    v_exp_f32 v53, v53
    v_mfma_f32_16x16x32_bf16 v[8:11], v[104:107], a[196:199], v[8:11]
    v_exp_f32 v54, v54
    v_mfma_f32_16x16x32_bf16 v[28:31], v[120:123], a[196:199], v[28:31]
    v_exp_f32 v55, v55
    v_exp_f32 v72, v72
    v_mfma_f32_16x16x32_bf16 v[8:11], v[108:111], a[200:203], v[8:11]
    v_exp_f32 v73, v73
    v_exp_f32 v74, v74
    v_mfma_f32_16x16x32_bf16 v[28:31], v[124:127], a[200:203], v[28:31]
    v_exp_f32 v75, v75
    v_mfma_f32_16x16x32_bf16 v[8:11], v[112:115], a[204:207], v[8:11]
    v_cvt_pk_bf16_f32 v92, v52, v53
    v_cvt_pk_bf16_f32 v93, v54, v55
    v_mfma_f32_16x16x32_bf16 v[28:31], v[128:131], a[204:207], v[28:31]
    v_cvt_pk_bf16_f32 v94, v72, v73
    v_cvt_pk_bf16_f32 v95, v74, v75
    v_mfma_f32_16x16x32_bf16 a[4:7], v[132:135], v[84:87], a[4:7]
    buffer_load_dwordx4 v233, s[36:39], s64 offen offset:3072 nt lds
    s_add_u32 s64, s64, 8192
    s_and_b32 s64, s64, 262143
    v_mfma_f32_16x16x32_bf16 a[24:27], v[136:139], v[84:87], a[24:27]
    v_exp_f32 v56, v56
    v_mfma_f32_16x16x32_bf16 a[44:47], v[140:143], v[84:87], a[44:47]
    v_exp_f32 v57, v57
    v_exp_f32 v58, v58
    v_mfma_f32_16x16x32_bf16 a[64:67], v[144:147], v[84:87], a[64:67]
    v_exp_f32 v59, v59
    v_mfma_f32_16x16x32_bf16 a[84:87], v[148:151], v[84:87], a[84:87]
    v_exp_f32 v76, v76
    v_exp_f32 v77, v77
    v_mfma_f32_16x16x32_bf16 a[104:107], v[152:155], v[84:87], a[104:107]
    v_exp_f32 v78, v78
    v_mfma_f32_16x16x32_bf16 a[124:127], v[156:159], v[84:87], a[124:127]
    v_exp_f32 v79, v79
    v_cvt_pk_bf16_f32 v96, v56, v57
    v_mfma_f32_16x16x32_bf16 a[144:147], v[160:163], v[84:87], a[144:147]
    v_cvt_pk_bf16_f32 v97, v58, v59
    v_mfma_f32_16x16x32_bf16 v[188:191], v[204:207], v[84:87], v[188:191]
    v_cvt_pk_bf16_f32 v98, v76, v77
    v_cvt_pk_bf16_f32 v99, v78, v79
    v_mfma_f32_16x16x32_bf16 v[12:15], v[100:103], a[208:211], v[176:179]
    v_mfma_f32_16x16x32_bf16 v[32:35], v[116:119], a[208:211], v[176:179]
    s_cmp_lg_u32 s66, 7
    s_cbranch_scc1 K1_NSV
    s_mov_b32 s40, s48
    s_mov_b32 s41, s49
    s_mov_b32 s42, s50
    s_mov_b32 s43, s51
    s_mov_b32 s65, s83
K1_NSV:
    s_add_u32 m0, s30, 32768
    s_nop 0
    buffer_load_dwordx4 v234, s[40:43], s65 offen offset:0 nt lds
    v_mfma_f32_16x16x32_bf16 v[12:15], v[104:107], a[212:215], v[12:15]
    v_mfma_f32_16x16x32_bf16 v[32:35], v[120:123], a[212:215], v[32:35]
    v_max3_f32 v208, v0, v1, v2
    v_mfma_f32_16x16x32_bf16 v[12:15], v[108:111], a[216:219], v[12:15]
    v_max3_f32 v208, v208, v3, v20
    v_mfma_f32_16x16x32_bf16 v[32:35], v[124:127], a[216:219], v[32:35]
    v_mfma_f32_16x16x32_bf16 v[12:15], v[112:115], a[220:223], v[12:15]
    v_max3_f32 v208, v208, v21, v22
    v_mfma_f32_16x16x32_bf16 v[32:35], v[128:131], a[220:223], v[32:35]
    v_max_f32 v208, v208, v23
    v_mfma_f32_16x16x32_bf16 a[8:11], v[132:135], v[88:91], a[8:11]
    v_mfma_f32_16x16x32_bf16 a[28:31], v[136:139], v[88:91], a[28:31]
    buffer_load_dwordx4 v234, s[40:43], s65 offen offset:1024 nt lds
    v_mfma_f32_16x16x32_bf16 a[48:51], v[140:143], v[88:91], a[48:51]
    v_mfma_f32_16x16x32_bf16 a[68:71], v[144:147], v[88:91], a[68:71]
    v_max3_f32 v209, v4, v5, v6
    v_mfma_f32_16x16x32_bf16 a[88:91], v[148:151], v[88:91], a[88:91]
    v_mfma_f32_16x16x32_bf16 a[108:111], v[152:155], v[88:91], a[108:111]
    v_max3_f32 v209, v209, v7, v24
    v_mfma_f32_16x16x32_bf16 a[128:131], v[156:159], v[88:91], a[128:131]
    v_mfma_f32_16x16x32_bf16 a[148:151], v[160:163], v[88:91], a[148:151]
    v_max3_f32 v209, v209, v25, v26
    v_mfma_f32_16x16x32_bf16 v[192:195], v[204:207], v[88:91], v[192:195]
    v_max_f32 v209, v209, v27
    v_mfma_f32_16x16x32_bf16 v[16:19], v[100:103], a[224:227], v[180:183]
    v_mfma_f32_16x16x32_bf16 v[36:39], v[116:119], a[224:227], v[180:183]
    buffer_load_dwordx4 v234, s[40:43], s65 offen offset:2048 nt lds
    v_mfma_f32_16x16x32_bf16 v[16:19], v[104:107], a[228:231], v[16:19]
    v_mfma_f32_16x16x32_bf16 v[36:39], v[120:123], a[228:231], v[36:39]
    v_max3_f32 v210, v8, v9, v10
    v_mfma_f32_16x16x32_bf16 v[16:19], v[108:111], a[232:235], v[16:19]
    v_max3_f32 v210, v210, v11, v28
    v_mfma_f32_16x16x32_bf16 v[36:39], v[124:127], a[232:235], v[36:39]
    v_mfma_f32_16x16x32_bf16 v[16:19], v[112:115], a[236:239], v[16:19]
    v_max3_f32 v210, v210, v29, v30
    v_mfma_f32_16x16x32_bf16 v[36:39], v[128:131], a[236:239], v[36:39]
    v_max_f32 v210, v210, v31
    v_mfma_f32_16x16x32_bf16 a[12:15], v[132:135], v[92:95], a[12:15]
    buffer_load_dwordx4 v234, s[40:43], s65 offen offset:3072 nt lds
    s_add_u32 s65, s65, 8192
    s_and_b32 s65, s65, 262143
    v_mfma_f32_16x16x32_bf16 a[32:35], v[136:139], v[92:95], a[32:35]
    ds_read_b128 v[100:103], v218 offset:24576
    v_mfma_f32_16x16x32_bf16 a[52:55], v[140:143], v[92:95], a[52:55]
    ds_read_b128 v[104:107], v219 offset:24576
    v_mfma_f32_16x16x32_bf16 a[72:75], v[144:147], v[92:95], a[72:75]
    ds_read_b128 v[108:111], v220 offset:24576
    v_mfma_f32_16x16x32_bf16 a[92:95], v[148:151], v[92:95], a[92:95]
    ds_read_b128 v[112:115], v221 offset:24576
    v_mfma_f32_16x16x32_bf16 a[112:115], v[152:155], v[92:95], a[112:115]
    ds_read_b128 v[116:119], v218 offset:28672
    v_mfma_f32_16x16x32_bf16 a[132:135], v[156:159], v[92:95], a[132:135]
    ds_read_b128 v[120:123], v219 offset:28672
    v_mfma_f32_16x16x32_bf16 a[152:155], v[160:163], v[92:95], a[152:155]
    ds_read_b128 v[124:127], v220 offset:28672
    v_mfma_f32_16x16x32_bf16 v[196:199], v[204:207], v[92:95], v[196:199]
    ds_read_b128 v[128:131], v221 offset:28672
    v_mfma_f32_16x16x32_bf16 a[16:19], v[132:135], v[96:99], a[16:19]
    v_mfma_f32_16x16x32_bf16 a[36:39], v[136:139], v[96:99], a[36:39]
    v_max3_f32 v211, v12, v13, v14
    v_mfma_f32_16x16x32_bf16 a[56:59], v[140:143], v[96:99], a[56:59]
    v_max3_f32 v211, v211, v15, v32
    v_mfma_f32_16x16x32_bf16 a[76:79], v[144:147], v[96:99], a[76:79]
    v_max3_f32 v211, v211, v33, v34
    v_mfma_f32_16x16x32_bf16 a[96:99], v[148:151], v[96:99], a[96:99]
    v_max_f32 v211, v211, v35
    v_mfma_f32_16x16x32_bf16 a[116:119], v[152:155], v[96:99], a[116:119]
    v_max3_f32 v212, v16, v17, v18
    v_mfma_f32_16x16x32_bf16 a[136:139], v[156:159], v[96:99], a[136:139]
    v_max3_f32 v212, v212, v19, v36
    v_mfma_f32_16x16x32_bf16 a[156:159], v[160:163], v[96:99], a[156:159]
    v_max3_f32 v212, v212, v37, v38
    v_mfma_f32_16x16x32_bf16 v[200:203], v[204:207], v[96:99], v[200:203]
    v_max_f32 v212, v212, v39
    v_max3_f32 v242, v208, v209, v210
    v_max3_f32 v242, v242, v211, v212
    v_cmp_gt_f32 s[70:71], v242, s72
    s_nop 3
    s_cmp_lg_u64 s[70:71], 0
    s_cbranch_scc1 K1_RESC1
K1_RESC1_RET:
    s_waitcnt vmcnt(16) lgkmcnt(0)
    s_barrier
    v_mfma_f32_16x16x32_bf16 v[40:43], v[100:103], a[160:163], v[164:167]
    ds_read_b64_tr_b16 v[132:133], v222 offset:49152
    ds_read_b64_tr_b16 v[134:135], v222 offset:53248
    v_mfma_f32_16x16x32_bf16 v[60:63], v[116:119], a[160:163], v[164:167]
    ds_read_b64_tr_b16 v[136:137], v222 offset:49160
    ds_read_b64_tr_b16 v[138:139], v222 offset:53256
    ds_read_b64_tr_b16 v[140:141], v223 offset:49152
    v_mfma_f32_16x16x32_bf16 v[40:43], v[104:107], a[164:167], v[40:43]
    ds_read_b64_tr_b16 v[142:143], v223 offset:53248
    ds_read_b64_tr_b16 v[144:145], v223 offset:49160
    v_mfma_f32_16x16x32_bf16 v[60:63], v[120:123], a[164:167], v[60:63]
    ds_read_b64_tr_b16 v[146:147], v223 offset:53256
    v_exp_f32 v0, v0
    v_exp_f32 v1, v1
    v_mfma_f32_16x16x32_bf16 v[40:43], v[108:111], a[168:171], v[40:43]
    v_exp_f32 v2, v2
    v_exp_f32 v3, v3
    v_mfma_f32_16x16x32_bf16 v[60:63], v[124:127], a[168:171], v[60:63]
    v_exp_f32 v20, v20
    v_exp_f32 v21, v21
    v_exp_f32 v22, v22
    v_mfma_f32_16x16x32_bf16 v[40:43], v[112:115], a[172:175], v[40:43]
    v_exp_f32 v23, v23
    v_cvt_pk_bf16_f32 v80, v0, v1
    v_mfma_f32_16x16x32_bf16 v[60:63], v[128:131], a[172:175], v[60:63]
    v_cvt_pk_bf16_f32 v81, v2, v3
    v_cvt_pk_bf16_f32 v82, v20, v21
    v_cvt_pk_bf16_f32 v83, v22, v23
    v_mfma_f32_16x16x32_bf16 v[44:47], v[100:103], a[176:179], v[168:171]
    s_add_u32 m0, s30, 24576
    s_nop 0
    buffer_load_dwordx4 v230, s[36:39], s64 offen offset:0 nt lds
    ds_read_b64_tr_b16 v[148:149], v224 offset:49152
    v_mfma_f32_16x16x32_bf16 v[64:67], v[116:119], a[176:179], v[168:171]
    ds_read_b64_tr_b16 v[150:151], v224 offset:53248
    ds_read_b64_tr_b16 v[152:153], v224 offset:49160
    ds_read_b64_tr_b16 v[154:155], v224 offset:53256
    v_mfma_f32_16x16x32_bf16 v[44:47], v[104:107], a[180:183], v[44:47]
    ds_read_b64_tr_b16 v[156:157], v225 offset:49152
    ds_read_b64_tr_b16 v[158:159], v225 offset:53248
    v_mfma_f32_16x16x32_bf16 v[64:67], v[120:123], a[180:183], v[64:67]
    ds_read_b64_tr_b16 v[160:161], v225 offset:49160
    ds_read_b64_tr_b16 v[162:163], v225 offset:53256
    v_exp_f32 v4, v4
    v_mfma_f32_16x16x32_bf16 v[44:47], v[108:111], a[184:187], v[44:47]
    v_exp_f32 v5, v5
    v_exp_f32 v6, v6
    v_exp_f32 v7, v7
    v_mfma_f32_16x16x32_bf16 v[64:67], v[124:127], a[184:187], v[64:67]
    v_exp_f32 v24, v24
    v_exp_f32 v25, v25
    v_mfma_f32_16x16x32_bf16 v[44:47], v[112:115], a[188:191], v[44:47]
    v_exp_f32 v26, v26
    v_exp_f32 v27, v27
    v_cvt_pk_bf16_f32 v84, v4, v5
    v_mfma_f32_16x16x32_bf16 v[64:67], v[128:131], a[188:191], v[64:67]
    v_cvt_pk_bf16_f32 v85, v6, v7
    v_cvt_pk_bf16_f32 v86, v24, v25
    v_cvt_pk_bf16_f32 v87, v26, v27
    s_waitcnt lgkmcnt(14)
    v_mfma_f32_16x16x32_bf16 a[0:3], v[132:135], v[80:83], a[0:3]
    buffer_load_dwordx4 v231, s[36:39], s64 offen offset:1024 nt lds
    s_waitcnt lgkmcnt(12)
    v_mfma_f32_16x16x32_bf16 a[20:23], v[136:139], v[80:83], a[20:23]
    v_exp_f32 v8, v8
    s_waitcnt lgkmcnt(10)
    v_mfma_f32_16x16x32_bf16 a[40:43], v[140:143], v[80:83], a[40:43]
    v_exp_f32 v9, v9
    v_exp_f32 v10, v10
    s_waitcnt lgkmcnt(8)
    v_mfma_f32_16x16x32_bf16 a[60:63], v[144:147], v[80:83], a[60:63]
    v_exp_f32 v11, v11
    s_waitcnt lgkmcnt(6)
    v_mfma_f32_16x16x32_bf16 a[80:83], v[148:151], v[80:83], a[80:83]
    v_exp_f32 v28, v28
    v_exp_f32 v29, v29
    s_waitcnt lgkmcnt(4)
    v_mfma_f32_16x16x32_bf16 a[100:103], v[152:155], v[80:83], a[100:103]
    v_exp_f32 v30, v30
    s_waitcnt lgkmcnt(2)
    v_mfma_f32_16x16x32_bf16 a[120:123], v[156:159], v[80:83], a[120:123]
    v_exp_f32 v31, v31
    v_cvt_pk_bf16_f32 v88, v8, v9
    s_waitcnt lgkmcnt(0)
    v_mfma_f32_16x16x32_bf16 a[140:143], v[160:163], v[80:83], a[140:143]
    v_cvt_pk_bf16_f32 v89, v10, v11
    v_mfma_f32_16x16x32_bf16 v[184:187], v[204:207], v[80:83], v[184:187]
    v_cvt_pk_bf16_f32 v90, v28, v29
    v_cvt_pk_bf16_f32 v91, v30, v31
    v_mfma_f32_16x16x32_bf16 v[48:51], v[100:103], a[192:195], v[172:175]
    buffer_load_dwordx4 v232, s[36:39], s64 offen offset:2048 nt lds
    v_mfma_f32_16x16x32_bf16 v[68:71], v[116:119], a[192:195], v[172:175]
    v_exp_f32 v12, v12
    v_exp_f32 v13, v13
    v_mfma_f32_16x16x32_bf16 v[48:51], v[104:107], a[196:199], v[48:51]
    v_exp_f32 v14, v14
    v_mfma_f32_16x16x32_bf16 v[68:71], v[120:123], a[196:199], v[68:71]
    v_exp_f32 v15, v15
    v_exp_f32 v32, v32
    v_mfma_f32_16x16x32_bf16 v[48:51], v[108:111], a[200:203], v[48:51]
    v_exp_f32 v33, v33
    v_exp_f32 v34, v34
    v_mfma_f32_16x16x32_bf16 v[68:71], v[124:127], a[200:203], v[68:71]
    v_exp_f32 v35, v35
    v_mfma_f32_16x16x32_bf16 v[48:51], v[112:115], a[204:207], v[48:51]
    v_cvt_pk_bf16_f32 v92, v12, v13
    v_cvt_pk_bf16_f32 v93, v14, v15
    v_mfma_f32_16x16x32_bf16 v[68:71], v[128:131], a[204:207], v[68:71]
    v_cvt_pk_bf16_f32 v94, v32, v33
    v_cvt_pk_bf16_f32 v95, v34, v35
    v_mfma_f32_16x16x32_bf16 a[4:7], v[132:135], v[84:87], a[4:7]
    buffer_load_dwordx4 v233, s[36:39], s64 offen offset:3072 nt lds
    s_add_u32 s64, s64, 8192
    s_and_b32 s64, s64, 262143
    v_mfma_f32_16x16x32_bf16 a[24:27], v[136:139], v[84:87], a[24:27]
    v_exp_f32 v16, v16
    v_mfma_f32_16x16x32_bf16 a[44:47], v[140:143], v[84:87], a[44:47]
    v_exp_f32 v17, v17
    v_exp_f32 v18, v18
    v_mfma_f32_16x16x32_bf16 a[64:67], v[144:147], v[84:87], a[64:67]
    v_exp_f32 v19, v19
    v_mfma_f32_16x16x32_bf16 a[84:87], v[148:151], v[84:87], a[84:87]
    v_exp_f32 v36, v36
    v_exp_f32 v37, v37
    v_mfma_f32_16x16x32_bf16 a[104:107], v[152:155], v[84:87], a[104:107]
    v_exp_f32 v38, v38
    v_mfma_f32_16x16x32_bf16 a[124:127], v[156:159], v[84:87], a[124:127]
    v_exp_f32 v39, v39
    v_cvt_pk_bf16_f32 v96, v16, v17
    v_mfma_f32_16x16x32_bf16 a[144:147], v[160:163], v[84:87], a[144:147]
    v_cvt_pk_bf16_f32 v97, v18, v19
    v_mfma_f32_16x16x32_bf16 v[188:191], v[204:207], v[84:87], v[188:191]
    v_cvt_pk_bf16_f32 v98, v36, v37
    v_cvt_pk_bf16_f32 v99, v38, v39
    v_mfma_f32_16x16x32_bf16 v[52:55], v[100:103], a[208:211], v[176:179]
    v_mfma_f32_16x16x32_bf16 v[72:75], v[116:119], a[208:211], v[176:179]
    s_add_u32 m0, s30, 40960
    s_nop 0
    buffer_load_dwordx4 v234, s[40:43], s65 offen offset:0 nt lds
    v_mfma_f32_16x16x32_bf16 v[52:55], v[104:107], a[212:215], v[52:55]
    v_mfma_f32_16x16x32_bf16 v[72:75], v[120:123], a[212:215], v[72:75]
    v_max3_f32 v208, v40, v41, v42
    v_mfma_f32_16x16x32_bf16 v[52:55], v[108:111], a[216:219], v[52:55]
    v_max3_f32 v208, v208, v43, v60
    v_mfma_f32_16x16x32_bf16 v[72:75], v[124:127], a[216:219], v[72:75]
    v_mfma_f32_16x16x32_bf16 v[52:55], v[112:115], a[220:223], v[52:55]
    v_max3_f32 v208, v208, v61, v62
    v_mfma_f32_16x16x32_bf16 v[72:75], v[128:131], a[220:223], v[72:75]
    v_max_f32 v208, v208, v63
    v_mfma_f32_16x16x32_bf16 a[8:11], v[132:135], v[88:91], a[8:11]
    v_mfma_f32_16x16x32_bf16 a[28:31], v[136:139], v[88:91], a[28:31]
    buffer_load_dwordx4 v234, s[40:43], s65 offen offset:1024 nt lds
    v_mfma_f32_16x16x32_bf16 a[48:51], v[140:143], v[88:91], a[48:51]
    v_mfma_f32_16x16x32_bf16 a[68:71], v[144:147], v[88:91], a[68:71]
    v_max3_f32 v209, v44, v45, v46
    v_mfma_f32_16x16x32_bf16 a[88:91], v[148:151], v[88:91], a[88:91]
    v_mfma_f32_16x16x32_bf16 a[108:111], v[152:155], v[88:91], a[108:111]
    v_max3_f32 v209, v209, v47, v64
    v_mfma_f32_16x16x32_bf16 a[128:131], v[156:159], v[88:91], a[128:131]
    v_mfma_f32_16x16x32_bf16 a[148:151], v[160:163], v[88:91], a[148:151]
    v_max3_f32 v209, v209, v65, v66
    v_mfma_f32_16x16x32_bf16 v[192:195], v[204:207], v[88:91], v[192:195]
    v_max_f32 v209, v209, v67
    v_mfma_f32_16x16x32_bf16 v[56:59], v[100:103], a[224:227], v[180:183]
    v_mfma_f32_16x16x32_bf16 v[76:79], v[116:119], a[224:227], v[180:183]
    buffer_load_dwordx4 v234, s[40:43], s65 offen offset:2048 nt lds
    v_mfma_f32_16x16x32_bf16 v[56:59], v[104:107], a[228:231], v[56:59]
    v_mfma_f32_16x16x32_bf16 v[76:79], v[120:123], a[228:231], v[76:79]
    v_max3_f32 v210, v48, v49, v50
    v_mfma_f32_16x16x32_bf16 v[56:59], v[108:111], a[232:235], v[56:59]
    v_max3_f32 v210, v210, v51, v68
    v_mfma_f32_16x16x32_bf16 v[76:79], v[124:127], a[232:235], v[76:79]
    v_mfma_f32_16x16x32_bf16 v[56:59], v[112:115], a[236:239], v[56:59]
    v_max3_f32 v210, v210, v69, v70
    v_mfma_f32_16x16x32_bf16 v[76:79], v[128:131], a[236:239], v[76:79]
    v_max_f32 v210, v210, v71
    v_mfma_f32_16x16x32_bf16 a[12:15], v[132:135], v[92:95], a[12:15]
    buffer_load_dwordx4 v234, s[40:43], s65 offen offset:3072 nt lds
    s_add_u32 s65, s65, 8192
    s_and_b32 s65, s65, 262143
    v_mfma_f32_16x16x32_bf16 a[32:35], v[136:139], v[92:95], a[32:35]
    ds_read_b128 v[100:103], v218 offset:0
    v_mfma_f32_16x16x32_bf16 a[52:55], v[140:143], v[92:95], a[52:55]
    ds_read_b128 v[104:107], v219 offset:0
    v_mfma_f32_16x16x32_bf16 a[72:75], v[144:147], v[92:95], a[72:75]
    ds_read_b128 v[108:111], v220 offset:0
    v_mfma_f32_16x16x32_bf16 a[92:95], v[148:151], v[92:95], a[92:95]
    ds_read_b128 v[112:115], v221 offset:0
    v_mfma_f32_16x16x32_bf16 a[112:115], v[152:155], v[92:95], a[112:115]
    ds_read_b128 v[116:119], v218 offset:4096
    v_mfma_f32_16x16x32_bf16 a[132:135], v[156:159], v[92:95], a[132:135]
    ds_read_b128 v[120:123], v219 offset:4096
    v_mfma_f32_16x16x32_bf16 a[152:155], v[160:163], v[92:95], a[152:155]
    ds_read_b128 v[124:127], v220 offset:4096
    v_mfma_f32_16x16x32_bf16 v[196:199], v[204:207], v[92:95], v[196:199]
    ds_read_b128 v[128:131], v221 offset:4096
    v_mfma_f32_16x16x32_bf16 a[16:19], v[132:135], v[96:99], a[16:19]
    v_mfma_f32_16x16x32_bf16 a[36:39], v[136:139], v[96:99], a[36:39]
    v_max3_f32 v211, v52, v53, v54
    v_mfma_f32_16x16x32_bf16 a[56:59], v[140:143], v[96:99], a[56:59]
    v_max3_f32 v211, v211, v55, v72
    v_mfma_f32_16x16x32_bf16 a[76:79], v[144:147], v[96:99], a[76:79]
    v_max3_f32 v211, v211, v73, v74
    v_mfma_f32_16x16x32_bf16 a[96:99], v[148:151], v[96:99], a[96:99]
    v_max_f32 v211, v211, v75
    v_mfma_f32_16x16x32_bf16 a[116:119], v[152:155], v[96:99], a[116:119]
    v_max3_f32 v212, v56, v57, v58
    v_mfma_f32_16x16x32_bf16 a[136:139], v[156:159], v[96:99], a[136:139]
    v_max3_f32 v212, v212, v59, v76
    v_mfma_f32_16x16x32_bf16 a[156:159], v[160:163], v[96:99], a[156:159]
    v_max3_f32 v212, v212, v77, v78
    v_mfma_f32_16x16x32_bf16 v[200:203], v[204:207], v[96:99], v[200:203]
    v_max_f32 v212, v212, v79
    v_max3_f32 v242, v208, v209, v210
    v_max3_f32 v242, v242, v211, v212
    v_cmp_gt_f32 s[70:71], v242, s72
    s_nop 3
    s_cmp_lg_u64 s[70:71], 0
    s_cbranch_scc1 K1_RESC2
K1_RESC2_RET:
    s_cmp_eq_u32 s66, 7
    s_cbranch_scc1 K1_LAST
    s_waitcnt vmcnt(16) lgkmcnt(0)
    s_barrier
    v_mfma_f32_16x16x32_bf16 v[0:3], v[100:103], a[160:163], v[164:167]
    ds_read_b64_tr_b16 v[132:133], v222 offset:57344
    ds_read_b64_tr_b16 v[134:135], v222 offset:61440
    v_mfma_f32_16x16x32_bf16 v[20:23], v[116:119], a[160:163], v[164:167]
    ds_read_b64_tr_b16 v[136:137], v222 offset:57352
    ds_read_b64_tr_b16 v[138:139], v222 offset:61448
    ds_read_b64_tr_b16 v[140:141], v223 offset:57344
    v_mfma_f32_16x16x32_bf16 v[0:3], v[104:107], a[164:167], v[0:3]
    ds_read_b64_tr_b16 v[142:143], v223 offset:61440
    ds_read_b64_tr_b16 v[144:145], v223 offset:57352
    v_mfma_f32_16x16x32_bf16 v[20:23], v[120:123], a[164:167], v[20:23]
    ds_read_b64_tr_b16 v[146:147], v223 offset:61448
    v_exp_f32 v40, v40
    v_exp_f32 v41, v41
    v_mfma_f32_16x16x32_bf16 v[0:3], v[108:111], a[168:171], v[0:3]
    v_exp_f32 v42, v42
    v_exp_f32 v43, v43
    v_mfma_f32_16x16x32_bf16 v[20:23], v[124:127], a[168:171], v[20:23]
    v_exp_f32 v60, v60
    v_exp_f32 v61, v61
    v_exp_f32 v62, v62
    v_mfma_f32_16x16x32_bf16 v[0:3], v[112:115], a[172:175], v[0:3]
    v_exp_f32 v63, v63
    v_cvt_pk_bf16_f32 v80, v40, v41
    v_mfma_f32_16x16x32_bf16 v[20:23], v[128:131], a[172:175], v[20:23]
    v_cvt_pk_bf16_f32 v81, v42, v43
    v_cvt_pk_bf16_f32 v82, v60, v61
    v_cvt_pk_bf16_f32 v83, v62, v63
    v_mfma_f32_16x16x32_bf16 v[4:7], v[100:103], a[176:179], v[168:171]
    s_cmp_lg_u32 s66, 6
    s_cbranch_scc1 K1_NSK
    s_mov_b32 s36, s44
    s_mov_b32 s37, s45
    s_mov_b32 s38, s46
    s_mov_b32 s39, s47
    s_mov_b32 s64, s83
K1_NSK:
    s_add_u32 m0, s30, 0
    s_nop 0
    buffer_load_dwordx4 v230, s[36:39], s64 offen offset:0 nt lds
    ds_read_b64_tr_b16 v[148:149], v224 offset:57344
    v_mfma_f32_16x16x32_bf16 v[24:27], v[116:119], a[176:179], v[168:171]
    ds_read_b64_tr_b16 v[150:151], v224 offset:61440
    ds_read_b64_tr_b16 v[152:153], v224 offset:57352
    ds_read_b64_tr_b16 v[154:155], v224 offset:61448
    v_mfma_f32_16x16x32_bf16 v[4:7], v[104:107], a[180:183], v[4:7]
    ds_read_b64_tr_b16 v[156:157], v225 offset:57344
    ds_read_b64_tr_b16 v[158:159], v225 offset:61440
    v_mfma_f32_16x16x32_bf16 v[24:27], v[120:123], a[180:183], v[24:27]
    ds_read_b64_tr_b16 v[160:161], v225 offset:57352
    ds_read_b64_tr_b16 v[162:163], v225 offset:61448
    v_exp_f32 v44, v44
    v_mfma_f32_16x16x32_bf16 v[4:7], v[108:111], a[184:187], v[4:7]
    v_exp_f32 v45, v45
    v_exp_f32 v46, v46
    v_exp_f32 v47, v47
    v_mfma_f32_16x16x32_bf16 v[24:27], v[124:127], a[184:187], v[24:27]
    v_exp_f32 v64, v64
    v_exp_f32 v65, v65
    v_mfma_f32_16x16x32_bf16 v[4:7], v[112:115], a[188:191], v[4:7]
    v_exp_f32 v66, v66
    v_exp_f32 v67, v67
    v_cvt_pk_bf16_f32 v84, v44, v45
    v_mfma_f32_16x16x32_bf16 v[24:27], v[128:131], a[188:191], v[24:27]
    v_cvt_pk_bf16_f32 v85, v46, v47
    v_cvt_pk_bf16_f32 v86, v64, v65
    v_cvt_pk_bf16_f32 v87, v66, v67
    s_waitcnt lgkmcnt(14)
    v_mfma_f32_16x16x32_bf16 a[0:3], v[132:135], v[80:83], a[0:3]
    buffer_load_dwordx4 v231, s[36:39], s64 offen offset:1024 nt lds
    s_waitcnt lgkmcnt(12)
    v_mfma_f32_16x16x32_bf16 a[20:23], v[136:139], v[80:83], a[20:23]
    v_exp_f32 v48, v48
    s_waitcnt lgkmcnt(10)
    v_mfma_f32_16x16x32_bf16 a[40:43], v[140:143], v[80:83], a[40:43]
    v_exp_f32 v49, v49
    v_exp_f32 v50, v50
    s_waitcnt lgkmcnt(8)
    v_mfma_f32_16x16x32_bf16 a[60:63], v[144:147], v[80:83], a[60:63]
    v_exp_f32 v51, v51
    s_waitcnt lgkmcnt(6)
    v_mfma_f32_16x16x32_bf16 a[80:83], v[148:151], v[80:83], a[80:83]
    v_exp_f32 v68, v68
    v_exp_f32 v69, v69
    s_waitcnt lgkmcnt(4)
    v_mfma_f32_16x16x32_bf16 a[100:103], v[152:155], v[80:83], a[100:103]
    v_exp_f32 v70, v70
    s_waitcnt lgkmcnt(2)
    v_mfma_f32_16x16x32_bf16 a[120:123], v[156:159], v[80:83], a[120:123]
    v_exp_f32 v71, v71
    v_cvt_pk_bf16_f32 v88, v48, v49
    s_waitcnt lgkmcnt(0)
    v_mfma_f32_16x16x32_bf16 a[140:143], v[160:163], v[80:83], a[140:143]
    v_cvt_pk_bf16_f32 v89, v50, v51
    v_mfma_f32_16x16x32_bf16 v[184:187], v[204:207], v[80:83], v[184:187]
    v_cvt_pk_bf16_f32 v90, v68, v69
    v_cvt_pk_bf16_f32 v91, v70, v71
    v_mfma_f32_16x16x32_bf16 v[8:11], v[100:103], a[192:195], v[172:175]
    buffer_load_dwordx4 v232, s[36:39], s64 offen offset:2048 nt lds
    v_mfma_f32_16x16x32_bf16 v[28:31], v[116:119], a[192:195], v[172:175]
    v_exp_f32 v52, v52
    v_exp_f32 v53, v53
    v_mfma_f32_16x16x32_bf16 v[8:11], v[104:107], a[196:199], v[8:11]
    v_exp_f32 v54, v54
    v_mfma_f32_16x16x32_bf16 v[28:31], v[120:123], a[196:199], v[28:31]
    v_exp_f32 v55, v55
    v_exp_f32 v72, v72
    v_mfma_f32_16x16x32_bf16 v[8:11], v[108:111], a[200:203], v[8:11]
    v_exp_f32 v73, v73
    v_exp_f32 v74, v74
    v_mfma_f32_16x16x32_bf16 v[28:31], v[124:127], a[200:203], v[28:31]
    v_exp_f32 v75, v75
    v_mfma_f32_16x16x32_bf16 v[8:11], v[112:115], a[204:207], v[8:11]
    v_cvt_pk_bf16_f32 v92, v52, v53
    v_cvt_pk_bf16_f32 v93, v54, v55
    v_mfma_f32_16x16x32_bf16 v[28:31], v[128:131], a[204:207], v[28:31]
    v_cvt_pk_bf16_f32 v94, v72, v73
    v_cvt_pk_bf16_f32 v95, v74, v75
    v_mfma_f32_16x16x32_bf16 a[4:7], v[132:135], v[84:87], a[4:7]
    buffer_load_dwordx4 v233, s[36:39], s64 offen offset:3072 nt lds
    s_add_u32 s64, s64, 8192
    s_and_b32 s64, s64, 262143
    v_mfma_f32_16x16x32_bf16 a[24:27], v[136:139], v[84:87], a[24:27]
    v_exp_f32 v56, v56
    v_mfma_f32_16x16x32_bf16 a[44:47], v[140:143], v[84:87], a[44:47]
    v_exp_f32 v57, v57
    v_exp_f32 v58, v58
    v_mfma_f32_16x16x32_bf16 a[64:67], v[144:147], v[84:87], a[64:67]
    v_exp_f32 v59, v59
    v_mfma_f32_16x16x32_bf16 a[84:87], v[148:151], v[84:87], a[84:87]
    v_exp_f32 v76, v76
    v_exp_f32 v77, v77
    v_mfma_f32_16x16x32_bf16 a[104:107], v[152:155], v[84:87], a[104:107]
    v_exp_f32 v78, v78
    v_mfma_f32_16x16x32_bf16 a[124:127], v[156:159], v[84:87], a[124:127]
    v_exp_f32 v79, v79
    v_cvt_pk_bf16_f32 v96, v56, v57
    v_mfma_f32_16x16x32_bf16 a[144:147], v[160:163], v[84:87], a[144:147]
    v_cvt_pk_bf16_f32 v97, v58, v59
    v_mfma_f32_16x16x32_bf16 v[188:191], v[204:207], v[84:87], v[188:191]
    v_cvt_pk_bf16_f32 v98, v76, v77
    v_cvt_pk_bf16_f32 v99, v78, v79
    v_mfma_f32_16x16x32_bf16 v[12:15], v[100:103], a[208:211], v[176:179]
    v_mfma_f32_16x16x32_bf16 v[32:35], v[116:119], a[208:211], v[176:179]
    s_add_u32 m0, s30, 49152
    s_nop 0
    buffer_load_dwordx4 v234, s[40:43], s65 offen offset:0 nt lds
    v_mfma_f32_16x16x32_bf16 v[12:15], v[104:107], a[212:215], v[12:15]
    v_mfma_f32_16x16x32_bf16 v[32:35], v[120:123], a[212:215], v[32:35]
    v_max3_f32 v208, v0, v1, v2
    v_mfma_f32_16x16x32_bf16 v[12:15], v[108:111], a[216:219], v[12:15]
    v_max3_f32 v208, v208, v3, v20
    v_mfma_f32_16x16x32_bf16 v[32:35], v[124:127], a[216:219], v[32:35]
    v_mfma_f32_16x16x32_bf16 v[12:15], v[112:115], a[220:223], v[12:15]
    v_max3_f32 v208, v208, v21, v22
    v_mfma_f32_16x16x32_bf16 v[32:35], v[128:131], a[220:223], v[32:35]
    v_max_f32 v208, v208, v23
    v_mfma_f32_16x16x32_bf16 a[8:11], v[132:135], v[88:91], a[8:11]
    v_mfma_f32_16x16x32_bf16 a[28:31], v[136:139], v[88:91], a[28:31]
    buffer_load_dwordx4 v234, s[40:43], s65 offen offset:1024 nt lds
    v_mfma_f32_16x16x32_bf16 a[48:51], v[140:143], v[88:91], a[48:51]
    v_mfma_f32_16x16x32_bf16 a[68:71], v[144:147], v[88:91], a[68:71]
    v_max3_f32 v209, v4, v5, v6
    v_mfma_f32_16x16x32_bf16 a[88:91], v[148:151], v[88:91], a[88:91]
    v_mfma_f32_16x16x32_bf16 a[108:111], v[152:155], v[88:91], a[108:111]
    v_max3_f32 v209, v209, v7, v24
    v_mfma_f32_16x16x32_bf16 a[128:131], v[156:159], v[88:91], a[128:131]
    v_mfma_f32_16x16x32_bf16 a[148:151], v[160:163], v[88:91], a[148:151]
    v_max3_f32 v209, v209, v25, v26
    v_mfma_f32_16x16x32_bf16 v[192:195], v[204:207], v[88:91], v[192:195]
    v_max_f32 v209, v209, v27
    v_mfma_f32_16x16x32_bf16 v[16:19], v[100:103], a[224:227], v[180:183]
    v_mfma_f32_16x16x32_bf16 v[36:39], v[116:119], a[224:227], v[180:183]
    buffer_load_dwordx4 v234, s[40:43], s65 offen offset:2048 nt lds
    v_mfma_f32_16x16x32_bf16 v[16:19], v[104:107], a[228:231], v[16:19]
    v_mfma_f32_16x16x32_bf16 v[36:39], v[120:123], a[228:231], v[36:39]
    v_max3_f32 v210, v8, v9, v10
    v_mfma_f32_16x16x32_bf16 v[16:19], v[108:111], a[232:235], v[16:19]
    v_max3_f32 v210, v210, v11, v28
    v_mfma_f32_16x16x32_bf16 v[36:39], v[124:127], a[232:235], v[36:39]
    v_mfma_f32_16x16x32_bf16 v[16:19], v[112:115], a[236:239], v[16:19]
    v_max3_f32 v210, v210, v29, v30
    v_mfma_f32_16x16x32_bf16 v[36:39], v[128:131], a[236:239], v[36:39]
    v_max_f32 v210, v210, v31
    v_mfma_f32_16x16x32_bf16 a[12:15], v[132:135], v[92:95], a[12:15]
    buffer_load_dwordx4 v234, s[40:43], s65 offen offset:3072 nt lds
    s_add_u32 s65, s65, 8192
    s_and_b32 s65, s65, 262143
    v_mfma_f32_16x16x32_bf16 a[32:35], v[136:139], v[92:95], a[32:35]
    ds_read_b128 v[100:103], v218 offset:8192
    v_mfma_f32_16x16x32_bf16 a[52:55], v[140:143], v[92:95], a[52:55]
    ds_read_b128 v[104:107], v219 offset:8192
    v_mfma_f32_16x16x32_bf16 a[72:75], v[144:147], v[92:95], a[72:75]
    ds_read_b128 v[108:111], v220 offset:8192
    v_mfma_f32_16x16x32_bf16 a[92:95], v[148:151], v[92:95], a[92:95]
    ds_read_b128 v[112:115], v221 offset:8192
    v_mfma_f32_16x16x32_bf16 a[112:115], v[152:155], v[92:95], a[112:115]
    ds_read_b128 v[116:119], v218 offset:12288
    v_mfma_f32_16x16x32_bf16 a[132:135], v[156:159], v[92:95], a[132:135]
    ds_read_b128 v[120:123], v219 offset:12288
    v_mfma_f32_16x16x32_bf16 a[152:155], v[160:163], v[92:95], a[152:155]
    ds_read_b128 v[124:127], v220 offset:12288
    v_mfma_f32_16x16x32_bf16 v[196:199], v[204:207], v[92:95], v[196:199]
    ds_read_b128 v[128:131], v221 offset:12288
    v_mfma_f32_16x16x32_bf16 a[16:19], v[132:135], v[96:99], a[16:19]
    v_mfma_f32_16x16x32_bf16 a[36:39], v[136:139], v[96:99], a[36:39]
    v_max3_f32 v211, v12, v13, v14
    v_mfma_f32_16x16x32_bf16 a[56:59], v[140:143], v[96:99], a[56:59]
    v_max3_f32 v211, v211, v15, v32
    v_mfma_f32_16x16x32_bf16 a[76:79], v[144:147], v[96:99], a[76:79]
    v_max3_f32 v211, v211, v33, v34
    v_mfma_f32_16x16x32_bf16 a[96:99], v[148:151], v[96:99], a[96:99]
    v_max_f32 v211, v211, v35
    v_mfma_f32_16x16x32_bf16 a[116:119], v[152:155], v[96:99], a[116:119]
    v_max3_f32 v212, v16, v17, v18
    v_mfma_f32_16x16x32_bf16 a[136:139], v[156:159], v[96:99], a[136:139]
    v_max3_f32 v212, v212, v19, v36
    v_mfma_f32_16x16x32_bf16 a[156:159], v[160:163], v[96:99], a[156:159]
    v_max3_f32 v212, v212, v37, v38
    v_mfma_f32_16x16x32_bf16 v[200:203], v[204:207], v[96:99], v[200:203]
    v_max_f32 v212, v212, v39
    v_max3_f32 v242, v208, v209, v210
    v_max3_f32 v242, v242, v211, v212
    v_cmp_gt_f32 s[70:71], v242, s72
    s_nop 3
    s_cmp_lg_u64 s[70:71], 0
    s_cbranch_scc1 K1_RESC3
K1_RESC3_RET:
    s_add_u32 s66, s66, 1
    s_branch K1_LOOP
K1_LAST:
    s_waitcnt vmcnt(16) lgkmcnt(0)
    s_barrier
    s_mov_b32 s74, 1
    s_lshl_b32 s68, s74, 4
    s_add_u32 s68, s68, s32
    s_mul_i32 s68, s68, 163840
    s_add_u32 s68, s68, 67108864
    s_add_u32 s56, s26, s68
    s_addc_u32 s57, s27, 0
    s_and_b32 s57, s57, 65535
    s_mov_b32 s58, 163840
    s_mov_b32 s59, 131072
    s_lshl_b32 s68, s74, 5
    s_add_u32 s68, s68, s33
    s_lshl_b32 s68, s68, 17
    s_add_u32 s68, s68, 83886080
    s_add_u32 s52, s26, s68
    s_addc_u32 s53, s27, 0
    s_and_b32 s53, s53, 65535
    s_mov_b32 s54, 131072
    s_mov_b32 s55, 131072
    ds_read_b64_tr_b16 v[132:133], v222 offset:57344
    ds_read_b64_tr_b16 v[134:135], v222 offset:61440
    ds_read_b64_tr_b16 v[136:137], v222 offset:57352
    ds_read_b64_tr_b16 v[138:139], v222 offset:61448
    ds_read_b64_tr_b16 v[140:141], v223 offset:57344
    ds_read_b64_tr_b16 v[142:143], v223 offset:61440
    ds_read_b64_tr_b16 v[144:145], v223 offset:57352
    ds_read_b64_tr_b16 v[146:147], v223 offset:61448
    v_exp_f32 v40, v40
    v_exp_f32 v41, v41
    v_exp_f32 v42, v42
    v_exp_f32 v43, v43
    v_exp_f32 v60, v60
    v_exp_f32 v61, v61
    v_exp_f32 v62, v62
    v_exp_f32 v63, v63
    v_cvt_pk_bf16_f32 v80, v40, v41
    v_cvt_pk_bf16_f32 v81, v42, v43
    v_cvt_pk_bf16_f32 v82, v60, v61
    v_cvt_pk_bf16_f32 v83, v62, v63
    ds_read_b64_tr_b16 v[148:149], v224 offset:57344
    ds_read_b64_tr_b16 v[150:151], v224 offset:61440
    ds_read_b64_tr_b16 v[152:153], v224 offset:57352
    ds_read_b64_tr_b16 v[154:155], v224 offset:61448
    ds_read_b64_tr_b16 v[156:157], v225 offset:57344
    ds_read_b64_tr_b16 v[158:159], v225 offset:61440
    ds_read_b64_tr_b16 v[160:161], v225 offset:57352
    ds_read_b64_tr_b16 v[162:163], v225 offset:61448
    v_exp_f32 v44, v44
    v_exp_f32 v45, v45
    v_exp_f32 v46, v46
    v_exp_f32 v47, v47
    v_exp_f32 v64, v64
    v_exp_f32 v65, v65
    v_exp_f32 v66, v66
    v_exp_f32 v67, v67
    v_cvt_pk_bf16_f32 v84, v44, v45
    v_cvt_pk_bf16_f32 v85, v46, v47
    v_cvt_pk_bf16_f32 v86, v64, v65
    v_cvt_pk_bf16_f32 v87, v66, v67
    s_waitcnt lgkmcnt(14)
    v_mfma_f32_16x16x32_bf16 a[0:3], v[132:135], v[80:83], a[0:3]
    v_exp_f32 v48, v48
    s_waitcnt lgkmcnt(12)
    v_mfma_f32_16x16x32_bf16 a[20:23], v[136:139], v[80:83], a[20:23]
    v_exp_f32 v49, v49
    s_waitcnt lgkmcnt(10)
    v_mfma_f32_16x16x32_bf16 a[40:43], v[140:143], v[80:83], a[40:43]
    v_exp_f32 v50, v50
    v_exp_f32 v51, v51
    s_waitcnt lgkmcnt(8)
    v_mfma_f32_16x16x32_bf16 a[60:63], v[144:147], v[80:83], a[60:63]
    v_exp_f32 v68, v68
    s_waitcnt lgkmcnt(6)
    v_mfma_f32_16x16x32_bf16 a[80:83], v[148:151], v[80:83], a[80:83]
    v_exp_f32 v69, v69
    s_waitcnt lgkmcnt(4)
    v_mfma_f32_16x16x32_bf16 a[100:103], v[152:155], v[80:83], a[100:103]
    v_exp_f32 v70, v70
    v_exp_f32 v71, v71
    s_waitcnt lgkmcnt(2)
    v_mfma_f32_16x16x32_bf16 a[120:123], v[156:159], v[80:83], a[120:123]
    v_cvt_pk_bf16_f32 v88, v48, v49
    s_waitcnt lgkmcnt(0)
    v_mfma_f32_16x16x32_bf16 a[140:143], v[160:163], v[80:83], a[140:143]
    v_cvt_pk_bf16_f32 v89, v50, v51
    v_mfma_f32_16x16x32_bf16 v[184:187], v[204:207], v[80:83], v[184:187]
    v_cvt_pk_bf16_f32 v90, v68, v69
    v_cvt_pk_bf16_f32 v91, v70, v71
    v_exp_f32 v52, v52
    v_exp_f32 v53, v53
    v_exp_f32 v54, v54
    v_exp_f32 v55, v55
    v_exp_f32 v72, v72
    v_exp_f32 v73, v73
    v_exp_f32 v74, v74
    v_exp_f32 v75, v75
    v_cvt_pk_bf16_f32 v92, v52, v53
    v_cvt_pk_bf16_f32 v93, v54, v55
    v_cvt_pk_bf16_f32 v94, v72, v73
    v_cvt_pk_bf16_f32 v95, v74, v75
    v_mfma_f32_16x16x32_bf16 a[4:7], v[132:135], v[84:87], a[4:7]
    v_exp_f32 v56, v56
    v_mfma_f32_16x16x32_bf16 a[24:27], v[136:139], v[84:87], a[24:27]
    v_exp_f32 v57, v57
    v_mfma_f32_16x16x32_bf16 a[44:47], v[140:143], v[84:87], a[44:47]
    v_exp_f32 v58, v58
    v_exp_f32 v59, v59
    v_mfma_f32_16x16x32_bf16 a[64:67], v[144:147], v[84:87], a[64:67]
    v_exp_f32 v76, v76
    v_mfma_f32_16x16x32_bf16 a[84:87], v[148:151], v[84:87], a[84:87]
    v_exp_f32 v77, v77
    v_mfma_f32_16x16x32_bf16 a[104:107], v[152:155], v[84:87], a[104:107]
    v_exp_f32 v78, v78
    v_exp_f32 v79, v79
    v_mfma_f32_16x16x32_bf16 a[124:127], v[156:159], v[84:87], a[124:127]
    v_cvt_pk_bf16_f32 v96, v56, v57
    v_mfma_f32_16x16x32_bf16 a[144:147], v[160:163], v[84:87], a[144:147]
    v_cvt_pk_bf16_f32 v97, v58, v59
    v_mfma_f32_16x16x32_bf16 v[188:191], v[204:207], v[84:87], v[188:191]
    v_cvt_pk_bf16_f32 v98, v76, v77
    v_cvt_pk_bf16_f32 v99, v78, v79
    v_mfma_f32_16x16x32_bf16 a[8:11], v[132:135], v[88:91], a[8:11]
    v_mfma_f32_16x16x32_bf16 a[28:31], v[136:139], v[88:91], a[28:31]
    v_mfma_f32_16x16x32_bf16 a[48:51], v[140:143], v[88:91], a[48:51]
    v_mfma_f32_16x16x32_bf16 a[68:71], v[144:147], v[88:91], a[68:71]
    v_mfma_f32_16x16x32_bf16 a[88:91], v[148:151], v[88:91], a[88:91]
    v_mfma_f32_16x16x32_bf16 a[108:111], v[152:155], v[88:91], a[108:111]
    v_mfma_f32_16x16x32_bf16 a[128:131], v[156:159], v[88:91], a[128:131]
    v_mfma_f32_16x16x32_bf16 a[148:151], v[160:163], v[88:91], a[148:151]
    v_mfma_f32_16x16x32_bf16 v[192:195], v[204:207], v[88:91], v[192:195]
    v_mfma_f32_16x16x32_bf16 a[12:15], v[132:135], v[92:95], a[12:15]
    v_mfma_f32_16x16x32_bf16 a[32:35], v[136:139], v[92:95], a[32:35]
    v_mfma_f32_16x16x32_bf16 a[52:55], v[140:143], v[92:95], a[52:55]
    v_mfma_f32_16x16x32_bf16 a[72:75], v[144:147], v[92:95], a[72:75]
    v_mfma_f32_16x16x32_bf16 a[92:95], v[148:151], v[92:95], a[92:95]
    v_mfma_f32_16x16x32_bf16 a[112:115], v[152:155], v[92:95], a[112:115]
    v_mfma_f32_16x16x32_bf16 a[132:135], v[156:159], v[92:95], a[132:135]
    v_mfma_f32_16x16x32_bf16 a[152:155], v[160:163], v[92:95], a[152:155]
    v_mfma_f32_16x16x32_bf16 v[196:199], v[204:207], v[92:95], v[196:199]
    v_mfma_f32_16x16x32_bf16 a[16:19], v[132:135], v[96:99], a[16:19]
    v_mfma_f32_16x16x32_bf16 a[36:39], v[136:139], v[96:99], a[36:39]
    v_mfma_f32_16x16x32_bf16 a[56:59], v[140:143], v[96:99], a[56:59]
    v_mfma_f32_16x16x32_bf16 a[76:79], v[144:147], v[96:99], a[76:79]
    v_mfma_f32_16x16x32_bf16 a[96:99], v[148:151], v[96:99], a[96:99]
    v_mfma_f32_16x16x32_bf16 a[116:119], v[152:155], v[96:99], a[116:119]
    v_mfma_f32_16x16x32_bf16 a[136:139], v[156:159], v[96:99], a[136:139]
    v_mfma_f32_16x16x32_bf16 a[156:159], v[160:163], v[96:99], a[156:159]
    v_mfma_f32_16x16x32_bf16 v[200:203], v[204:207], v[96:99], v[200:203]
    s_nop 15
    v_rcp_f32 v213, v184
    v_rcp_f32 v214, v188
    v_rcp_f32 v215, v192
    v_rcp_f32 v216, v196
    v_rcp_f32 v217, v200
    v_accvgpr_read_b32 v0, a0
    v_accvgpr_read_b32 v1, a1
    v_accvgpr_read_b32 v2, a2
    v_accvgpr_read_b32 v3, a3
    v_accvgpr_read_b32 v4, a20
    v_accvgpr_read_b32 v5, a21
    v_accvgpr_read_b32 v6, a22
    v_accvgpr_read_b32 v7, a23
    v_mul_f32 v0, v0, v213
    v_mul_f32 v1, v1, v213
    v_mul_f32 v2, v2, v213
    v_mul_f32 v3, v3, v213
    v_mul_f32 v4, v4, v213
    v_mul_f32 v5, v5, v213
    v_mul_f32 v6, v6, v213
    v_mul_f32 v7, v7, v213
    v_cvt_pk_bf16_f32 v8, v0, v1
    v_cvt_pk_bf16_f32 v9, v2, v3
    v_cvt_pk_bf16_f32 v10, v4, v5
    v_cvt_pk_bf16_f32 v11, v6, v7
    s_add_u32 s68, s84, 0
    buffer_store_dwordx4 v[8:11], v241, s[60:63], s68 offen offset:0
    v_accvgpr_read_b32 v12, a40
    v_accvgpr_read_b32 v13, a41
    v_accvgpr_read_b32 v14, a42
    v_accvgpr_read_b32 v15, a43
    v_accvgpr_read_b32 v16, a60
    v_accvgpr_read_b32 v17, a61
    v_accvgpr_read_b32 v18, a62
    v_accvgpr_read_b32 v19, a63
    v_mul_f32 v12, v12, v213
    v_mul_f32 v13, v13, v213
    v_mul_f32 v14, v14, v213
    v_mul_f32 v15, v15, v213
    v_mul_f32 v16, v16, v213
    v_mul_f32 v17, v17, v213
    v_mul_f32 v18, v18, v213
    v_mul_f32 v19, v19, v213
    v_cvt_pk_bf16_f32 v20, v12, v13
    v_cvt_pk_bf16_f32 v21, v14, v15
    v_cvt_pk_bf16_f32 v22, v16, v17
    v_cvt_pk_bf16_f32 v23, v18, v19
    s_add_u32 s68, s84, 10240
    buffer_store_dwordx4 v[20:23], v241, s[60:63], s68 offen offset:0
    v_accvgpr_read_b32 v24, a80
    v_accvgpr_read_b32 v25, a81
    v_accvgpr_read_b32 v26, a82
    v_accvgpr_read_b32 v27, a83
    v_accvgpr_read_b32 v28, a100
    v_accvgpr_read_b32 v29, a101
    v_accvgpr_read_b32 v30, a102
    v_accvgpr_read_b32 v31, a103
    v_mul_f32 v24, v24, v213
    v_mul_f32 v25, v25, v213
    v_mul_f32 v26, v26, v213
    v_mul_f32 v27, v27, v213
    v_mul_f32 v28, v28, v213
    v_mul_f32 v29, v29, v213
    v_mul_f32 v30, v30, v213
    v_mul_f32 v31, v31, v213
    v_cvt_pk_bf16_f32 v32, v24, v25
    v_cvt_pk_bf16_f32 v33, v26, v27
    v_cvt_pk_bf16_f32 v34, v28, v29
    v_cvt_pk_bf16_f32 v35, v30, v31
    s_add_u32 s68, s84, 20480
    buffer_store_dwordx4 v[32:35], v241, s[60:63], s68 offen offset:0
    v_accvgpr_read_b32 v36, a120
    v_accvgpr_read_b32 v37, a121
    v_accvgpr_read_b32 v38, a122
    v_accvgpr_read_b32 v39, a123
    v_accvgpr_read_b32 v40, a140
    v_accvgpr_read_b32 v41, a141
    v_accvgpr_read_b32 v42, a142
    v_accvgpr_read_b32 v43, a143
    v_mul_f32 v36, v36, v213
    v_mul_f32 v37, v37, v213
    v_mul_f32 v38, v38, v213
    v_mul_f32 v39, v39, v213
    v_mul_f32 v40, v40, v213
    v_mul_f32 v41, v41, v213
    v_mul_f32 v42, v42, v213
    v_mul_f32 v43, v43, v213
    v_cvt_pk_bf16_f32 v44, v36, v37
    v_cvt_pk_bf16_f32 v45, v38, v39
    v_cvt_pk_bf16_f32 v46, v40, v41
    v_cvt_pk_bf16_f32 v47, v42, v43
    s_add_u32 s68, s84, 30720
    buffer_store_dwordx4 v[44:47], v241, s[60:63], s68 offen offset:0
    v_accvgpr_read_b32 v0, a4
    v_accvgpr_read_b32 v1, a5
    v_accvgpr_read_b32 v2, a6
    v_accvgpr_read_b32 v3, a7
    v_accvgpr_read_b32 v4, a24
    v_accvgpr_read_b32 v5, a25
    v_accvgpr_read_b32 v6, a26
    v_accvgpr_read_b32 v7, a27
    v_mul_f32 v0, v0, v214
    v_mul_f32 v1, v1, v214
    v_mul_f32 v2, v2, v214
    v_mul_f32 v3, v3, v214
    v_mul_f32 v4, v4, v214
    v_mul_f32 v5, v5, v214
    v_mul_f32 v6, v6, v214
    v_mul_f32 v7, v7, v214
    v_cvt_pk_bf16_f32 v8, v0, v1
    v_cvt_pk_bf16_f32 v9, v2, v3
    v_cvt_pk_bf16_f32 v10, v4, v5
    v_cvt_pk_bf16_f32 v11, v6, v7
    s_add_u32 s68, s84, 1024
    buffer_store_dwordx4 v[8:11], v241, s[60:63], s68 offen offset:0
    v_accvgpr_read_b32 v12, a44
    v_accvgpr_read_b32 v13, a45
    v_accvgpr_read_b32 v14, a46
    v_accvgpr_read_b32 v15, a47
    v_accvgpr_read_b32 v16, a64
    v_accvgpr_read_b32 v17, a65
    v_accvgpr_read_b32 v18, a66
    v_accvgpr_read_b32 v19, a67
    v_mul_f32 v12, v12, v214
    v_mul_f32 v13, v13, v214
    v_mul_f32 v14, v14, v214
    v_mul_f32 v15, v15, v214
    v_mul_f32 v16, v16, v214
    v_mul_f32 v17, v17, v214
    v_mul_f32 v18, v18, v214
    v_mul_f32 v19, v19, v214
    v_cvt_pk_bf16_f32 v20, v12, v13
    v_cvt_pk_bf16_f32 v21, v14, v15
    v_cvt_pk_bf16_f32 v22, v16, v17
    v_cvt_pk_bf16_f32 v23, v18, v19
    s_add_u32 s68, s84, 11264
    buffer_store_dwordx4 v[20:23], v241, s[60:63], s68 offen offset:0
    v_accvgpr_read_b32 v24, a84
    v_accvgpr_read_b32 v25, a85
    v_accvgpr_read_b32 v26, a86
    v_accvgpr_read_b32 v27, a87
    v_accvgpr_read_b32 v28, a104
    v_accvgpr_read_b32 v29, a105
    v_accvgpr_read_b32 v30, a106
    v_accvgpr_read_b32 v31, a107
    v_mul_f32 v24, v24, v214
    v_mul_f32 v25, v25, v214
    v_mul_f32 v26, v26, v214
    v_mul_f32 v27, v27, v214
    v_mul_f32 v28, v28, v214
    v_mul_f32 v29, v29, v214
    v_mul_f32 v30, v30, v214
    v_mul_f32 v31, v31, v214
    v_cvt_pk_bf16_f32 v32, v24, v25
    v_cvt_pk_bf16_f32 v33, v26, v27
    v_cvt_pk_bf16_f32 v34, v28, v29
    v_cvt_pk_bf16_f32 v35, v30, v31
    s_add_u32 s68, s84, 21504
    buffer_store_dwordx4 v[32:35], v241, s[60:63], s68 offen offset:0
    v_accvgpr_read_b32 v36, a124
    v_accvgpr_read_b32 v37, a125
    v_accvgpr_read_b32 v38, a126
    v_accvgpr_read_b32 v39, a127
    v_accvgpr_read_b32 v40, a144
    v_accvgpr_read_b32 v41, a145
    v_accvgpr_read_b32 v42, a146
    v_accvgpr_read_b32 v43, a147
    v_mul_f32 v36, v36, v214
    v_mul_f32 v37, v37, v214
    v_mul_f32 v38, v38, v214
    v_mul_f32 v39, v39, v214
    v_mul_f32 v40, v40, v214
    v_mul_f32 v41, v41, v214
    v_mul_f32 v42, v42, v214
    v_mul_f32 v43, v43, v214
    v_cvt_pk_bf16_f32 v44, v36, v37
    v_cvt_pk_bf16_f32 v45, v38, v39
    v_cvt_pk_bf16_f32 v46, v40, v41
    v_cvt_pk_bf16_f32 v47, v42, v43
    s_add_u32 s68, s84, 31744
    buffer_store_dwordx4 v[44:47], v241, s[60:63], s68 offen offset:0
    v_accvgpr_read_b32 v0, a8
    v_accvgpr_read_b32 v1, a9
    v_accvgpr_read_b32 v2, a10
    v_accvgpr_read_b32 v3, a11
    v_accvgpr_read_b32 v4, a28
    v_accvgpr_read_b32 v5, a29
    v_accvgpr_read_b32 v6, a30
    v_accvgpr_read_b32 v7, a31
    v_mul_f32 v0, v0, v215
    v_mul_f32 v1, v1, v215
    v_mul_f32 v2, v2, v215
    v_mul_f32 v3, v3, v215
    v_mul_f32 v4, v4, v215
    v_mul_f32 v5, v5, v215
    v_mul_f32 v6, v6, v215
    v_mul_f32 v7, v7, v215
    v_cvt_pk_bf16_f32 v8, v0, v1
    v_cvt_pk_bf16_f32 v9, v2, v3
    v_cvt_pk_bf16_f32 v10, v4, v5
    v_cvt_pk_bf16_f32 v11, v6, v7
    s_add_u32 s68, s84, 2048
    buffer_store_dwordx4 v[8:11], v241, s[60:63], s68 offen offset:0
    v_accvgpr_read_b32 v12, a48
    v_accvgpr_read_b32 v13, a49
    v_accvgpr_read_b32 v14, a50
    v_accvgpr_read_b32 v15, a51
    v_accvgpr_read_b32 v16, a68
    v_accvgpr_read_b32 v17, a69
    v_accvgpr_read_b32 v18, a70
    v_accvgpr_read_b32 v19, a71
    v_mul_f32 v12, v12, v215
    v_mul_f32 v13, v13, v215
    v_mul_f32 v14, v14, v215
    v_mul_f32 v15, v15, v215
    v_mul_f32 v16, v16, v215
    v_mul_f32 v17, v17, v215
    v_mul_f32 v18, v18, v215
    v_mul_f32 v19, v19, v215
    v_cvt_pk_bf16_f32 v20, v12, v13
    v_cvt_pk_bf16_f32 v21, v14, v15
    v_cvt_pk_bf16_f32 v22, v16, v17
    v_cvt_pk_bf16_f32 v23, v18, v19
    s_add_u32 s68, s84, 12288
    buffer_store_dwordx4 v[20:23], v241, s[60:63], s68 offen offset:0
    v_accvgpr_read_b32 v24, a88
    v_accvgpr_read_b32 v25, a89
    v_accvgpr_read_b32 v26, a90
    v_accvgpr_read_b32 v27, a91
    v_accvgpr_read_b32 v28, a108
    v_accvgpr_read_b32 v29, a109
    v_accvgpr_read_b32 v30, a110
    v_accvgpr_read_b32 v31, a111
    v_mul_f32 v24, v24, v215
    v_mul_f32 v25, v25, v215
    v_mul_f32 v26, v26, v215
    v_mul_f32 v27, v27, v215
    v_mul_f32 v28, v28, v215
    v_mul_f32 v29, v29, v215
    v_mul_f32 v30, v30, v215
    v_mul_f32 v31, v31, v215
    v_cvt_pk_bf16_f32 v32, v24, v25
    v_cvt_pk_bf16_f32 v33, v26, v27
    v_cvt_pk_bf16_f32 v34, v28, v29
    v_cvt_pk_bf16_f32 v35, v30, v31
    s_add_u32 s68, s84, 22528
    buffer_store_dwordx4 v[32:35], v241, s[60:63], s68 offen offset:0
    v_accvgpr_read_b32 v36, a128
    v_accvgpr_read_b32 v37, a129
    v_accvgpr_read_b32 v38, a130
    v_accvgpr_read_b32 v39, a131
    v_accvgpr_read_b32 v40, a148
    v_accvgpr_read_b32 v41, a149
    v_accvgpr_read_b32 v42, a150
    v_accvgpr_read_b32 v43, a151
    v_mul_f32 v36, v36, v215
    v_mul_f32 v37, v37, v215
    v_mul_f32 v38, v38, v215
    v_mul_f32 v39, v39, v215
    v_mul_f32 v40, v40, v215
    v_mul_f32 v41, v41, v215
    v_mul_f32 v42, v42, v215
    v_mul_f32 v43, v43, v215
    v_cvt_pk_bf16_f32 v44, v36, v37
    v_cvt_pk_bf16_f32 v45, v38, v39
    v_cvt_pk_bf16_f32 v46, v40, v41
    v_cvt_pk_bf16_f32 v47, v42, v43
    s_add_u32 s68, s84, 32768
    buffer_store_dwordx4 v[44:47], v241, s[60:63], s68 offen offset:0
    v_accvgpr_read_b32 v0, a12
    v_accvgpr_read_b32 v1, a13
    v_accvgpr_read_b32 v2, a14
    v_accvgpr_read_b32 v3, a15
    v_accvgpr_read_b32 v4, a32
    v_accvgpr_read_b32 v5, a33
    v_accvgpr_read_b32 v6, a34
    v_accvgpr_read_b32 v7, a35
    v_mul_f32 v0, v0, v216
    v_mul_f32 v1, v1, v216
    v_mul_f32 v2, v2, v216
    v_mul_f32 v3, v3, v216
    v_mul_f32 v4, v4, v216
    v_mul_f32 v5, v5, v216
    v_mul_f32 v6, v6, v216
    v_mul_f32 v7, v7, v216
    v_cvt_pk_bf16_f32 v8, v0, v1
    v_cvt_pk_bf16_f32 v9, v2, v3
    v_cvt_pk_bf16_f32 v10, v4, v5
    v_cvt_pk_bf16_f32 v11, v6, v7
    s_add_u32 s68, s84, 3072
    buffer_store_dwordx4 v[8:11], v241, s[60:63], s68 offen offset:0
    v_accvgpr_read_b32 v12, a52
    v_accvgpr_read_b32 v13, a53
    v_accvgpr_read_b32 v14, a54
    v_accvgpr_read_b32 v15, a55
    v_accvgpr_read_b32 v16, a72
    v_accvgpr_read_b32 v17, a73
    v_accvgpr_read_b32 v18, a74
    v_accvgpr_read_b32 v19, a75
    v_mul_f32 v12, v12, v216
    v_mul_f32 v13, v13, v216
    v_mul_f32 v14, v14, v216
    v_mul_f32 v15, v15, v216
    v_mul_f32 v16, v16, v216
    v_mul_f32 v17, v17, v216
    v_mul_f32 v18, v18, v216
    v_mul_f32 v19, v19, v216
    v_cvt_pk_bf16_f32 v20, v12, v13
    v_cvt_pk_bf16_f32 v21, v14, v15
    v_cvt_pk_bf16_f32 v22, v16, v17
    v_cvt_pk_bf16_f32 v23, v18, v19
    s_add_u32 s68, s84, 13312
    buffer_store_dwordx4 v[20:23], v241, s[60:63], s68 offen offset:0
    v_accvgpr_read_b32 v24, a92
    v_accvgpr_read_b32 v25, a93
    v_accvgpr_read_b32 v26, a94
    v_accvgpr_read_b32 v27, a95
    v_accvgpr_read_b32 v28, a112
    v_accvgpr_read_b32 v29, a113
    v_accvgpr_read_b32 v30, a114
    v_accvgpr_read_b32 v31, a115
    v_mul_f32 v24, v24, v216
    v_mul_f32 v25, v25, v216
    v_mul_f32 v26, v26, v216
    v_mul_f32 v27, v27, v216
    v_mul_f32 v28, v28, v216
    v_mul_f32 v29, v29, v216
    v_mul_f32 v30, v30, v216
    v_mul_f32 v31, v31, v216
    v_cvt_pk_bf16_f32 v32, v24, v25
    v_cvt_pk_bf16_f32 v33, v26, v27
    v_cvt_pk_bf16_f32 v34, v28, v29
    v_cvt_pk_bf16_f32 v35, v30, v31
    s_add_u32 s68, s84, 23552
    buffer_store_dwordx4 v[32:35], v241, s[60:63], s68 offen offset:0
    v_accvgpr_read_b32 v36, a132
    v_accvgpr_read_b32 v37, a133
    v_accvgpr_read_b32 v38, a134
    v_accvgpr_read_b32 v39, a135
    v_accvgpr_read_b32 v40, a152
    v_accvgpr_read_b32 v41, a153
    v_accvgpr_read_b32 v42, a154
    v_accvgpr_read_b32 v43, a155
    v_mul_f32 v36, v36, v216
    v_mul_f32 v37, v37, v216
    v_mul_f32 v38, v38, v216
    v_mul_f32 v39, v39, v216
    v_mul_f32 v40, v40, v216
    v_mul_f32 v41, v41, v216
    v_mul_f32 v42, v42, v216
    v_mul_f32 v43, v43, v216
    v_cvt_pk_bf16_f32 v44, v36, v37
    v_cvt_pk_bf16_f32 v45, v38, v39
    v_cvt_pk_bf16_f32 v46, v40, v41
    v_cvt_pk_bf16_f32 v47, v42, v43
    s_add_u32 s68, s84, 33792
    buffer_store_dwordx4 v[44:47], v241, s[60:63], s68 offen offset:0
    v_accvgpr_read_b32 v0, a16
    v_accvgpr_read_b32 v1, a17
    v_accvgpr_read_b32 v2, a18
    v_accvgpr_read_b32 v3, a19
    v_accvgpr_read_b32 v4, a36
    v_accvgpr_read_b32 v5, a37
    v_accvgpr_read_b32 v6, a38
    v_accvgpr_read_b32 v7, a39
    v_mul_f32 v0, v0, v217
    v_mul_f32 v1, v1, v217
    v_mul_f32 v2, v2, v217
    v_mul_f32 v3, v3, v217
    v_mul_f32 v4, v4, v217
    v_mul_f32 v5, v5, v217
    v_mul_f32 v6, v6, v217
    v_mul_f32 v7, v7, v217
    v_cvt_pk_bf16_f32 v8, v0, v1
    v_cvt_pk_bf16_f32 v9, v2, v3
    v_cvt_pk_bf16_f32 v10, v4, v5
    v_cvt_pk_bf16_f32 v11, v6, v7
    s_add_u32 s68, s84, 4096
    buffer_store_dwordx4 v[8:11], v241, s[60:63], s68 offen offset:0
    v_accvgpr_read_b32 v12, a56
    v_accvgpr_read_b32 v13, a57
    v_accvgpr_read_b32 v14, a58
    v_accvgpr_read_b32 v15, a59
    v_accvgpr_read_b32 v16, a76
    v_accvgpr_read_b32 v17, a77
    v_accvgpr_read_b32 v18, a78
    v_accvgpr_read_b32 v19, a79
    v_mul_f32 v12, v12, v217
    v_mul_f32 v13, v13, v217
    v_mul_f32 v14, v14, v217
    v_mul_f32 v15, v15, v217
    v_mul_f32 v16, v16, v217
    v_mul_f32 v17, v17, v217
    v_mul_f32 v18, v18, v217
    v_mul_f32 v19, v19, v217
    v_cvt_pk_bf16_f32 v20, v12, v13
    v_cvt_pk_bf16_f32 v21, v14, v15
    v_cvt_pk_bf16_f32 v22, v16, v17
    v_cvt_pk_bf16_f32 v23, v18, v19
    s_add_u32 s68, s84, 14336
    buffer_store_dwordx4 v[20:23], v241, s[60:63], s68 offen offset:0
    v_accvgpr_read_b32 v24, a96
    v_accvgpr_read_b32 v25, a97
    v_accvgpr_read_b32 v26, a98
    v_accvgpr_read_b32 v27, a99
    v_accvgpr_read_b32 v28, a116
    v_accvgpr_read_b32 v29, a117
    v_accvgpr_read_b32 v30, a118
    v_accvgpr_read_b32 v31, a119
    v_mul_f32 v24, v24, v217
    v_mul_f32 v25, v25, v217
    v_mul_f32 v26, v26, v217
    v_mul_f32 v27, v27, v217
    v_mul_f32 v28, v28, v217
    v_mul_f32 v29, v29, v217
    v_mul_f32 v30, v30, v217
    v_mul_f32 v31, v31, v217
    v_cvt_pk_bf16_f32 v32, v24, v25
    v_cvt_pk_bf16_f32 v33, v26, v27
    v_cvt_pk_bf16_f32 v34, v28, v29
    v_cvt_pk_bf16_f32 v35, v30, v31
    s_add_u32 s68, s84, 24576
    buffer_store_dwordx4 v[32:35], v241, s[60:63], s68 offen offset:0
    v_accvgpr_read_b32 v36, a136
    v_accvgpr_read_b32 v37, a137
    v_accvgpr_read_b32 v38, a138
    v_accvgpr_read_b32 v39, a139
    v_accvgpr_read_b32 v40, a156
    v_accvgpr_read_b32 v41, a157
    v_accvgpr_read_b32 v42, a158
    v_accvgpr_read_b32 v43, a159
    v_mul_f32 v36, v36, v217
    v_mul_f32 v37, v37, v217
    v_mul_f32 v38, v38, v217
    v_mul_f32 v39, v39, v217
    v_mul_f32 v40, v40, v217
    v_mul_f32 v41, v41, v217
    v_mul_f32 v42, v42, v217
    v_mul_f32 v43, v43, v217
    v_cvt_pk_bf16_f32 v44, v36, v37
    v_cvt_pk_bf16_f32 v45, v38, v39
    v_cvt_pk_bf16_f32 v46, v40, v41
    v_cvt_pk_bf16_f32 v47, v42, v43
    s_add_u32 s68, s84, 34816
    buffer_store_dwordx4 v[44:47], v241, s[60:63], s68 offen offset:0
    s_mov_b32 s46, 0
    s_mov_b32 s50, 0
    s_add_u32 s31, s31, 1
    s_cmp_lt_u32 s31, 2
    s_cbranch_scc1 K1_ROUND
K1_END:
    s_endpgm
K1_RESC0:
    s_nop 15
    v_mov_b32 v213, v208
    s_nop 1
    v_permlane32_swap_b32 v213, v208
    v_max_f32 v208, v208, v213
    v_mov_b32 v213, v208
    s_nop 1
    v_permlane16_swap_b32 v213, v208
    v_max_f32 v208, v208, v213
    v_mov_b32 v214, v209
    s_nop 1
    v_permlane32_swap_b32 v214, v209
    v_max_f32 v209, v209, v214
    v_mov_b32 v214, v209
    s_nop 1
    v_permlane16_swap_b32 v214, v209
    v_max_f32 v209, v209, v214
    v_mov_b32 v215, v210
    s_nop 1
    v_permlane32_swap_b32 v215, v210
    v_max_f32 v210, v210, v215
    v_mov_b32 v215, v210
    s_nop 1
    v_permlane16_swap_b32 v215, v210
    v_max_f32 v210, v210, v215
    v_mov_b32 v216, v211
    s_nop 1
    v_permlane32_swap_b32 v216, v211
    v_max_f32 v211, v211, v216
    v_mov_b32 v216, v211
    s_nop 1
    v_permlane16_swap_b32 v216, v211
    v_max_f32 v211, v211, v216
    v_mov_b32 v217, v212
    s_nop 1
    v_permlane32_swap_b32 v217, v212
    v_max_f32 v212, v212, v217
    v_mov_b32 v217, v212
    s_nop 1
    v_permlane16_swap_b32 v217, v212
    v_max_f32 v212, v212, v217
    v_max_f32 v208, 0, v208
    v_sub_f32 v213, 0, v208
    v_exp_f32 v213, v213
    v_sub_f32 v164, v164, v208
    v_mul_f32 v184, v184, v213
    v_sub_f32 v165, v165, v208
    v_mul_f32 v185, v185, v213
    v_sub_f32 v166, v166, v208
    v_mul_f32 v186, v186, v213
    v_sub_f32 v167, v167, v208
    v_mul_f32 v187, v187, v213
    v_sub_f32 v40, v40, v208
    v_sub_f32 v41, v41, v208
    v_sub_f32 v42, v42, v208
    v_sub_f32 v43, v43, v208
    v_sub_f32 v60, v60, v208
    v_sub_f32 v61, v61, v208
    v_sub_f32 v62, v62, v208
    v_sub_f32 v63, v63, v208
    v_max_f32 v209, 0, v209
    v_sub_f32 v214, 0, v209
    v_exp_f32 v214, v214
    v_sub_f32 v168, v168, v209
    v_mul_f32 v188, v188, v214
    v_sub_f32 v169, v169, v209
    v_mul_f32 v189, v189, v214
    v_sub_f32 v170, v170, v209
    v_mul_f32 v190, v190, v214
    v_sub_f32 v171, v171, v209
    v_mul_f32 v191, v191, v214
    v_sub_f32 v44, v44, v209
    v_sub_f32 v45, v45, v209
    v_sub_f32 v46, v46, v209
    v_sub_f32 v47, v47, v209
    v_sub_f32 v64, v64, v209
    v_sub_f32 v65, v65, v209
    v_sub_f32 v66, v66, v209
    v_sub_f32 v67, v67, v209
    v_max_f32 v210, 0, v210
    v_sub_f32 v215, 0, v210
    v_exp_f32 v215, v215
    v_sub_f32 v172, v172, v210
    v_mul_f32 v192, v192, v215
    v_sub_f32 v173, v173, v210
    v_mul_f32 v193, v193, v215
    v_sub_f32 v174, v174, v210
    v_mul_f32 v194, v194, v215
    v_sub_f32 v175, v175, v210
    v_mul_f32 v195, v195, v215
    v_sub_f32 v48, v48, v210
    v_sub_f32 v49, v49, v210
    v_sub_f32 v50, v50, v210
    v_sub_f32 v51, v51, v210
    v_sub_f32 v68, v68, v210
    v_sub_f32 v69, v69, v210
    v_sub_f32 v70, v70, v210
    v_sub_f32 v71, v71, v210
    v_max_f32 v211, 0, v211
    v_sub_f32 v216, 0, v211
    v_exp_f32 v216, v216
    v_sub_f32 v176, v176, v211
    v_mul_f32 v196, v196, v216
    v_sub_f32 v177, v177, v211
    v_mul_f32 v197, v197, v216
    v_sub_f32 v178, v178, v211
    v_mul_f32 v198, v198, v216
    v_sub_f32 v179, v179, v211
    v_mul_f32 v199, v199, v216
    v_sub_f32 v52, v52, v211
    v_sub_f32 v53, v53, v211
    v_sub_f32 v54, v54, v211
    v_sub_f32 v55, v55, v211
    v_sub_f32 v72, v72, v211
    v_sub_f32 v73, v73, v211
    v_sub_f32 v74, v74, v211
    v_sub_f32 v75, v75, v211
    v_max_f32 v212, 0, v212
    v_sub_f32 v217, 0, v212
    v_exp_f32 v217, v217
    v_sub_f32 v180, v180, v212
    v_mul_f32 v200, v200, v217
    v_sub_f32 v181, v181, v212
    v_mul_f32 v201, v201, v217
    v_sub_f32 v182, v182, v212
    v_mul_f32 v202, v202, v217
    v_sub_f32 v183, v183, v212
    v_mul_f32 v203, v203, v217
    v_sub_f32 v56, v56, v212
    v_sub_f32 v57, v57, v212
    v_sub_f32 v58, v58, v212
    v_sub_f32 v59, v59, v212
    v_sub_f32 v76, v76, v212
    v_sub_f32 v77, v77, v212
    v_sub_f32 v78, v78, v212
    v_sub_f32 v79, v79, v212
    v_accvgpr_read_b32 v80, a0
    v_accvgpr_read_b32 v81, a1
    v_accvgpr_read_b32 v82, a2
    v_accvgpr_read_b32 v83, a3
    v_mul_f32 v80, v80, v213
    v_mul_f32 v81, v81, v213
    v_mul_f32 v82, v82, v213
    v_mul_f32 v83, v83, v213
    v_accvgpr_write_b32 a0, v80
    v_accvgpr_write_b32 a1, v81
    v_accvgpr_write_b32 a2, v82
    v_accvgpr_write_b32 a3, v83
    v_accvgpr_read_b32 v84, a4
    v_accvgpr_read_b32 v85, a5
    v_accvgpr_read_b32 v86, a6
    v_accvgpr_read_b32 v87, a7
    v_mul_f32 v84, v84, v214
    v_mul_f32 v85, v85, v214
    v_mul_f32 v86, v86, v214
    v_mul_f32 v87, v87, v214
    v_accvgpr_write_b32 a4, v84
    v_accvgpr_write_b32 a5, v85
    v_accvgpr_write_b32 a6, v86
    v_accvgpr_write_b32 a7, v87
    v_accvgpr_read_b32 v88, a8
    v_accvgpr_read_b32 v89, a9
    v_accvgpr_read_b32 v90, a10
    v_accvgpr_read_b32 v91, a11
    v_mul_f32 v88, v88, v215
    v_mul_f32 v89, v89, v215
    v_mul_f32 v90, v90, v215
    v_mul_f32 v91, v91, v215
    v_accvgpr_write_b32 a8, v88
    v_accvgpr_write_b32 a9, v89
    v_accvgpr_write_b32 a10, v90
    v_accvgpr_write_b32 a11, v91
    v_accvgpr_read_b32 v92, a12
    v_accvgpr_read_b32 v93, a13
    v_accvgpr_read_b32 v94, a14
    v_accvgpr_read_b32 v95, a15
    v_mul_f32 v92, v92, v216
    v_mul_f32 v93, v93, v216
    v_mul_f32 v94, v94, v216
    v_mul_f32 v95, v95, v216
    v_accvgpr_write_b32 a12, v92
    v_accvgpr_write_b32 a13, v93
    v_accvgpr_write_b32 a14, v94
    v_accvgpr_write_b32 a15, v95
    v_accvgpr_read_b32 v96, a16
    v_accvgpr_read_b32 v97, a17
    v_accvgpr_read_b32 v98, a18
    v_accvgpr_read_b32 v99, a19
    v_mul_f32 v96, v96, v217
    v_mul_f32 v97, v97, v217
    v_mul_f32 v98, v98, v217
    v_mul_f32 v99, v99, v217
    v_accvgpr_write_b32 a16, v96
    v_accvgpr_write_b32 a17, v97
    v_accvgpr_write_b32 a18, v98
    v_accvgpr_write_b32 a19, v99
    v_accvgpr_read_b32 v80, a20
    v_accvgpr_read_b32 v81, a21
    v_accvgpr_read_b32 v82, a22
    v_accvgpr_read_b32 v83, a23
    v_mul_f32 v80, v80, v213
    v_mul_f32 v81, v81, v213
    v_mul_f32 v82, v82, v213
    v_mul_f32 v83, v83, v213
    v_accvgpr_write_b32 a20, v80
    v_accvgpr_write_b32 a21, v81
    v_accvgpr_write_b32 a22, v82
    v_accvgpr_write_b32 a23, v83
    v_accvgpr_read_b32 v84, a24
    v_accvgpr_read_b32 v85, a25
    v_accvgpr_read_b32 v86, a26
    v_accvgpr_read_b32 v87, a27
    v_mul_f32 v84, v84, v214
    v_mul_f32 v85, v85, v214
    v_mul_f32 v86, v86, v214
    v_mul_f32 v87, v87, v214
    v_accvgpr_write_b32 a24, v84
    v_accvgpr_write_b32 a25, v85
    v_accvgpr_write_b32 a26, v86
    v_accvgpr_write_b32 a27, v87
    v_accvgpr_read_b32 v88, a28
    v_accvgpr_read_b32 v89, a29
    v_accvgpr_read_b32 v90, a30
    v_accvgpr_read_b32 v91, a31
    v_mul_f32 v88, v88, v215
    v_mul_f32 v89, v89, v215
    v_mul_f32 v90, v90, v215
    v_mul_f32 v91, v91, v215
    v_accvgpr_write_b32 a28, v88
    v_accvgpr_write_b32 a29, v89
    v_accvgpr_write_b32 a30, v90
    v_accvgpr_write_b32 a31, v91
    v_accvgpr_read_b32 v92, a32
    v_accvgpr_read_b32 v93, a33
    v_accvgpr_read_b32 v94, a34
    v_accvgpr_read_b32 v95, a35
    v_mul_f32 v92, v92, v216
    v_mul_f32 v93, v93, v216
    v_mul_f32 v94, v94, v216
    v_mul_f32 v95, v95, v216
    v_accvgpr_write_b32 a32, v92
    v_accvgpr_write_b32 a33, v93
    v_accvgpr_write_b32 a34, v94
    v_accvgpr_write_b32 a35, v95
    v_accvgpr_read_b32 v96, a36
    v_accvgpr_read_b32 v97, a37
    v_accvgpr_read_b32 v98, a38
    v_accvgpr_read_b32 v99, a39
    v_mul_f32 v96, v96, v217
    v_mul_f32 v97, v97, v217
    v_mul_f32 v98, v98, v217
    v_mul_f32 v99, v99, v217
    v_accvgpr_write_b32 a36, v96
    v_accvgpr_write_b32 a37, v97
    v_accvgpr_write_b32 a38, v98
    v_accvgpr_write_b32 a39, v99
    v_accvgpr_read_b32 v80, a40
    v_accvgpr_read_b32 v81, a41
    v_accvgpr_read_b32 v82, a42
    v_accvgpr_read_b32 v83, a43
    v_mul_f32 v80, v80, v213
    v_mul_f32 v81, v81, v213
    v_mul_f32 v82, v82, v213
    v_mul_f32 v83, v83, v213
    v_accvgpr_write_b32 a40, v80
    v_accvgpr_write_b32 a41, v81
    v_accvgpr_write_b32 a42, v82
    v_accvgpr_write_b32 a43, v83
    v_accvgpr_read_b32 v84, a44
    v_accvgpr_read_b32 v85, a45
    v_accvgpr_read_b32 v86, a46
    v_accvgpr_read_b32 v87, a47
    v_mul_f32 v84, v84, v214
    v_mul_f32 v85, v85, v214
    v_mul_f32 v86, v86, v214
    v_mul_f32 v87, v87, v214
    v_accvgpr_write_b32 a44, v84
    v_accvgpr_write_b32 a45, v85
    v_accvgpr_write_b32 a46, v86
    v_accvgpr_write_b32 a47, v87
    v_accvgpr_read_b32 v88, a48
    v_accvgpr_read_b32 v89, a49
    v_accvgpr_read_b32 v90, a50
    v_accvgpr_read_b32 v91, a51
    v_mul_f32 v88, v88, v215
    v_mul_f32 v89, v89, v215
    v_mul_f32 v90, v90, v215
    v_mul_f32 v91, v91, v215
    v_accvgpr_write_b32 a48, v88
    v_accvgpr_write_b32 a49, v89
    v_accvgpr_write_b32 a50, v90
    v_accvgpr_write_b32 a51, v91
    v_accvgpr_read_b32 v92, a52
    v_accvgpr_read_b32 v93, a53
    v_accvgpr_read_b32 v94, a54
    v_accvgpr_read_b32 v95, a55
    v_mul_f32 v92, v92, v216
    v_mul_f32 v93, v93, v216
    v_mul_f32 v94, v94, v216
    v_mul_f32 v95, v95, v216
    v_accvgpr_write_b32 a52, v92
    v_accvgpr_write_b32 a53, v93
    v_accvgpr_write_b32 a54, v94
    v_accvgpr_write_b32 a55, v95
    v_accvgpr_read_b32 v96, a56
    v_accvgpr_read_b32 v97, a57
    v_accvgpr_read_b32 v98, a58
    v_accvgpr_read_b32 v99, a59
    v_mul_f32 v96, v96, v217
    v_mul_f32 v97, v97, v217
    v_mul_f32 v98, v98, v217
    v_mul_f32 v99, v99, v217
    v_accvgpr_write_b32 a56, v96
    v_accvgpr_write_b32 a57, v97
    v_accvgpr_write_b32 a58, v98
    v_accvgpr_write_b32 a59, v99
    v_accvgpr_read_b32 v80, a60
    v_accvgpr_read_b32 v81, a61
    v_accvgpr_read_b32 v82, a62
    v_accvgpr_read_b32 v83, a63
    v_mul_f32 v80, v80, v213
    v_mul_f32 v81, v81, v213
    v_mul_f32 v82, v82, v213
    v_mul_f32 v83, v83, v213
    v_accvgpr_write_b32 a60, v80
    v_accvgpr_write_b32 a61, v81
    v_accvgpr_write_b32 a62, v82
    v_accvgpr_write_b32 a63, v83
    v_accvgpr_read_b32 v84, a64
    v_accvgpr_read_b32 v85, a65
    v_accvgpr_read_b32 v86, a66
    v_accvgpr_read_b32 v87, a67
    v_mul_f32 v84, v84, v214
    v_mul_f32 v85, v85, v214
    v_mul_f32 v86, v86, v214
    v_mul_f32 v87, v87, v214
    v_accvgpr_write_b32 a64, v84
    v_accvgpr_write_b32 a65, v85
    v_accvgpr_write_b32 a66, v86
    v_accvgpr_write_b32 a67, v87
    v_accvgpr_read_b32 v88, a68
    v_accvgpr_read_b32 v89, a69
    v_accvgpr_read_b32 v90, a70
    v_accvgpr_read_b32 v91, a71
    v_mul_f32 v88, v88, v215
    v_mul_f32 v89, v89, v215
    v_mul_f32 v90, v90, v215
    v_mul_f32 v91, v91, v215
    v_accvgpr_write_b32 a68, v88
    v_accvgpr_write_b32 a69, v89
    v_accvgpr_write_b32 a70, v90
    v_accvgpr_write_b32 a71, v91
    v_accvgpr_read_b32 v92, a72
    v_accvgpr_read_b32 v93, a73
    v_accvgpr_read_b32 v94, a74
    v_accvgpr_read_b32 v95, a75
    v_mul_f32 v92, v92, v216
    v_mul_f32 v93, v93, v216
    v_mul_f32 v94, v94, v216
    v_mul_f32 v95, v95, v216
    v_accvgpr_write_b32 a72, v92
    v_accvgpr_write_b32 a73, v93
    v_accvgpr_write_b32 a74, v94
    v_accvgpr_write_b32 a75, v95
    v_accvgpr_read_b32 v96, a76
    v_accvgpr_read_b32 v97, a77
    v_accvgpr_read_b32 v98, a78
    v_accvgpr_read_b32 v99, a79
    v_mul_f32 v96, v96, v217
    v_mul_f32 v97, v97, v217
    v_mul_f32 v98, v98, v217
    v_mul_f32 v99, v99, v217
    v_accvgpr_write_b32 a76, v96
    v_accvgpr_write_b32 a77, v97
    v_accvgpr_write_b32 a78, v98
    v_accvgpr_write_b32 a79, v99
    v_accvgpr_read_b32 v80, a80
    v_accvgpr_read_b32 v81, a81
    v_accvgpr_read_b32 v82, a82
    v_accvgpr_read_b32 v83, a83
    v_mul_f32 v80, v80, v213
    v_mul_f32 v81, v81, v213
    v_mul_f32 v82, v82, v213
    v_mul_f32 v83, v83, v213
    v_accvgpr_write_b32 a80, v80
    v_accvgpr_write_b32 a81, v81
    v_accvgpr_write_b32 a82, v82
    v_accvgpr_write_b32 a83, v83
    v_accvgpr_read_b32 v84, a84
    v_accvgpr_read_b32 v85, a85
    v_accvgpr_read_b32 v86, a86
    v_accvgpr_read_b32 v87, a87
    v_mul_f32 v84, v84, v214
    v_mul_f32 v85, v85, v214
    v_mul_f32 v86, v86, v214
    v_mul_f32 v87, v87, v214
    v_accvgpr_write_b32 a84, v84
    v_accvgpr_write_b32 a85, v85
    v_accvgpr_write_b32 a86, v86
    v_accvgpr_write_b32 a87, v87
    v_accvgpr_read_b32 v88, a88
    v_accvgpr_read_b32 v89, a89
    v_accvgpr_read_b32 v90, a90
    v_accvgpr_read_b32 v91, a91
    v_mul_f32 v88, v88, v215
    v_mul_f32 v89, v89, v215
    v_mul_f32 v90, v90, v215
    v_mul_f32 v91, v91, v215
    v_accvgpr_write_b32 a88, v88
    v_accvgpr_write_b32 a89, v89
    v_accvgpr_write_b32 a90, v90
    v_accvgpr_write_b32 a91, v91
    v_accvgpr_read_b32 v92, a92
    v_accvgpr_read_b32 v93, a93
    v_accvgpr_read_b32 v94, a94
    v_accvgpr_read_b32 v95, a95
    v_mul_f32 v92, v92, v216
    v_mul_f32 v93, v93, v216
    v_mul_f32 v94, v94, v216
    v_mul_f32 v95, v95, v216
    v_accvgpr_write_b32 a92, v92
    v_accvgpr_write_b32 a93, v93
    v_accvgpr_write_b32 a94, v94
    v_accvgpr_write_b32 a95, v95
    v_accvgpr_read_b32 v96, a96
    v_accvgpr_read_b32 v97, a97
    v_accvgpr_read_b32 v98, a98
    v_accvgpr_read_b32 v99, a99
    v_mul_f32 v96, v96, v217
    v_mul_f32 v97, v97, v217
    v_mul_f32 v98, v98, v217
    v_mul_f32 v99, v99, v217
    v_accvgpr_write_b32 a96, v96
    v_accvgpr_write_b32 a97, v97
    v_accvgpr_write_b32 a98, v98
    v_accvgpr_write_b32 a99, v99
    v_accvgpr_read_b32 v80, a100
    v_accvgpr_read_b32 v81, a101
    v_accvgpr_read_b32 v82, a102
    v_accvgpr_read_b32 v83, a103
    v_mul_f32 v80, v80, v213
    v_mul_f32 v81, v81, v213
    v_mul_f32 v82, v82, v213
    v_mul_f32 v83, v83, v213
    v_accvgpr_write_b32 a100, v80
    v_accvgpr_write_b32 a101, v81
    v_accvgpr_write_b32 a102, v82
    v_accvgpr_write_b32 a103, v83
    v_accvgpr_read_b32 v84, a104
    v_accvgpr_read_b32 v85, a105
    v_accvgpr_read_b32 v86, a106
    v_accvgpr_read_b32 v87, a107
    v_mul_f32 v84, v84, v214
    v_mul_f32 v85, v85, v214
    v_mul_f32 v86, v86, v214
    v_mul_f32 v87, v87, v214
    v_accvgpr_write_b32 a104, v84
    v_accvgpr_write_b32 a105, v85
    v_accvgpr_write_b32 a106, v86
    v_accvgpr_write_b32 a107, v87
    v_accvgpr_read_b32 v88, a108
    v_accvgpr_read_b32 v89, a109
    v_accvgpr_read_b32 v90, a110
    v_accvgpr_read_b32 v91, a111
    v_mul_f32 v88, v88, v215
    v_mul_f32 v89, v89, v215
    v_mul_f32 v90, v90, v215
    v_mul_f32 v91, v91, v215
    v_accvgpr_write_b32 a108, v88
    v_accvgpr_write_b32 a109, v89
    v_accvgpr_write_b32 a110, v90
    v_accvgpr_write_b32 a111, v91
    v_accvgpr_read_b32 v92, a112
    v_accvgpr_read_b32 v93, a113
    v_accvgpr_read_b32 v94, a114
    v_accvgpr_read_b32 v95, a115
    v_mul_f32 v92, v92, v216
    v_mul_f32 v93, v93, v216
    v_mul_f32 v94, v94, v216
    v_mul_f32 v95, v95, v216
    v_accvgpr_write_b32 a112, v92
    v_accvgpr_write_b32 a113, v93
    v_accvgpr_write_b32 a114, v94
    v_accvgpr_write_b32 a115, v95
    v_accvgpr_read_b32 v96, a116
    v_accvgpr_read_b32 v97, a117
    v_accvgpr_read_b32 v98, a118
    v_accvgpr_read_b32 v99, a119
    v_mul_f32 v96, v96, v217
    v_mul_f32 v97, v97, v217
    v_mul_f32 v98, v98, v217
    v_mul_f32 v99, v99, v217
    v_accvgpr_write_b32 a116, v96
    v_accvgpr_write_b32 a117, v97
    v_accvgpr_write_b32 a118, v98
    v_accvgpr_write_b32 a119, v99
    v_accvgpr_read_b32 v80, a120
    v_accvgpr_read_b32 v81, a121
    v_accvgpr_read_b32 v82, a122
    v_accvgpr_read_b32 v83, a123
    v_mul_f32 v80, v80, v213
    v_mul_f32 v81, v81, v213
    v_mul_f32 v82, v82, v213
    v_mul_f32 v83, v83, v213
    v_accvgpr_write_b32 a120, v80
    v_accvgpr_write_b32 a121, v81
    v_accvgpr_write_b32 a122, v82
    v_accvgpr_write_b32 a123, v83
    v_accvgpr_read_b32 v84, a124
    v_accvgpr_read_b32 v85, a125
    v_accvgpr_read_b32 v86, a126
    v_accvgpr_read_b32 v87, a127
    v_mul_f32 v84, v84, v214
    v_mul_f32 v85, v85, v214
    v_mul_f32 v86, v86, v214
    v_mul_f32 v87, v87, v214
    v_accvgpr_write_b32 a124, v84
    v_accvgpr_write_b32 a125, v85
    v_accvgpr_write_b32 a126, v86
    v_accvgpr_write_b32 a127, v87
    v_accvgpr_read_b32 v88, a128
    v_accvgpr_read_b32 v89, a129
    v_accvgpr_read_b32 v90, a130
    v_accvgpr_read_b32 v91, a131
    v_mul_f32 v88, v88, v215
    v_mul_f32 v89, v89, v215
    v_mul_f32 v90, v90, v215
    v_mul_f32 v91, v91, v215
    v_accvgpr_write_b32 a128, v88
    v_accvgpr_write_b32 a129, v89
    v_accvgpr_write_b32 a130, v90
    v_accvgpr_write_b32 a131, v91
    v_accvgpr_read_b32 v92, a132
    v_accvgpr_read_b32 v93, a133
    v_accvgpr_read_b32 v94, a134
    v_accvgpr_read_b32 v95, a135
    v_mul_f32 v92, v92, v216
    v_mul_f32 v93, v93, v216
    v_mul_f32 v94, v94, v216
    v_mul_f32 v95, v95, v216
    v_accvgpr_write_b32 a132, v92
    v_accvgpr_write_b32 a133, v93
    v_accvgpr_write_b32 a134, v94
    v_accvgpr_write_b32 a135, v95
    v_accvgpr_read_b32 v96, a136
    v_accvgpr_read_b32 v97, a137
    v_accvgpr_read_b32 v98, a138
    v_accvgpr_read_b32 v99, a139
    v_mul_f32 v96, v96, v217
    v_mul_f32 v97, v97, v217
    v_mul_f32 v98, v98, v217
    v_mul_f32 v99, v99, v217
    v_accvgpr_write_b32 a136, v96
    v_accvgpr_write_b32 a137, v97
    v_accvgpr_write_b32 a138, v98
    v_accvgpr_write_b32 a139, v99
    v_accvgpr_read_b32 v80, a140
    v_accvgpr_read_b32 v81, a141
    v_accvgpr_read_b32 v82, a142
    v_accvgpr_read_b32 v83, a143
    v_mul_f32 v80, v80, v213
    v_mul_f32 v81, v81, v213
    v_mul_f32 v82, v82, v213
    v_mul_f32 v83, v83, v213
    v_accvgpr_write_b32 a140, v80
    v_accvgpr_write_b32 a141, v81
    v_accvgpr_write_b32 a142, v82
    v_accvgpr_write_b32 a143, v83
    v_accvgpr_read_b32 v84, a144
    v_accvgpr_read_b32 v85, a145
    v_accvgpr_read_b32 v86, a146
    v_accvgpr_read_b32 v87, a147
    v_mul_f32 v84, v84, v214
    v_mul_f32 v85, v85, v214
    v_mul_f32 v86, v86, v214
    v_mul_f32 v87, v87, v214
    v_accvgpr_write_b32 a144, v84
    v_accvgpr_write_b32 a145, v85
    v_accvgpr_write_b32 a146, v86
    v_accvgpr_write_b32 a147, v87
    v_accvgpr_read_b32 v88, a148
    v_accvgpr_read_b32 v89, a149
    v_accvgpr_read_b32 v90, a150
    v_accvgpr_read_b32 v91, a151
    v_mul_f32 v88, v88, v215
    v_mul_f32 v89, v89, v215
    v_mul_f32 v90, v90, v215
    v_mul_f32 v91, v91, v215
    v_accvgpr_write_b32 a148, v88
    v_accvgpr_write_b32 a149, v89
    v_accvgpr_write_b32 a150, v90
    v_accvgpr_write_b32 a151, v91
    v_accvgpr_read_b32 v92, a152
    v_accvgpr_read_b32 v93, a153
    v_accvgpr_read_b32 v94, a154
    v_accvgpr_read_b32 v95, a155
    v_mul_f32 v92, v92, v216
    v_mul_f32 v93, v93, v216
    v_mul_f32 v94, v94, v216
    v_mul_f32 v95, v95, v216
    v_accvgpr_write_b32 a152, v92
    v_accvgpr_write_b32 a153, v93
    v_accvgpr_write_b32 a154, v94
    v_accvgpr_write_b32 a155, v95
    v_accvgpr_read_b32 v96, a156
    v_accvgpr_read_b32 v97, a157
    v_accvgpr_read_b32 v98, a158
    v_accvgpr_read_b32 v99, a159
    v_mul_f32 v96, v96, v217
    v_mul_f32 v97, v97, v217
    v_mul_f32 v98, v98, v217
    v_mul_f32 v99, v99, v217
    v_accvgpr_write_b32 a156, v96
    v_accvgpr_write_b32 a157, v97
    v_accvgpr_write_b32 a158, v98
    v_accvgpr_write_b32 a159, v99
    s_nop 3
    s_branch K1_RESC0_RET
K1_RESC1:
    s_nop 15
    v_mov_b32 v213, v208
    s_nop 1
    v_permlane32_swap_b32 v213, v208
    v_max_f32 v208, v208, v213
    v_mov_b32 v213, v208
    s_nop 1
    v_permlane16_swap_b32 v213, v208
    v_max_f32 v208, v208, v213
    v_mov_b32 v214, v209
    s_nop 1
    v_permlane32_swap_b32 v214, v209
    v_max_f32 v209, v209, v214
    v_mov_b32 v214, v209
    s_nop 1
    v_permlane16_swap_b32 v214, v209
    v_max_f32 v209, v209, v214
    v_mov_b32 v215, v210
    s_nop 1
    v_permlane32_swap_b32 v215, v210
    v_max_f32 v210, v210, v215
    v_mov_b32 v215, v210
    s_nop 1
    v_permlane16_swap_b32 v215, v210
    v_max_f32 v210, v210, v215
    v_mov_b32 v216, v211
    s_nop 1
    v_permlane32_swap_b32 v216, v211
    v_max_f32 v211, v211, v216
    v_mov_b32 v216, v211
    s_nop 1
    v_permlane16_swap_b32 v216, v211
    v_max_f32 v211, v211, v216
    v_mov_b32 v217, v212
    s_nop 1
    v_permlane32_swap_b32 v217, v212
    v_max_f32 v212, v212, v217
    v_mov_b32 v217, v212
    s_nop 1
    v_permlane16_swap_b32 v217, v212
    v_max_f32 v212, v212, v217
    v_max_f32 v208, 0, v208
    v_sub_f32 v213, 0, v208
    v_exp_f32 v213, v213
    v_sub_f32 v164, v164, v208
    v_mul_f32 v184, v184, v213
    v_sub_f32 v165, v165, v208
    v_mul_f32 v185, v185, v213
    v_sub_f32 v166, v166, v208
    v_mul_f32 v186, v186, v213
    v_sub_f32 v167, v167, v208
    v_mul_f32 v187, v187, v213
    v_sub_f32 v0, v0, v208
    v_sub_f32 v1, v1, v208
    v_sub_f32 v2, v2, v208
    v_sub_f32 v3, v3, v208
    v_sub_f32 v20, v20, v208
    v_sub_f32 v21, v21, v208
    v_sub_f32 v22, v22, v208
    v_sub_f32 v23, v23, v208
    v_max_f32 v209, 0, v209
    v_sub_f32 v214, 0, v209
    v_exp_f32 v214, v214
    v_sub_f32 v168, v168, v209
    v_mul_f32 v188, v188, v214
    v_sub_f32 v169, v169, v209
    v_mul_f32 v189, v189, v214
    v_sub_f32 v170, v170, v209
    v_mul_f32 v190, v190, v214
    v_sub_f32 v171, v171, v209
    v_mul_f32 v191, v191, v214
    v_sub_f32 v4, v4, v209
    v_sub_f32 v5, v5, v209
    v_sub_f32 v6, v6, v209
    v_sub_f32 v7, v7, v209
    v_sub_f32 v24, v24, v209
    v_sub_f32 v25, v25, v209
    v_sub_f32 v26, v26, v209
    v_sub_f32 v27, v27, v209
    v_max_f32 v210, 0, v210
    v_sub_f32 v215, 0, v210
    v_exp_f32 v215, v215
    v_sub_f32 v172, v172, v210
    v_mul_f32 v192, v192, v215
    v_sub_f32 v173, v173, v210
    v_mul_f32 v193, v193, v215
    v_sub_f32 v174, v174, v210
    v_mul_f32 v194, v194, v215
    v_sub_f32 v175, v175, v210
    v_mul_f32 v195, v195, v215
    v_sub_f32 v8, v8, v210
    v_sub_f32 v9, v9, v210
    v_sub_f32 v10, v10, v210
    v_sub_f32 v11, v11, v210
    v_sub_f32 v28, v28, v210
    v_sub_f32 v29, v29, v210
    v_sub_f32 v30, v30, v210
    v_sub_f32 v31, v31, v210
    v_max_f32 v211, 0, v211
    v_sub_f32 v216, 0, v211
    v_exp_f32 v216, v216
    v_sub_f32 v176, v176, v211
    v_mul_f32 v196, v196, v216
    v_sub_f32 v177, v177, v211
    v_mul_f32 v197, v197, v216
    v_sub_f32 v178, v178, v211
    v_mul_f32 v198, v198, v216
    v_sub_f32 v179, v179, v211
    v_mul_f32 v199, v199, v216
    v_sub_f32 v12, v12, v211
    v_sub_f32 v13, v13, v211
    v_sub_f32 v14, v14, v211
    v_sub_f32 v15, v15, v211
    v_sub_f32 v32, v32, v211
    v_sub_f32 v33, v33, v211
    v_sub_f32 v34, v34, v211
    v_sub_f32 v35, v35, v211
    v_max_f32 v212, 0, v212
    v_sub_f32 v217, 0, v212
    v_exp_f32 v217, v217
    v_sub_f32 v180, v180, v212
    v_mul_f32 v200, v200, v217
    v_sub_f32 v181, v181, v212
    v_mul_f32 v201, v201, v217
    v_sub_f32 v182, v182, v212
    v_mul_f32 v202, v202, v217
    v_sub_f32 v183, v183, v212
    v_mul_f32 v203, v203, v217
    v_sub_f32 v16, v16, v212
    v_sub_f32 v17, v17, v212
    v_sub_f32 v18, v18, v212
    v_sub_f32 v19, v19, v212
    v_sub_f32 v36, v36, v212
    v_sub_f32 v37, v37, v212
    v_sub_f32 v38, v38, v212
    v_sub_f32 v39, v39, v212
    v_accvgpr_read_b32 v80, a0
    v_accvgpr_read_b32 v81, a1
    v_accvgpr_read_b32 v82, a2
    v_accvgpr_read_b32 v83, a3
    v_mul_f32 v80, v80, v213
    v_mul_f32 v81, v81, v213
    v_mul_f32 v82, v82, v213
    v_mul_f32 v83, v83, v213
    v_accvgpr_write_b32 a0, v80
    v_accvgpr_write_b32 a1, v81
    v_accvgpr_write_b32 a2, v82
    v_accvgpr_write_b32 a3, v83
    v_accvgpr_read_b32 v84, a4
    v_accvgpr_read_b32 v85, a5
    v_accvgpr_read_b32 v86, a6
    v_accvgpr_read_b32 v87, a7
    v_mul_f32 v84, v84, v214
    v_mul_f32 v85, v85, v214
    v_mul_f32 v86, v86, v214
    v_mul_f32 v87, v87, v214
    v_accvgpr_write_b32 a4, v84
    v_accvgpr_write_b32 a5, v85
    v_accvgpr_write_b32 a6, v86
    v_accvgpr_write_b32 a7, v87
    v_accvgpr_read_b32 v88, a8
    v_accvgpr_read_b32 v89, a9
    v_accvgpr_read_b32 v90, a10
    v_accvgpr_read_b32 v91, a11
    v_mul_f32 v88, v88, v215
    v_mul_f32 v89, v89, v215
    v_mul_f32 v90, v90, v215
    v_mul_f32 v91, v91, v215
    v_accvgpr_write_b32 a8, v88
    v_accvgpr_write_b32 a9, v89
    v_accvgpr_write_b32 a10, v90
    v_accvgpr_write_b32 a11, v91
    v_accvgpr_read_b32 v92, a12
    v_accvgpr_read_b32 v93, a13
    v_accvgpr_read_b32 v94, a14
    v_accvgpr_read_b32 v95, a15
    v_mul_f32 v92, v92, v216
    v_mul_f32 v93, v93, v216
    v_mul_f32 v94, v94, v216
    v_mul_f32 v95, v95, v216
    v_accvgpr_write_b32 a12, v92
    v_accvgpr_write_b32 a13, v93
    v_accvgpr_write_b32 a14, v94
    v_accvgpr_write_b32 a15, v95
    v_accvgpr_read_b32 v96, a16
    v_accvgpr_read_b32 v97, a17
    v_accvgpr_read_b32 v98, a18
    v_accvgpr_read_b32 v99, a19
    v_mul_f32 v96, v96, v217
    v_mul_f32 v97, v97, v217
    v_mul_f32 v98, v98, v217
    v_mul_f32 v99, v99, v217
    v_accvgpr_write_b32 a16, v96
    v_accvgpr_write_b32 a17, v97
    v_accvgpr_write_b32 a18, v98
    v_accvgpr_write_b32 a19, v99
    v_accvgpr_read_b32 v80, a20
    v_accvgpr_read_b32 v81, a21
    v_accvgpr_read_b32 v82, a22
    v_accvgpr_read_b32 v83, a23
    v_mul_f32 v80, v80, v213
    v_mul_f32 v81, v81, v213
    v_mul_f32 v82, v82, v213
    v_mul_f32 v83, v83, v213
    v_accvgpr_write_b32 a20, v80
    v_accvgpr_write_b32 a21, v81
    v_accvgpr_write_b32 a22, v82
    v_accvgpr_write_b32 a23, v83
    v_accvgpr_read_b32 v84, a24
    v_accvgpr_read_b32 v85, a25
    v_accvgpr_read_b32 v86, a26
    v_accvgpr_read_b32 v87, a27
    v_mul_f32 v84, v84, v214
    v_mul_f32 v85, v85, v214
    v_mul_f32 v86, v86, v214
    v_mul_f32 v87, v87, v214
    v_accvgpr_write_b32 a24, v84
    v_accvgpr_write_b32 a25, v85
    v_accvgpr_write_b32 a26, v86
    v_accvgpr_write_b32 a27, v87
    v_accvgpr_read_b32 v88, a28
    v_accvgpr_read_b32 v89, a29
    v_accvgpr_read_b32 v90, a30
    v_accvgpr_read_b32 v91, a31
    v_mul_f32 v88, v88, v215
    v_mul_f32 v89, v89, v215
    v_mul_f32 v90, v90, v215
    v_mul_f32 v91, v91, v215
    v_accvgpr_write_b32 a28, v88
    v_accvgpr_write_b32 a29, v89
    v_accvgpr_write_b32 a30, v90
    v_accvgpr_write_b32 a31, v91
    v_accvgpr_read_b32 v92, a32
    v_accvgpr_read_b32 v93, a33
    v_accvgpr_read_b32 v94, a34
    v_accvgpr_read_b32 v95, a35
    v_mul_f32 v92, v92, v216
    v_mul_f32 v93, v93, v216
    v_mul_f32 v94, v94, v216
    v_mul_f32 v95, v95, v216
    v_accvgpr_write_b32 a32, v92
    v_accvgpr_write_b32 a33, v93
    v_accvgpr_write_b32 a34, v94
    v_accvgpr_write_b32 a35, v95
    v_accvgpr_read_b32 v96, a36
    v_accvgpr_read_b32 v97, a37
    v_accvgpr_read_b32 v98, a38
    v_accvgpr_read_b32 v99, a39
    v_mul_f32 v96, v96, v217
    v_mul_f32 v97, v97, v217
    v_mul_f32 v98, v98, v217
    v_mul_f32 v99, v99, v217
    v_accvgpr_write_b32 a36, v96
    v_accvgpr_write_b32 a37, v97
    v_accvgpr_write_b32 a38, v98
    v_accvgpr_write_b32 a39, v99
    v_accvgpr_read_b32 v80, a40
    v_accvgpr_read_b32 v81, a41
    v_accvgpr_read_b32 v82, a42
    v_accvgpr_read_b32 v83, a43
    v_mul_f32 v80, v80, v213
    v_mul_f32 v81, v81, v213
    v_mul_f32 v82, v82, v213
    v_mul_f32 v83, v83, v213
    v_accvgpr_write_b32 a40, v80
    v_accvgpr_write_b32 a41, v81
    v_accvgpr_write_b32 a42, v82
    v_accvgpr_write_b32 a43, v83
    v_accvgpr_read_b32 v84, a44
    v_accvgpr_read_b32 v85, a45
    v_accvgpr_read_b32 v86, a46
    v_accvgpr_read_b32 v87, a47
    v_mul_f32 v84, v84, v214
    v_mul_f32 v85, v85, v214
    v_mul_f32 v86, v86, v214
    v_mul_f32 v87, v87, v214
    v_accvgpr_write_b32 a44, v84
    v_accvgpr_write_b32 a45, v85
    v_accvgpr_write_b32 a46, v86
    v_accvgpr_write_b32 a47, v87
    v_accvgpr_read_b32 v88, a48
    v_accvgpr_read_b32 v89, a49
    v_accvgpr_read_b32 v90, a50
    v_accvgpr_read_b32 v91, a51
    v_mul_f32 v88, v88, v215
    v_mul_f32 v89, v89, v215
    v_mul_f32 v90, v90, v215
    v_mul_f32 v91, v91, v215
    v_accvgpr_write_b32 a48, v88
    v_accvgpr_write_b32 a49, v89
    v_accvgpr_write_b32 a50, v90
    v_accvgpr_write_b32 a51, v91
    v_accvgpr_read_b32 v92, a52
    v_accvgpr_read_b32 v93, a53
    v_accvgpr_read_b32 v94, a54
    v_accvgpr_read_b32 v95, a55
    v_mul_f32 v92, v92, v216
    v_mul_f32 v93, v93, v216
    v_mul_f32 v94, v94, v216
    v_mul_f32 v95, v95, v216
    v_accvgpr_write_b32 a52, v92
    v_accvgpr_write_b32 a53, v93
    v_accvgpr_write_b32 a54, v94
    v_accvgpr_write_b32 a55, v95
    v_accvgpr_read_b32 v96, a56
    v_accvgpr_read_b32 v97, a57
    v_accvgpr_read_b32 v98, a58
    v_accvgpr_read_b32 v99, a59
    v_mul_f32 v96, v96, v217
    v_mul_f32 v97, v97, v217
    v_mul_f32 v98, v98, v217
    v_mul_f32 v99, v99, v217
    v_accvgpr_write_b32 a56, v96
    v_accvgpr_write_b32 a57, v97
    v_accvgpr_write_b32 a58, v98
    v_accvgpr_write_b32 a59, v99
    v_accvgpr_read_b32 v80, a60
    v_accvgpr_read_b32 v81, a61
    v_accvgpr_read_b32 v82, a62
    v_accvgpr_read_b32 v83, a63
    v_mul_f32 v80, v80, v213
    v_mul_f32 v81, v81, v213
    v_mul_f32 v82, v82, v213
    v_mul_f32 v83, v83, v213
    v_accvgpr_write_b32 a60, v80
    v_accvgpr_write_b32 a61, v81
    v_accvgpr_write_b32 a62, v82
    v_accvgpr_write_b32 a63, v83
    v_accvgpr_read_b32 v84, a64
    v_accvgpr_read_b32 v85, a65
    v_accvgpr_read_b32 v86, a66
    v_accvgpr_read_b32 v87, a67
    v_mul_f32 v84, v84, v214
    v_mul_f32 v85, v85, v214
    v_mul_f32 v86, v86, v214
    v_mul_f32 v87, v87, v214
    v_accvgpr_write_b32 a64, v84
    v_accvgpr_write_b32 a65, v85
    v_accvgpr_write_b32 a66, v86
    v_accvgpr_write_b32 a67, v87
    v_accvgpr_read_b32 v88, a68
    v_accvgpr_read_b32 v89, a69
    v_accvgpr_read_b32 v90, a70
    v_accvgpr_read_b32 v91, a71
    v_mul_f32 v88, v88, v215
    v_mul_f32 v89, v89, v215
    v_mul_f32 v90, v90, v215
    v_mul_f32 v91, v91, v215
    v_accvgpr_write_b32 a68, v88
    v_accvgpr_write_b32 a69, v89
    v_accvgpr_write_b32 a70, v90
    v_accvgpr_write_b32 a71, v91
    v_accvgpr_read_b32 v92, a72
    v_accvgpr_read_b32 v93, a73
    v_accvgpr_read_b32 v94, a74
    v_accvgpr_read_b32 v95, a75
    v_mul_f32 v92, v92, v216
    v_mul_f32 v93, v93, v216
    v_mul_f32 v94, v94, v216
    v_mul_f32 v95, v95, v216
    v_accvgpr_write_b32 a72, v92
    v_accvgpr_write_b32 a73, v93
    v_accvgpr_write_b32 a74, v94
    v_accvgpr_write_b32 a75, v95
    v_accvgpr_read_b32 v96, a76
    v_accvgpr_read_b32 v97, a77
    v_accvgpr_read_b32 v98, a78
    v_accvgpr_read_b32 v99, a79
    v_mul_f32 v96, v96, v217
    v_mul_f32 v97, v97, v217
    v_mul_f32 v98, v98, v217
    v_mul_f32 v99, v99, v217
    v_accvgpr_write_b32 a76, v96
    v_accvgpr_write_b32 a77, v97
    v_accvgpr_write_b32 a78, v98
    v_accvgpr_write_b32 a79, v99
    v_accvgpr_read_b32 v80, a80
    v_accvgpr_read_b32 v81, a81
    v_accvgpr_read_b32 v82, a82
    v_accvgpr_read_b32 v83, a83
    v_mul_f32 v80, v80, v213
    v_mul_f32 v81, v81, v213
    v_mul_f32 v82, v82, v213
    v_mul_f32 v83, v83, v213
    v_accvgpr_write_b32 a80, v80
    v_accvgpr_write_b32 a81, v81
    v_accvgpr_write_b32 a82, v82
    v_accvgpr_write_b32 a83, v83
    v_accvgpr_read_b32 v84, a84
    v_accvgpr_read_b32 v85, a85
    v_accvgpr_read_b32 v86, a86
    v_accvgpr_read_b32 v87, a87
    v_mul_f32 v84, v84, v214
    v_mul_f32 v85, v85, v214
    v_mul_f32 v86, v86, v214
    v_mul_f32 v87, v87, v214
    v_accvgpr_write_b32 a84, v84
    v_accvgpr_write_b32 a85, v85
    v_accvgpr_write_b32 a86, v86
    v_accvgpr_write_b32 a87, v87
    v_accvgpr_read_b32 v88, a88
    v_accvgpr_read_b32 v89, a89
    v_accvgpr_read_b32 v90, a90
    v_accvgpr_read_b32 v91, a91
    v_mul_f32 v88, v88, v215
    v_mul_f32 v89, v89, v215
    v_mul_f32 v90, v90, v215
    v_mul_f32 v91, v91, v215
    v_accvgpr_write_b32 a88, v88
    v_accvgpr_write_b32 a89, v89
    v_accvgpr_write_b32 a90, v90
    v_accvgpr_write_b32 a91, v91
    v_accvgpr_read_b32 v92, a92
    v_accvgpr_read_b32 v93, a93
    v_accvgpr_read_b32 v94, a94
    v_accvgpr_read_b32 v95, a95
    v_mul_f32 v92, v92, v216
    v_mul_f32 v93, v93, v216
    v_mul_f32 v94, v94, v216
    v_mul_f32 v95, v95, v216
    v_accvgpr_write_b32 a92, v92
    v_accvgpr_write_b32 a93, v93
    v_accvgpr_write_b32 a94, v94
    v_accvgpr_write_b32 a95, v95
    v_accvgpr_read_b32 v96, a96
    v_accvgpr_read_b32 v97, a97
    v_accvgpr_read_b32 v98, a98
    v_accvgpr_read_b32 v99, a99
    v_mul_f32 v96, v96, v217
    v_mul_f32 v97, v97, v217
    v_mul_f32 v98, v98, v217
    v_mul_f32 v99, v99, v217
    v_accvgpr_write_b32 a96, v96
    v_accvgpr_write_b32 a97, v97
    v_accvgpr_write_b32 a98, v98
    v_accvgpr_write_b32 a99, v99
    v_accvgpr_read_b32 v80, a100
    v_accvgpr_read_b32 v81, a101
    v_accvgpr_read_b32 v82, a102
    v_accvgpr_read_b32 v83, a103
    v_mul_f32 v80, v80, v213
    v_mul_f32 v81, v81, v213
    v_mul_f32 v82, v82, v213
    v_mul_f32 v83, v83, v213
    v_accvgpr_write_b32 a100, v80
    v_accvgpr_write_b32 a101, v81
    v_accvgpr_write_b32 a102, v82
    v_accvgpr_write_b32 a103, v83
    v_accvgpr_read_b32 v84, a104
    v_accvgpr_read_b32 v85, a105
    v_accvgpr_read_b32 v86, a106
    v_accvgpr_read_b32 v87, a107
    v_mul_f32 v84, v84, v214
    v_mul_f32 v85, v85, v214
    v_mul_f32 v86, v86, v214
    v_mul_f32 v87, v87, v214
    v_accvgpr_write_b32 a104, v84
    v_accvgpr_write_b32 a105, v85
    v_accvgpr_write_b32 a106, v86
    v_accvgpr_write_b32 a107, v87
    v_accvgpr_read_b32 v88, a108
    v_accvgpr_read_b32 v89, a109
    v_accvgpr_read_b32 v90, a110
    v_accvgpr_read_b32 v91, a111
    v_mul_f32 v88, v88, v215
    v_mul_f32 v89, v89, v215
    v_mul_f32 v90, v90, v215
    v_mul_f32 v91, v91, v215
    v_accvgpr_write_b32 a108, v88
    v_accvgpr_write_b32 a109, v89
    v_accvgpr_write_b32 a110, v90
    v_accvgpr_write_b32 a111, v91
    v_accvgpr_read_b32 v92, a112
    v_accvgpr_read_b32 v93, a113
    v_accvgpr_read_b32 v94, a114
    v_accvgpr_read_b32 v95, a115
    v_mul_f32 v92, v92, v216
    v_mul_f32 v93, v93, v216
    v_mul_f32 v94, v94, v216
    v_mul_f32 v95, v95, v216
    v_accvgpr_write_b32 a112, v92
    v_accvgpr_write_b32 a113, v93
    v_accvgpr_write_b32 a114, v94
    v_accvgpr_write_b32 a115, v95
    v_accvgpr_read_b32 v96, a116
    v_accvgpr_read_b32 v97, a117
    v_accvgpr_read_b32 v98, a118
    v_accvgpr_read_b32 v99, a119
    v_mul_f32 v96, v96, v217
    v_mul_f32 v97, v97, v217
    v_mul_f32 v98, v98, v217
    v_mul_f32 v99, v99, v217
    v_accvgpr_write_b32 a116, v96
    v_accvgpr_write_b32 a117, v97
    v_accvgpr_write_b32 a118, v98
    v_accvgpr_write_b32 a119, v99
    v_accvgpr_read_b32 v80, a120
    v_accvgpr_read_b32 v81, a121
    v_accvgpr_read_b32 v82, a122
    v_accvgpr_read_b32 v83, a123
    v_mul_f32 v80, v80, v213
    v_mul_f32 v81, v81, v213
    v_mul_f32 v82, v82, v213
    v_mul_f32 v83, v83, v213
    v_accvgpr_write_b32 a120, v80
    v_accvgpr_write_b32 a121, v81
    v_accvgpr_write_b32 a122, v82
    v_accvgpr_write_b32 a123, v83
    v_accvgpr_read_b32 v84, a124
    v_accvgpr_read_b32 v85, a125
    v_accvgpr_read_b32 v86, a126
    v_accvgpr_read_b32 v87, a127
    v_mul_f32 v84, v84, v214
    v_mul_f32 v85, v85, v214
    v_mul_f32 v86, v86, v214
    v_mul_f32 v87, v87, v214
    v_accvgpr_write_b32 a124, v84
    v_accvgpr_write_b32 a125, v85
    v_accvgpr_write_b32 a126, v86
    v_accvgpr_write_b32 a127, v87
    v_accvgpr_read_b32 v88, a128
    v_accvgpr_read_b32 v89, a129
    v_accvgpr_read_b32 v90, a130
    v_accvgpr_read_b32 v91, a131
    v_mul_f32 v88, v88, v215
    v_mul_f32 v89, v89, v215
    v_mul_f32 v90, v90, v215
    v_mul_f32 v91, v91, v215
    v_accvgpr_write_b32 a128, v88
    v_accvgpr_write_b32 a129, v89
    v_accvgpr_write_b32 a130, v90
    v_accvgpr_write_b32 a131, v91
    v_accvgpr_read_b32 v92, a132
    v_accvgpr_read_b32 v93, a133
    v_accvgpr_read_b32 v94, a134
    v_accvgpr_read_b32 v95, a135
    v_mul_f32 v92, v92, v216
    v_mul_f32 v93, v93, v216
    v_mul_f32 v94, v94, v216
    v_mul_f32 v95, v95, v216
    v_accvgpr_write_b32 a132, v92
    v_accvgpr_write_b32 a133, v93
    v_accvgpr_write_b32 a134, v94
    v_accvgpr_write_b32 a135, v95
    v_accvgpr_read_b32 v96, a136
    v_accvgpr_read_b32 v97, a137
    v_accvgpr_read_b32 v98, a138
    v_accvgpr_read_b32 v99, a139
    v_mul_f32 v96, v96, v217
    v_mul_f32 v97, v97, v217
    v_mul_f32 v98, v98, v217
    v_mul_f32 v99, v99, v217
    v_accvgpr_write_b32 a136, v96
    v_accvgpr_write_b32 a137, v97
    v_accvgpr_write_b32 a138, v98
    v_accvgpr_write_b32 a139, v99
    v_accvgpr_read_b32 v80, a140
    v_accvgpr_read_b32 v81, a141
    v_accvgpr_read_b32 v82, a142
    v_accvgpr_read_b32 v83, a143
    v_mul_f32 v80, v80, v213
    v_mul_f32 v81, v81, v213
    v_mul_f32 v82, v82, v213
    v_mul_f32 v83, v83, v213
    v_accvgpr_write_b32 a140, v80
    v_accvgpr_write_b32 a141, v81
    v_accvgpr_write_b32 a142, v82
    v_accvgpr_write_b32 a143, v83
    v_accvgpr_read_b32 v84, a144
    v_accvgpr_read_b32 v85, a145
    v_accvgpr_read_b32 v86, a146
    v_accvgpr_read_b32 v87, a147
    v_mul_f32 v84, v84, v214
    v_mul_f32 v85, v85, v214
    v_mul_f32 v86, v86, v214
    v_mul_f32 v87, v87, v214
    v_accvgpr_write_b32 a144, v84
    v_accvgpr_write_b32 a145, v85
    v_accvgpr_write_b32 a146, v86
    v_accvgpr_write_b32 a147, v87
    v_accvgpr_read_b32 v88, a148
    v_accvgpr_read_b32 v89, a149
    v_accvgpr_read_b32 v90, a150
    v_accvgpr_read_b32 v91, a151
    v_mul_f32 v88, v88, v215
    v_mul_f32 v89, v89, v215
    v_mul_f32 v90, v90, v215
    v_mul_f32 v91, v91, v215
    v_accvgpr_write_b32 a148, v88
    v_accvgpr_write_b32 a149, v89
    v_accvgpr_write_b32 a150, v90
    v_accvgpr_write_b32 a151, v91
    v_accvgpr_read_b32 v92, a152
    v_accvgpr_read_b32 v93, a153
    v_accvgpr_read_b32 v94, a154
    v_accvgpr_read_b32 v95, a155
    v_mul_f32 v92, v92, v216
    v_mul_f32 v93, v93, v216
    v_mul_f32 v94, v94, v216
    v_mul_f32 v95, v95, v216
    v_accvgpr_write_b32 a152, v92
    v_accvgpr_write_b32 a153, v93
    v_accvgpr_write_b32 a154, v94
    v_accvgpr_write_b32 a155, v95
    v_accvgpr_read_b32 v96, a156
    v_accvgpr_read_b32 v97, a157
    v_accvgpr_read_b32 v98, a158
    v_accvgpr_read_b32 v99, a159
    v_mul_f32 v96, v96, v217
    v_mul_f32 v97, v97, v217
    v_mul_f32 v98, v98, v217
    v_mul_f32 v99, v99, v217
    v_accvgpr_write_b32 a156, v96
    v_accvgpr_write_b32 a157, v97
    v_accvgpr_write_b32 a158, v98
    v_accvgpr_write_b32 a159, v99
    s_nop 3
    s_branch K1_RESC1_RET
K1_RESC2:
    s_nop 15
    v_mov_b32 v213, v208
    s_nop 1
    v_permlane32_swap_b32 v213, v208
    v_max_f32 v208, v208, v213
    v_mov_b32 v213, v208
    s_nop 1
    v_permlane16_swap_b32 v213, v208
    v_max_f32 v208, v208, v213
    v_mov_b32 v214, v209
    s_nop 1
    v_permlane32_swap_b32 v214, v209
    v_max_f32 v209, v209, v214
    v_mov_b32 v214, v209
    s_nop 1
    v_permlane16_swap_b32 v214, v209
    v_max_f32 v209, v209, v214
    v_mov_b32 v215, v210
    s_nop 1
    v_permlane32_swap_b32 v215, v210
    v_max_f32 v210, v210, v215
    v_mov_b32 v215, v210
    s_nop 1
    v_permlane16_swap_b32 v215, v210
    v_max_f32 v210, v210, v215
    v_mov_b32 v216, v211
    s_nop 1
    v_permlane32_swap_b32 v216, v211
    v_max_f32 v211, v211, v216
    v_mov_b32 v216, v211
    s_nop 1
    v_permlane16_swap_b32 v216, v211
    v_max_f32 v211, v211, v216
    v_mov_b32 v217, v212
    s_nop 1
    v_permlane32_swap_b32 v217, v212
    v_max_f32 v212, v212, v217
    v_mov_b32 v217, v212
    s_nop 1
    v_permlane16_swap_b32 v217, v212
    v_max_f32 v212, v212, v217
    v_max_f32 v208, 0, v208
    v_sub_f32 v213, 0, v208
    v_exp_f32 v213, v213
    v_sub_f32 v164, v164, v208
    v_mul_f32 v184, v184, v213
    v_sub_f32 v165, v165, v208
    v_mul_f32 v185, v185, v213
    v_sub_f32 v166, v166, v208
    v_mul_f32 v186, v186, v213
    v_sub_f32 v167, v167, v208
    v_mul_f32 v187, v187, v213
    v_sub_f32 v40, v40, v208
    v_sub_f32 v41, v41, v208
    v_sub_f32 v42, v42, v208
    v_sub_f32 v43, v43, v208
    v_sub_f32 v60, v60, v208
    v_sub_f32 v61, v61, v208
    v_sub_f32 v62, v62, v208
    v_sub_f32 v63, v63, v208
    v_max_f32 v209, 0, v209
    v_sub_f32 v214, 0, v209
    v_exp_f32 v214, v214
    v_sub_f32 v168, v168, v209
    v_mul_f32 v188, v188, v214
    v_sub_f32 v169, v169, v209
    v_mul_f32 v189, v189, v214
    v_sub_f32 v170, v170, v209
    v_mul_f32 v190, v190, v214
    v_sub_f32 v171, v171, v209
    v_mul_f32 v191, v191, v214
    v_sub_f32 v44, v44, v209
    v_sub_f32 v45, v45, v209
    v_sub_f32 v46, v46, v209
    v_sub_f32 v47, v47, v209
    v_sub_f32 v64, v64, v209
    v_sub_f32 v65, v65, v209
    v_sub_f32 v66, v66, v209
    v_sub_f32 v67, v67, v209
    v_max_f32 v210, 0, v210
    v_sub_f32 v215, 0, v210
    v_exp_f32 v215, v215
    v_sub_f32 v172, v172, v210
    v_mul_f32 v192, v192, v215
    v_sub_f32 v173, v173, v210
    v_mul_f32 v193, v193, v215
    v_sub_f32 v174, v174, v210
    v_mul_f32 v194, v194, v215
    v_sub_f32 v175, v175, v210
    v_mul_f32 v195, v195, v215
    v_sub_f32 v48, v48, v210
    v_sub_f32 v49, v49, v210
    v_sub_f32 v50, v50, v210
    v_sub_f32 v51, v51, v210
    v_sub_f32 v68, v68, v210
    v_sub_f32 v69, v69, v210
    v_sub_f32 v70, v70, v210
    v_sub_f32 v71, v71, v210
    v_max_f32 v211, 0, v211
    v_sub_f32 v216, 0, v211
    v_exp_f32 v216, v216
    v_sub_f32 v176, v176, v211
    v_mul_f32 v196, v196, v216
    v_sub_f32 v177, v177, v211
    v_mul_f32 v197, v197, v216
    v_sub_f32 v178, v178, v211
    v_mul_f32 v198, v198, v216
    v_sub_f32 v179, v179, v211
    v_mul_f32 v199, v199, v216
    v_sub_f32 v52, v52, v211
    v_sub_f32 v53, v53, v211
    v_sub_f32 v54, v54, v211
    v_sub_f32 v55, v55, v211
    v_sub_f32 v72, v72, v211
    v_sub_f32 v73, v73, v211
    v_sub_f32 v74, v74, v211
    v_sub_f32 v75, v75, v211
    v_max_f32 v212, 0, v212
    v_sub_f32 v217, 0, v212
    v_exp_f32 v217, v217
    v_sub_f32 v180, v180, v212
    v_mul_f32 v200, v200, v217
    v_sub_f32 v181, v181, v212
    v_mul_f32 v201, v201, v217
    v_sub_f32 v182, v182, v212
    v_mul_f32 v202, v202, v217
    v_sub_f32 v183, v183, v212
    v_mul_f32 v203, v203, v217
    v_sub_f32 v56, v56, v212
    v_sub_f32 v57, v57, v212
    v_sub_f32 v58, v58, v212
    v_sub_f32 v59, v59, v212
    v_sub_f32 v76, v76, v212
    v_sub_f32 v77, v77, v212
    v_sub_f32 v78, v78, v212
    v_sub_f32 v79, v79, v212
    v_accvgpr_read_b32 v80, a0
    v_accvgpr_read_b32 v81, a1
    v_accvgpr_read_b32 v82, a2
    v_accvgpr_read_b32 v83, a3
    v_mul_f32 v80, v80, v213
    v_mul_f32 v81, v81, v213
    v_mul_f32 v82, v82, v213
    v_mul_f32 v83, v83, v213
    v_accvgpr_write_b32 a0, v80
    v_accvgpr_write_b32 a1, v81
    v_accvgpr_write_b32 a2, v82
    v_accvgpr_write_b32 a3, v83
    v_accvgpr_read_b32 v84, a4
    v_accvgpr_read_b32 v85, a5
    v_accvgpr_read_b32 v86, a6
    v_accvgpr_read_b32 v87, a7
    v_mul_f32 v84, v84, v214
    v_mul_f32 v85, v85, v214
    v_mul_f32 v86, v86, v214
    v_mul_f32 v87, v87, v214
    v_accvgpr_write_b32 a4, v84
    v_accvgpr_write_b32 a5, v85
    v_accvgpr_write_b32 a6, v86
    v_accvgpr_write_b32 a7, v87
    v_accvgpr_read_b32 v88, a8
    v_accvgpr_read_b32 v89, a9
    v_accvgpr_read_b32 v90, a10
    v_accvgpr_read_b32 v91, a11
    v_mul_f32 v88, v88, v215
    v_mul_f32 v89, v89, v215
    v_mul_f32 v90, v90, v215
    v_mul_f32 v91, v91, v215
    v_accvgpr_write_b32 a8, v88
    v_accvgpr_write_b32 a9, v89
    v_accvgpr_write_b32 a10, v90
    v_accvgpr_write_b32 a11, v91
    v_accvgpr_read_b32 v92, a12
    v_accvgpr_read_b32 v93, a13
    v_accvgpr_read_b32 v94, a14
    v_accvgpr_read_b32 v95, a15
    v_mul_f32 v92, v92, v216
    v_mul_f32 v93, v93, v216
    v_mul_f32 v94, v94, v216
    v_mul_f32 v95, v95, v216
    v_accvgpr_write_b32 a12, v92
    v_accvgpr_write_b32 a13, v93
    v_accvgpr_write_b32 a14, v94
    v_accvgpr_write_b32 a15, v95
    v_accvgpr_read_b32 v96, a16
    v_accvgpr_read_b32 v97, a17
    v_accvgpr_read_b32 v98, a18
    v_accvgpr_read_b32 v99, a19
    v_mul_f32 v96, v96, v217
    v_mul_f32 v97, v97, v217
    v_mul_f32 v98, v98, v217
    v_mul_f32 v99, v99, v217
    v_accvgpr_write_b32 a16, v96
    v_accvgpr_write_b32 a17, v97
    v_accvgpr_write_b32 a18, v98
    v_accvgpr_write_b32 a19, v99
    v_accvgpr_read_b32 v80, a20
    v_accvgpr_read_b32 v81, a21
    v_accvgpr_read_b32 v82, a22
    v_accvgpr_read_b32 v83, a23
    v_mul_f32 v80, v80, v213
    v_mul_f32 v81, v81, v213
    v_mul_f32 v82, v82, v213
    v_mul_f32 v83, v83, v213
    v_accvgpr_write_b32 a20, v80
    v_accvgpr_write_b32 a21, v81
    v_accvgpr_write_b32 a22, v82
    v_accvgpr_write_b32 a23, v83
    v_accvgpr_read_b32 v84, a24
    v_accvgpr_read_b32 v85, a25
    v_accvgpr_read_b32 v86, a26
    v_accvgpr_read_b32 v87, a27
    v_mul_f32 v84, v84, v214
    v_mul_f32 v85, v85, v214
    v_mul_f32 v86, v86, v214
    v_mul_f32 v87, v87, v214
    v_accvgpr_write_b32 a24, v84
    v_accvgpr_write_b32 a25, v85
    v_accvgpr_write_b32 a26, v86
    v_accvgpr_write_b32 a27, v87
    v_accvgpr_read_b32 v88, a28
    v_accvgpr_read_b32 v89, a29
    v_accvgpr_read_b32 v90, a30
    v_accvgpr_read_b32 v91, a31
    v_mul_f32 v88, v88, v215
    v_mul_f32 v89, v89, v215
    v_mul_f32 v90, v90, v215
    v_mul_f32 v91, v91, v215
    v_accvgpr_write_b32 a28, v88
    v_accvgpr_write_b32 a29, v89
    v_accvgpr_write_b32 a30, v90
    v_accvgpr_write_b32 a31, v91
    v_accvgpr_read_b32 v92, a32
    v_accvgpr_read_b32 v93, a33
    v_accvgpr_read_b32 v94, a34
    v_accvgpr_read_b32 v95, a35
    v_mul_f32 v92, v92, v216
    v_mul_f32 v93, v93, v216
    v_mul_f32 v94, v94, v216
    v_mul_f32 v95, v95, v216
    v_accvgpr_write_b32 a32, v92
    v_accvgpr_write_b32 a33, v93
    v_accvgpr_write_b32 a34, v94
    v_accvgpr_write_b32 a35, v95
    v_accvgpr_read_b32 v96, a36
    v_accvgpr_read_b32 v97, a37
    v_accvgpr_read_b32 v98, a38
    v_accvgpr_read_b32 v99, a39
    v_mul_f32 v96, v96, v217
    v_mul_f32 v97, v97, v217
    v_mul_f32 v98, v98, v217
    v_mul_f32 v99, v99, v217
    v_accvgpr_write_b32 a36, v96
    v_accvgpr_write_b32 a37, v97
    v_accvgpr_write_b32 a38, v98
    v_accvgpr_write_b32 a39, v99
    v_accvgpr_read_b32 v80, a40
    v_accvgpr_read_b32 v81, a41
    v_accvgpr_read_b32 v82, a42
    v_accvgpr_read_b32 v83, a43
    v_mul_f32 v80, v80, v213
    v_mul_f32 v81, v81, v213
    v_mul_f32 v82, v82, v213
    v_mul_f32 v83, v83, v213
    v_accvgpr_write_b32 a40, v80
    v_accvgpr_write_b32 a41, v81
    v_accvgpr_write_b32 a42, v82
    v_accvgpr_write_b32 a43, v83
    v_accvgpr_read_b32 v84, a44
    v_accvgpr_read_b32 v85, a45
    v_accvgpr_read_b32 v86, a46
    v_accvgpr_read_b32 v87, a47
    v_mul_f32 v84, v84, v214
    v_mul_f32 v85, v85, v214
    v_mul_f32 v86, v86, v214
    v_mul_f32 v87, v87, v214
    v_accvgpr_write_b32 a44, v84
    v_accvgpr_write_b32 a45, v85
    v_accvgpr_write_b32 a46, v86
    v_accvgpr_write_b32 a47, v87
    v_accvgpr_read_b32 v88, a48
    v_accvgpr_read_b32 v89, a49
    v_accvgpr_read_b32 v90, a50
    v_accvgpr_read_b32 v91, a51
    v_mul_f32 v88, v88, v215
    v_mul_f32 v89, v89, v215
    v_mul_f32 v90, v90, v215
    v_mul_f32 v91, v91, v215
    v_accvgpr_write_b32 a48, v88
    v_accvgpr_write_b32 a49, v89
    v_accvgpr_write_b32 a50, v90
    v_accvgpr_write_b32 a51, v91
    v_accvgpr_read_b32 v92, a52
    v_accvgpr_read_b32 v93, a53
    v_accvgpr_read_b32 v94, a54
    v_accvgpr_read_b32 v95, a55
    v_mul_f32 v92, v92, v216
    v_mul_f32 v93, v93, v216
    v_mul_f32 v94, v94, v216
    v_mul_f32 v95, v95, v216
    v_accvgpr_write_b32 a52, v92
    v_accvgpr_write_b32 a53, v93
    v_accvgpr_write_b32 a54, v94
    v_accvgpr_write_b32 a55, v95
    v_accvgpr_read_b32 v96, a56
    v_accvgpr_read_b32 v97, a57
    v_accvgpr_read_b32 v98, a58
    v_accvgpr_read_b32 v99, a59
    v_mul_f32 v96, v96, v217
    v_mul_f32 v97, v97, v217
    v_mul_f32 v98, v98, v217
    v_mul_f32 v99, v99, v217
    v_accvgpr_write_b32 a56, v96
    v_accvgpr_write_b32 a57, v97
    v_accvgpr_write_b32 a58, v98
    v_accvgpr_write_b32 a59, v99
    v_accvgpr_read_b32 v80, a60
    v_accvgpr_read_b32 v81, a61
    v_accvgpr_read_b32 v82, a62
    v_accvgpr_read_b32 v83, a63
    v_mul_f32 v80, v80, v213
    v_mul_f32 v81, v81, v213
    v_mul_f32 v82, v82, v213
    v_mul_f32 v83, v83, v213
    v_accvgpr_write_b32 a60, v80
    v_accvgpr_write_b32 a61, v81
    v_accvgpr_write_b32 a62, v82
    v_accvgpr_write_b32 a63, v83
    v_accvgpr_read_b32 v84, a64
    v_accvgpr_read_b32 v85, a65
    v_accvgpr_read_b32 v86, a66
    v_accvgpr_read_b32 v87, a67
    v_mul_f32 v84, v84, v214
    v_mul_f32 v85, v85, v214
    v_mul_f32 v86, v86, v214
    v_mul_f32 v87, v87, v214
    v_accvgpr_write_b32 a64, v84
    v_accvgpr_write_b32 a65, v85
    v_accvgpr_write_b32 a66, v86
    v_accvgpr_write_b32 a67, v87
    v_accvgpr_read_b32 v88, a68
    v_accvgpr_read_b32 v89, a69
    v_accvgpr_read_b32 v90, a70
    v_accvgpr_read_b32 v91, a71
    v_mul_f32 v88, v88, v215
    v_mul_f32 v89, v89, v215
    v_mul_f32 v90, v90, v215
    v_mul_f32 v91, v91, v215
    v_accvgpr_write_b32 a68, v88
    v_accvgpr_write_b32 a69, v89
    v_accvgpr_write_b32 a70, v90
    v_accvgpr_write_b32 a71, v91
    v_accvgpr_read_b32 v92, a72
    v_accvgpr_read_b32 v93, a73
    v_accvgpr_read_b32 v94, a74
    v_accvgpr_read_b32 v95, a75
    v_mul_f32 v92, v92, v216
    v_mul_f32 v93, v93, v216
    v_mul_f32 v94, v94, v216
    v_mul_f32 v95, v95, v216
    v_accvgpr_write_b32 a72, v92
    v_accvgpr_write_b32 a73, v93
    v_accvgpr_write_b32 a74, v94
    v_accvgpr_write_b32 a75, v95
    v_accvgpr_read_b32 v96, a76
    v_accvgpr_read_b32 v97, a77
    v_accvgpr_read_b32 v98, a78
    v_accvgpr_read_b32 v99, a79
    v_mul_f32 v96, v96, v217
    v_mul_f32 v97, v97, v217
    v_mul_f32 v98, v98, v217
    v_mul_f32 v99, v99, v217
    v_accvgpr_write_b32 a76, v96
    v_accvgpr_write_b32 a77, v97
    v_accvgpr_write_b32 a78, v98
    v_accvgpr_write_b32 a79, v99
    v_accvgpr_read_b32 v80, a80
    v_accvgpr_read_b32 v81, a81
    v_accvgpr_read_b32 v82, a82
    v_accvgpr_read_b32 v83, a83
    v_mul_f32 v80, v80, v213
    v_mul_f32 v81, v81, v213
    v_mul_f32 v82, v82, v213
    v_mul_f32 v83, v83, v213
    v_accvgpr_write_b32 a80, v80
    v_accvgpr_write_b32 a81, v81
    v_accvgpr_write_b32 a82, v82
    v_accvgpr_write_b32 a83, v83
    v_accvgpr_read_b32 v84, a84
    v_accvgpr_read_b32 v85, a85
    v_accvgpr_read_b32 v86, a86
    v_accvgpr_read_b32 v87, a87
    v_mul_f32 v84, v84, v214
    v_mul_f32 v85, v85, v214
    v_mul_f32 v86, v86, v214
    v_mul_f32 v87, v87, v214
    v_accvgpr_write_b32 a84, v84
    v_accvgpr_write_b32 a85, v85
    v_accvgpr_write_b32 a86, v86
    v_accvgpr_write_b32 a87, v87
    v_accvgpr_read_b32 v88, a88
    v_accvgpr_read_b32 v89, a89
    v_accvgpr_read_b32 v90, a90
    v_accvgpr_read_b32 v91, a91
    v_mul_f32 v88, v88, v215
    v_mul_f32 v89, v89, v215
    v_mul_f32 v90, v90, v215
    v_mul_f32 v91, v91, v215
    v_accvgpr_write_b32 a88, v88
    v_accvgpr_write_b32 a89, v89
    v_accvgpr_write_b32 a90, v90
    v_accvgpr_write_b32 a91, v91
    v_accvgpr_read_b32 v92, a92
    v_accvgpr_read_b32 v93, a93
    v_accvgpr_read_b32 v94, a94
    v_accvgpr_read_b32 v95, a95
    v_mul_f32 v92, v92, v216
    v_mul_f32 v93, v93, v216
    v_mul_f32 v94, v94, v216
    v_mul_f32 v95, v95, v216
    v_accvgpr_write_b32 a92, v92
    v_accvgpr_write_b32 a93, v93
    v_accvgpr_write_b32 a94, v94
    v_accvgpr_write_b32 a95, v95
    v_accvgpr_read_b32 v96, a96
    v_accvgpr_read_b32 v97, a97
    v_accvgpr_read_b32 v98, a98
    v_accvgpr_read_b32 v99, a99
    v_mul_f32 v96, v96, v217
    v_mul_f32 v97, v97, v217
    v_mul_f32 v98, v98, v217
    v_mul_f32 v99, v99, v217
    v_accvgpr_write_b32 a96, v96
    v_accvgpr_write_b32 a97, v97
    v_accvgpr_write_b32 a98, v98
    v_accvgpr_write_b32 a99, v99
    v_accvgpr_read_b32 v80, a100
    v_accvgpr_read_b32 v81, a101
    v_accvgpr_read_b32 v82, a102
    v_accvgpr_read_b32 v83, a103
    v_mul_f32 v80, v80, v213
    v_mul_f32 v81, v81, v213
    v_mul_f32 v82, v82, v213
    v_mul_f32 v83, v83, v213
    v_accvgpr_write_b32 a100, v80
    v_accvgpr_write_b32 a101, v81
    v_accvgpr_write_b32 a102, v82
    v_accvgpr_write_b32 a103, v83
    v_accvgpr_read_b32 v84, a104
    v_accvgpr_read_b32 v85, a105
    v_accvgpr_read_b32 v86, a106
    v_accvgpr_read_b32 v87, a107
    v_mul_f32 v84, v84, v214
    v_mul_f32 v85, v85, v214
    v_mul_f32 v86, v86, v214
    v_mul_f32 v87, v87, v214
    v_accvgpr_write_b32 a104, v84
    v_accvgpr_write_b32 a105, v85
    v_accvgpr_write_b32 a106, v86
    v_accvgpr_write_b32 a107, v87
    v_accvgpr_read_b32 v88, a108
    v_accvgpr_read_b32 v89, a109
    v_accvgpr_read_b32 v90, a110
    v_accvgpr_read_b32 v91, a111
    v_mul_f32 v88, v88, v215
    v_mul_f32 v89, v89, v215
    v_mul_f32 v90, v90, v215
    v_mul_f32 v91, v91, v215
    v_accvgpr_write_b32 a108, v88
    v_accvgpr_write_b32 a109, v89
    v_accvgpr_write_b32 a110, v90
    v_accvgpr_write_b32 a111, v91
    v_accvgpr_read_b32 v92, a112
    v_accvgpr_read_b32 v93, a113
    v_accvgpr_read_b32 v94, a114
    v_accvgpr_read_b32 v95, a115
    v_mul_f32 v92, v92, v216
    v_mul_f32 v93, v93, v216
    v_mul_f32 v94, v94, v216
    v_mul_f32 v95, v95, v216
    v_accvgpr_write_b32 a112, v92
    v_accvgpr_write_b32 a113, v93
    v_accvgpr_write_b32 a114, v94
    v_accvgpr_write_b32 a115, v95
    v_accvgpr_read_b32 v96, a116
    v_accvgpr_read_b32 v97, a117
    v_accvgpr_read_b32 v98, a118
    v_accvgpr_read_b32 v99, a119
    v_mul_f32 v96, v96, v217
    v_mul_f32 v97, v97, v217
    v_mul_f32 v98, v98, v217
    v_mul_f32 v99, v99, v217
    v_accvgpr_write_b32 a116, v96
    v_accvgpr_write_b32 a117, v97
    v_accvgpr_write_b32 a118, v98
    v_accvgpr_write_b32 a119, v99
    v_accvgpr_read_b32 v80, a120
    v_accvgpr_read_b32 v81, a121
    v_accvgpr_read_b32 v82, a122
    v_accvgpr_read_b32 v83, a123
    v_mul_f32 v80, v80, v213
    v_mul_f32 v81, v81, v213
    v_mul_f32 v82, v82, v213
    v_mul_f32 v83, v83, v213
    v_accvgpr_write_b32 a120, v80
    v_accvgpr_write_b32 a121, v81
    v_accvgpr_write_b32 a122, v82
    v_accvgpr_write_b32 a123, v83
    v_accvgpr_read_b32 v84, a124
    v_accvgpr_read_b32 v85, a125
    v_accvgpr_read_b32 v86, a126
    v_accvgpr_read_b32 v87, a127
    v_mul_f32 v84, v84, v214
    v_mul_f32 v85, v85, v214
    v_mul_f32 v86, v86, v214
    v_mul_f32 v87, v87, v214
    v_accvgpr_write_b32 a124, v84
    v_accvgpr_write_b32 a125, v85
    v_accvgpr_write_b32 a126, v86
    v_accvgpr_write_b32 a127, v87
    v_accvgpr_read_b32 v88, a128
    v_accvgpr_read_b32 v89, a129
    v_accvgpr_read_b32 v90, a130
    v_accvgpr_read_b32 v91, a131
    v_mul_f32 v88, v88, v215
    v_mul_f32 v89, v89, v215
    v_mul_f32 v90, v90, v215
    v_mul_f32 v91, v91, v215
    v_accvgpr_write_b32 a128, v88
    v_accvgpr_write_b32 a129, v89
    v_accvgpr_write_b32 a130, v90
    v_accvgpr_write_b32 a131, v91
    v_accvgpr_read_b32 v92, a132
    v_accvgpr_read_b32 v93, a133
    v_accvgpr_read_b32 v94, a134
    v_accvgpr_read_b32 v95, a135
    v_mul_f32 v92, v92, v216
    v_mul_f32 v93, v93, v216
    v_mul_f32 v94, v94, v216
    v_mul_f32 v95, v95, v216
    v_accvgpr_write_b32 a132, v92
    v_accvgpr_write_b32 a133, v93
    v_accvgpr_write_b32 a134, v94
    v_accvgpr_write_b32 a135, v95
    v_accvgpr_read_b32 v96, a136
    v_accvgpr_read_b32 v97, a137
    v_accvgpr_read_b32 v98, a138
    v_accvgpr_read_b32 v99, a139
    v_mul_f32 v96, v96, v217
    v_mul_f32 v97, v97, v217
    v_mul_f32 v98, v98, v217
    v_mul_f32 v99, v99, v217
    v_accvgpr_write_b32 a136, v96
    v_accvgpr_write_b32 a137, v97
    v_accvgpr_write_b32 a138, v98
    v_accvgpr_write_b32 a139, v99
    v_accvgpr_read_b32 v80, a140
    v_accvgpr_read_b32 v81, a141
    v_accvgpr_read_b32 v82, a142
    v_accvgpr_read_b32 v83, a143
    v_mul_f32 v80, v80, v213
    v_mul_f32 v81, v81, v213
    v_mul_f32 v82, v82, v213
    v_mul_f32 v83, v83, v213
    v_accvgpr_write_b32 a140, v80
    v_accvgpr_write_b32 a141, v81
    v_accvgpr_write_b32 a142, v82
    v_accvgpr_write_b32 a143, v83
    v_accvgpr_read_b32 v84, a144
    v_accvgpr_read_b32 v85, a145
    v_accvgpr_read_b32 v86, a146
    v_accvgpr_read_b32 v87, a147
    v_mul_f32 v84, v84, v214
    v_mul_f32 v85, v85, v214
    v_mul_f32 v86, v86, v214
    v_mul_f32 v87, v87, v214
    v_accvgpr_write_b32 a144, v84
    v_accvgpr_write_b32 a145, v85
    v_accvgpr_write_b32 a146, v86
    v_accvgpr_write_b32 a147, v87
    v_accvgpr_read_b32 v88, a148
    v_accvgpr_read_b32 v89, a149
    v_accvgpr_read_b32 v90, a150
    v_accvgpr_read_b32 v91, a151
    v_mul_f32 v88, v88, v215
    v_mul_f32 v89, v89, v215
    v_mul_f32 v90, v90, v215
    v_mul_f32 v91, v91, v215
    v_accvgpr_write_b32 a148, v88
    v_accvgpr_write_b32 a149, v89
    v_accvgpr_write_b32 a150, v90
    v_accvgpr_write_b32 a151, v91
    v_accvgpr_read_b32 v92, a152
    v_accvgpr_read_b32 v93, a153
    v_accvgpr_read_b32 v94, a154
    v_accvgpr_read_b32 v95, a155
    v_mul_f32 v92, v92, v216
    v_mul_f32 v93, v93, v216
    v_mul_f32 v94, v94, v216
    v_mul_f32 v95, v95, v216
    v_accvgpr_write_b32 a152, v92
    v_accvgpr_write_b32 a153, v93
    v_accvgpr_write_b32 a154, v94
    v_accvgpr_write_b32 a155, v95
    v_accvgpr_read_b32 v96, a156
    v_accvgpr_read_b32 v97, a157
    v_accvgpr_read_b32 v98, a158
    v_accvgpr_read_b32 v99, a159
    v_mul_f32 v96, v96, v217
    v_mul_f32 v97, v97, v217
    v_mul_f32 v98, v98, v217
    v_mul_f32 v99, v99, v217
    v_accvgpr_write_b32 a156, v96
    v_accvgpr_write_b32 a157, v97
    v_accvgpr_write_b32 a158, v98
    v_accvgpr_write_b32 a159, v99
    s_nop 3
    s_branch K1_RESC2_RET
K1_RESC3:
    s_nop 15
    v_mov_b32 v213, v208
    s_nop 1
    v_permlane32_swap_b32 v213, v208
    v_max_f32 v208, v208, v213
    v_mov_b32 v213, v208
    s_nop 1
    v_permlane16_swap_b32 v213, v208
    v_max_f32 v208, v208, v213
    v_mov_b32 v214, v209
    s_nop 1
    v_permlane32_swap_b32 v214, v209
    v_max_f32 v209, v209, v214
    v_mov_b32 v214, v209
    s_nop 1
    v_permlane16_swap_b32 v214, v209
    v_max_f32 v209, v209, v214
    v_mov_b32 v215, v210
    s_nop 1
    v_permlane32_swap_b32 v215, v210
    v_max_f32 v210, v210, v215
    v_mov_b32 v215, v210
    s_nop 1
    v_permlane16_swap_b32 v215, v210
    v_max_f32 v210, v210, v215
    v_mov_b32 v216, v211
    s_nop 1
    v_permlane32_swap_b32 v216, v211
    v_max_f32 v211, v211, v216
    v_mov_b32 v216, v211
    s_nop 1
    v_permlane16_swap_b32 v216, v211
    v_max_f32 v211, v211, v216
    v_mov_b32 v217, v212
    s_nop 1
    v_permlane32_swap_b32 v217, v212
    v_max_f32 v212, v212, v217
    v_mov_b32 v217, v212
    s_nop 1
    v_permlane16_swap_b32 v217, v212
    v_max_f32 v212, v212, v217
    v_max_f32 v208, 0, v208
    v_sub_f32 v213, 0, v208
    v_exp_f32 v213, v213
    v_sub_f32 v164, v164, v208
    v_mul_f32 v184, v184, v213
    v_sub_f32 v165, v165, v208
    v_mul_f32 v185, v185, v213
    v_sub_f32 v166, v166, v208
    v_mul_f32 v186, v186, v213
    v_sub_f32 v167, v167, v208
    v_mul_f32 v187, v187, v213
    v_sub_f32 v0, v0, v208
    v_sub_f32 v1, v1, v208
    v_sub_f32 v2, v2, v208
    v_sub_f32 v3, v3, v208
    v_sub_f32 v20, v20, v208
    v_sub_f32 v21, v21, v208
    v_sub_f32 v22, v22, v208
    v_sub_f32 v23, v23, v208
    v_max_f32 v209, 0, v209
    v_sub_f32 v214, 0, v209
    v_exp_f32 v214, v214
    v_sub_f32 v168, v168, v209
    v_mul_f32 v188, v188, v214
    v_sub_f32 v169, v169, v209
    v_mul_f32 v189, v189, v214
    v_sub_f32 v170, v170, v209
    v_mul_f32 v190, v190, v214
    v_sub_f32 v171, v171, v209
    v_mul_f32 v191, v191, v214
    v_sub_f32 v4, v4, v209
    v_sub_f32 v5, v5, v209
    v_sub_f32 v6, v6, v209
    v_sub_f32 v7, v7, v209
    v_sub_f32 v24, v24, v209
    v_sub_f32 v25, v25, v209
    v_sub_f32 v26, v26, v209
    v_sub_f32 v27, v27, v209
    v_max_f32 v210, 0, v210
    v_sub_f32 v215, 0, v210
    v_exp_f32 v215, v215
    v_sub_f32 v172, v172, v210
    v_mul_f32 v192, v192, v215
    v_sub_f32 v173, v173, v210
    v_mul_f32 v193, v193, v215
    v_sub_f32 v174, v174, v210
    v_mul_f32 v194, v194, v215
    v_sub_f32 v175, v175, v210
    v_mul_f32 v195, v195, v215
    v_sub_f32 v8, v8, v210
    v_sub_f32 v9, v9, v210
    v_sub_f32 v10, v10, v210
    v_sub_f32 v11, v11, v210
    v_sub_f32 v28, v28, v210
    v_sub_f32 v29, v29, v210
    v_sub_f32 v30, v30, v210
    v_sub_f32 v31, v31, v210
    v_max_f32 v211, 0, v211
    v_sub_f32 v216, 0, v211
    v_exp_f32 v216, v216
    v_sub_f32 v176, v176, v211
    v_mul_f32 v196, v196, v216
    v_sub_f32 v177, v177, v211
    v_mul_f32 v197, v197, v216
    v_sub_f32 v178, v178, v211
    v_mul_f32 v198, v198, v216
    v_sub_f32 v179, v179, v211
    v_mul_f32 v199, v199, v216
    v_sub_f32 v12, v12, v211
    v_sub_f32 v13, v13, v211
    v_sub_f32 v14, v14, v211
    v_sub_f32 v15, v15, v211
    v_sub_f32 v32, v32, v211
    v_sub_f32 v33, v33, v211
    v_sub_f32 v34, v34, v211
    v_sub_f32 v35, v35, v211
    v_max_f32 v212, 0, v212
    v_sub_f32 v217, 0, v212
    v_exp_f32 v217, v217
    v_sub_f32 v180, v180, v212
    v_mul_f32 v200, v200, v217
    v_sub_f32 v181, v181, v212
    v_mul_f32 v201, v201, v217
    v_sub_f32 v182, v182, v212
    v_mul_f32 v202, v202, v217
    v_sub_f32 v183, v183, v212
    v_mul_f32 v203, v203, v217
    v_sub_f32 v16, v16, v212
    v_sub_f32 v17, v17, v212
    v_sub_f32 v18, v18, v212
    v_sub_f32 v19, v19, v212
    v_sub_f32 v36, v36, v212
    v_sub_f32 v37, v37, v212
    v_sub_f32 v38, v38, v212
    v_sub_f32 v39, v39, v212
    v_accvgpr_read_b32 v80, a0
    v_accvgpr_read_b32 v81, a1
    v_accvgpr_read_b32 v82, a2
    v_accvgpr_read_b32 v83, a3
    v_mul_f32 v80, v80, v213
    v_mul_f32 v81, v81, v213
    v_mul_f32 v82, v82, v213
    v_mul_f32 v83, v83, v213
    v_accvgpr_write_b32 a0, v80
    v_accvgpr_write_b32 a1, v81
    v_accvgpr_write_b32 a2, v82
    v_accvgpr_write_b32 a3, v83
    v_accvgpr_read_b32 v84, a4
    v_accvgpr_read_b32 v85, a5
    v_accvgpr_read_b32 v86, a6
    v_accvgpr_read_b32 v87, a7
    v_mul_f32 v84, v84, v214
    v_mul_f32 v85, v85, v214
    v_mul_f32 v86, v86, v214
    v_mul_f32 v87, v87, v214
    v_accvgpr_write_b32 a4, v84
    v_accvgpr_write_b32 a5, v85
    v_accvgpr_write_b32 a6, v86
    v_accvgpr_write_b32 a7, v87
    v_accvgpr_read_b32 v88, a8
    v_accvgpr_read_b32 v89, a9
    v_accvgpr_read_b32 v90, a10
    v_accvgpr_read_b32 v91, a11
    v_mul_f32 v88, v88, v215
    v_mul_f32 v89, v89, v215
    v_mul_f32 v90, v90, v215
    v_mul_f32 v91, v91, v215
    v_accvgpr_write_b32 a8, v88
    v_accvgpr_write_b32 a9, v89
    v_accvgpr_write_b32 a10, v90
    v_accvgpr_write_b32 a11, v91
    v_accvgpr_read_b32 v92, a12
    v_accvgpr_read_b32 v93, a13
    v_accvgpr_read_b32 v94, a14
    v_accvgpr_read_b32 v95, a15
    v_mul_f32 v92, v92, v216
    v_mul_f32 v93, v93, v216
    v_mul_f32 v94, v94, v216
    v_mul_f32 v95, v95, v216
    v_accvgpr_write_b32 a12, v92
    v_accvgpr_write_b32 a13, v93
    v_accvgpr_write_b32 a14, v94
    v_accvgpr_write_b32 a15, v95
    v_accvgpr_read_b32 v96, a16
    v_accvgpr_read_b32 v97, a17
    v_accvgpr_read_b32 v98, a18
    v_accvgpr_read_b32 v99, a19
    v_mul_f32 v96, v96, v217
    v_mul_f32 v97, v97, v217
    v_mul_f32 v98, v98, v217
    v_mul_f32 v99, v99, v217
    v_accvgpr_write_b32 a16, v96
    v_accvgpr_write_b32 a17, v97
    v_accvgpr_write_b32 a18, v98
    v_accvgpr_write_b32 a19, v99
    v_accvgpr_read_b32 v80, a20
    v_accvgpr_read_b32 v81, a21
    v_accvgpr_read_b32 v82, a22
    v_accvgpr_read_b32 v83, a23
    v_mul_f32 v80, v80, v213
    v_mul_f32 v81, v81, v213
    v_mul_f32 v82, v82, v213
    v_mul_f32 v83, v83, v213
    v_accvgpr_write_b32 a20, v80
    v_accvgpr_write_b32 a21, v81
    v_accvgpr_write_b32 a22, v82
    v_accvgpr_write_b32 a23, v83
    v_accvgpr_read_b32 v84, a24
    v_accvgpr_read_b32 v85, a25
    v_accvgpr_read_b32 v86, a26
    v_accvgpr_read_b32 v87, a27
    v_mul_f32 v84, v84, v214
    v_mul_f32 v85, v85, v214
    v_mul_f32 v86, v86, v214
    v_mul_f32 v87, v87, v214
    v_accvgpr_write_b32 a24, v84
    v_accvgpr_write_b32 a25, v85
    v_accvgpr_write_b32 a26, v86
    v_accvgpr_write_b32 a27, v87
    v_accvgpr_read_b32 v88, a28
    v_accvgpr_read_b32 v89, a29
    v_accvgpr_read_b32 v90, a30
    v_accvgpr_read_b32 v91, a31
    v_mul_f32 v88, v88, v215
    v_mul_f32 v89, v89, v215
    v_mul_f32 v90, v90, v215
    v_mul_f32 v91, v91, v215
    v_accvgpr_write_b32 a28, v88
    v_accvgpr_write_b32 a29, v89
    v_accvgpr_write_b32 a30, v90
    v_accvgpr_write_b32 a31, v91
    v_accvgpr_read_b32 v92, a32
    v_accvgpr_read_b32 v93, a33
    v_accvgpr_read_b32 v94, a34
    v_accvgpr_read_b32 v95, a35
    v_mul_f32 v92, v92, v216
    v_mul_f32 v93, v93, v216
    v_mul_f32 v94, v94, v216
    v_mul_f32 v95, v95, v216
    v_accvgpr_write_b32 a32, v92
    v_accvgpr_write_b32 a33, v93
    v_accvgpr_write_b32 a34, v94
    v_accvgpr_write_b32 a35, v95
    v_accvgpr_read_b32 v96, a36
    v_accvgpr_read_b32 v97, a37
    v_accvgpr_read_b32 v98, a38
    v_accvgpr_read_b32 v99, a39
    v_mul_f32 v96, v96, v217
    v_mul_f32 v97, v97, v217
    v_mul_f32 v98, v98, v217
    v_mul_f32 v99, v99, v217
    v_accvgpr_write_b32 a36, v96
    v_accvgpr_write_b32 a37, v97
    v_accvgpr_write_b32 a38, v98
    v_accvgpr_write_b32 a39, v99
    v_accvgpr_read_b32 v80, a40
    v_accvgpr_read_b32 v81, a41
    v_accvgpr_read_b32 v82, a42
    v_accvgpr_read_b32 v83, a43
    v_mul_f32 v80, v80, v213
    v_mul_f32 v81, v81, v213
    v_mul_f32 v82, v82, v213
    v_mul_f32 v83, v83, v213
    v_accvgpr_write_b32 a40, v80
    v_accvgpr_write_b32 a41, v81
    v_accvgpr_write_b32 a42, v82
    v_accvgpr_write_b32 a43, v83
    v_accvgpr_read_b32 v84, a44
    v_accvgpr_read_b32 v85, a45
    v_accvgpr_read_b32 v86, a46
    v_accvgpr_read_b32 v87, a47
    v_mul_f32 v84, v84, v214
    v_mul_f32 v85, v85, v214
    v_mul_f32 v86, v86, v214
    v_mul_f32 v87, v87, v214
    v_accvgpr_write_b32 a44, v84
    v_accvgpr_write_b32 a45, v85
    v_accvgpr_write_b32 a46, v86
    v_accvgpr_write_b32 a47, v87
    v_accvgpr_read_b32 v88, a48
    v_accvgpr_read_b32 v89, a49
    v_accvgpr_read_b32 v90, a50
    v_accvgpr_read_b32 v91, a51
    v_mul_f32 v88, v88, v215
    v_mul_f32 v89, v89, v215
    v_mul_f32 v90, v90, v215
    v_mul_f32 v91, v91, v215
    v_accvgpr_write_b32 a48, v88
    v_accvgpr_write_b32 a49, v89
    v_accvgpr_write_b32 a50, v90
    v_accvgpr_write_b32 a51, v91
    v_accvgpr_read_b32 v92, a52
    v_accvgpr_read_b32 v93, a53
    v_accvgpr_read_b32 v94, a54
    v_accvgpr_read_b32 v95, a55
    v_mul_f32 v92, v92, v216
    v_mul_f32 v93, v93, v216
    v_mul_f32 v94, v94, v216
    v_mul_f32 v95, v95, v216
    v_accvgpr_write_b32 a52, v92
    v_accvgpr_write_b32 a53, v93
    v_accvgpr_write_b32 a54, v94
    v_accvgpr_write_b32 a55, v95
    v_accvgpr_read_b32 v96, a56
    v_accvgpr_read_b32 v97, a57
    v_accvgpr_read_b32 v98, a58
    v_accvgpr_read_b32 v99, a59
    v_mul_f32 v96, v96, v217
    v_mul_f32 v97, v97, v217
    v_mul_f32 v98, v98, v217
    v_mul_f32 v99, v99, v217
    v_accvgpr_write_b32 a56, v96
    v_accvgpr_write_b32 a57, v97
    v_accvgpr_write_b32 a58, v98
    v_accvgpr_write_b32 a59, v99
    v_accvgpr_read_b32 v80, a60
    v_accvgpr_read_b32 v81, a61
    v_accvgpr_read_b32 v82, a62
    v_accvgpr_read_b32 v83, a63
    v_mul_f32 v80, v80, v213
    v_mul_f32 v81, v81, v213
    v_mul_f32 v82, v82, v213
    v_mul_f32 v83, v83, v213
    v_accvgpr_write_b32 a60, v80
    v_accvgpr_write_b32 a61, v81
    v_accvgpr_write_b32 a62, v82
    v_accvgpr_write_b32 a63, v83
    v_accvgpr_read_b32 v84, a64
    v_accvgpr_read_b32 v85, a65
    v_accvgpr_read_b32 v86, a66
    v_accvgpr_read_b32 v87, a67
    v_mul_f32 v84, v84, v214
    v_mul_f32 v85, v85, v214
    v_mul_f32 v86, v86, v214
    v_mul_f32 v87, v87, v214
    v_accvgpr_write_b32 a64, v84
    v_accvgpr_write_b32 a65, v85
    v_accvgpr_write_b32 a66, v86
    v_accvgpr_write_b32 a67, v87
    v_accvgpr_read_b32 v88, a68
    v_accvgpr_read_b32 v89, a69
    v_accvgpr_read_b32 v90, a70
    v_accvgpr_read_b32 v91, a71
    v_mul_f32 v88, v88, v215
    v_mul_f32 v89, v89, v215
    v_mul_f32 v90, v90, v215
    v_mul_f32 v91, v91, v215
    v_accvgpr_write_b32 a68, v88
    v_accvgpr_write_b32 a69, v89
    v_accvgpr_write_b32 a70, v90
    v_accvgpr_write_b32 a71, v91
    v_accvgpr_read_b32 v92, a72
    v_accvgpr_read_b32 v93, a73
    v_accvgpr_read_b32 v94, a74
    v_accvgpr_read_b32 v95, a75
    v_mul_f32 v92, v92, v216
    v_mul_f32 v93, v93, v216
    v_mul_f32 v94, v94, v216
    v_mul_f32 v95, v95, v216
    v_accvgpr_write_b32 a72, v92
    v_accvgpr_write_b32 a73, v93
    v_accvgpr_write_b32 a74, v94
    v_accvgpr_write_b32 a75, v95
    v_accvgpr_read_b32 v96, a76
    v_accvgpr_read_b32 v97, a77
    v_accvgpr_read_b32 v98, a78
    v_accvgpr_read_b32 v99, a79
    v_mul_f32 v96, v96, v217
    v_mul_f32 v97, v97, v217
    v_mul_f32 v98, v98, v217
    v_mul_f32 v99, v99, v217
    v_accvgpr_write_b32 a76, v96
    v_accvgpr_write_b32 a77, v97
    v_accvgpr_write_b32 a78, v98
    v_accvgpr_write_b32 a79, v99
    v_accvgpr_read_b32 v80, a80
    v_accvgpr_read_b32 v81, a81
    v_accvgpr_read_b32 v82, a82
    v_accvgpr_read_b32 v83, a83
    v_mul_f32 v80, v80, v213
    v_mul_f32 v81, v81, v213
    v_mul_f32 v82, v82, v213
    v_mul_f32 v83, v83, v213
    v_accvgpr_write_b32 a80, v80
    v_accvgpr_write_b32 a81, v81
    v_accvgpr_write_b32 a82, v82
    v_accvgpr_write_b32 a83, v83
    v_accvgpr_read_b32 v84, a84
    v_accvgpr_read_b32 v85, a85
    v_accvgpr_read_b32 v86, a86
    v_accvgpr_read_b32 v87, a87
    v_mul_f32 v84, v84, v214
    v_mul_f32 v85, v85, v214
    v_mul_f32 v86, v86, v214
    v_mul_f32 v87, v87, v214
    v_accvgpr_write_b32 a84, v84
    v_accvgpr_write_b32 a85, v85
    v_accvgpr_write_b32 a86, v86
    v_accvgpr_write_b32 a87, v87
    v_accvgpr_read_b32 v88, a88
    v_accvgpr_read_b32 v89, a89
    v_accvgpr_read_b32 v90, a90
    v_accvgpr_read_b32 v91, a91
    v_mul_f32 v88, v88, v215
    v_mul_f32 v89, v89, v215
    v_mul_f32 v90, v90, v215
    v_mul_f32 v91, v91, v215
    v_accvgpr_write_b32 a88, v88
    v_accvgpr_write_b32 a89, v89
    v_accvgpr_write_b32 a90, v90
    v_accvgpr_write_b32 a91, v91
    v_accvgpr_read_b32 v92, a92
    v_accvgpr_read_b32 v93, a93
    v_accvgpr_read_b32 v94, a94
    v_accvgpr_read_b32 v95, a95
    v_mul_f32 v92, v92, v216
    v_mul_f32 v93, v93, v216
    v_mul_f32 v94, v94, v216
    v_mul_f32 v95, v95, v216
    v_accvgpr_write_b32 a92, v92
    v_accvgpr_write_b32 a93, v93
    v_accvgpr_write_b32 a94, v94
    v_accvgpr_write_b32 a95, v95
    v_accvgpr_read_b32 v96, a96
    v_accvgpr_read_b32 v97, a97
    v_accvgpr_read_b32 v98, a98
    v_accvgpr_read_b32 v99, a99
    v_mul_f32 v96, v96, v217
    v_mul_f32 v97, v97, v217
    v_mul_f32 v98, v98, v217
    v_mul_f32 v99, v99, v217
    v_accvgpr_write_b32 a96, v96
    v_accvgpr_write_b32 a97, v97
    v_accvgpr_write_b32 a98, v98
    v_accvgpr_write_b32 a99, v99
    v_accvgpr_read_b32 v80, a100
    v_accvgpr_read_b32 v81, a101
    v_accvgpr_read_b32 v82, a102
    v_accvgpr_read_b32 v83, a103
    v_mul_f32 v80, v80, v213
    v_mul_f32 v81, v81, v213
    v_mul_f32 v82, v82, v213
    v_mul_f32 v83, v83, v213
    v_accvgpr_write_b32 a100, v80
    v_accvgpr_write_b32 a101, v81
    v_accvgpr_write_b32 a102, v82
    v_accvgpr_write_b32 a103, v83
    v_accvgpr_read_b32 v84, a104
    v_accvgpr_read_b32 v85, a105
    v_accvgpr_read_b32 v86, a106
    v_accvgpr_read_b32 v87, a107
    v_mul_f32 v84, v84, v214
    v_mul_f32 v85, v85, v214
    v_mul_f32 v86, v86, v214
    v_mul_f32 v87, v87, v214
    v_accvgpr_write_b32 a104, v84
    v_accvgpr_write_b32 a105, v85
    v_accvgpr_write_b32 a106, v86
    v_accvgpr_write_b32 a107, v87
    v_accvgpr_read_b32 v88, a108
    v_accvgpr_read_b32 v89, a109
    v_accvgpr_read_b32 v90, a110
    v_accvgpr_read_b32 v91, a111
    v_mul_f32 v88, v88, v215
    v_mul_f32 v89, v89, v215
    v_mul_f32 v90, v90, v215
    v_mul_f32 v91, v91, v215
    v_accvgpr_write_b32 a108, v88
    v_accvgpr_write_b32 a109, v89
    v_accvgpr_write_b32 a110, v90
    v_accvgpr_write_b32 a111, v91
    v_accvgpr_read_b32 v92, a112
    v_accvgpr_read_b32 v93, a113
    v_accvgpr_read_b32 v94, a114
    v_accvgpr_read_b32 v95, a115
    v_mul_f32 v92, v92, v216
    v_mul_f32 v93, v93, v216
    v_mul_f32 v94, v94, v216
    v_mul_f32 v95, v95, v216
    v_accvgpr_write_b32 a112, v92
    v_accvgpr_write_b32 a113, v93
    v_accvgpr_write_b32 a114, v94
    v_accvgpr_write_b32 a115, v95
    v_accvgpr_read_b32 v96, a116
    v_accvgpr_read_b32 v97, a117
    v_accvgpr_read_b32 v98, a118
    v_accvgpr_read_b32 v99, a119
    v_mul_f32 v96, v96, v217
    v_mul_f32 v97, v97, v217
    v_mul_f32 v98, v98, v217
    v_mul_f32 v99, v99, v217
    v_accvgpr_write_b32 a116, v96
    v_accvgpr_write_b32 a117, v97
    v_accvgpr_write_b32 a118, v98
    v_accvgpr_write_b32 a119, v99
    v_accvgpr_read_b32 v80, a120
    v_accvgpr_read_b32 v81, a121
    v_accvgpr_read_b32 v82, a122
    v_accvgpr_read_b32 v83, a123
    v_mul_f32 v80, v80, v213
    v_mul_f32 v81, v81, v213
    v_mul_f32 v82, v82, v213
    v_mul_f32 v83, v83, v213
    v_accvgpr_write_b32 a120, v80
    v_accvgpr_write_b32 a121, v81
    v_accvgpr_write_b32 a122, v82
    v_accvgpr_write_b32 a123, v83
    v_accvgpr_read_b32 v84, a124
    v_accvgpr_read_b32 v85, a125
    v_accvgpr_read_b32 v86, a126
    v_accvgpr_read_b32 v87, a127
    v_mul_f32 v84, v84, v214
    v_mul_f32 v85, v85, v214
    v_mul_f32 v86, v86, v214
    v_mul_f32 v87, v87, v214
    v_accvgpr_write_b32 a124, v84
    v_accvgpr_write_b32 a125, v85
    v_accvgpr_write_b32 a126, v86
    v_accvgpr_write_b32 a127, v87
    v_accvgpr_read_b32 v88, a128
    v_accvgpr_read_b32 v89, a129
    v_accvgpr_read_b32 v90, a130
    v_accvgpr_read_b32 v91, a131
    v_mul_f32 v88, v88, v215
    v_mul_f32 v89, v89, v215
    v_mul_f32 v90, v90, v215
    v_mul_f32 v91, v91, v215
    v_accvgpr_write_b32 a128, v88
    v_accvgpr_write_b32 a129, v89
    v_accvgpr_write_b32 a130, v90
    v_accvgpr_write_b32 a131, v91
    v_accvgpr_read_b32 v92, a132
    v_accvgpr_read_b32 v93, a133
    v_accvgpr_read_b32 v94, a134
    v_accvgpr_read_b32 v95, a135
    v_mul_f32 v92, v92, v216
    v_mul_f32 v93, v93, v216
    v_mul_f32 v94, v94, v216
    v_mul_f32 v95, v95, v216
    v_accvgpr_write_b32 a132, v92
    v_accvgpr_write_b32 a133, v93
    v_accvgpr_write_b32 a134, v94
    v_accvgpr_write_b32 a135, v95
    v_accvgpr_read_b32 v96, a136
    v_accvgpr_read_b32 v97, a137
    v_accvgpr_read_b32 v98, a138
    v_accvgpr_read_b32 v99, a139
    v_mul_f32 v96, v96, v217
    v_mul_f32 v97, v97, v217
    v_mul_f32 v98, v98, v217
    v_mul_f32 v99, v99, v217
    v_accvgpr_write_b32 a136, v96
    v_accvgpr_write_b32 a137, v97
    v_accvgpr_write_b32 a138, v98
    v_accvgpr_write_b32 a139, v99
    v_accvgpr_read_b32 v80, a140
    v_accvgpr_read_b32 v81, a141
    v_accvgpr_read_b32 v82, a142
    v_accvgpr_read_b32 v83, a143
    v_mul_f32 v80, v80, v213
    v_mul_f32 v81, v81, v213
    v_mul_f32 v82, v82, v213
    v_mul_f32 v83, v83, v213
    v_accvgpr_write_b32 a140, v80
    v_accvgpr_write_b32 a141, v81
    v_accvgpr_write_b32 a142, v82
    v_accvgpr_write_b32 a143, v83
    v_accvgpr_read_b32 v84, a144
    v_accvgpr_read_b32 v85, a145
    v_accvgpr_read_b32 v86, a146
    v_accvgpr_read_b32 v87, a147
    v_mul_f32 v84, v84, v214
    v_mul_f32 v85, v85, v214
    v_mul_f32 v86, v86, v214
    v_mul_f32 v87, v87, v214
    v_accvgpr_write_b32 a144, v84
    v_accvgpr_write_b32 a145, v85
    v_accvgpr_write_b32 a146, v86
    v_accvgpr_write_b32 a147, v87
    v_accvgpr_read_b32 v88, a148
    v_accvgpr_read_b32 v89, a149
    v_accvgpr_read_b32 v90, a150
    v_accvgpr_read_b32 v91, a151
    v_mul_f32 v88, v88, v215
    v_mul_f32 v89, v89, v215
    v_mul_f32 v90, v90, v215
    v_mul_f32 v91, v91, v215
    v_accvgpr_write_b32 a148, v88
    v_accvgpr_write_b32 a149, v89
    v_accvgpr_write_b32 a150, v90
    v_accvgpr_write_b32 a151, v91
    v_accvgpr_read_b32 v92, a152
    v_accvgpr_read_b32 v93, a153
    v_accvgpr_read_b32 v94, a154
    v_accvgpr_read_b32 v95, a155
    v_mul_f32 v92, v92, v216
    v_mul_f32 v93, v93, v216
    v_mul_f32 v94, v94, v216
    v_mul_f32 v95, v95, v216
    v_accvgpr_write_b32 a152, v92
    v_accvgpr_write_b32 a153, v93
    v_accvgpr_write_b32 a154, v94
    v_accvgpr_write_b32 a155, v95
    v_accvgpr_read_b32 v96, a156
    v_accvgpr_read_b32 v97, a157
    v_accvgpr_read_b32 v98, a158
    v_accvgpr_read_b32 v99, a159
    v_mul_f32 v96, v96, v217
    v_mul_f32 v97, v97, v217
    v_mul_f32 v98, v98, v217
    v_mul_f32 v99, v99, v217
    v_accvgpr_write_b32 a156, v96
    v_accvgpr_write_b32 a157, v97
    v_accvgpr_write_b32 a158, v98
    v_accvgpr_write_b32 a159, v99
    s_nop 3
    s_branch K1_RESC3_RET
.globl oproj_kernel
.p2align 8
.type oproj_kernel,@function
oproj_kernel:
    s_cmp_ge_u32 s2, 256
    s_cbranch_scc1 K2_END
    s_load_dwordx2 s[4:5], s[0:1], 32
    s_load_dwordx2 s[6:7], s[0:1], 72
    s_load_dwordx2 s[8:9], s[0:1], 80
    s_load_dwordx2 s[10:11], s[0:1], 96
    v_lshrrev_b32 v208, 6, v0
    v_and_b32 v0, 63, v0
    s_nop 1
    v_readfirstlane_b32 s24, v208
    s_nop 3
    s_and_b32 s27, s2, 7
    s_lshr_b32 s28, s2, 3
    s_and_b32 s31, s28, 7
    s_lshr_b32 s28, s28, 3
    s_lshl_b32 s27, s27, 2
    s_add_u32 s27, s27, s28
    s_lshr_b32 s32, s27, 4
    s_and_b32 s33, s27, 15
    s_lshl_b32 s25, s24, 14
    v_and_b32 v209, 15, v0
    v_lshrrev_b32 v210, 4, v0
    v_bfe_u32 v211, v0, 2, 2
    v_and_b32 v212, 3, v0
    v_lshlrev_b32 v214, 4, v0
    v_add_u32 v2, 0, v214
    v_add_u32 v3, 4096, v214
    v_add_u32 v4, 8192, v214
    v_lshlrev_b32 v12, 4, v0
    v_lshrrev_b32 v213, 1, v211
    v_xor_b32 v213, 0, v213
    v_lshl_add_u32 v213, v213, 2, v212
    v_lshlrev_b32 v213, 4, v213
    v_lshl_add_u32 v214, v210, 3, v211
    v_lshl_add_u32 v214, v214, 7, v213
    v_add_u32 v14, s25, v214
    v_lshrrev_b32 v213, 1, v211
    v_xor_b32 v213, 1, v213
    v_lshl_add_u32 v213, v213, 2, v212
    v_lshlrev_b32 v213, 4, v213
    v_lshl_add_u32 v214, v210, 3, v211
    v_lshl_add_u32 v214, v214, 7, v213
    v_add_u32 v15, s25, v214
    v_lshlrev_b32 v214, 4, v210
    v_lshl_add_u32 v248, v209, 11, v214
    v_lshlrev_b32 v249, 4, v0
    s_waitcnt lgkmcnt(0)
    s_lshl_b32 s27, s31, 7
    s_lshl_b32 s28, s32, 3
    s_add_u32 s28, s28, s31
    s_lshl_b32 s28, s28, 7
    s_lshl_b32 s29, s24, 5
    s_add_u32 s28, s28, s29
    s_lshl_b32 s28, s28, 12
    s_add_u32 s28, s28, 100663296
    s_add_u32 s12, s10, s28
    s_addc_u32 s13, s11, 0
    s_and_b32 s13, s13, 65535
    s_mov_b32 s14, 131072
    s_mov_b32 s15, 131072
    s_lshl_b32 s28, s32, 4
    s_add_u32 s28, s28, s33
    s_lshl_b32 s28, s28, 5
    s_lshl_b32 s29, s24, 3
    s_add_u32 s28, s28, s29
    s_mul_i32 s28, s28, 40960
    s_add_u32 s16, s10, s28
    s_addc_u32 s17, s11, 0
    s_and_b32 s17, s17, 65535
    s_mov_b32 s18, 327680
    s_mov_b32 s19, 131072
    s_mul_i32 s28, s33, 327680
    s_lshl_b32 s29, s32, 10
    s_add_u32 s29, s29, s27
    s_add_u32 s28, s28, s29
    s_add_u32 s20, s8, s28
    s_addc_u32 s21, s9, 0
    s_and_b32 s21, s21, 65535
    s_sub_u32 s22, 327680, s29
    s_mov_b32 s23, 131072
    s_lshl_b32 s26, s24, 20
    v_lshlrev_b32 v252, 7, v0
    v_lshlrev_b32 v253, 10, v0
    s_add_u32 m0, s25, 0
    s_mov_b32 s30, 0
    buffer_load_dwordx4 v12, s[12:15], s30 offen offset:0 lds
    buffer_load_dwordx4 v12, s[12:15], s30 offen offset:1024 lds
    buffer_load_dwordx4 v12, s[12:15], s30 offen offset:2048 lds
    buffer_load_dwordx4 v12, s[12:15], s30 offen offset:3072 lds
    s_add_u32 m0, s25, 4096
    s_mov_b32 s30, 4096
    buffer_load_dwordx4 v12, s[12:15], s30 offen offset:0 lds
    buffer_load_dwordx4 v12, s[12:15], s30 offen offset:1024 lds
    buffer_load_dwordx4 v12, s[12:15], s30 offen offset:2048 lds
    buffer_load_dwordx4 v12, s[12:15], s30 offen offset:3072 lds
    s_add_u32 m0, s25, 8192
    s_mov_b32 s30, 8192
    buffer_load_dwordx4 v12, s[12:15], s30 offen offset:0 lds
    buffer_load_dwordx4 v12, s[12:15], s30 offen offset:1024 lds
    buffer_load_dwordx4 v12, s[12:15], s30 offen offset:2048 lds
    buffer_load_dwordx4 v12, s[12:15], s30 offen offset:3072 lds
    s_add_u32 m0, s25, 12288
    s_mov_b32 s30, 12288
    buffer_load_dwordx4 v12, s[12:15], s30 offen offset:0 lds
    buffer_load_dwordx4 v12, s[12:15], s30 offen offset:1024 lds
    buffer_load_dwordx4 v12, s[12:15], s30 offen offset:2048 lds
    buffer_load_dwordx4 v12, s[12:15], s30 offen offset:3072 lds
    s_mov_b32 s29, 0
    buffer_load_dwordx4 v[48:51], v2, s[16:19], s29 offen offset:0
    s_mov_b32 s29, 0
    buffer_load_dwordx4 v[52:55], v2, s[16:19], s29 offen offset:1024
    s_mov_b32 s29, 0
    buffer_load_dwordx4 v[56:59], v2, s[16:19], s29 offen offset:2048
    s_mov_b32 s29, 0
    buffer_load_dwordx4 v[60:63], v2, s[16:19], s29 offen offset:3072
    s_mov_b32 s29, 0
    buffer_load_dwordx4 v[64:67], v3, s[16:19], s29 offen offset:0
    s_mov_b32 s29, 0
    buffer_load_dwordx4 v[68:71], v3, s[16:19], s29 offen offset:1024
    s_mov_b32 s29, 0
    buffer_load_dwordx4 v[72:75], v3, s[16:19], s29 offen offset:2048
    s_mov_b32 s29, 0
    buffer_load_dwordx4 v[76:79], v3, s[16:19], s29 offen offset:3072
    s_mov_b32 s29, 0
    buffer_load_dwordx4 v[80:83], v4, s[16:19], s29 offen offset:0
    s_mov_b32 s29, 0
    buffer_load_dwordx4 v[84:87], v4, s[16:19], s29 offen offset:1024
    s_mov_b32 s29, 10240
    buffer_load_dwordx4 v[88:91], v2, s[16:19], s29 offen offset:0
    s_mov_b32 s29, 10240
    buffer_load_dwordx4 v[92:95], v2, s[16:19], s29 offen offset:1024
    s_mov_b32 s29, 10240
    buffer_load_dwordx4 v[96:99], v2, s[16:19], s29 offen offset:2048
    s_mov_b32 s29, 10240
    buffer_load_dwordx4 v[100:103], v2, s[16:19], s29 offen offset:3072
    s_mov_b32 s29, 10240
    buffer_load_dwordx4 v[104:107], v3, s[16:19], s29 offen offset:0
    s_mov_b32 s29, 10240
    buffer_load_dwordx4 v[108:111], v3, s[16:19], s29 offen offset:1024
    s_mov_b32 s29, 10240
    buffer_load_dwordx4 v[112:115], v3, s[16:19], s29 offen offset:2048
    s_mov_b32 s29, 10240
    buffer_load_dwordx4 v[116:119], v3, s[16:19], s29 offen offset:3072
    s_mov_b32 s29, 10240
    buffer_load_dwordx4 v[120:123], v4, s[16:19], s29 offen offset:0
    s_mov_b32 s29, 10240
    buffer_load_dwordx4 v[124:127], v4, s[16:19], s29 offen offset:1024
    s_mov_b32 s29, 20480
    buffer_load_dwordx4 v[128:131], v2, s[16:19], s29 offen offset:0
    s_mov_b32 s29, 20480
    buffer_load_dwordx4 v[132:135], v2, s[16:19], s29 offen offset:1024
    s_mov_b32 s29, 20480
    buffer_load_dwordx4 v[136:139], v2, s[16:19], s29 offen offset:2048
    s_mov_b32 s29, 20480
    buffer_load_dwordx4 v[140:143], v2, s[16:19], s29 offen offset:3072
    s_mov_b32 s29, 20480
    buffer_load_dwordx4 v[144:147], v3, s[16:19], s29 offen offset:0
    s_mov_b32 s29, 20480
    buffer_load_dwordx4 v[148:151], v3, s[16:19], s29 offen offset:1024
    s_mov_b32 s29, 20480
    buffer_load_dwordx4 v[152:155], v3, s[16:19], s29 offen offset:2048
    s_mov_b32 s29, 20480
    buffer_load_dwordx4 v[156:159], v3, s[16:19], s29 offen offset:3072
    s_mov_b32 s29, 20480
    buffer_load_dwordx4 v[160:163], v4, s[16:19], s29 offen offset:0
    s_mov_b32 s29, 20480
    buffer_load_dwordx4 v[164:167], v4, s[16:19], s29 offen offset:1024
    s_mov_b32 s29, 30720
    buffer_load_dwordx4 v[168:171], v2, s[16:19], s29 offen offset:0
    s_mov_b32 s29, 30720
    buffer_load_dwordx4 v[172:175], v2, s[16:19], s29 offen offset:1024
    s_mov_b32 s29, 30720
    buffer_load_dwordx4 v[176:179], v2, s[16:19], s29 offen offset:2048
    s_mov_b32 s29, 30720
    buffer_load_dwordx4 v[180:183], v2, s[16:19], s29 offen offset:3072
    s_mov_b32 s29, 30720
    buffer_load_dwordx4 v[184:187], v3, s[16:19], s29 offen offset:0
    s_mov_b32 s29, 30720
    buffer_load_dwordx4 v[188:191], v3, s[16:19], s29 offen offset:1024
    s_mov_b32 s29, 30720
    buffer_load_dwordx4 v[192:195], v3, s[16:19], s29 offen offset:2048
    s_mov_b32 s29, 30720
    buffer_load_dwordx4 v[196:199], v3, s[16:19], s29 offen offset:3072
    s_mov_b32 s29, 30720
    buffer_load_dwordx4 v[200:203], v4, s[16:19], s29 offen offset:0
    s_mov_b32 s29, 30720
    buffer_load_dwordx4 v[204:207], v4, s[16:19], s29 offen offset:1024
    s_waitcnt vmcnt(52)
    ds_read_b64_tr_b16 v[16:17], v14 offset:0
    ds_read_b64_tr_b16 v[18:19], v14 offset:512
    ds_read_b64_tr_b16 v[20:21], v14 offset:8
    ds_read_b64_tr_b16 v[22:23], v14 offset:520
    ds_read_b64_tr_b16 v[24:25], v15 offset:0
    ds_read_b64_tr_b16 v[26:27], v15 offset:512
    ds_read_b64_tr_b16 v[28:29], v15 offset:8
    ds_read_b64_tr_b16 v[30:31], v15 offset:520
    s_waitcnt vmcnt(48)
    s_waitcnt lgkmcnt(0)
    s_waitcnt vmcnt(39)
    v_mfma_f32_16x16x32_bf16 a[0:3], v[16:19], v[48:51], 0
    v_mfma_f32_16x16x32_bf16 a[40:43], v[20:23], v[48:51], 0
    s_add_u32 m0, s25, 0
    s_mov_b32 s30, 16384
    buffer_load_dwordx4 v12, s[12:15], s30 offen offset:0 lds
    v_mfma_f32_16x16x32_bf16 a[80:83], v[24:27], v[48:51], 0
    ds_read_b64_tr_b16 v[32:33], v14 offset:4096
    v_mfma_f32_16x16x32_bf16 a[120:123], v[28:31], v[48:51], 0
    buffer_load_dwordx4 v12, s[12:15], s30 offen offset:1024 lds
    s_waitcnt vmcnt(40)
    v_mfma_f32_16x16x32_bf16 a[4:7], v[16:19], v[52:55], 0
    ds_read_b64_tr_b16 v[34:35], v14 offset:4608
    v_mfma_f32_16x16x32_bf16 a[44:47], v[20:23], v[52:55], 0
    v_mfma_f32_16x16x32_bf16 a[84:87], v[24:27], v[52:55], 0
    buffer_load_dwordx4 v12, s[12:15], s30 offen offset:2048 lds
    ds_read_b64_tr_b16 v[36:37], v14 offset:4104
    v_mfma_f32_16x16x32_bf16 a[124:127], v[28:31], v[52:55], 0
    s_waitcnt vmcnt(40)
    v_mfma_f32_16x16x32_bf16 a[8:11], v[16:19], v[56:59], 0
    buffer_load_dwordx4 v12, s[12:15], s30 offen offset:3072 lds
    ds_read_b64_tr_b16 v[38:39], v14 offset:4616
    v_mfma_f32_16x16x32_bf16 a[48:51], v[20:23], v[56:59], 0
    v_mfma_f32_16x16x32_bf16 a[88:91], v[24:27], v[56:59], 0
    ds_read_b64_tr_b16 v[40:41], v15 offset:4096
    v_mfma_f32_16x16x32_bf16 a[128:131], v[28:31], v[56:59], 0
    s_mov_b32 s29, 40960
    buffer_load_dwordx4 v[208:211], v2, s[16:19], s29 offen offset:0
    s_waitcnt vmcnt(41)
    v_mfma_f32_16x16x32_bf16 a[12:15], v[16:19], v[60:63], 0
    ds_read_b64_tr_b16 v[42:43], v15 offset:4608
    v_mfma_f32_16x16x32_bf16 a[52:55], v[20:23], v[60:63], 0
    v_mfma_f32_16x16x32_bf16 a[92:95], v[24:27], v[60:63], 0
    s_mov_b32 s29, 40960
    buffer_load_dwordx4 v[212:215], v2, s[16:19], s29 offen offset:1024
    ds_read_b64_tr_b16 v[44:45], v15 offset:4104
    v_mfma_f32_16x16x32_bf16 a[132:135], v[28:31], v[60:63], 0
    s_waitcnt vmcnt(41)
    v_mfma_f32_16x16x32_bf16 a[16:19], v[16:19], v[64:67], 0
    s_mov_b32 s29, 40960
    buffer_load_dwordx4 v[216:219], v2, s[16:19], s29 offen offset:2048
    ds_read_b64_tr_b16 v[46:47], v15 offset:4616
    v_mfma_f32_16x16x32_bf16 a[56:59], v[20:23], v[64:67], 0
    v_mfma_f32_16x16x32_bf16 a[96:99], v[24:27], v[64:67], 0
    v_mfma_f32_16x16x32_bf16 a[136:139], v[28:31], v[64:67], 0
    s_mov_b32 s29, 40960
    buffer_load_dwordx4 v[220:223], v2, s[16:19], s29 offen offset:3072
    s_waitcnt vmcnt(42)
    v_mfma_f32_16x16x32_bf16 a[20:23], v[16:19], v[68:71], 0
    v_mfma_f32_16x16x32_bf16 a[60:63], v[20:23], v[68:71], 0
    v_mfma_f32_16x16x32_bf16 a[100:103], v[24:27], v[68:71], 0
    s_mov_b32 s29, 40960
    buffer_load_dwordx4 v[224:227], v3, s[16:19], s29 offen offset:0
    v_mfma_f32_16x16x32_bf16 a[140:143], v[28:31], v[68:71], 0
    s_waitcnt vmcnt(42)
    v_mfma_f32_16x16x32_bf16 a[24:27], v[16:19], v[72:75], 0
    s_mov_b32 s29, 40960
    buffer_load_dwordx4 v[228:231], v3, s[16:19], s29 offen offset:1024
    v_mfma_f32_16x16x32_bf16 a[64:67], v[20:23], v[72:75], 0
    v_mfma_f32_16x16x32_bf16 a[104:107], v[24:27], v[72:75], 0
    v_mfma_f32_16x16x32_bf16 a[144:147], v[28:31], v[72:75], 0
    s_mov_b32 s29, 40960
    buffer_load_dwordx4 v[232:235], v3, s[16:19], s29 offen offset:2048
    s_waitcnt vmcnt(43)
    v_mfma_f32_16x16x32_bf16 a[28:31], v[16:19], v[76:79], 0
    v_mfma_f32_16x16x32_bf16 a[68:71], v[20:23], v[76:79], 0
    v_mfma_f32_16x16x32_bf16 a[108:111], v[24:27], v[76:79], 0
    s_mov_b32 s29, 40960
    buffer_load_dwordx4 v[236:239], v3, s[16:19], s29 offen offset:3072
    v_mfma_f32_16x16x32_bf16 a[148:151], v[28:31], v[76:79], 0
    s_waitcnt vmcnt(43)
    v_mfma_f32_16x16x32_bf16 a[32:35], v[16:19], v[80:83], 0
    s_mov_b32 s29, 40960
    buffer_load_dwordx4 v[240:243], v4, s[16:19], s29 offen offset:0
    v_mfma_f32_16x16x32_bf16 a[72:75], v[20:23], v[80:83], 0
    v_mfma_f32_16x16x32_bf16 a[112:115], v[24:27], v[80:83], 0
    v_mfma_f32_16x16x32_bf16 a[152:155], v[28:31], v[80:83], 0
    s_mov_b32 s29, 40960
    buffer_load_dwordx4 v[244:247], v4, s[16:19], s29 offen offset:1024
    s_waitcnt vmcnt(44)
    v_mfma_f32_16x16x32_bf16 a[36:39], v[16:19], v[84:87], 0
    v_mfma_f32_16x16x32_bf16 a[76:79], v[20:23], v[84:87], 0
    v_mfma_f32_16x16x32_bf16 a[116:119], v[24:27], v[84:87], 0
    v_mfma_f32_16x16x32_bf16 a[156:159], v[28:31], v[84:87], 0
    s_waitcnt lgkmcnt(0)
    s_waitcnt vmcnt(43)
    v_mfma_f32_16x16x32_bf16 a[0:3], v[32:35], v[88:91], a[0:3]
    v_mfma_f32_16x16x32_bf16 a[40:43], v[36:39], v[88:91], a[40:43]
    s_add_u32 m0, s25, 4096
    s_mov_b32 s30, 20480
    buffer_load_dwordx4 v12, s[12:15], s30 offen offset:0 lds
    v_mfma_f32_16x16x32_bf16 a[80:83], v[40:43], v[88:91], a[80:83]
    ds_read_b64_tr_b16 v[16:17], v14 offset:8192
    v_mfma_f32_16x16x32_bf16 a[120:123], v[44:47], v[88:91], a[120:123]
    buffer_load_dwordx4 v12, s[12:15], s30 offen offset:1024 lds
    s_waitcnt vmcnt(44)
    v_mfma_f32_16x16x32_bf16 a[4:7], v[32:35], v[92:95], a[4:7]
    ds_read_b64_tr_b16 v[18:19], v14 offset:8704
    v_mfma_f32_16x16x32_bf16 a[44:47], v[36:39], v[92:95], a[44:47]
    v_mfma_f32_16x16x32_bf16 a[84:87], v[40:43], v[92:95], a[84:87]
    buffer_load_dwordx4 v12, s[12:15], s30 offen offset:2048 lds
    ds_read_b64_tr_b16 v[20:21], v14 offset:8200
    v_mfma_f32_16x16x32_bf16 a[124:127], v[44:47], v[92:95], a[124:127]
    s_waitcnt vmcnt(44)
    v_mfma_f32_16x16x32_bf16 a[8:11], v[32:35], v[96:99], a[8:11]
    buffer_load_dwordx4 v12, s[12:15], s30 offen offset:3072 lds
    ds_read_b64_tr_b16 v[22:23], v14 offset:8712
    v_mfma_f32_16x16x32_bf16 a[48:51], v[36:39], v[96:99], a[48:51]
    v_mfma_f32_16x16x32_bf16 a[88:91], v[40:43], v[96:99], a[88:91]
    ds_read_b64_tr_b16 v[24:25], v15 offset:8192
    v_mfma_f32_16x16x32_bf16 a[128:131], v[44:47], v[96:99], a[128:131]
    s_mov_b32 s29, 51200
    buffer_load_dwordx4 v[48:51], v2, s[16:19], s29 offen offset:0
    s_waitcnt vmcnt(45)
    v_mfma_f32_16x16x32_bf16 a[12:15], v[32:35], v[100:103], a[12:15]
    ds_read_b64_tr_b16 v[26:27], v15 offset:8704
    v_mfma_f32_16x16x32_bf16 a[52:55], v[36:39], v[100:103], a[52:55]
    v_mfma_f32_16x16x32_bf16 a[92:95], v[40:43], v[100:103], a[92:95]
    s_mov_b32 s29, 51200
    buffer_load_dwordx4 v[52:55], v2, s[16:19], s29 offen offset:1024
    ds_read_b64_tr_b16 v[28:29], v15 offset:8200
    v_mfma_f32_16x16x32_bf16 a[132:135], v[44:47], v[100:103], a[132:135]
    s_waitcnt vmcnt(45)
    v_mfma_f32_16x16x32_bf16 a[16:19], v[32:35], v[104:107], a[16:19]
    s_mov_b32 s29, 51200
    buffer_load_dwordx4 v[56:59], v2, s[16:19], s29 offen offset:2048
    ds_read_b64_tr_b16 v[30:31], v15 offset:8712
    v_mfma_f32_16x16x32_bf16 a[56:59], v[36:39], v[104:107], a[56:59]
    v_mfma_f32_16x16x32_bf16 a[96:99], v[40:43], v[104:107], a[96:99]
    v_mfma_f32_16x16x32_bf16 a[136:139], v[44:47], v[104:107], a[136:139]
    s_mov_b32 s29, 51200
    buffer_load_dwordx4 v[60:63], v2, s[16:19], s29 offen offset:3072
    s_waitcnt vmcnt(46)
    v_mfma_f32_16x16x32_bf16 a[20:23], v[32:35], v[108:111], a[20:23]
    v_mfma_f32_16x16x32_bf16 a[60:63], v[36:39], v[108:111], a[60:63]
    v_mfma_f32_16x16x32_bf16 a[100:103], v[40:43], v[108:111], a[100:103]
    s_mov_b32 s29, 51200
    buffer_load_dwordx4 v[64:67], v3, s[16:19], s29 offen offset:0
    v_mfma_f32_16x16x32_bf16 a[140:143], v[44:47], v[108:111], a[140:143]
    s_waitcnt vmcnt(46)
    v_mfma_f32_16x16x32_bf16 a[24:27], v[32:35], v[112:115], a[24:27]
    s_mov_b32 s29, 51200
    buffer_load_dwordx4 v[68:71], v3, s[16:19], s29 offen offset:1024
    v_mfma_f32_16x16x32_bf16 a[64:67], v[36:39], v[112:115], a[64:67]
    v_mfma_f32_16x16x32_bf16 a[104:107], v[40:43], v[112:115], a[104:107]
    v_mfma_f32_16x16x32_bf16 a[144:147], v[44:47], v[112:115], a[144:147]
    s_mov_b32 s29, 51200
    buffer_load_dwordx4 v[72:75], v3, s[16:19], s29 offen offset:2048
    s_waitcnt vmcnt(47)
    v_mfma_f32_16x16x32_bf16 a[28:31], v[32:35], v[116:119], a[28:31]
    v_mfma_f32_16x16x32_bf16 a[68:71], v[36:39], v[116:119], a[68:71]
    v_mfma_f32_16x16x32_bf16 a[108:111], v[40:43], v[116:119], a[108:111]
    s_mov_b32 s29, 51200
    buffer_load_dwordx4 v[76:79], v3, s[16:19], s29 offen offset:3072
    v_mfma_f32_16x16x32_bf16 a[148:151], v[44:47], v[116:119], a[148:151]
    s_waitcnt vmcnt(47)
    v_mfma_f32_16x16x32_bf16 a[32:35], v[32:35], v[120:123], a[32:35]
    s_mov_b32 s29, 51200
    buffer_load_dwordx4 v[80:83], v4, s[16:19], s29 offen offset:0
    v_mfma_f32_16x16x32_bf16 a[72:75], v[36:39], v[120:123], a[72:75]
    v_mfma_f32_16x16x32_bf16 a[112:115], v[40:43], v[120:123], a[112:115]
    v_mfma_f32_16x16x32_bf16 a[152:155], v[44:47], v[120:123], a[152:155]
    s_mov_b32 s29, 51200
    buffer_load_dwordx4 v[84:87], v4, s[16:19], s29 offen offset:1024
    s_waitcnt vmcnt(48)
    v_mfma_f32_16x16x32_bf16 a[36:39], v[32:35], v[124:127], a[36:39]
    v_mfma_f32_16x16x32_bf16 a[76:79], v[36:39], v[124:127], a[76:79]
    v_mfma_f32_16x16x32_bf16 a[116:119], v[40:43], v[124:127], a[116:119]
    v_mfma_f32_16x16x32_bf16 a[156:159], v[44:47], v[124:127], a[156:159]
    s_waitcnt lgkmcnt(0)
    s_waitcnt vmcnt(47)
    v_mfma_f32_16x16x32_bf16 a[0:3], v[16:19], v[128:131], a[0:3]
    v_mfma_f32_16x16x32_bf16 a[40:43], v[20:23], v[128:131], a[40:43]
    s_add_u32 m0, s25, 8192
    s_mov_b32 s30, 24576
    buffer_load_dwordx4 v12, s[12:15], s30 offen offset:0 lds
    v_mfma_f32_16x16x32_bf16 a[80:83], v[24:27], v[128:131], a[80:83]
    ds_read_b64_tr_b16 v[32:33], v14 offset:12288
    v_mfma_f32_16x16x32_bf16 a[120:123], v[28:31], v[128:131], a[120:123]
    buffer_load_dwordx4 v12, s[12:15], s30 offen offset:1024 lds
    s_waitcnt vmcnt(48)
    v_mfma_f32_16x16x32_bf16 a[4:7], v[16:19], v[132:135], a[4:7]
    ds_read_b64_tr_b16 v[34:35], v14 offset:12800
    v_mfma_f32_16x16x32_bf16 a[44:47], v[20:23], v[132:135], a[44:47]
    v_mfma_f32_16x16x32_bf16 a[84:87], v[24:27], v[132:135], a[84:87]
    buffer_load_dwordx4 v12, s[12:15], s30 offen offset:2048 lds
    ds_read_b64_tr_b16 v[36:37], v14 offset:12296
    v_mfma_f32_16x16x32_bf16 a[124:127], v[28:31], v[132:135], a[124:127]
    s_waitcnt vmcnt(48)
    v_mfma_f32_16x16x32_bf16 a[8:11], v[16:19], v[136:139], a[8:11]
    buffer_load_dwordx4 v12, s[12:15], s30 offen offset:3072 lds
    ds_read_b64_tr_b16 v[38:39], v14 offset:12808
    v_mfma_f32_16x16x32_bf16 a[48:51], v[20:23], v[136:139], a[48:51]
    v_mfma_f32_16x16x32_bf16 a[88:91], v[24:27], v[136:139], a[88:91]
    ds_read_b64_tr_b16 v[40:41], v15 offset:12288
    v_mfma_f32_16x16x32_bf16 a[128:131], v[28:31], v[136:139], a[128:131]
    s_mov_b32 s29, 61440
    buffer_load_dwordx4 v[88:91], v2, s[16:19], s29 offen offset:0
    s_waitcnt vmcnt(49)
    v_mfma_f32_16x16x32_bf16 a[12:15], v[16:19], v[140:143], a[12:15]
    ds_read_b64_tr_b16 v[42:43], v15 offset:12800
    v_mfma_f32_16x16x32_bf16 a[52:55], v[20:23], v[140:143], a[52:55]
    v_mfma_f32_16x16x32_bf16 a[92:95], v[24:27], v[140:143], a[92:95]
    s_mov_b32 s29, 61440
    buffer_load_dwordx4 v[92:95], v2, s[16:19], s29 offen offset:1024
    ds_read_b64_tr_b16 v[44:45], v15 offset:12296
    v_mfma_f32_16x16x32_bf16 a[132:135], v[28:31], v[140:143], a[132:135]
    s_waitcnt vmcnt(49)
    v_mfma_f32_16x16x32_bf16 a[16:19], v[16:19], v[144:147], a[16:19]
    s_mov_b32 s29, 61440
    buffer_load_dwordx4 v[96:99], v2, s[16:19], s29 offen offset:2048
    ds_read_b64_tr_b16 v[46:47], v15 offset:12808
    v_mfma_f32_16x16x32_bf16 a[56:59], v[20:23], v[144:147], a[56:59]
    v_mfma_f32_16x16x32_bf16 a[96:99], v[24:27], v[144:147], a[96:99]
    v_mfma_f32_16x16x32_bf16 a[136:139], v[28:31], v[144:147], a[136:139]
    s_mov_b32 s29, 61440
    buffer_load_dwordx4 v[100:103], v2, s[16:19], s29 offen offset:3072
    s_waitcnt vmcnt(50)
    v_mfma_f32_16x16x32_bf16 a[20:23], v[16:19], v[148:151], a[20:23]
    v_mfma_f32_16x16x32_bf16 a[60:63], v[20:23], v[148:151], a[60:63]
    v_mfma_f32_16x16x32_bf16 a[100:103], v[24:27], v[148:151], a[100:103]
    s_mov_b32 s29, 61440
    buffer_load_dwordx4 v[104:107], v3, s[16:19], s29 offen offset:0
    v_mfma_f32_16x16x32_bf16 a[140:143], v[28:31], v[148:151], a[140:143]
    s_waitcnt vmcnt(50)
    v_mfma_f32_16x16x32_bf16 a[24:27], v[16:19], v[152:155], a[24:27]
    s_mov_b32 s29, 61440
    buffer_load_dwordx4 v[108:111], v3, s[16:19], s29 offen offset:1024
    v_mfma_f32_16x16x32_bf16 a[64:67], v[20:23], v[152:155], a[64:67]
    v_mfma_f32_16x16x32_bf16 a[104:107], v[24:27], v[152:155], a[104:107]
    v_mfma_f32_16x16x32_bf16 a[144:147], v[28:31], v[152:155], a[144:147]
    s_mov_b32 s29, 61440
    buffer_load_dwordx4 v[112:115], v3, s[16:19], s29 offen offset:2048
    s_waitcnt vmcnt(51)
    v_mfma_f32_16x16x32_bf16 a[28:31], v[16:19], v[156:159], a[28:31]
    v_mfma_f32_16x16x32_bf16 a[68:71], v[20:23], v[156:159], a[68:71]
    v_mfma_f32_16x16x32_bf16 a[108:111], v[24:27], v[156:159], a[108:111]
    s_mov_b32 s29, 61440
    buffer_load_dwordx4 v[116:119], v3, s[16:19], s29 offen offset:3072
    v_mfma_f32_16x16x32_bf16 a[148:151], v[28:31], v[156:159], a[148:151]
    s_waitcnt vmcnt(51)
    v_mfma_f32_16x16x32_bf16 a[32:35], v[16:19], v[160:163], a[32:35]
    s_mov_b32 s29, 61440
    buffer_load_dwordx4 v[120:123], v4, s[16:19], s29 offen offset:0
    v_mfma_f32_16x16x32_bf16 a[72:75], v[20:23], v[160:163], a[72:75]
    v_mfma_f32_16x16x32_bf16 a[112:115], v[24:27], v[160:163], a[112:115]
    v_mfma_f32_16x16x32_bf16 a[152:155], v[28:31], v[160:163], a[152:155]
    s_mov_b32 s29, 61440
    buffer_load_dwordx4 v[124:127], v4, s[16:19], s29 offen offset:1024
    s_waitcnt vmcnt(52)
    v_mfma_f32_16x16x32_bf16 a[36:39], v[16:19], v[164:167], a[36:39]
    v_mfma_f32_16x16x32_bf16 a[76:79], v[20:23], v[164:167], a[76:79]
    v_mfma_f32_16x16x32_bf16 a[116:119], v[24:27], v[164:167], a[116:119]
    v_mfma_f32_16x16x32_bf16 a[156:159], v[28:31], v[164:167], a[156:159]
    s_waitcnt vmcnt(38)
    s_waitcnt lgkmcnt(0)
    v_mfma_f32_16x16x32_bf16 a[0:3], v[32:35], v[168:171], a[0:3]
    v_mfma_f32_16x16x32_bf16 a[40:43], v[36:39], v[168:171], a[40:43]
    s_add_u32 m0, s25, 12288
    s_mov_b32 s30, 28672
    buffer_load_dwordx4 v12, s[12:15], s30 offen offset:0 lds
    v_mfma_f32_16x16x32_bf16 a[80:83], v[40:43], v[168:171], a[80:83]
    ds_read_b64_tr_b16 v[16:17], v14 offset:0
    v_mfma_f32_16x16x32_bf16 a[120:123], v[44:47], v[168:171], a[120:123]
    buffer_load_dwordx4 v12, s[12:15], s30 offen offset:1024 lds
    v_mfma_f32_16x16x32_bf16 a[4:7], v[32:35], v[172:175], a[4:7]
    ds_read_b64_tr_b16 v[18:19], v14 offset:512
    v_mfma_f32_16x16x32_bf16 a[44:47], v[36:39], v[172:175], a[44:47]
    v_mfma_f32_16x16x32_bf16 a[84:87], v[40:43], v[172:175], a[84:87]
    buffer_load_dwordx4 v12, s[12:15], s30 offen offset:2048 lds
    ds_read_b64_tr_b16 v[20:21], v14 offset:8
    v_mfma_f32_16x16x32_bf16 a[124:127], v[44:47], v[172:175], a[124:127]
    v_mfma_f32_16x16x32_bf16 a[8:11], v[32:35], v[176:179], a[8:11]
    buffer_load_dwordx4 v12, s[12:15], s30 offen offset:3072 lds
    ds_read_b64_tr_b16 v[22:23], v14 offset:520
    v_mfma_f32_16x16x32_bf16 a[48:51], v[36:39], v[176:179], a[48:51]
    v_mfma_f32_16x16x32_bf16 a[88:91], v[40:43], v[176:179], a[88:91]
    ds_read_b64_tr_b16 v[24:25], v15 offset:0
    v_mfma_f32_16x16x32_bf16 a[128:131], v[44:47], v[176:179], a[128:131]
    s_mov_b32 s29, 71680
    buffer_load_dwordx4 v[128:131], v2, s[16:19], s29 offen offset:0
    v_mfma_f32_16x16x32_bf16 a[12:15], v[32:35], v[180:183], a[12:15]
    ds_read_b64_tr_b16 v[26:27], v15 offset:512
    v_mfma_f32_16x16x32_bf16 a[52:55], v[36:39], v[180:183], a[52:55]
    v_mfma_f32_16x16x32_bf16 a[92:95], v[40:43], v[180:183], a[92:95]
    s_mov_b32 s29, 71680
    buffer_load_dwordx4 v[132:135], v2, s[16:19], s29 offen offset:1024
    ds_read_b64_tr_b16 v[28:29], v15 offset:8
    v_mfma_f32_16x16x32_bf16 a[132:135], v[44:47], v[180:183], a[132:135]
    v_mfma_f32_16x16x32_bf16 a[16:19], v[32:35], v[184:187], a[16:19]
    s_mov_b32 s29, 71680
    buffer_load_dwordx4 v[136:139], v2, s[16:19], s29 offen offset:2048
    ds_read_b64_tr_b16 v[30:31], v15 offset:520
    v_mfma_f32_16x16x32_bf16 a[56:59], v[36:39], v[184:187], a[56:59]
    v_mfma_f32_16x16x32_bf16 a[96:99], v[40:43], v[184:187], a[96:99]
    v_mfma_f32_16x16x32_bf16 a[136:139], v[44:47], v[184:187], a[136:139]
    s_mov_b32 s29, 71680
    buffer_load_dwordx4 v[140:143], v2, s[16:19], s29 offen offset:3072
    v_mfma_f32_16x16x32_bf16 a[20:23], v[32:35], v[188:191], a[20:23]
    v_mfma_f32_16x16x32_bf16 a[60:63], v[36:39], v[188:191], a[60:63]
    v_mfma_f32_16x16x32_bf16 a[100:103], v[40:43], v[188:191], a[100:103]
    s_mov_b32 s29, 71680
    buffer_load_dwordx4 v[144:147], v3, s[16:19], s29 offen offset:0
    v_mfma_f32_16x16x32_bf16 a[140:143], v[44:47], v[188:191], a[140:143]
    v_mfma_f32_16x16x32_bf16 a[24:27], v[32:35], v[192:195], a[24:27]
    s_mov_b32 s29, 71680
    buffer_load_dwordx4 v[148:151], v3, s[16:19], s29 offen offset:1024
    v_mfma_f32_16x16x32_bf16 a[64:67], v[36:39], v[192:195], a[64:67]
    v_mfma_f32_16x16x32_bf16 a[104:107], v[40:43], v[192:195], a[104:107]
    v_mfma_f32_16x16x32_bf16 a[144:147], v[44:47], v[192:195], a[144:147]
    s_mov_b32 s29, 71680
    buffer_load_dwordx4 v[152:155], v3, s[16:19], s29 offen offset:2048
    v_mfma_f32_16x16x32_bf16 a[28:31], v[32:35], v[196:199], a[28:31]
    v_mfma_f32_16x16x32_bf16 a[68:71], v[36:39], v[196:199], a[68:71]
    v_mfma_f32_16x16x32_bf16 a[108:111], v[40:43], v[196:199], a[108:111]
    s_mov_b32 s29, 71680
    buffer_load_dwordx4 v[156:159], v3, s[16:19], s29 offen offset:3072
    v_mfma_f32_16x16x32_bf16 a[148:151], v[44:47], v[196:199], a[148:151]
    v_mfma_f32_16x16x32_bf16 a[32:35], v[32:35], v[200:203], a[32:35]
    s_mov_b32 s29, 71680
    buffer_load_dwordx4 v[160:163], v4, s[16:19], s29 offen offset:0
    v_mfma_f32_16x16x32_bf16 a[72:75], v[36:39], v[200:203], a[72:75]
    v_mfma_f32_16x16x32_bf16 a[112:115], v[40:43], v[200:203], a[112:115]
    v_mfma_f32_16x16x32_bf16 a[152:155], v[44:47], v[200:203], a[152:155]
    s_mov_b32 s29, 71680
    buffer_load_dwordx4 v[164:167], v4, s[16:19], s29 offen offset:1024
    v_mfma_f32_16x16x32_bf16 a[36:39], v[32:35], v[204:207], a[36:39]
    v_mfma_f32_16x16x32_bf16 a[76:79], v[36:39], v[204:207], a[76:79]
    v_mfma_f32_16x16x32_bf16 a[116:119], v[40:43], v[204:207], a[116:119]
    v_mfma_f32_16x16x32_bf16 a[156:159], v[44:47], v[204:207], a[156:159]
    s_waitcnt vmcnt(38)
    s_waitcnt lgkmcnt(0)
    v_mfma_f32_16x16x32_bf16 a[0:3], v[16:19], v[208:211], a[0:3]
    v_mfma_f32_16x16x32_bf16 a[40:43], v[20:23], v[208:211], a[40:43]
    s_add_u32 m0, s25, 0
    s_mov_b32 s30, 32768
    buffer_load_dwordx4 v12, s[12:15], s30 offen offset:0 lds
    v_mfma_f32_16x16x32_bf16 a[80:83], v[24:27], v[208:211], a[80:83]
    ds_read_b64_tr_b16 v[32:33], v14 offset:4096
    v_mfma_f32_16x16x32_bf16 a[120:123], v[28:31], v[208:211], a[120:123]
    buffer_load_dwordx4 v12, s[12:15], s30 offen offset:1024 lds
    v_mfma_f32_16x16x32_bf16 a[4:7], v[16:19], v[212:215], a[4:7]
    ds_read_b64_tr_b16 v[34:35], v14 offset:4608
    v_mfma_f32_16x16x32_bf16 a[44:47], v[20:23], v[212:215], a[44:47]
    v_mfma_f32_16x16x32_bf16 a[84:87], v[24:27], v[212:215], a[84:87]
    buffer_load_dwordx4 v12, s[12:15], s30 offen offset:2048 lds
    ds_read_b64_tr_b16 v[36:37], v14 offset:4104
    v_mfma_f32_16x16x32_bf16 a[124:127], v[28:31], v[212:215], a[124:127]
    v_mfma_f32_16x16x32_bf16 a[8:11], v[16:19], v[216:219], a[8:11]
    buffer_load_dwordx4 v12, s[12:15], s30 offen offset:3072 lds
    ds_read_b64_tr_b16 v[38:39], v14 offset:4616
    v_mfma_f32_16x16x32_bf16 a[48:51], v[20:23], v[216:219], a[48:51]
    v_mfma_f32_16x16x32_bf16 a[88:91], v[24:27], v[216:219], a[88:91]
    ds_read_b64_tr_b16 v[40:41], v15 offset:4096
    v_mfma_f32_16x16x32_bf16 a[128:131], v[28:31], v[216:219], a[128:131]
    s_mov_b32 s29, 81920
    buffer_load_dwordx4 v[168:171], v2, s[16:19], s29 offen offset:0
    v_mfma_f32_16x16x32_bf16 a[12:15], v[16:19], v[220:223], a[12:15]
    ds_read_b64_tr_b16 v[42:43], v15 offset:4608
    v_mfma_f32_16x16x32_bf16 a[52:55], v[20:23], v[220:223], a[52:55]
    v_mfma_f32_16x16x32_bf16 a[92:95], v[24:27], v[220:223], a[92:95]
    s_mov_b32 s29, 81920
    buffer_load_dwordx4 v[172:175], v2, s[16:19], s29 offen offset:1024
    ds_read_b64_tr_b16 v[44:45], v15 offset:4104
    v_mfma_f32_16x16x32_bf16 a[132:135], v[28:31], v[220:223], a[132:135]
    v_mfma_f32_16x16x32_bf16 a[16:19], v[16:19], v[224:227], a[16:19]
    s_mov_b32 s29, 81920
    buffer_load_dwordx4 v[176:179], v2, s[16:19], s29 offen offset:2048
    ds_read_b64_tr_b16 v[46:47], v15 offset:4616
    v_mfma_f32_16x16x32_bf16 a[56:59], v[20:23], v[224:227], a[56:59]
    v_mfma_f32_16x16x32_bf16 a[96:99], v[24:27], v[224:227], a[96:99]
    v_mfma_f32_16x16x32_bf16 a[136:139], v[28:31], v[224:227], a[136:139]
    s_mov_b32 s29, 81920
    buffer_load_dwordx4 v[180:183], v2, s[16:19], s29 offen offset:3072
    v_mfma_f32_16x16x32_bf16 a[20:23], v[16:19], v[228:231], a[20:23]
    v_mfma_f32_16x16x32_bf16 a[60:63], v[20:23], v[228:231], a[60:63]
    v_mfma_f32_16x16x32_bf16 a[100:103], v[24:27], v[228:231], a[100:103]
    s_mov_b32 s29, 81920
    buffer_load_dwordx4 v[184:187], v3, s[16:19], s29 offen offset:0
    v_mfma_f32_16x16x32_bf16 a[140:143], v[28:31], v[228:231], a[140:143]
    v_mfma_f32_16x16x32_bf16 a[24:27], v[16:19], v[232:235], a[24:27]
    s_mov_b32 s29, 81920
    buffer_load_dwordx4 v[188:191], v3, s[16:19], s29 offen offset:1024
    v_mfma_f32_16x16x32_bf16 a[64:67], v[20:23], v[232:235], a[64:67]
    v_mfma_f32_16x16x32_bf16 a[104:107], v[24:27], v[232:235], a[104:107]
    v_mfma_f32_16x16x32_bf16 a[144:147], v[28:31], v[232:235], a[144:147]
    s_mov_b32 s29, 81920
    buffer_load_dwordx4 v[192:195], v3, s[16:19], s29 offen offset:2048
    v_mfma_f32_16x16x32_bf16 a[28:31], v[16:19], v[236:239], a[28:31]
    v_mfma_f32_16x16x32_bf16 a[68:71], v[20:23], v[236:239], a[68:71]
    v_mfma_f32_16x16x32_bf16 a[108:111], v[24:27], v[236:239], a[108:111]
    s_mov_b32 s29, 81920
    buffer_load_dwordx4 v[196:199], v3, s[16:19], s29 offen offset:3072
    v_mfma_f32_16x16x32_bf16 a[148:151], v[28:31], v[236:239], a[148:151]
    v_mfma_f32_16x16x32_bf16 a[32:35], v[16:19], v[240:243], a[32:35]
    s_mov_b32 s29, 81920
    buffer_load_dwordx4 v[200:203], v4, s[16:19], s29 offen offset:0
    v_mfma_f32_16x16x32_bf16 a[72:75], v[20:23], v[240:243], a[72:75]
    v_mfma_f32_16x16x32_bf16 a[112:115], v[24:27], v[240:243], a[112:115]
    v_mfma_f32_16x16x32_bf16 a[152:155], v[28:31], v[240:243], a[152:155]
    s_mov_b32 s29, 81920
    buffer_load_dwordx4 v[204:207], v4, s[16:19], s29 offen offset:1024
    v_mfma_f32_16x16x32_bf16 a[36:39], v[16:19], v[244:247], a[36:39]
    v_mfma_f32_16x16x32_bf16 a[76:79], v[20:23], v[244:247], a[76:79]
    v_mfma_f32_16x16x32_bf16 a[116:119], v[24:27], v[244:247], a[116:119]
    v_mfma_f32_16x16x32_bf16 a[156:159], v[28:31], v[244:247], a[156:159]
    s_waitcnt vmcnt(38)
    s_waitcnt lgkmcnt(0)
    v_mfma_f32_16x16x32_bf16 a[0:3], v[32:35], v[48:51], a[0:3]
    v_mfma_f32_16x16x32_bf16 a[40:43], v[36:39], v[48:51], a[40:43]
    s_add_u32 m0, s25, 4096
    s_mov_b32 s30, 36864
    buffer_load_dwordx4 v12, s[12:15], s30 offen offset:0 lds
    v_mfma_f32_16x16x32_bf16 a[80:83], v[40:43], v[48:51], a[80:83]
    ds_read_b64_tr_b16 v[16:17], v14 offset:8192
    v_mfma_f32_16x16x32_bf16 a[120:123], v[44:47], v[48:51], a[120:123]
    buffer_load_dwordx4 v12, s[12:15], s30 offen offset:1024 lds
    v_mfma_f32_16x16x32_bf16 a[4:7], v[32:35], v[52:55], a[4:7]
    ds_read_b64_tr_b16 v[18:19], v14 offset:8704
    v_mfma_f32_16x16x32_bf16 a[44:47], v[36:39], v[52:55], a[44:47]
    v_mfma_f32_16x16x32_bf16 a[84:87], v[40:43], v[52:55], a[84:87]
    buffer_load_dwordx4 v12, s[12:15], s30 offen offset:2048 lds
    ds_read_b64_tr_b16 v[20:21], v14 offset:8200
    v_mfma_f32_16x16x32_bf16 a[124:127], v[44:47], v[52:55], a[124:127]
    v_mfma_f32_16x16x32_bf16 a[8:11], v[32:35], v[56:59], a[8:11]
    buffer_load_dwordx4 v12, s[12:15], s30 offen offset:3072 lds
    ds_read_b64_tr_b16 v[22:23], v14 offset:8712
    v_mfma_f32_16x16x32_bf16 a[48:51], v[36:39], v[56:59], a[48:51]
    v_mfma_f32_16x16x32_bf16 a[88:91], v[40:43], v[56:59], a[88:91]
    ds_read_b64_tr_b16 v[24:25], v15 offset:8192
    v_mfma_f32_16x16x32_bf16 a[128:131], v[44:47], v[56:59], a[128:131]
    s_mov_b32 s29, 92160
    buffer_load_dwordx4 v[208:211], v2, s[16:19], s29 offen offset:0
    v_mfma_f32_16x16x32_bf16 a[12:15], v[32:35], v[60:63], a[12:15]
    ds_read_b64_tr_b16 v[26:27], v15 offset:8704
    v_mfma_f32_16x16x32_bf16 a[52:55], v[36:39], v[60:63], a[52:55]
    v_mfma_f32_16x16x32_bf16 a[92:95], v[40:43], v[60:63], a[92:95]
    s_mov_b32 s29, 92160
    buffer_load_dwordx4 v[212:215], v2, s[16:19], s29 offen offset:1024
    ds_read_b64_tr_b16 v[28:29], v15 offset:8200
    v_mfma_f32_16x16x32_bf16 a[132:135], v[44:47], v[60:63], a[132:135]
    v_mfma_f32_16x16x32_bf16 a[16:19], v[32:35], v[64:67], a[16:19]
    s_mov_b32 s29, 92160
    buffer_load_dwordx4 v[216:219], v2, s[16:19], s29 offen offset:2048
    ds_read_b64_tr_b16 v[30:31], v15 offset:8712
    v_mfma_f32_16x16x32_bf16 a[56:59], v[36:39], v[64:67], a[56:59]
    v_mfma_f32_16x16x32_bf16 a[96:99], v[40:43], v[64:67], a[96:99]
    v_mfma_f32_16x16x32_bf16 a[136:139], v[44:47], v[64:67], a[136:139]
    s_mov_b32 s29, 92160
    buffer_load_dwordx4 v[220:223], v2, s[16:19], s29 offen offset:3072
    v_mfma_f32_16x16x32_bf16 a[20:23], v[32:35], v[68:71], a[20:23]
    v_mfma_f32_16x16x32_bf16 a[60:63], v[36:39], v[68:71], a[60:63]
    v_mfma_f32_16x16x32_bf16 a[100:103], v[40:43], v[68:71], a[100:103]
    s_mov_b32 s29, 92160
    buffer_load_dwordx4 v[224:227], v3, s[16:19], s29 offen offset:0
    v_mfma_f32_16x16x32_bf16 a[140:143], v[44:47], v[68:71], a[140:143]
    v_mfma_f32_16x16x32_bf16 a[24:27], v[32:35], v[72:75], a[24:27]
    s_mov_b32 s29, 92160
    buffer_load_dwordx4 v[228:231], v3, s[16:19], s29 offen offset:1024
    v_mfma_f32_16x16x32_bf16 a[64:67], v[36:39], v[72:75], a[64:67]
    v_mfma_f32_16x16x32_bf16 a[104:107], v[40:43], v[72:75], a[104:107]
    v_mfma_f32_16x16x32_bf16 a[144:147], v[44:47], v[72:75], a[144:147]
    s_mov_b32 s29, 92160
    buffer_load_dwordx4 v[232:235], v3, s[16:19], s29 offen offset:2048
    v_mfma_f32_16x16x32_bf16 a[28:31], v[32:35], v[76:79], a[28:31]
    v_mfma_f32_16x16x32_bf16 a[68:71], v[36:39], v[76:79], a[68:71]
    v_mfma_f32_16x16x32_bf16 a[108:111], v[40:43], v[76:79], a[108:111]
    s_mov_b32 s29, 92160
    buffer_load_dwordx4 v[236:239], v3, s[16:19], s29 offen offset:3072
    v_mfma_f32_16x16x32_bf16 a[148:151], v[44:47], v[76:79], a[148:151]
    v_mfma_f32_16x16x32_bf16 a[32:35], v[32:35], v[80:83], a[32:35]
    s_mov_b32 s29, 92160
    buffer_load_dwordx4 v[240:243], v4, s[16:19], s29 offen offset:0
    v_mfma_f32_16x16x32_bf16 a[72:75], v[36:39], v[80:83], a[72:75]
    v_mfma_f32_16x16x32_bf16 a[112:115], v[40:43], v[80:83], a[112:115]
    v_mfma_f32_16x16x32_bf16 a[152:155], v[44:47], v[80:83], a[152:155]
    s_mov_b32 s29, 92160
    buffer_load_dwordx4 v[244:247], v4, s[16:19], s29 offen offset:1024
    v_mfma_f32_16x16x32_bf16 a[36:39], v[32:35], v[84:87], a[36:39]
    v_mfma_f32_16x16x32_bf16 a[76:79], v[36:39], v[84:87], a[76:79]
    v_mfma_f32_16x16x32_bf16 a[116:119], v[40:43], v[84:87], a[116:119]
    v_mfma_f32_16x16x32_bf16 a[156:159], v[44:47], v[84:87], a[156:159]
    s_waitcnt vmcnt(38)
    s_waitcnt lgkmcnt(0)
    v_mfma_f32_16x16x32_bf16 a[0:3], v[16:19], v[88:91], a[0:3]
    v_mfma_f32_16x16x32_bf16 a[40:43], v[20:23], v[88:91], a[40:43]
    s_add_u32 m0, s25, 8192
    s_mov_b32 s30, 40960
    buffer_load_dwordx4 v12, s[12:15], s30 offen offset:0 lds
    v_mfma_f32_16x16x32_bf16 a[80:83], v[24:27], v[88:91], a[80:83]
    ds_read_b64_tr_b16 v[32:33], v14 offset:12288
    v_mfma_f32_16x16x32_bf16 a[120:123], v[28:31], v[88:91], a[120:123]
    buffer_load_dwordx4 v12, s[12:15], s30 offen offset:1024 lds
    v_mfma_f32_16x16x32_bf16 a[4:7], v[16:19], v[92:95], a[4:7]
    ds_read_b64_tr_b16 v[34:35], v14 offset:12800
    v_mfma_f32_16x16x32_bf16 a[44:47], v[20:23], v[92:95], a[44:47]
    v_mfma_f32_16x16x32_bf16 a[84:87], v[24:27], v[92:95], a[84:87]
    buffer_load_dwordx4 v12, s[12:15], s30 offen offset:2048 lds
    ds_read_b64_tr_b16 v[36:37], v14 offset:12296
    v_mfma_f32_16x16x32_bf16 a[124:127], v[28:31], v[92:95], a[124:127]
    v_mfma_f32_16x16x32_bf16 a[8:11], v[16:19], v[96:99], a[8:11]
    buffer_load_dwordx4 v12, s[12:15], s30 offen offset:3072 lds
    ds_read_b64_tr_b16 v[38:39], v14 offset:12808
    v_mfma_f32_16x16x32_bf16 a[48:51], v[20:23], v[96:99], a[48:51]
    v_mfma_f32_16x16x32_bf16 a[88:91], v[24:27], v[96:99], a[88:91]
    ds_read_b64_tr_b16 v[40:41], v15 offset:12288
    v_mfma_f32_16x16x32_bf16 a[128:131], v[28:31], v[96:99], a[128:131]
    s_mov_b32 s29, 102400
    buffer_load_dwordx4 v[48:51], v2, s[16:19], s29 offen offset:0
    v_mfma_f32_16x16x32_bf16 a[12:15], v[16:19], v[100:103], a[12:15]
    ds_read_b64_tr_b16 v[42:43], v15 offset:12800
    v_mfma_f32_16x16x32_bf16 a[52:55], v[20:23], v[100:103], a[52:55]
    v_mfma_f32_16x16x32_bf16 a[92:95], v[24:27], v[100:103], a[92:95]
    s_mov_b32 s29, 102400
    buffer_load_dwordx4 v[52:55], v2, s[16:19], s29 offen offset:1024
    ds_read_b64_tr_b16 v[44:45], v15 offset:12296
    v_mfma_f32_16x16x32_bf16 a[132:135], v[28:31], v[100:103], a[132:135]
    v_mfma_f32_16x16x32_bf16 a[16:19], v[16:19], v[104:107], a[16:19]
    s_mov_b32 s29, 102400
    buffer_load_dwordx4 v[56:59], v2, s[16:19], s29 offen offset:2048
    ds_read_b64_tr_b16 v[46:47], v15 offset:12808
    v_mfma_f32_16x16x32_bf16 a[56:59], v[20:23], v[104:107], a[56:59]
    v_mfma_f32_16x16x32_bf16 a[96:99], v[24:27], v[104:107], a[96:99]
    v_mfma_f32_16x16x32_bf16 a[136:139], v[28:31], v[104:107], a[136:139]
    s_mov_b32 s29, 102400
    buffer_load_dwordx4 v[60:63], v2, s[16:19], s29 offen offset:3072
    v_mfma_f32_16x16x32_bf16 a[20:23], v[16:19], v[108:111], a[20:23]
    v_mfma_f32_16x16x32_bf16 a[60:63], v[20:23], v[108:111], a[60:63]
    v_mfma_f32_16x16x32_bf16 a[100:103], v[24:27], v[108:111], a[100:103]
    s_mov_b32 s29, 102400
    buffer_load_dwordx4 v[64:67], v3, s[16:19], s29 offen offset:0
    v_mfma_f32_16x16x32_bf16 a[140:143], v[28:31], v[108:111], a[140:143]
    v_mfma_f32_16x16x32_bf16 a[24:27], v[16:19], v[112:115], a[24:27]
    s_mov_b32 s29, 102400
    buffer_load_dwordx4 v[68:71], v3, s[16:19], s29 offen offset:1024
    v_mfma_f32_16x16x32_bf16 a[64:67], v[20:23], v[112:115], a[64:67]
    v_mfma_f32_16x16x32_bf16 a[104:107], v[24:27], v[112:115], a[104:107]
    v_mfma_f32_16x16x32_bf16 a[144:147], v[28:31], v[112:115], a[144:147]
    s_mov_b32 s29, 102400
    buffer_load_dwordx4 v[72:75], v3, s[16:19], s29 offen offset:2048
    v_mfma_f32_16x16x32_bf16 a[28:31], v[16:19], v[116:119], a[28:31]
    v_mfma_f32_16x16x32_bf16 a[68:71], v[20:23], v[116:119], a[68:71]
    v_mfma_f32_16x16x32_bf16 a[108:111], v[24:27], v[116:119], a[108:111]
    s_mov_b32 s29, 102400
    buffer_load_dwordx4 v[76:79], v3, s[16:19], s29 offen offset:3072
    v_mfma_f32_16x16x32_bf16 a[148:151], v[28:31], v[116:119], a[148:151]
    v_mfma_f32_16x16x32_bf16 a[32:35], v[16:19], v[120:123], a[32:35]
    s_mov_b32 s29, 102400
    buffer_load_dwordx4 v[80:83], v4, s[16:19], s29 offen offset:0
    v_mfma_f32_16x16x32_bf16 a[72:75], v[20:23], v[120:123], a[72:75]
    v_mfma_f32_16x16x32_bf16 a[112:115], v[24:27], v[120:123], a[112:115]
    v_mfma_f32_16x16x32_bf16 a[152:155], v[28:31], v[120:123], a[152:155]
    s_mov_b32 s29, 102400
    buffer_load_dwordx4 v[84:87], v4, s[16:19], s29 offen offset:1024
    v_mfma_f32_16x16x32_bf16 a[36:39], v[16:19], v[124:127], a[36:39]
    v_mfma_f32_16x16x32_bf16 a[76:79], v[20:23], v[124:127], a[76:79]
    v_mfma_f32_16x16x32_bf16 a[116:119], v[24:27], v[124:127], a[116:119]
    v_mfma_f32_16x16x32_bf16 a[156:159], v[28:31], v[124:127], a[156:159]
    s_waitcnt vmcnt(38)
    s_waitcnt lgkmcnt(0)
    v_mfma_f32_16x16x32_bf16 a[0:3], v[32:35], v[128:131], a[0:3]
    v_mfma_f32_16x16x32_bf16 a[40:43], v[36:39], v[128:131], a[40:43]
    s_add_u32 m0, s25, 12288
    s_mov_b32 s30, 45056
    buffer_load_dwordx4 v12, s[12:15], s30 offen offset:0 lds
    v_mfma_f32_16x16x32_bf16 a[80:83], v[40:43], v[128:131], a[80:83]
    ds_read_b64_tr_b16 v[16:17], v14 offset:0
    v_mfma_f32_16x16x32_bf16 a[120:123], v[44:47], v[128:131], a[120:123]
    buffer_load_dwordx4 v12, s[12:15], s30 offen offset:1024 lds
    v_mfma_f32_16x16x32_bf16 a[4:7], v[32:35], v[132:135], a[4:7]
    ds_read_b64_tr_b16 v[18:19], v14 offset:512
    v_mfma_f32_16x16x32_bf16 a[44:47], v[36:39], v[132:135], a[44:47]
    v_mfma_f32_16x16x32_bf16 a[84:87], v[40:43], v[132:135], a[84:87]
    buffer_load_dwordx4 v12, s[12:15], s30 offen offset:2048 lds
    ds_read_b64_tr_b16 v[20:21], v14 offset:8
    v_mfma_f32_16x16x32_bf16 a[124:127], v[44:47], v[132:135], a[124:127]
    v_mfma_f32_16x16x32_bf16 a[8:11], v[32:35], v[136:139], a[8:11]
    buffer_load_dwordx4 v12, s[12:15], s30 offen offset:3072 lds
    ds_read_b64_tr_b16 v[22:23], v14 offset:520
    v_mfma_f32_16x16x32_bf16 a[48:51], v[36:39], v[136:139], a[48:51]
    v_mfma_f32_16x16x32_bf16 a[88:91], v[40:43], v[136:139], a[88:91]
    ds_read_b64_tr_b16 v[24:25], v15 offset:0
    v_mfma_f32_16x16x32_bf16 a[128:131], v[44:47], v[136:139], a[128:131]
    s_mov_b32 s29, 112640
    buffer_load_dwordx4 v[88:91], v2, s[16:19], s29 offen offset:0
    v_mfma_f32_16x16x32_bf16 a[12:15], v[32:35], v[140:143], a[12:15]
    ds_read_b64_tr_b16 v[26:27], v15 offset:512
    v_mfma_f32_16x16x32_bf16 a[52:55], v[36:39], v[140:143], a[52:55]
    v_mfma_f32_16x16x32_bf16 a[92:95], v[40:43], v[140:143], a[92:95]
    s_mov_b32 s29, 112640
    buffer_load_dwordx4 v[92:95], v2, s[16:19], s29 offen offset:1024
    ds_read_b64_tr_b16 v[28:29], v15 offset:8
    v_mfma_f32_16x16x32_bf16 a[132:135], v[44:47], v[140:143], a[132:135]
    v_mfma_f32_16x16x32_bf16 a[16:19], v[32:35], v[144:147], a[16:19]
    s_mov_b32 s29, 112640
    buffer_load_dwordx4 v[96:99], v2, s[16:19], s29 offen offset:2048
    ds_read_b64_tr_b16 v[30:31], v15 offset:520
    v_mfma_f32_16x16x32_bf16 a[56:59], v[36:39], v[144:147], a[56:59]
    v_mfma_f32_16x16x32_bf16 a[96:99], v[40:43], v[144:147], a[96:99]
    v_mfma_f32_16x16x32_bf16 a[136:139], v[44:47], v[144:147], a[136:139]
    s_mov_b32 s29, 112640
    buffer_load_dwordx4 v[100:103], v2, s[16:19], s29 offen offset:3072
    v_mfma_f32_16x16x32_bf16 a[20:23], v[32:35], v[148:151], a[20:23]
    v_mfma_f32_16x16x32_bf16 a[60:63], v[36:39], v[148:151], a[60:63]
    v_mfma_f32_16x16x32_bf16 a[100:103], v[40:43], v[148:151], a[100:103]
    s_mov_b32 s29, 112640
    buffer_load_dwordx4 v[104:107], v3, s[16:19], s29 offen offset:0
    v_mfma_f32_16x16x32_bf16 a[140:143], v[44:47], v[148:151], a[140:143]
    v_mfma_f32_16x16x32_bf16 a[24:27], v[32:35], v[152:155], a[24:27]
    s_mov_b32 s29, 112640
    buffer_load_dwordx4 v[108:111], v3, s[16:19], s29 offen offset:1024
    v_mfma_f32_16x16x32_bf16 a[64:67], v[36:39], v[152:155], a[64:67]
    v_mfma_f32_16x16x32_bf16 a[104:107], v[40:43], v[152:155], a[104:107]
    v_mfma_f32_16x16x32_bf16 a[144:147], v[44:47], v[152:155], a[144:147]
    s_mov_b32 s29, 112640
    buffer_load_dwordx4 v[112:115], v3, s[16:19], s29 offen offset:2048
    v_mfma_f32_16x16x32_bf16 a[28:31], v[32:35], v[156:159], a[28:31]
    v_mfma_f32_16x16x32_bf16 a[68:71], v[36:39], v[156:159], a[68:71]
    v_mfma_f32_16x16x32_bf16 a[108:111], v[40:43], v[156:159], a[108:111]
    s_mov_b32 s29, 112640
    buffer_load_dwordx4 v[116:119], v3, s[16:19], s29 offen offset:3072
    v_mfma_f32_16x16x32_bf16 a[148:151], v[44:47], v[156:159], a[148:151]
    v_mfma_f32_16x16x32_bf16 a[32:35], v[32:35], v[160:163], a[32:35]
    s_mov_b32 s29, 112640
    buffer_load_dwordx4 v[120:123], v4, s[16:19], s29 offen offset:0
    v_mfma_f32_16x16x32_bf16 a[72:75], v[36:39], v[160:163], a[72:75]
    v_mfma_f32_16x16x32_bf16 a[112:115], v[40:43], v[160:163], a[112:115]
    v_mfma_f32_16x16x32_bf16 a[152:155], v[44:47], v[160:163], a[152:155]
    s_mov_b32 s29, 112640
    buffer_load_dwordx4 v[124:127], v4, s[16:19], s29 offen offset:1024
    v_mfma_f32_16x16x32_bf16 a[36:39], v[32:35], v[164:167], a[36:39]
    v_mfma_f32_16x16x32_bf16 a[76:79], v[36:39], v[164:167], a[76:79]
    v_mfma_f32_16x16x32_bf16 a[116:119], v[40:43], v[164:167], a[116:119]
    v_mfma_f32_16x16x32_bf16 a[156:159], v[44:47], v[164:167], a[156:159]
    s_waitcnt vmcnt(38)
    s_waitcnt lgkmcnt(0)
    v_mfma_f32_16x16x32_bf16 a[0:3], v[16:19], v[168:171], a[0:3]
    v_mfma_f32_16x16x32_bf16 a[40:43], v[20:23], v[168:171], a[40:43]
    s_add_u32 m0, s25, 0
    s_mov_b32 s30, 49152
    buffer_load_dwordx4 v12, s[12:15], s30 offen offset:0 lds
    v_mfma_f32_16x16x32_bf16 a[80:83], v[24:27], v[168:171], a[80:83]
    ds_read_b64_tr_b16 v[32:33], v14 offset:4096
    v_mfma_f32_16x16x32_bf16 a[120:123], v[28:31], v[168:171], a[120:123]
    buffer_load_dwordx4 v12, s[12:15], s30 offen offset:1024 lds
    v_mfma_f32_16x16x32_bf16 a[4:7], v[16:19], v[172:175], a[4:7]
    ds_read_b64_tr_b16 v[34:35], v14 offset:4608
    v_mfma_f32_16x16x32_bf16 a[44:47], v[20:23], v[172:175], a[44:47]
    v_mfma_f32_16x16x32_bf16 a[84:87], v[24:27], v[172:175], a[84:87]
    buffer_load_dwordx4 v12, s[12:15], s30 offen offset:2048 lds
    ds_read_b64_tr_b16 v[36:37], v14 offset:4104
    v_mfma_f32_16x16x32_bf16 a[124:127], v[28:31], v[172:175], a[124:127]
    v_mfma_f32_16x16x32_bf16 a[8:11], v[16:19], v[176:179], a[8:11]
    buffer_load_dwordx4 v12, s[12:15], s30 offen offset:3072 lds
    ds_read_b64_tr_b16 v[38:39], v14 offset:4616
    v_mfma_f32_16x16x32_bf16 a[48:51], v[20:23], v[176:179], a[48:51]
    v_mfma_f32_16x16x32_bf16 a[88:91], v[24:27], v[176:179], a[88:91]
    ds_read_b64_tr_b16 v[40:41], v15 offset:4096
    v_mfma_f32_16x16x32_bf16 a[128:131], v[28:31], v[176:179], a[128:131]
    s_mov_b32 s29, 122880
    buffer_load_dwordx4 v[128:131], v2, s[16:19], s29 offen offset:0
    v_mfma_f32_16x16x32_bf16 a[12:15], v[16:19], v[180:183], a[12:15]
    ds_read_b64_tr_b16 v[42:43], v15 offset:4608
    v_mfma_f32_16x16x32_bf16 a[52:55], v[20:23], v[180:183], a[52:55]
    v_mfma_f32_16x16x32_bf16 a[92:95], v[24:27], v[180:183], a[92:95]
    s_mov_b32 s29, 122880
    buffer_load_dwordx4 v[132:135], v2, s[16:19], s29 offen offset:1024
    ds_read_b64_tr_b16 v[44:45], v15 offset:4104
    v_mfma_f32_16x16x32_bf16 a[132:135], v[28:31], v[180:183], a[132:135]
    v_mfma_f32_16x16x32_bf16 a[16:19], v[16:19], v[184:187], a[16:19]
    s_mov_b32 s29, 122880
    buffer_load_dwordx4 v[136:139], v2, s[16:19], s29 offen offset:2048
    ds_read_b64_tr_b16 v[46:47], v15 offset:4616
    v_mfma_f32_16x16x32_bf16 a[56:59], v[20:23], v[184:187], a[56:59]
    v_mfma_f32_16x16x32_bf16 a[96:99], v[24:27], v[184:187], a[96:99]
    v_mfma_f32_16x16x32_bf16 a[136:139], v[28:31], v[184:187], a[136:139]
    s_mov_b32 s29, 122880
    buffer_load_dwordx4 v[140:143], v2, s[16:19], s29 offen offset:3072
    v_mfma_f32_16x16x32_bf16 a[20:23], v[16:19], v[188:191], a[20:23]
    v_mfma_f32_16x16x32_bf16 a[60:63], v[20:23], v[188:191], a[60:63]
    v_mfma_f32_16x16x32_bf16 a[100:103], v[24:27], v[188:191], a[100:103]
    s_mov_b32 s29, 122880
    buffer_load_dwordx4 v[144:147], v3, s[16:19], s29 offen offset:0
    v_mfma_f32_16x16x32_bf16 a[140:143], v[28:31], v[188:191], a[140:143]
    v_mfma_f32_16x16x32_bf16 a[24:27], v[16:19], v[192:195], a[24:27]
    s_mov_b32 s29, 122880
    buffer_load_dwordx4 v[148:151], v3, s[16:19], s29 offen offset:1024
    v_mfma_f32_16x16x32_bf16 a[64:67], v[20:23], v[192:195], a[64:67]
    v_mfma_f32_16x16x32_bf16 a[104:107], v[24:27], v[192:195], a[104:107]
    v_mfma_f32_16x16x32_bf16 a[144:147], v[28:31], v[192:195], a[144:147]
    s_mov_b32 s29, 122880
    buffer_load_dwordx4 v[152:155], v3, s[16:19], s29 offen offset:2048
    v_mfma_f32_16x16x32_bf16 a[28:31], v[16:19], v[196:199], a[28:31]
    v_mfma_f32_16x16x32_bf16 a[68:71], v[20:23], v[196:199], a[68:71]
    v_mfma_f32_16x16x32_bf16 a[108:111], v[24:27], v[196:199], a[108:111]
    s_mov_b32 s29, 122880
    buffer_load_dwordx4 v[156:159], v3, s[16:19], s29 offen offset:3072
    v_mfma_f32_16x16x32_bf16 a[148:151], v[28:31], v[196:199], a[148:151]
    v_mfma_f32_16x16x32_bf16 a[32:35], v[16:19], v[200:203], a[32:35]
    s_mov_b32 s29, 122880
    buffer_load_dwordx4 v[160:163], v4, s[16:19], s29 offen offset:0
    v_mfma_f32_16x16x32_bf16 a[72:75], v[20:23], v[200:203], a[72:75]
    v_mfma_f32_16x16x32_bf16 a[112:115], v[24:27], v[200:203], a[112:115]
    v_mfma_f32_16x16x32_bf16 a[152:155], v[28:31], v[200:203], a[152:155]
    s_mov_b32 s29, 122880
    buffer_load_dwordx4 v[164:167], v4, s[16:19], s29 offen offset:1024
    v_mfma_f32_16x16x32_bf16 a[36:39], v[16:19], v[204:207], a[36:39]
    v_mfma_f32_16x16x32_bf16 a[76:79], v[20:23], v[204:207], a[76:79]
    v_mfma_f32_16x16x32_bf16 a[116:119], v[24:27], v[204:207], a[116:119]
    v_mfma_f32_16x16x32_bf16 a[156:159], v[28:31], v[204:207], a[156:159]
    s_waitcnt vmcnt(38)
    s_waitcnt lgkmcnt(0)
    v_mfma_f32_16x16x32_bf16 a[0:3], v[32:35], v[208:211], a[0:3]
    v_mfma_f32_16x16x32_bf16 a[40:43], v[36:39], v[208:211], a[40:43]
    s_add_u32 m0, s25, 4096
    s_mov_b32 s30, 53248
    buffer_load_dwordx4 v12, s[12:15], s30 offen offset:0 lds
    v_mfma_f32_16x16x32_bf16 a[80:83], v[40:43], v[208:211], a[80:83]
    ds_read_b64_tr_b16 v[16:17], v14 offset:8192
    v_mfma_f32_16x16x32_bf16 a[120:123], v[44:47], v[208:211], a[120:123]
    buffer_load_dwordx4 v12, s[12:15], s30 offen offset:1024 lds
    v_mfma_f32_16x16x32_bf16 a[4:7], v[32:35], v[212:215], a[4:7]
    ds_read_b64_tr_b16 v[18:19], v14 offset:8704
    v_mfma_f32_16x16x32_bf16 a[44:47], v[36:39], v[212:215], a[44:47]
    v_mfma_f32_16x16x32_bf16 a[84:87], v[40:43], v[212:215], a[84:87]
    buffer_load_dwordx4 v12, s[12:15], s30 offen offset:2048 lds
    ds_read_b64_tr_b16 v[20:21], v14 offset:8200
    v_mfma_f32_16x16x32_bf16 a[124:127], v[44:47], v[212:215], a[124:127]
    v_mfma_f32_16x16x32_bf16 a[8:11], v[32:35], v[216:219], a[8:11]
    buffer_load_dwordx4 v12, s[12:15], s30 offen offset:3072 lds
    ds_read_b64_tr_b16 v[22:23], v14 offset:8712
    v_mfma_f32_16x16x32_bf16 a[48:51], v[36:39], v[216:219], a[48:51]
    v_mfma_f32_16x16x32_bf16 a[88:91], v[40:43], v[216:219], a[88:91]
    ds_read_b64_tr_b16 v[24:25], v15 offset:8192
    v_mfma_f32_16x16x32_bf16 a[128:131], v[44:47], v[216:219], a[128:131]
    s_mov_b32 s29, 133120
    buffer_load_dwordx4 v[168:171], v2, s[16:19], s29 offen offset:0
    v_mfma_f32_16x16x32_bf16 a[12:15], v[32:35], v[220:223], a[12:15]
    ds_read_b64_tr_b16 v[26:27], v15 offset:8704
    v_mfma_f32_16x16x32_bf16 a[52:55], v[36:39], v[220:223], a[52:55]
    v_mfma_f32_16x16x32_bf16 a[92:95], v[40:43], v[220:223], a[92:95]
    s_mov_b32 s29, 133120
    buffer_load_dwordx4 v[172:175], v2, s[16:19], s29 offen offset:1024
    ds_read_b64_tr_b16 v[28:29], v15 offset:8200
    v_mfma_f32_16x16x32_bf16 a[132:135], v[44:47], v[220:223], a[132:135]
    v_mfma_f32_16x16x32_bf16 a[16:19], v[32:35], v[224:227], a[16:19]
    s_mov_b32 s29, 133120
    buffer_load_dwordx4 v[176:179], v2, s[16:19], s29 offen offset:2048
    ds_read_b64_tr_b16 v[30:31], v15 offset:8712
    v_mfma_f32_16x16x32_bf16 a[56:59], v[36:39], v[224:227], a[56:59]
    v_mfma_f32_16x16x32_bf16 a[96:99], v[40:43], v[224:227], a[96:99]
    v_mfma_f32_16x16x32_bf16 a[136:139], v[44:47], v[224:227], a[136:139]
    s_mov_b32 s29, 133120
    buffer_load_dwordx4 v[180:183], v2, s[16:19], s29 offen offset:3072
    v_mfma_f32_16x16x32_bf16 a[20:23], v[32:35], v[228:231], a[20:23]
    v_mfma_f32_16x16x32_bf16 a[60:63], v[36:39], v[228:231], a[60:63]
    v_mfma_f32_16x16x32_bf16 a[100:103], v[40:43], v[228:231], a[100:103]
    s_mov_b32 s29, 133120
    buffer_load_dwordx4 v[184:187], v3, s[16:19], s29 offen offset:0
    v_mfma_f32_16x16x32_bf16 a[140:143], v[44:47], v[228:231], a[140:143]
    v_mfma_f32_16x16x32_bf16 a[24:27], v[32:35], v[232:235], a[24:27]
    s_mov_b32 s29, 133120
    buffer_load_dwordx4 v[188:191], v3, s[16:19], s29 offen offset:1024
    v_mfma_f32_16x16x32_bf16 a[64:67], v[36:39], v[232:235], a[64:67]
    v_mfma_f32_16x16x32_bf16 a[104:107], v[40:43], v[232:235], a[104:107]
    v_mfma_f32_16x16x32_bf16 a[144:147], v[44:47], v[232:235], a[144:147]
    s_mov_b32 s29, 133120
    buffer_load_dwordx4 v[192:195], v3, s[16:19], s29 offen offset:2048
    v_mfma_f32_16x16x32_bf16 a[28:31], v[32:35], v[236:239], a[28:31]
    v_mfma_f32_16x16x32_bf16 a[68:71], v[36:39], v[236:239], a[68:71]
    v_mfma_f32_16x16x32_bf16 a[108:111], v[40:43], v[236:239], a[108:111]
    s_mov_b32 s29, 133120
    buffer_load_dwordx4 v[196:199], v3, s[16:19], s29 offen offset:3072
    v_mfma_f32_16x16x32_bf16 a[148:151], v[44:47], v[236:239], a[148:151]
    v_mfma_f32_16x16x32_bf16 a[32:35], v[32:35], v[240:243], a[32:35]
    s_mov_b32 s29, 133120
    buffer_load_dwordx4 v[200:203], v4, s[16:19], s29 offen offset:0
    v_mfma_f32_16x16x32_bf16 a[72:75], v[36:39], v[240:243], a[72:75]
    v_mfma_f32_16x16x32_bf16 a[112:115], v[40:43], v[240:243], a[112:115]
    v_mfma_f32_16x16x32_bf16 a[152:155], v[44:47], v[240:243], a[152:155]
    s_mov_b32 s29, 133120
    buffer_load_dwordx4 v[204:207], v4, s[16:19], s29 offen offset:1024
    v_mfma_f32_16x16x32_bf16 a[36:39], v[32:35], v[244:247], a[36:39]
    v_mfma_f32_16x16x32_bf16 a[76:79], v[36:39], v[244:247], a[76:79]
    v_mfma_f32_16x16x32_bf16 a[116:119], v[40:43], v[244:247], a[116:119]
    v_mfma_f32_16x16x32_bf16 a[156:159], v[44:47], v[244:247], a[156:159]
    s_waitcnt vmcnt(38)
    s_waitcnt lgkmcnt(0)
    v_mfma_f32_16x16x32_bf16 a[0:3], v[16:19], v[48:51], a[0:3]
    v_mfma_f32_16x16x32_bf16 a[40:43], v[20:23], v[48:51], a[40:43]
    s_add_u32 m0, s25, 8192
    s_mov_b32 s30, 57344
    buffer_load_dwordx4 v12, s[12:15], s30 offen offset:0 lds
    v_mfma_f32_16x16x32_bf16 a[80:83], v[24:27], v[48:51], a[80:83]
    ds_read_b64_tr_b16 v[32:33], v14 offset:12288
    v_mfma_f32_16x16x32_bf16 a[120:123], v[28:31], v[48:51], a[120:123]
    buffer_load_dwordx4 v12, s[12:15], s30 offen offset:1024 lds
    v_mfma_f32_16x16x32_bf16 a[4:7], v[16:19], v[52:55], a[4:7]
    ds_read_b64_tr_b16 v[34:35], v14 offset:12800
    v_mfma_f32_16x16x32_bf16 a[44:47], v[20:23], v[52:55], a[44:47]
    v_mfma_f32_16x16x32_bf16 a[84:87], v[24:27], v[52:55], a[84:87]
    buffer_load_dwordx4 v12, s[12:15], s30 offen offset:2048 lds
    ds_read_b64_tr_b16 v[36:37], v14 offset:12296
    v_mfma_f32_16x16x32_bf16 a[124:127], v[28:31], v[52:55], a[124:127]
    v_mfma_f32_16x16x32_bf16 a[8:11], v[16:19], v[56:59], a[8:11]
    buffer_load_dwordx4 v12, s[12:15], s30 offen offset:3072 lds
    ds_read_b64_tr_b16 v[38:39], v14 offset:12808
    v_mfma_f32_16x16x32_bf16 a[48:51], v[20:23], v[56:59], a[48:51]
    v_mfma_f32_16x16x32_bf16 a[88:91], v[24:27], v[56:59], a[88:91]
    ds_read_b64_tr_b16 v[40:41], v15 offset:12288
    v_mfma_f32_16x16x32_bf16 a[128:131], v[28:31], v[56:59], a[128:131]
    s_mov_b32 s29, 143360
    buffer_load_dwordx4 v[208:211], v2, s[16:19], s29 offen offset:0
    v_mfma_f32_16x16x32_bf16 a[12:15], v[16:19], v[60:63], a[12:15]
    ds_read_b64_tr_b16 v[42:43], v15 offset:12800
    v_mfma_f32_16x16x32_bf16 a[52:55], v[20:23], v[60:63], a[52:55]
    v_mfma_f32_16x16x32_bf16 a[92:95], v[24:27], v[60:63], a[92:95]
    s_mov_b32 s29, 143360
    buffer_load_dwordx4 v[212:215], v2, s[16:19], s29 offen offset:1024
    ds_read_b64_tr_b16 v[44:45], v15 offset:12296
    v_mfma_f32_16x16x32_bf16 a[132:135], v[28:31], v[60:63], a[132:135]
    v_mfma_f32_16x16x32_bf16 a[16:19], v[16:19], v[64:67], a[16:19]
    s_mov_b32 s29, 143360
    buffer_load_dwordx4 v[216:219], v2, s[16:19], s29 offen offset:2048
    ds_read_b64_tr_b16 v[46:47], v15 offset:12808
    v_mfma_f32_16x16x32_bf16 a[56:59], v[20:23], v[64:67], a[56:59]
    v_mfma_f32_16x16x32_bf16 a[96:99], v[24:27], v[64:67], a[96:99]
    v_mfma_f32_16x16x32_bf16 a[136:139], v[28:31], v[64:67], a[136:139]
    s_mov_b32 s29, 143360
    buffer_load_dwordx4 v[220:223], v2, s[16:19], s29 offen offset:3072
    v_mfma_f32_16x16x32_bf16 a[20:23], v[16:19], v[68:71], a[20:23]
    v_mfma_f32_16x16x32_bf16 a[60:63], v[20:23], v[68:71], a[60:63]
    v_mfma_f32_16x16x32_bf16 a[100:103], v[24:27], v[68:71], a[100:103]
    s_mov_b32 s29, 143360
    buffer_load_dwordx4 v[224:227], v3, s[16:19], s29 offen offset:0
    v_mfma_f32_16x16x32_bf16 a[140:143], v[28:31], v[68:71], a[140:143]
    v_mfma_f32_16x16x32_bf16 a[24:27], v[16:19], v[72:75], a[24:27]
    s_mov_b32 s29, 143360
    buffer_load_dwordx4 v[228:231], v3, s[16:19], s29 offen offset:1024
    v_mfma_f32_16x16x32_bf16 a[64:67], v[20:23], v[72:75], a[64:67]
    v_mfma_f32_16x16x32_bf16 a[104:107], v[24:27], v[72:75], a[104:107]
    v_mfma_f32_16x16x32_bf16 a[144:147], v[28:31], v[72:75], a[144:147]
    s_mov_b32 s29, 143360
    buffer_load_dwordx4 v[232:235], v3, s[16:19], s29 offen offset:2048
    v_mfma_f32_16x16x32_bf16 a[28:31], v[16:19], v[76:79], a[28:31]
    v_mfma_f32_16x16x32_bf16 a[68:71], v[20:23], v[76:79], a[68:71]
    v_mfma_f32_16x16x32_bf16 a[108:111], v[24:27], v[76:79], a[108:111]
    s_mov_b32 s29, 143360
    buffer_load_dwordx4 v[236:239], v3, s[16:19], s29 offen offset:3072
    v_mfma_f32_16x16x32_bf16 a[148:151], v[28:31], v[76:79], a[148:151]
    v_mfma_f32_16x16x32_bf16 a[32:35], v[16:19], v[80:83], a[32:35]
    s_mov_b32 s29, 143360
    buffer_load_dwordx4 v[240:243], v4, s[16:19], s29 offen offset:0
    v_mfma_f32_16x16x32_bf16 a[72:75], v[20:23], v[80:83], a[72:75]
    v_mfma_f32_16x16x32_bf16 a[112:115], v[24:27], v[80:83], a[112:115]
    v_mfma_f32_16x16x32_bf16 a[152:155], v[28:31], v[80:83], a[152:155]
    s_mov_b32 s29, 143360
    buffer_load_dwordx4 v[244:247], v4, s[16:19], s29 offen offset:1024
    v_mfma_f32_16x16x32_bf16 a[36:39], v[16:19], v[84:87], a[36:39]
    v_mfma_f32_16x16x32_bf16 a[76:79], v[20:23], v[84:87], a[76:79]
    v_mfma_f32_16x16x32_bf16 a[116:119], v[24:27], v[84:87], a[116:119]
    v_mfma_f32_16x16x32_bf16 a[156:159], v[28:31], v[84:87], a[156:159]
    s_waitcnt vmcnt(38)
    s_waitcnt lgkmcnt(0)
    v_mfma_f32_16x16x32_bf16 a[0:3], v[32:35], v[88:91], a[0:3]
    v_mfma_f32_16x16x32_bf16 a[40:43], v[36:39], v[88:91], a[40:43]
    s_add_u32 m0, s25, 12288
    s_mov_b32 s30, 61440
    buffer_load_dwordx4 v12, s[12:15], s30 offen offset:0 lds
    v_mfma_f32_16x16x32_bf16 a[80:83], v[40:43], v[88:91], a[80:83]
    ds_read_b64_tr_b16 v[16:17], v14 offset:0
    v_mfma_f32_16x16x32_bf16 a[120:123], v[44:47], v[88:91], a[120:123]
    buffer_load_dwordx4 v12, s[12:15], s30 offen offset:1024 lds
    v_mfma_f32_16x16x32_bf16 a[4:7], v[32:35], v[92:95], a[4:7]
    ds_read_b64_tr_b16 v[18:19], v14 offset:512
    v_mfma_f32_16x16x32_bf16 a[44:47], v[36:39], v[92:95], a[44:47]
    v_mfma_f32_16x16x32_bf16 a[84:87], v[40:43], v[92:95], a[84:87]
    buffer_load_dwordx4 v12, s[12:15], s30 offen offset:2048 lds
    ds_read_b64_tr_b16 v[20:21], v14 offset:8
    v_mfma_f32_16x16x32_bf16 a[124:127], v[44:47], v[92:95], a[124:127]
    v_mfma_f32_16x16x32_bf16 a[8:11], v[32:35], v[96:99], a[8:11]
    buffer_load_dwordx4 v12, s[12:15], s30 offen offset:3072 lds
    ds_read_b64_tr_b16 v[22:23], v14 offset:520
    v_mfma_f32_16x16x32_bf16 a[48:51], v[36:39], v[96:99], a[48:51]
    v_mfma_f32_16x16x32_bf16 a[88:91], v[40:43], v[96:99], a[88:91]
    ds_read_b64_tr_b16 v[24:25], v15 offset:0
    v_mfma_f32_16x16x32_bf16 a[128:131], v[44:47], v[96:99], a[128:131]
    s_mov_b32 s29, 153600
    buffer_load_dwordx4 v[48:51], v2, s[16:19], s29 offen offset:0
    v_mfma_f32_16x16x32_bf16 a[12:15], v[32:35], v[100:103], a[12:15]
    ds_read_b64_tr_b16 v[26:27], v15 offset:512
    v_mfma_f32_16x16x32_bf16 a[52:55], v[36:39], v[100:103], a[52:55]
    v_mfma_f32_16x16x32_bf16 a[92:95], v[40:43], v[100:103], a[92:95]
    s_mov_b32 s29, 153600
    buffer_load_dwordx4 v[52:55], v2, s[16:19], s29 offen offset:1024
    ds_read_b64_tr_b16 v[28:29], v15 offset:8
    v_mfma_f32_16x16x32_bf16 a[132:135], v[44:47], v[100:103], a[132:135]
    v_mfma_f32_16x16x32_bf16 a[16:19], v[32:35], v[104:107], a[16:19]
    s_mov_b32 s29, 153600
    buffer_load_dwordx4 v[56:59], v2, s[16:19], s29 offen offset:2048
    ds_read_b64_tr_b16 v[30:31], v15 offset:520
    v_mfma_f32_16x16x32_bf16 a[56:59], v[36:39], v[104:107], a[56:59]
    v_mfma_f32_16x16x32_bf16 a[96:99], v[40:43], v[104:107], a[96:99]
    v_mfma_f32_16x16x32_bf16 a[136:139], v[44:47], v[104:107], a[136:139]
    s_mov_b32 s29, 153600
    buffer_load_dwordx4 v[60:63], v2, s[16:19], s29 offen offset:3072
    v_mfma_f32_16x16x32_bf16 a[20:23], v[32:35], v[108:111], a[20:23]
    v_mfma_f32_16x16x32_bf16 a[60:63], v[36:39], v[108:111], a[60:63]
    v_mfma_f32_16x16x32_bf16 a[100:103], v[40:43], v[108:111], a[100:103]
    s_mov_b32 s29, 153600
    buffer_load_dwordx4 v[64:67], v3, s[16:19], s29 offen offset:0
    v_mfma_f32_16x16x32_bf16 a[140:143], v[44:47], v[108:111], a[140:143]
    v_mfma_f32_16x16x32_bf16 a[24:27], v[32:35], v[112:115], a[24:27]
    s_mov_b32 s29, 153600
    buffer_load_dwordx4 v[68:71], v3, s[16:19], s29 offen offset:1024
    v_mfma_f32_16x16x32_bf16 a[64:67], v[36:39], v[112:115], a[64:67]
    v_mfma_f32_16x16x32_bf16 a[104:107], v[40:43], v[112:115], a[104:107]
    v_mfma_f32_16x16x32_bf16 a[144:147], v[44:47], v[112:115], a[144:147]
    s_mov_b32 s29, 153600
    buffer_load_dwordx4 v[72:75], v3, s[16:19], s29 offen offset:2048
    v_mfma_f32_16x16x32_bf16 a[28:31], v[32:35], v[116:119], a[28:31]
    v_mfma_f32_16x16x32_bf16 a[68:71], v[36:39], v[116:119], a[68:71]
    v_mfma_f32_16x16x32_bf16 a[108:111], v[40:43], v[116:119], a[108:111]
    s_mov_b32 s29, 153600
    buffer_load_dwordx4 v[76:79], v3, s[16:19], s29 offen offset:3072
    v_mfma_f32_16x16x32_bf16 a[148:151], v[44:47], v[116:119], a[148:151]
    v_mfma_f32_16x16x32_bf16 a[32:35], v[32:35], v[120:123], a[32:35]
    s_mov_b32 s29, 153600
    buffer_load_dwordx4 v[80:83], v4, s[16:19], s29 offen offset:0
    v_mfma_f32_16x16x32_bf16 a[72:75], v[36:39], v[120:123], a[72:75]
    v_mfma_f32_16x16x32_bf16 a[112:115], v[40:43], v[120:123], a[112:115]
    v_mfma_f32_16x16x32_bf16 a[152:155], v[44:47], v[120:123], a[152:155]
    s_mov_b32 s29, 153600
    buffer_load_dwordx4 v[84:87], v4, s[16:19], s29 offen offset:1024
    v_mfma_f32_16x16x32_bf16 a[36:39], v[32:35], v[124:127], a[36:39]
    v_mfma_f32_16x16x32_bf16 a[76:79], v[36:39], v[124:127], a[76:79]
    v_mfma_f32_16x16x32_bf16 a[116:119], v[40:43], v[124:127], a[116:119]
    v_mfma_f32_16x16x32_bf16 a[156:159], v[44:47], v[124:127], a[156:159]
    s_waitcnt vmcnt(38)
    s_waitcnt lgkmcnt(0)
    v_mfma_f32_16x16x32_bf16 a[0:3], v[16:19], v[128:131], a[0:3]
    v_mfma_f32_16x16x32_bf16 a[40:43], v[20:23], v[128:131], a[40:43]
    s_add_u32 m0, s25, 0
    s_mov_b32 s30, 65536
    buffer_load_dwordx4 v12, s[12:15], s30 offen offset:0 lds
    v_mfma_f32_16x16x32_bf16 a[80:83], v[24:27], v[128:131], a[80:83]
    ds_read_b64_tr_b16 v[32:33], v14 offset:4096
    v_mfma_f32_16x16x32_bf16 a[120:123], v[28:31], v[128:131], a[120:123]
    buffer_load_dwordx4 v12, s[12:15], s30 offen offset:1024 lds
    v_mfma_f32_16x16x32_bf16 a[4:7], v[16:19], v[132:135], a[4:7]
    ds_read_b64_tr_b16 v[34:35], v14 offset:4608
    v_mfma_f32_16x16x32_bf16 a[44:47], v[20:23], v[132:135], a[44:47]
    v_mfma_f32_16x16x32_bf16 a[84:87], v[24:27], v[132:135], a[84:87]
    buffer_load_dwordx4 v12, s[12:15], s30 offen offset:2048 lds
    ds_read_b64_tr_b16 v[36:37], v14 offset:4104
    v_mfma_f32_16x16x32_bf16 a[124:127], v[28:31], v[132:135], a[124:127]
    v_mfma_f32_16x16x32_bf16 a[8:11], v[16:19], v[136:139], a[8:11]
    buffer_load_dwordx4 v12, s[12:15], s30 offen offset:3072 lds
    ds_read_b64_tr_b16 v[38:39], v14 offset:4616
    v_mfma_f32_16x16x32_bf16 a[48:51], v[20:23], v[136:139], a[48:51]
    v_mfma_f32_16x16x32_bf16 a[88:91], v[24:27], v[136:139], a[88:91]
    ds_read_b64_tr_b16 v[40:41], v15 offset:4096
    v_mfma_f32_16x16x32_bf16 a[128:131], v[28:31], v[136:139], a[128:131]
    s_mov_b32 s29, 163840
    buffer_load_dwordx4 v[88:91], v2, s[16:19], s29 offen offset:0
    v_mfma_f32_16x16x32_bf16 a[12:15], v[16:19], v[140:143], a[12:15]
    ds_read_b64_tr_b16 v[42:43], v15 offset:4608
    v_mfma_f32_16x16x32_bf16 a[52:55], v[20:23], v[140:143], a[52:55]
    v_mfma_f32_16x16x32_bf16 a[92:95], v[24:27], v[140:143], a[92:95]
    s_mov_b32 s29, 163840
    buffer_load_dwordx4 v[92:95], v2, s[16:19], s29 offen offset:1024
    ds_read_b64_tr_b16 v[44:45], v15 offset:4104
    v_mfma_f32_16x16x32_bf16 a[132:135], v[28:31], v[140:143], a[132:135]
    v_mfma_f32_16x16x32_bf16 a[16:19], v[16:19], v[144:147], a[16:19]
    s_mov_b32 s29, 163840
    buffer_load_dwordx4 v[96:99], v2, s[16:19], s29 offen offset:2048
    ds_read_b64_tr_b16 v[46:47], v15 offset:4616
    v_mfma_f32_16x16x32_bf16 a[56:59], v[20:23], v[144:147], a[56:59]
    v_mfma_f32_16x16x32_bf16 a[96:99], v[24:27], v[144:147], a[96:99]
    v_mfma_f32_16x16x32_bf16 a[136:139], v[28:31], v[144:147], a[136:139]
    s_mov_b32 s29, 163840
    buffer_load_dwordx4 v[100:103], v2, s[16:19], s29 offen offset:3072
    v_mfma_f32_16x16x32_bf16 a[20:23], v[16:19], v[148:151], a[20:23]
    v_mfma_f32_16x16x32_bf16 a[60:63], v[20:23], v[148:151], a[60:63]
    v_mfma_f32_16x16x32_bf16 a[100:103], v[24:27], v[148:151], a[100:103]
    s_mov_b32 s29, 163840
    buffer_load_dwordx4 v[104:107], v3, s[16:19], s29 offen offset:0
    v_mfma_f32_16x16x32_bf16 a[140:143], v[28:31], v[148:151], a[140:143]
    v_mfma_f32_16x16x32_bf16 a[24:27], v[16:19], v[152:155], a[24:27]
    s_mov_b32 s29, 163840
    buffer_load_dwordx4 v[108:111], v3, s[16:19], s29 offen offset:1024
    v_mfma_f32_16x16x32_bf16 a[64:67], v[20:23], v[152:155], a[64:67]
    v_mfma_f32_16x16x32_bf16 a[104:107], v[24:27], v[152:155], a[104:107]
    v_mfma_f32_16x16x32_bf16 a[144:147], v[28:31], v[152:155], a[144:147]
    s_mov_b32 s29, 163840
    buffer_load_dwordx4 v[112:115], v3, s[16:19], s29 offen offset:2048
    v_mfma_f32_16x16x32_bf16 a[28:31], v[16:19], v[156:159], a[28:31]
    v_mfma_f32_16x16x32_bf16 a[68:71], v[20:23], v[156:159], a[68:71]
    v_mfma_f32_16x16x32_bf16 a[108:111], v[24:27], v[156:159], a[108:111]
    s_mov_b32 s29, 163840
    buffer_load_dwordx4 v[116:119], v3, s[16:19], s29 offen offset:3072
    v_mfma_f32_16x16x32_bf16 a[148:151], v[28:31], v[156:159], a[148:151]
    v_mfma_f32_16x16x32_bf16 a[32:35], v[16:19], v[160:163], a[32:35]
    s_mov_b32 s29, 163840
    buffer_load_dwordx4 v[120:123], v4, s[16:19], s29 offen offset:0
    v_mfma_f32_16x16x32_bf16 a[72:75], v[20:23], v[160:163], a[72:75]
    v_mfma_f32_16x16x32_bf16 a[112:115], v[24:27], v[160:163], a[112:115]
    v_mfma_f32_16x16x32_bf16 a[152:155], v[28:31], v[160:163], a[152:155]
    s_mov_b32 s29, 163840
    buffer_load_dwordx4 v[124:127], v4, s[16:19], s29 offen offset:1024
    v_mfma_f32_16x16x32_bf16 a[36:39], v[16:19], v[164:167], a[36:39]
    v_mfma_f32_16x16x32_bf16 a[76:79], v[20:23], v[164:167], a[76:79]
    v_mfma_f32_16x16x32_bf16 a[116:119], v[24:27], v[164:167], a[116:119]
    v_mfma_f32_16x16x32_bf16 a[156:159], v[28:31], v[164:167], a[156:159]
    s_waitcnt vmcnt(38)
    s_waitcnt lgkmcnt(0)
    v_mfma_f32_16x16x32_bf16 a[0:3], v[32:35], v[168:171], a[0:3]
    v_mfma_f32_16x16x32_bf16 a[40:43], v[36:39], v[168:171], a[40:43]
    s_add_u32 m0, s25, 4096
    s_mov_b32 s30, 69632
    buffer_load_dwordx4 v12, s[12:15], s30 offen offset:0 lds
    v_mfma_f32_16x16x32_bf16 a[80:83], v[40:43], v[168:171], a[80:83]
    ds_read_b64_tr_b16 v[16:17], v14 offset:8192
    v_mfma_f32_16x16x32_bf16 a[120:123], v[44:47], v[168:171], a[120:123]
    buffer_load_dwordx4 v12, s[12:15], s30 offen offset:1024 lds
    v_mfma_f32_16x16x32_bf16 a[4:7], v[32:35], v[172:175], a[4:7]
    ds_read_b64_tr_b16 v[18:19], v14 offset:8704
    v_mfma_f32_16x16x32_bf16 a[44:47], v[36:39], v[172:175], a[44:47]
    v_mfma_f32_16x16x32_bf16 a[84:87], v[40:43], v[172:175], a[84:87]
    buffer_load_dwordx4 v12, s[12:15], s30 offen offset:2048 lds
    ds_read_b64_tr_b16 v[20:21], v14 offset:8200
    v_mfma_f32_16x16x32_bf16 a[124:127], v[44:47], v[172:175], a[124:127]
    v_mfma_f32_16x16x32_bf16 a[8:11], v[32:35], v[176:179], a[8:11]
    buffer_load_dwordx4 v12, s[12:15], s30 offen offset:3072 lds
    ds_read_b64_tr_b16 v[22:23], v14 offset:8712
    v_mfma_f32_16x16x32_bf16 a[48:51], v[36:39], v[176:179], a[48:51]
    v_mfma_f32_16x16x32_bf16 a[88:91], v[40:43], v[176:179], a[88:91]
    ds_read_b64_tr_b16 v[24:25], v15 offset:8192
    v_mfma_f32_16x16x32_bf16 a[128:131], v[44:47], v[176:179], a[128:131]
    s_mov_b32 s29, 174080
    buffer_load_dwordx4 v[128:131], v2, s[16:19], s29 offen offset:0
    v_mfma_f32_16x16x32_bf16 a[12:15], v[32:35], v[180:183], a[12:15]
    ds_read_b64_tr_b16 v[26:27], v15 offset:8704
    v_mfma_f32_16x16x32_bf16 a[52:55], v[36:39], v[180:183], a[52:55]
    v_mfma_f32_16x16x32_bf16 a[92:95], v[40:43], v[180:183], a[92:95]
    s_mov_b32 s29, 174080
    buffer_load_dwordx4 v[132:135], v2, s[16:19], s29 offen offset:1024
    ds_read_b64_tr_b16 v[28:29], v15 offset:8200
    v_mfma_f32_16x16x32_bf16 a[132:135], v[44:47], v[180:183], a[132:135]
    v_mfma_f32_16x16x32_bf16 a[16:19], v[32:35], v[184:187], a[16:19]
    s_mov_b32 s29, 174080
    buffer_load_dwordx4 v[136:139], v2, s[16:19], s29 offen offset:2048
    ds_read_b64_tr_b16 v[30:31], v15 offset:8712
    v_mfma_f32_16x16x32_bf16 a[56:59], v[36:39], v[184:187], a[56:59]
    v_mfma_f32_16x16x32_bf16 a[96:99], v[40:43], v[184:187], a[96:99]
    v_mfma_f32_16x16x32_bf16 a[136:139], v[44:47], v[184:187], a[136:139]
    s_mov_b32 s29, 174080
    buffer_load_dwordx4 v[140:143], v2, s[16:19], s29 offen offset:3072
    v_mfma_f32_16x16x32_bf16 a[20:23], v[32:35], v[188:191], a[20:23]
    v_mfma_f32_16x16x32_bf16 a[60:63], v[36:39], v[188:191], a[60:63]
    v_mfma_f32_16x16x32_bf16 a[100:103], v[40:43], v[188:191], a[100:103]
    s_mov_b32 s29, 174080
    buffer_load_dwordx4 v[144:147], v3, s[16:19], s29 offen offset:0
    v_mfma_f32_16x16x32_bf16 a[140:143], v[44:47], v[188:191], a[140:143]
    v_mfma_f32_16x16x32_bf16 a[24:27], v[32:35], v[192:195], a[24:27]
    s_mov_b32 s29, 174080
    buffer_load_dwordx4 v[148:151], v3, s[16:19], s29 offen offset:1024
    v_mfma_f32_16x16x32_bf16 a[64:67], v[36:39], v[192:195], a[64:67]
    v_mfma_f32_16x16x32_bf16 a[104:107], v[40:43], v[192:195], a[104:107]
    v_mfma_f32_16x16x32_bf16 a[144:147], v[44:47], v[192:195], a[144:147]
    s_mov_b32 s29, 174080
    buffer_load_dwordx4 v[152:155], v3, s[16:19], s29 offen offset:2048
    v_mfma_f32_16x16x32_bf16 a[28:31], v[32:35], v[196:199], a[28:31]
    v_mfma_f32_16x16x32_bf16 a[68:71], v[36:39], v[196:199], a[68:71]
    v_mfma_f32_16x16x32_bf16 a[108:111], v[40:43], v[196:199], a[108:111]
    s_mov_b32 s29, 174080
    buffer_load_dwordx4 v[156:159], v3, s[16:19], s29 offen offset:3072
    v_mfma_f32_16x16x32_bf16 a[148:151], v[44:47], v[196:199], a[148:151]
    v_mfma_f32_16x16x32_bf16 a[32:35], v[32:35], v[200:203], a[32:35]
    s_mov_b32 s29, 174080
    buffer_load_dwordx4 v[160:163], v4, s[16:19], s29 offen offset:0
    v_mfma_f32_16x16x32_bf16 a[72:75], v[36:39], v[200:203], a[72:75]
    v_mfma_f32_16x16x32_bf16 a[112:115], v[40:43], v[200:203], a[112:115]
    v_mfma_f32_16x16x32_bf16 a[152:155], v[44:47], v[200:203], a[152:155]
    s_mov_b32 s29, 174080
    buffer_load_dwordx4 v[164:167], v4, s[16:19], s29 offen offset:1024
    v_mfma_f32_16x16x32_bf16 a[36:39], v[32:35], v[204:207], a[36:39]
    v_mfma_f32_16x16x32_bf16 a[76:79], v[36:39], v[204:207], a[76:79]
    v_mfma_f32_16x16x32_bf16 a[116:119], v[40:43], v[204:207], a[116:119]
    v_mfma_f32_16x16x32_bf16 a[156:159], v[44:47], v[204:207], a[156:159]
    s_waitcnt vmcnt(38)
    s_waitcnt lgkmcnt(0)
    v_mfma_f32_16x16x32_bf16 a[0:3], v[16:19], v[208:211], a[0:3]
    v_mfma_f32_16x16x32_bf16 a[40:43], v[20:23], v[208:211], a[40:43]
    s_add_u32 m0, s25, 8192
    s_mov_b32 s30, 73728
    buffer_load_dwordx4 v12, s[12:15], s30 offen offset:0 lds
    v_mfma_f32_16x16x32_bf16 a[80:83], v[24:27], v[208:211], a[80:83]
    ds_read_b64_tr_b16 v[32:33], v14 offset:12288
    v_mfma_f32_16x16x32_bf16 a[120:123], v[28:31], v[208:211], a[120:123]
    buffer_load_dwordx4 v12, s[12:15], s30 offen offset:1024 lds
    v_mfma_f32_16x16x32_bf16 a[4:7], v[16:19], v[212:215], a[4:7]
    ds_read_b64_tr_b16 v[34:35], v14 offset:12800
    v_mfma_f32_16x16x32_bf16 a[44:47], v[20:23], v[212:215], a[44:47]
    v_mfma_f32_16x16x32_bf16 a[84:87], v[24:27], v[212:215], a[84:87]
    buffer_load_dwordx4 v12, s[12:15], s30 offen offset:2048 lds
    ds_read_b64_tr_b16 v[36:37], v14 offset:12296
    v_mfma_f32_16x16x32_bf16 a[124:127], v[28:31], v[212:215], a[124:127]
    v_mfma_f32_16x16x32_bf16 a[8:11], v[16:19], v[216:219], a[8:11]
    buffer_load_dwordx4 v12, s[12:15], s30 offen offset:3072 lds
    ds_read_b64_tr_b16 v[38:39], v14 offset:12808
    v_mfma_f32_16x16x32_bf16 a[48:51], v[20:23], v[216:219], a[48:51]
    v_mfma_f32_16x16x32_bf16 a[88:91], v[24:27], v[216:219], a[88:91]
    ds_read_b64_tr_b16 v[40:41], v15 offset:12288
    v_mfma_f32_16x16x32_bf16 a[128:131], v[28:31], v[216:219], a[128:131]
    s_mov_b32 s29, 184320
    buffer_load_dwordx4 v[168:171], v2, s[16:19], s29 offen offset:0
    v_mfma_f32_16x16x32_bf16 a[12:15], v[16:19], v[220:223], a[12:15]
    ds_read_b64_tr_b16 v[42:43], v15 offset:12800
    v_mfma_f32_16x16x32_bf16 a[52:55], v[20:23], v[220:223], a[52:55]
    v_mfma_f32_16x16x32_bf16 a[92:95], v[24:27], v[220:223], a[92:95]
    s_mov_b32 s29, 184320
    buffer_load_dwordx4 v[172:175], v2, s[16:19], s29 offen offset:1024
    ds_read_b64_tr_b16 v[44:45], v15 offset:12296
    v_mfma_f32_16x16x32_bf16 a[132:135], v[28:31], v[220:223], a[132:135]
    v_mfma_f32_16x16x32_bf16 a[16:19], v[16:19], v[224:227], a[16:19]
    s_mov_b32 s29, 184320
    buffer_load_dwordx4 v[176:179], v2, s[16:19], s29 offen offset:2048
    ds_read_b64_tr_b16 v[46:47], v15 offset:12808
    v_mfma_f32_16x16x32_bf16 a[56:59], v[20:23], v[224:227], a[56:59]
    v_mfma_f32_16x16x32_bf16 a[96:99], v[24:27], v[224:227], a[96:99]
    v_mfma_f32_16x16x32_bf16 a[136:139], v[28:31], v[224:227], a[136:139]
    s_mov_b32 s29, 184320
    buffer_load_dwordx4 v[180:183], v2, s[16:19], s29 offen offset:3072
    v_mfma_f32_16x16x32_bf16 a[20:23], v[16:19], v[228:231], a[20:23]
    v_mfma_f32_16x16x32_bf16 a[60:63], v[20:23], v[228:231], a[60:63]
    v_mfma_f32_16x16x32_bf16 a[100:103], v[24:27], v[228:231], a[100:103]
    s_mov_b32 s29, 184320
    buffer_load_dwordx4 v[184:187], v3, s[16:19], s29 offen offset:0
    v_mfma_f32_16x16x32_bf16 a[140:143], v[28:31], v[228:231], a[140:143]
    v_mfma_f32_16x16x32_bf16 a[24:27], v[16:19], v[232:235], a[24:27]
    s_mov_b32 s29, 184320
    buffer_load_dwordx4 v[188:191], v3, s[16:19], s29 offen offset:1024
    v_mfma_f32_16x16x32_bf16 a[64:67], v[20:23], v[232:235], a[64:67]
    v_mfma_f32_16x16x32_bf16 a[104:107], v[24:27], v[232:235], a[104:107]
    v_mfma_f32_16x16x32_bf16 a[144:147], v[28:31], v[232:235], a[144:147]
    s_mov_b32 s29, 184320
    buffer_load_dwordx4 v[192:195], v3, s[16:19], s29 offen offset:2048
    v_mfma_f32_16x16x32_bf16 a[28:31], v[16:19], v[236:239], a[28:31]
    v_mfma_f32_16x16x32_bf16 a[68:71], v[20:23], v[236:239], a[68:71]
    v_mfma_f32_16x16x32_bf16 a[108:111], v[24:27], v[236:239], a[108:111]
    s_mov_b32 s29, 184320
    buffer_load_dwordx4 v[196:199], v3, s[16:19], s29 offen offset:3072
    v_mfma_f32_16x16x32_bf16 a[148:151], v[28:31], v[236:239], a[148:151]
    v_mfma_f32_16x16x32_bf16 a[32:35], v[16:19], v[240:243], a[32:35]
    s_mov_b32 s29, 184320
    buffer_load_dwordx4 v[200:203], v4, s[16:19], s29 offen offset:0
    v_mfma_f32_16x16x32_bf16 a[72:75], v[20:23], v[240:243], a[72:75]
    v_mfma_f32_16x16x32_bf16 a[112:115], v[24:27], v[240:243], a[112:115]
    v_mfma_f32_16x16x32_bf16 a[152:155], v[28:31], v[240:243], a[152:155]
    s_mov_b32 s29, 184320
    buffer_load_dwordx4 v[204:207], v4, s[16:19], s29 offen offset:1024
    v_mfma_f32_16x16x32_bf16 a[36:39], v[16:19], v[244:247], a[36:39]
    v_mfma_f32_16x16x32_bf16 a[76:79], v[20:23], v[244:247], a[76:79]
    v_mfma_f32_16x16x32_bf16 a[116:119], v[24:27], v[244:247], a[116:119]
    v_mfma_f32_16x16x32_bf16 a[156:159], v[28:31], v[244:247], a[156:159]
    s_waitcnt vmcnt(38)
    s_waitcnt lgkmcnt(0)
    v_mfma_f32_16x16x32_bf16 a[0:3], v[32:35], v[48:51], a[0:3]
    v_mfma_f32_16x16x32_bf16 a[40:43], v[36:39], v[48:51], a[40:43]
    s_add_u32 m0, s25, 12288
    s_mov_b32 s30, 77824
    buffer_load_dwordx4 v12, s[12:15], s30 offen offset:0 lds
    v_mfma_f32_16x16x32_bf16 a[80:83], v[40:43], v[48:51], a[80:83]
    ds_read_b64_tr_b16 v[16:17], v14 offset:0
    v_mfma_f32_16x16x32_bf16 a[120:123], v[44:47], v[48:51], a[120:123]
    buffer_load_dwordx4 v12, s[12:15], s30 offen offset:1024 lds
    v_mfma_f32_16x16x32_bf16 a[4:7], v[32:35], v[52:55], a[4:7]
    ds_read_b64_tr_b16 v[18:19], v14 offset:512
    v_mfma_f32_16x16x32_bf16 a[44:47], v[36:39], v[52:55], a[44:47]
    v_mfma_f32_16x16x32_bf16 a[84:87], v[40:43], v[52:55], a[84:87]
    buffer_load_dwordx4 v12, s[12:15], s30 offen offset:2048 lds
    ds_read_b64_tr_b16 v[20:21], v14 offset:8
    v_mfma_f32_16x16x32_bf16 a[124:127], v[44:47], v[52:55], a[124:127]
    v_mfma_f32_16x16x32_bf16 a[8:11], v[32:35], v[56:59], a[8:11]
    buffer_load_dwordx4 v12, s[12:15], s30 offen offset:3072 lds
    ds_read_b64_tr_b16 v[22:23], v14 offset:520
    v_mfma_f32_16x16x32_bf16 a[48:51], v[36:39], v[56:59], a[48:51]
    v_mfma_f32_16x16x32_bf16 a[88:91], v[40:43], v[56:59], a[88:91]
    ds_read_b64_tr_b16 v[24:25], v15 offset:0
    v_mfma_f32_16x16x32_bf16 a[128:131], v[44:47], v[56:59], a[128:131]
    s_mov_b32 s29, 194560
    buffer_load_dwordx4 v[208:211], v2, s[16:19], s29 offen offset:0
    v_mfma_f32_16x16x32_bf16 a[12:15], v[32:35], v[60:63], a[12:15]
    ds_read_b64_tr_b16 v[26:27], v15 offset:512
    v_mfma_f32_16x16x32_bf16 a[52:55], v[36:39], v[60:63], a[52:55]
    v_mfma_f32_16x16x32_bf16 a[92:95], v[40:43], v[60:63], a[92:95]
    s_mov_b32 s29, 194560
    buffer_load_dwordx4 v[212:215], v2, s[16:19], s29 offen offset:1024
    ds_read_b64_tr_b16 v[28:29], v15 offset:8
    v_mfma_f32_16x16x32_bf16 a[132:135], v[44:47], v[60:63], a[132:135]
    v_mfma_f32_16x16x32_bf16 a[16:19], v[32:35], v[64:67], a[16:19]
    s_mov_b32 s29, 194560
    buffer_load_dwordx4 v[216:219], v2, s[16:19], s29 offen offset:2048
    ds_read_b64_tr_b16 v[30:31], v15 offset:520
    v_mfma_f32_16x16x32_bf16 a[56:59], v[36:39], v[64:67], a[56:59]
    v_mfma_f32_16x16x32_bf16 a[96:99], v[40:43], v[64:67], a[96:99]
    v_mfma_f32_16x16x32_bf16 a[136:139], v[44:47], v[64:67], a[136:139]
    s_mov_b32 s29, 194560
    buffer_load_dwordx4 v[220:223], v2, s[16:19], s29 offen offset:3072
    v_mfma_f32_16x16x32_bf16 a[20:23], v[32:35], v[68:71], a[20:23]
    v_mfma_f32_16x16x32_bf16 a[60:63], v[36:39], v[68:71], a[60:63]
    v_mfma_f32_16x16x32_bf16 a[100:103], v[40:43], v[68:71], a[100:103]
    s_mov_b32 s29, 194560
    buffer_load_dwordx4 v[224:227], v3, s[16:19], s29 offen offset:0
    v_mfma_f32_16x16x32_bf16 a[140:143], v[44:47], v[68:71], a[140:143]
    v_mfma_f32_16x16x32_bf16 a[24:27], v[32:35], v[72:75], a[24:27]
    s_mov_b32 s29, 194560
    buffer_load_dwordx4 v[228:231], v3, s[16:19], s29 offen offset:1024
    v_mfma_f32_16x16x32_bf16 a[64:67], v[36:39], v[72:75], a[64:67]
    v_mfma_f32_16x16x32_bf16 a[104:107], v[40:43], v[72:75], a[104:107]
    v_mfma_f32_16x16x32_bf16 a[144:147], v[44:47], v[72:75], a[144:147]
    s_mov_b32 s29, 194560
    buffer_load_dwordx4 v[232:235], v3, s[16:19], s29 offen offset:2048
    v_mfma_f32_16x16x32_bf16 a[28:31], v[32:35], v[76:79], a[28:31]
    v_mfma_f32_16x16x32_bf16 a[68:71], v[36:39], v[76:79], a[68:71]
    v_mfma_f32_16x16x32_bf16 a[108:111], v[40:43], v[76:79], a[108:111]
    s_mov_b32 s29, 194560
    buffer_load_dwordx4 v[236:239], v3, s[16:19], s29 offen offset:3072
    v_mfma_f32_16x16x32_bf16 a[148:151], v[44:47], v[76:79], a[148:151]
    v_mfma_f32_16x16x32_bf16 a[32:35], v[32:35], v[80:83], a[32:35]
    s_mov_b32 s29, 194560
    buffer_load_dwordx4 v[240:243], v4, s[16:19], s29 offen offset:0
    v_mfma_f32_16x16x32_bf16 a[72:75], v[36:39], v[80:83], a[72:75]
    v_mfma_f32_16x16x32_bf16 a[112:115], v[40:43], v[80:83], a[112:115]
    v_mfma_f32_16x16x32_bf16 a[152:155], v[44:47], v[80:83], a[152:155]
    s_mov_b32 s29, 194560
    buffer_load_dwordx4 v[244:247], v4, s[16:19], s29 offen offset:1024
    v_mfma_f32_16x16x32_bf16 a[36:39], v[32:35], v[84:87], a[36:39]
    v_mfma_f32_16x16x32_bf16 a[76:79], v[36:39], v[84:87], a[76:79]
    v_mfma_f32_16x16x32_bf16 a[116:119], v[40:43], v[84:87], a[116:119]
    v_mfma_f32_16x16x32_bf16 a[156:159], v[44:47], v[84:87], a[156:159]
    s_waitcnt vmcnt(38)
    s_waitcnt lgkmcnt(0)
    v_mfma_f32_16x16x32_bf16 a[0:3], v[16:19], v[88:91], a[0:3]
    v_mfma_f32_16x16x32_bf16 a[40:43], v[20:23], v[88:91], a[40:43]
    s_add_u32 m0, s25, 0
    s_mov_b32 s30, 81920
    buffer_load_dwordx4 v12, s[12:15], s30 offen offset:0 lds
    v_mfma_f32_16x16x32_bf16 a[80:83], v[24:27], v[88:91], a[80:83]
    ds_read_b64_tr_b16 v[32:33], v14 offset:4096
    v_mfma_f32_16x16x32_bf16 a[120:123], v[28:31], v[88:91], a[120:123]
    buffer_load_dwordx4 v12, s[12:15], s30 offen offset:1024 lds
    v_mfma_f32_16x16x32_bf16 a[4:7], v[16:19], v[92:95], a[4:7]
    ds_read_b64_tr_b16 v[34:35], v14 offset:4608
    v_mfma_f32_16x16x32_bf16 a[44:47], v[20:23], v[92:95], a[44:47]
    v_mfma_f32_16x16x32_bf16 a[84:87], v[24:27], v[92:95], a[84:87]
    buffer_load_dwordx4 v12, s[12:15], s30 offen offset:2048 lds
    ds_read_b64_tr_b16 v[36:37], v14 offset:4104
    v_mfma_f32_16x16x32_bf16 a[124:127], v[28:31], v[92:95], a[124:127]
    v_mfma_f32_16x16x32_bf16 a[8:11], v[16:19], v[96:99], a[8:11]
    buffer_load_dwordx4 v12, s[12:15], s30 offen offset:3072 lds
    ds_read_b64_tr_b16 v[38:39], v14 offset:4616
    v_mfma_f32_16x16x32_bf16 a[48:51], v[20:23], v[96:99], a[48:51]
    v_mfma_f32_16x16x32_bf16 a[88:91], v[24:27], v[96:99], a[88:91]
    ds_read_b64_tr_b16 v[40:41], v15 offset:4096
    v_mfma_f32_16x16x32_bf16 a[128:131], v[28:31], v[96:99], a[128:131]
    s_mov_b32 s29, 204800
    buffer_load_dwordx4 v[48:51], v2, s[16:19], s29 offen offset:0
    v_mfma_f32_16x16x32_bf16 a[12:15], v[16:19], v[100:103], a[12:15]
    ds_read_b64_tr_b16 v[42:43], v15 offset:4608
    v_mfma_f32_16x16x32_bf16 a[52:55], v[20:23], v[100:103], a[52:55]
    v_mfma_f32_16x16x32_bf16 a[92:95], v[24:27], v[100:103], a[92:95]
    s_mov_b32 s29, 204800
    buffer_load_dwordx4 v[52:55], v2, s[16:19], s29 offen offset:1024
    ds_read_b64_tr_b16 v[44:45], v15 offset:4104
    v_mfma_f32_16x16x32_bf16 a[132:135], v[28:31], v[100:103], a[132:135]
    v_mfma_f32_16x16x32_bf16 a[16:19], v[16:19], v[104:107], a[16:19]
    s_mov_b32 s29, 204800
    buffer_load_dwordx4 v[56:59], v2, s[16:19], s29 offen offset:2048
    ds_read_b64_tr_b16 v[46:47], v15 offset:4616
    v_mfma_f32_16x16x32_bf16 a[56:59], v[20:23], v[104:107], a[56:59]
    v_mfma_f32_16x16x32_bf16 a[96:99], v[24:27], v[104:107], a[96:99]
    v_mfma_f32_16x16x32_bf16 a[136:139], v[28:31], v[104:107], a[136:139]
    s_mov_b32 s29, 204800
    buffer_load_dwordx4 v[60:63], v2, s[16:19], s29 offen offset:3072
    v_mfma_f32_16x16x32_bf16 a[20:23], v[16:19], v[108:111], a[20:23]
    v_mfma_f32_16x16x32_bf16 a[60:63], v[20:23], v[108:111], a[60:63]
    v_mfma_f32_16x16x32_bf16 a[100:103], v[24:27], v[108:111], a[100:103]
    s_mov_b32 s29, 204800
    buffer_load_dwordx4 v[64:67], v3, s[16:19], s29 offen offset:0
    v_mfma_f32_16x16x32_bf16 a[140:143], v[28:31], v[108:111], a[140:143]
    v_mfma_f32_16x16x32_bf16 a[24:27], v[16:19], v[112:115], a[24:27]
    s_mov_b32 s29, 204800
    buffer_load_dwordx4 v[68:71], v3, s[16:19], s29 offen offset:1024
    v_mfma_f32_16x16x32_bf16 a[64:67], v[20:23], v[112:115], a[64:67]
    v_mfma_f32_16x16x32_bf16 a[104:107], v[24:27], v[112:115], a[104:107]
    v_mfma_f32_16x16x32_bf16 a[144:147], v[28:31], v[112:115], a[144:147]
    s_mov_b32 s29, 204800
    buffer_load_dwordx4 v[72:75], v3, s[16:19], s29 offen offset:2048
    v_mfma_f32_16x16x32_bf16 a[28:31], v[16:19], v[116:119], a[28:31]
    v_mfma_f32_16x16x32_bf16 a[68:71], v[20:23], v[116:119], a[68:71]
    v_mfma_f32_16x16x32_bf16 a[108:111], v[24:27], v[116:119], a[108:111]
    s_mov_b32 s29, 204800
    buffer_load_dwordx4 v[76:79], v3, s[16:19], s29 offen offset:3072
    v_mfma_f32_16x16x32_bf16 a[148:151], v[28:31], v[116:119], a[148:151]
    v_mfma_f32_16x16x32_bf16 a[32:35], v[16:19], v[120:123], a[32:35]
    s_mov_b32 s29, 204800
    buffer_load_dwordx4 v[80:83], v4, s[16:19], s29 offen offset:0
    v_mfma_f32_16x16x32_bf16 a[72:75], v[20:23], v[120:123], a[72:75]
    v_mfma_f32_16x16x32_bf16 a[112:115], v[24:27], v[120:123], a[112:115]
    v_mfma_f32_16x16x32_bf16 a[152:155], v[28:31], v[120:123], a[152:155]
    s_mov_b32 s29, 204800
    buffer_load_dwordx4 v[84:87], v4, s[16:19], s29 offen offset:1024
    v_mfma_f32_16x16x32_bf16 a[36:39], v[16:19], v[124:127], a[36:39]
    v_mfma_f32_16x16x32_bf16 a[76:79], v[20:23], v[124:127], a[76:79]
    v_mfma_f32_16x16x32_bf16 a[116:119], v[24:27], v[124:127], a[116:119]
    v_mfma_f32_16x16x32_bf16 a[156:159], v[28:31], v[124:127], a[156:159]
    s_waitcnt vmcnt(38)
    s_waitcnt lgkmcnt(0)
    v_mfma_f32_16x16x32_bf16 a[0:3], v[32:35], v[128:131], a[0:3]
    v_mfma_f32_16x16x32_bf16 a[40:43], v[36:39], v[128:131], a[40:43]
    s_add_u32 m0, s25, 4096
    s_mov_b32 s30, 86016
    buffer_load_dwordx4 v12, s[12:15], s30 offen offset:0 lds
    v_mfma_f32_16x16x32_bf16 a[80:83], v[40:43], v[128:131], a[80:83]
    ds_read_b64_tr_b16 v[16:17], v14 offset:8192
    v_mfma_f32_16x16x32_bf16 a[120:123], v[44:47], v[128:131], a[120:123]
    buffer_load_dwordx4 v12, s[12:15], s30 offen offset:1024 lds
    v_mfma_f32_16x16x32_bf16 a[4:7], v[32:35], v[132:135], a[4:7]
    ds_read_b64_tr_b16 v[18:19], v14 offset:8704
    v_mfma_f32_16x16x32_bf16 a[44:47], v[36:39], v[132:135], a[44:47]
    v_mfma_f32_16x16x32_bf16 a[84:87], v[40:43], v[132:135], a[84:87]
    buffer_load_dwordx4 v12, s[12:15], s30 offen offset:2048 lds
    ds_read_b64_tr_b16 v[20:21], v14 offset:8200
    v_mfma_f32_16x16x32_bf16 a[124:127], v[44:47], v[132:135], a[124:127]
    v_mfma_f32_16x16x32_bf16 a[8:11], v[32:35], v[136:139], a[8:11]
    buffer_load_dwordx4 v12, s[12:15], s30 offen offset:3072 lds
    ds_read_b64_tr_b16 v[22:23], v14 offset:8712
    v_mfma_f32_16x16x32_bf16 a[48:51], v[36:39], v[136:139], a[48:51]
    v_mfma_f32_16x16x32_bf16 a[88:91], v[40:43], v[136:139], a[88:91]
    ds_read_b64_tr_b16 v[24:25], v15 offset:8192
    v_mfma_f32_16x16x32_bf16 a[128:131], v[44:47], v[136:139], a[128:131]
    s_mov_b32 s29, 215040
    buffer_load_dwordx4 v[88:91], v2, s[16:19], s29 offen offset:0
    v_mfma_f32_16x16x32_bf16 a[12:15], v[32:35], v[140:143], a[12:15]
    ds_read_b64_tr_b16 v[26:27], v15 offset:8704
    v_mfma_f32_16x16x32_bf16 a[52:55], v[36:39], v[140:143], a[52:55]
    v_mfma_f32_16x16x32_bf16 a[92:95], v[40:43], v[140:143], a[92:95]
    s_mov_b32 s29, 215040
    buffer_load_dwordx4 v[92:95], v2, s[16:19], s29 offen offset:1024
    ds_read_b64_tr_b16 v[28:29], v15 offset:8200
    v_mfma_f32_16x16x32_bf16 a[132:135], v[44:47], v[140:143], a[132:135]
    v_mfma_f32_16x16x32_bf16 a[16:19], v[32:35], v[144:147], a[16:19]
    s_mov_b32 s29, 215040
    buffer_load_dwordx4 v[96:99], v2, s[16:19], s29 offen offset:2048
    ds_read_b64_tr_b16 v[30:31], v15 offset:8712
    v_mfma_f32_16x16x32_bf16 a[56:59], v[36:39], v[144:147], a[56:59]
    v_mfma_f32_16x16x32_bf16 a[96:99], v[40:43], v[144:147], a[96:99]
    v_mfma_f32_16x16x32_bf16 a[136:139], v[44:47], v[144:147], a[136:139]
    s_mov_b32 s29, 215040
    buffer_load_dwordx4 v[100:103], v2, s[16:19], s29 offen offset:3072
    v_mfma_f32_16x16x32_bf16 a[20:23], v[32:35], v[148:151], a[20:23]
    v_mfma_f32_16x16x32_bf16 a[60:63], v[36:39], v[148:151], a[60:63]
    v_mfma_f32_16x16x32_bf16 a[100:103], v[40:43], v[148:151], a[100:103]
    s_mov_b32 s29, 215040
    buffer_load_dwordx4 v[104:107], v3, s[16:19], s29 offen offset:0
    v_mfma_f32_16x16x32_bf16 a[140:143], v[44:47], v[148:151], a[140:143]
    v_mfma_f32_16x16x32_bf16 a[24:27], v[32:35], v[152:155], a[24:27]
    s_mov_b32 s29, 215040
    buffer_load_dwordx4 v[108:111], v3, s[16:19], s29 offen offset:1024
    v_mfma_f32_16x16x32_bf16 a[64:67], v[36:39], v[152:155], a[64:67]
    v_mfma_f32_16x16x32_bf16 a[104:107], v[40:43], v[152:155], a[104:107]
    v_mfma_f32_16x16x32_bf16 a[144:147], v[44:47], v[152:155], a[144:147]
    s_mov_b32 s29, 215040
    buffer_load_dwordx4 v[112:115], v3, s[16:19], s29 offen offset:2048
    v_mfma_f32_16x16x32_bf16 a[28:31], v[32:35], v[156:159], a[28:31]
    v_mfma_f32_16x16x32_bf16 a[68:71], v[36:39], v[156:159], a[68:71]
    v_mfma_f32_16x16x32_bf16 a[108:111], v[40:43], v[156:159], a[108:111]
    s_mov_b32 s29, 215040
    buffer_load_dwordx4 v[116:119], v3, s[16:19], s29 offen offset:3072
    v_mfma_f32_16x16x32_bf16 a[148:151], v[44:47], v[156:159], a[148:151]
    v_mfma_f32_16x16x32_bf16 a[32:35], v[32:35], v[160:163], a[32:35]
    s_mov_b32 s29, 215040
    buffer_load_dwordx4 v[120:123], v4, s[16:19], s29 offen offset:0
    v_mfma_f32_16x16x32_bf16 a[72:75], v[36:39], v[160:163], a[72:75]
    v_mfma_f32_16x16x32_bf16 a[112:115], v[40:43], v[160:163], a[112:115]
    v_mfma_f32_16x16x32_bf16 a[152:155], v[44:47], v[160:163], a[152:155]
    s_mov_b32 s29, 215040
    buffer_load_dwordx4 v[124:127], v4, s[16:19], s29 offen offset:1024
    v_mfma_f32_16x16x32_bf16 a[36:39], v[32:35], v[164:167], a[36:39]
    v_mfma_f32_16x16x32_bf16 a[76:79], v[36:39], v[164:167], a[76:79]
    v_mfma_f32_16x16x32_bf16 a[116:119], v[40:43], v[164:167], a[116:119]
    v_mfma_f32_16x16x32_bf16 a[156:159], v[44:47], v[164:167], a[156:159]
    s_waitcnt vmcnt(38)
    s_waitcnt lgkmcnt(0)
    v_mfma_f32_16x16x32_bf16 a[0:3], v[16:19], v[168:171], a[0:3]
    v_mfma_f32_16x16x32_bf16 a[40:43], v[20:23], v[168:171], a[40:43]
    s_add_u32 m0, s25, 8192
    s_mov_b32 s30, 90112
    buffer_load_dwordx4 v12, s[12:15], s30 offen offset:0 lds
    v_mfma_f32_16x16x32_bf16 a[80:83], v[24:27], v[168:171], a[80:83]
    ds_read_b64_tr_b16 v[32:33], v14 offset:12288
    v_mfma_f32_16x16x32_bf16 a[120:123], v[28:31], v[168:171], a[120:123]
    buffer_load_dwordx4 v12, s[12:15], s30 offen offset:1024 lds
    v_mfma_f32_16x16x32_bf16 a[4:7], v[16:19], v[172:175], a[4:7]
    ds_read_b64_tr_b16 v[34:35], v14 offset:12800
    v_mfma_f32_16x16x32_bf16 a[44:47], v[20:23], v[172:175], a[44:47]
    v_mfma_f32_16x16x32_bf16 a[84:87], v[24:27], v[172:175], a[84:87]
    buffer_load_dwordx4 v12, s[12:15], s30 offen offset:2048 lds
    ds_read_b64_tr_b16 v[36:37], v14 offset:12296
    v_mfma_f32_16x16x32_bf16 a[124:127], v[28:31], v[172:175], a[124:127]
    v_mfma_f32_16x16x32_bf16 a[8:11], v[16:19], v[176:179], a[8:11]
    buffer_load_dwordx4 v12, s[12:15], s30 offen offset:3072 lds
    ds_read_b64_tr_b16 v[38:39], v14 offset:12808
    v_mfma_f32_16x16x32_bf16 a[48:51], v[20:23], v[176:179], a[48:51]
    v_mfma_f32_16x16x32_bf16 a[88:91], v[24:27], v[176:179], a[88:91]
    ds_read_b64_tr_b16 v[40:41], v15 offset:12288
    v_mfma_f32_16x16x32_bf16 a[128:131], v[28:31], v[176:179], a[128:131]
    s_mov_b32 s29, 225280
    buffer_load_dwordx4 v[128:131], v2, s[16:19], s29 offen offset:0
    v_mfma_f32_16x16x32_bf16 a[12:15], v[16:19], v[180:183], a[12:15]
    ds_read_b64_tr_b16 v[42:43], v15 offset:12800
    v_mfma_f32_16x16x32_bf16 a[52:55], v[20:23], v[180:183], a[52:55]
    v_mfma_f32_16x16x32_bf16 a[92:95], v[24:27], v[180:183], a[92:95]
    s_mov_b32 s29, 225280
    buffer_load_dwordx4 v[132:135], v2, s[16:19], s29 offen offset:1024
    ds_read_b64_tr_b16 v[44:45], v15 offset:12296
    v_mfma_f32_16x16x32_bf16 a[132:135], v[28:31], v[180:183], a[132:135]
    v_mfma_f32_16x16x32_bf16 a[16:19], v[16:19], v[184:187], a[16:19]
    s_mov_b32 s29, 225280
    buffer_load_dwordx4 v[136:139], v2, s[16:19], s29 offen offset:2048
    ds_read_b64_tr_b16 v[46:47], v15 offset:12808
    v_mfma_f32_16x16x32_bf16 a[56:59], v[20:23], v[184:187], a[56:59]
    v_mfma_f32_16x16x32_bf16 a[96:99], v[24:27], v[184:187], a[96:99]
    v_mfma_f32_16x16x32_bf16 a[136:139], v[28:31], v[184:187], a[136:139]
    s_mov_b32 s29, 225280
    buffer_load_dwordx4 v[140:143], v2, s[16:19], s29 offen offset:3072
    v_mfma_f32_16x16x32_bf16 a[20:23], v[16:19], v[188:191], a[20:23]
    v_mfma_f32_16x16x32_bf16 a[60:63], v[20:23], v[188:191], a[60:63]
    v_mfma_f32_16x16x32_bf16 a[100:103], v[24:27], v[188:191], a[100:103]
    s_mov_b32 s29, 225280
    buffer_load_dwordx4 v[144:147], v3, s[16:19], s29 offen offset:0
    v_mfma_f32_16x16x32_bf16 a[140:143], v[28:31], v[188:191], a[140:143]
    v_mfma_f32_16x16x32_bf16 a[24:27], v[16:19], v[192:195], a[24:27]
    s_mov_b32 s29, 225280
    buffer_load_dwordx4 v[148:151], v3, s[16:19], s29 offen offset:1024
    v_mfma_f32_16x16x32_bf16 a[64:67], v[20:23], v[192:195], a[64:67]
    v_mfma_f32_16x16x32_bf16 a[104:107], v[24:27], v[192:195], a[104:107]
    v_mfma_f32_16x16x32_bf16 a[144:147], v[28:31], v[192:195], a[144:147]
    s_mov_b32 s29, 225280
    buffer_load_dwordx4 v[152:155], v3, s[16:19], s29 offen offset:2048
    v_mfma_f32_16x16x32_bf16 a[28:31], v[16:19], v[196:199], a[28:31]
    v_mfma_f32_16x16x32_bf16 a[68:71], v[20:23], v[196:199], a[68:71]
    v_mfma_f32_16x16x32_bf16 a[108:111], v[24:27], v[196:199], a[108:111]
    s_mov_b32 s29, 225280
    buffer_load_dwordx4 v[156:159], v3, s[16:19], s29 offen offset:3072
    v_mfma_f32_16x16x32_bf16 a[148:151], v[28:31], v[196:199], a[148:151]
    v_mfma_f32_16x16x32_bf16 a[32:35], v[16:19], v[200:203], a[32:35]
    s_mov_b32 s29, 225280
    buffer_load_dwordx4 v[160:163], v4, s[16:19], s29 offen offset:0
    v_mfma_f32_16x16x32_bf16 a[72:75], v[20:23], v[200:203], a[72:75]
    v_mfma_f32_16x16x32_bf16 a[112:115], v[24:27], v[200:203], a[112:115]
    v_mfma_f32_16x16x32_bf16 a[152:155], v[28:31], v[200:203], a[152:155]
    s_mov_b32 s29, 225280
    buffer_load_dwordx4 v[164:167], v4, s[16:19], s29 offen offset:1024
    v_mfma_f32_16x16x32_bf16 a[36:39], v[16:19], v[204:207], a[36:39]
    v_mfma_f32_16x16x32_bf16 a[76:79], v[20:23], v[204:207], a[76:79]
    v_mfma_f32_16x16x32_bf16 a[116:119], v[24:27], v[204:207], a[116:119]
    v_mfma_f32_16x16x32_bf16 a[156:159], v[28:31], v[204:207], a[156:159]
    s_waitcnt vmcnt(38)
    s_waitcnt lgkmcnt(0)
    v_mfma_f32_16x16x32_bf16 a[0:3], v[32:35], v[208:211], a[0:3]
    v_mfma_f32_16x16x32_bf16 a[40:43], v[36:39], v[208:211], a[40:43]
    s_add_u32 m0, s25, 12288
    s_mov_b32 s30, 94208
    buffer_load_dwordx4 v12, s[12:15], s30 offen offset:0 lds
    v_mfma_f32_16x16x32_bf16 a[80:83], v[40:43], v[208:211], a[80:83]
    ds_read_b64_tr_b16 v[16:17], v14 offset:0
    v_mfma_f32_16x16x32_bf16 a[120:123], v[44:47], v[208:211], a[120:123]
    buffer_load_dwordx4 v12, s[12:15], s30 offen offset:1024 lds
    v_mfma_f32_16x16x32_bf16 a[4:7], v[32:35], v[212:215], a[4:7]
    ds_read_b64_tr_b16 v[18:19], v14 offset:512
    v_mfma_f32_16x16x32_bf16 a[44:47], v[36:39], v[212:215], a[44:47]
    v_mfma_f32_16x16x32_bf16 a[84:87], v[40:43], v[212:215], a[84:87]
    buffer_load_dwordx4 v12, s[12:15], s30 offen offset:2048 lds
    ds_read_b64_tr_b16 v[20:21], v14 offset:8
    v_mfma_f32_16x16x32_bf16 a[124:127], v[44:47], v[212:215], a[124:127]
    v_mfma_f32_16x16x32_bf16 a[8:11], v[32:35], v[216:219], a[8:11]
    buffer_load_dwordx4 v12, s[12:15], s30 offen offset:3072 lds
    ds_read_b64_tr_b16 v[22:23], v14 offset:520
    v_mfma_f32_16x16x32_bf16 a[48:51], v[36:39], v[216:219], a[48:51]
    v_mfma_f32_16x16x32_bf16 a[88:91], v[40:43], v[216:219], a[88:91]
    ds_read_b64_tr_b16 v[24:25], v15 offset:0
    v_mfma_f32_16x16x32_bf16 a[128:131], v[44:47], v[216:219], a[128:131]
    s_mov_b32 s29, 235520
    buffer_load_dwordx4 v[168:171], v2, s[16:19], s29 offen offset:0
    v_mfma_f32_16x16x32_bf16 a[12:15], v[32:35], v[220:223], a[12:15]
    ds_read_b64_tr_b16 v[26:27], v15 offset:512
    v_mfma_f32_16x16x32_bf16 a[52:55], v[36:39], v[220:223], a[52:55]
    v_mfma_f32_16x16x32_bf16 a[92:95], v[40:43], v[220:223], a[92:95]
    s_mov_b32 s29, 235520
    buffer_load_dwordx4 v[172:175], v2, s[16:19], s29 offen offset:1024
    ds_read_b64_tr_b16 v[28:29], v15 offset:8
    v_mfma_f32_16x16x32_bf16 a[132:135], v[44:47], v[220:223], a[132:135]
    v_mfma_f32_16x16x32_bf16 a[16:19], v[32:35], v[224:227], a[16:19]
    s_mov_b32 s29, 235520
    buffer_load_dwordx4 v[176:179], v2, s[16:19], s29 offen offset:2048
    ds_read_b64_tr_b16 v[30:31], v15 offset:520
    v_mfma_f32_16x16x32_bf16 a[56:59], v[36:39], v[224:227], a[56:59]
    v_mfma_f32_16x16x32_bf16 a[96:99], v[40:43], v[224:227], a[96:99]
    v_mfma_f32_16x16x32_bf16 a[136:139], v[44:47], v[224:227], a[136:139]
    s_mov_b32 s29, 235520
    buffer_load_dwordx4 v[180:183], v2, s[16:19], s29 offen offset:3072
    v_mfma_f32_16x16x32_bf16 a[20:23], v[32:35], v[228:231], a[20:23]
    v_mfma_f32_16x16x32_bf16 a[60:63], v[36:39], v[228:231], a[60:63]
    v_mfma_f32_16x16x32_bf16 a[100:103], v[40:43], v[228:231], a[100:103]
    s_mov_b32 s29, 235520
    buffer_load_dwordx4 v[184:187], v3, s[16:19], s29 offen offset:0
    v_mfma_f32_16x16x32_bf16 a[140:143], v[44:47], v[228:231], a[140:143]
    v_mfma_f32_16x16x32_bf16 a[24:27], v[32:35], v[232:235], a[24:27]
    s_mov_b32 s29, 235520
    buffer_load_dwordx4 v[188:191], v3, s[16:19], s29 offen offset:1024
    v_mfma_f32_16x16x32_bf16 a[64:67], v[36:39], v[232:235], a[64:67]
    v_mfma_f32_16x16x32_bf16 a[104:107], v[40:43], v[232:235], a[104:107]
    v_mfma_f32_16x16x32_bf16 a[144:147], v[44:47], v[232:235], a[144:147]
    s_mov_b32 s29, 235520
    buffer_load_dwordx4 v[192:195], v3, s[16:19], s29 offen offset:2048
    v_mfma_f32_16x16x32_bf16 a[28:31], v[32:35], v[236:239], a[28:31]
    v_mfma_f32_16x16x32_bf16 a[68:71], v[36:39], v[236:239], a[68:71]
    v_mfma_f32_16x16x32_bf16 a[108:111], v[40:43], v[236:239], a[108:111]
    s_mov_b32 s29, 235520
    buffer_load_dwordx4 v[196:199], v3, s[16:19], s29 offen offset:3072
    v_mfma_f32_16x16x32_bf16 a[148:151], v[44:47], v[236:239], a[148:151]
    v_mfma_f32_16x16x32_bf16 a[32:35], v[32:35], v[240:243], a[32:35]
    s_mov_b32 s29, 235520
    buffer_load_dwordx4 v[200:203], v4, s[16:19], s29 offen offset:0
    v_mfma_f32_16x16x32_bf16 a[72:75], v[36:39], v[240:243], a[72:75]
    v_mfma_f32_16x16x32_bf16 a[112:115], v[40:43], v[240:243], a[112:115]
    v_mfma_f32_16x16x32_bf16 a[152:155], v[44:47], v[240:243], a[152:155]
    s_mov_b32 s29, 235520
    buffer_load_dwordx4 v[204:207], v4, s[16:19], s29 offen offset:1024
    v_mfma_f32_16x16x32_bf16 a[36:39], v[32:35], v[244:247], a[36:39]
    v_mfma_f32_16x16x32_bf16 a[76:79], v[36:39], v[244:247], a[76:79]
    v_mfma_f32_16x16x32_bf16 a[116:119], v[40:43], v[244:247], a[116:119]
    v_mfma_f32_16x16x32_bf16 a[156:159], v[44:47], v[244:247], a[156:159]
    s_waitcnt vmcnt(38)
    s_waitcnt lgkmcnt(0)
    v_mfma_f32_16x16x32_bf16 a[0:3], v[16:19], v[48:51], a[0:3]
    v_mfma_f32_16x16x32_bf16 a[40:43], v[20:23], v[48:51], a[40:43]
    s_add_u32 m0, s25, 0
    s_mov_b32 s30, 98304
    buffer_load_dwordx4 v12, s[12:15], s30 offen offset:0 lds
    v_mfma_f32_16x16x32_bf16 a[80:83], v[24:27], v[48:51], a[80:83]
    ds_read_b64_tr_b16 v[32:33], v14 offset:4096
    v_mfma_f32_16x16x32_bf16 a[120:123], v[28:31], v[48:51], a[120:123]
    buffer_load_dwordx4 v12, s[12:15], s30 offen offset:1024 lds
    v_mfma_f32_16x16x32_bf16 a[4:7], v[16:19], v[52:55], a[4:7]
    ds_read_b64_tr_b16 v[34:35], v14 offset:4608
    v_mfma_f32_16x16x32_bf16 a[44:47], v[20:23], v[52:55], a[44:47]
    v_mfma_f32_16x16x32_bf16 a[84:87], v[24:27], v[52:55], a[84:87]
    buffer_load_dwordx4 v12, s[12:15], s30 offen offset:2048 lds
    ds_read_b64_tr_b16 v[36:37], v14 offset:4104
    v_mfma_f32_16x16x32_bf16 a[124:127], v[28:31], v[52:55], a[124:127]
    v_mfma_f32_16x16x32_bf16 a[8:11], v[16:19], v[56:59], a[8:11]
    buffer_load_dwordx4 v12, s[12:15], s30 offen offset:3072 lds
    ds_read_b64_tr_b16 v[38:39], v14 offset:4616
    v_mfma_f32_16x16x32_bf16 a[48:51], v[20:23], v[56:59], a[48:51]
    v_mfma_f32_16x16x32_bf16 a[88:91], v[24:27], v[56:59], a[88:91]
    ds_read_b64_tr_b16 v[40:41], v15 offset:4096
    v_mfma_f32_16x16x32_bf16 a[128:131], v[28:31], v[56:59], a[128:131]
    s_mov_b32 s29, 245760
    buffer_load_dwordx4 v[208:211], v2, s[16:19], s29 offen offset:0
    v_mfma_f32_16x16x32_bf16 a[12:15], v[16:19], v[60:63], a[12:15]
    ds_read_b64_tr_b16 v[42:43], v15 offset:4608
    v_mfma_f32_16x16x32_bf16 a[52:55], v[20:23], v[60:63], a[52:55]
    v_mfma_f32_16x16x32_bf16 a[92:95], v[24:27], v[60:63], a[92:95]
    s_mov_b32 s29, 245760
    buffer_load_dwordx4 v[212:215], v2, s[16:19], s29 offen offset:1024
    ds_read_b64_tr_b16 v[44:45], v15 offset:4104
    v_mfma_f32_16x16x32_bf16 a[132:135], v[28:31], v[60:63], a[132:135]
    v_mfma_f32_16x16x32_bf16 a[16:19], v[16:19], v[64:67], a[16:19]
    s_mov_b32 s29, 245760
    buffer_load_dwordx4 v[216:219], v2, s[16:19], s29 offen offset:2048
    ds_read_b64_tr_b16 v[46:47], v15 offset:4616
    v_mfma_f32_16x16x32_bf16 a[56:59], v[20:23], v[64:67], a[56:59]
    v_mfma_f32_16x16x32_bf16 a[96:99], v[24:27], v[64:67], a[96:99]
    v_mfma_f32_16x16x32_bf16 a[136:139], v[28:31], v[64:67], a[136:139]
    s_mov_b32 s29, 245760
    buffer_load_dwordx4 v[220:223], v2, s[16:19], s29 offen offset:3072
    v_mfma_f32_16x16x32_bf16 a[20:23], v[16:19], v[68:71], a[20:23]
    v_mfma_f32_16x16x32_bf16 a[60:63], v[20:23], v[68:71], a[60:63]
    v_mfma_f32_16x16x32_bf16 a[100:103], v[24:27], v[68:71], a[100:103]
    s_mov_b32 s29, 245760
    buffer_load_dwordx4 v[224:227], v3, s[16:19], s29 offen offset:0
    v_mfma_f32_16x16x32_bf16 a[140:143], v[28:31], v[68:71], a[140:143]
    v_mfma_f32_16x16x32_bf16 a[24:27], v[16:19], v[72:75], a[24:27]
    s_mov_b32 s29, 245760
    buffer_load_dwordx4 v[228:231], v3, s[16:19], s29 offen offset:1024
    v_mfma_f32_16x16x32_bf16 a[64:67], v[20:23], v[72:75], a[64:67]
    v_mfma_f32_16x16x32_bf16 a[104:107], v[24:27], v[72:75], a[104:107]
    v_mfma_f32_16x16x32_bf16 a[144:147], v[28:31], v[72:75], a[144:147]
    s_mov_b32 s29, 245760
    buffer_load_dwordx4 v[232:235], v3, s[16:19], s29 offen offset:2048
    v_mfma_f32_16x16x32_bf16 a[28:31], v[16:19], v[76:79], a[28:31]
    v_mfma_f32_16x16x32_bf16 a[68:71], v[20:23], v[76:79], a[68:71]
    v_mfma_f32_16x16x32_bf16 a[108:111], v[24:27], v[76:79], a[108:111]
    s_mov_b32 s29, 245760
    buffer_load_dwordx4 v[236:239], v3, s[16:19], s29 offen offset:3072
    v_mfma_f32_16x16x32_bf16 a[148:151], v[28:31], v[76:79], a[148:151]
    v_mfma_f32_16x16x32_bf16 a[32:35], v[16:19], v[80:83], a[32:35]
    s_mov_b32 s29, 245760
    buffer_load_dwordx4 v[240:243], v4, s[16:19], s29 offen offset:0
    v_mfma_f32_16x16x32_bf16 a[72:75], v[20:23], v[80:83], a[72:75]
    v_mfma_f32_16x16x32_bf16 a[112:115], v[24:27], v[80:83], a[112:115]
    v_mfma_f32_16x16x32_bf16 a[152:155], v[28:31], v[80:83], a[152:155]
    s_mov_b32 s29, 245760
    buffer_load_dwordx4 v[244:247], v4, s[16:19], s29 offen offset:1024
    v_mfma_f32_16x16x32_bf16 a[36:39], v[16:19], v[84:87], a[36:39]
    v_mfma_f32_16x16x32_bf16 a[76:79], v[20:23], v[84:87], a[76:79]
    v_mfma_f32_16x16x32_bf16 a[116:119], v[24:27], v[84:87], a[116:119]
    v_mfma_f32_16x16x32_bf16 a[156:159], v[28:31], v[84:87], a[156:159]
    s_waitcnt vmcnt(38)
    s_waitcnt lgkmcnt(0)
    v_mfma_f32_16x16x32_bf16 a[0:3], v[32:35], v[88:91], a[0:3]
    v_mfma_f32_16x16x32_bf16 a[40:43], v[36:39], v[88:91], a[40:43]
    s_add_u32 m0, s25, 4096
    s_mov_b32 s30, 102400
    buffer_load_dwordx4 v12, s[12:15], s30 offen offset:0 lds
    v_mfma_f32_16x16x32_bf16 a[80:83], v[40:43], v[88:91], a[80:83]
    ds_read_b64_tr_b16 v[16:17], v14 offset:8192
    v_mfma_f32_16x16x32_bf16 a[120:123], v[44:47], v[88:91], a[120:123]
    buffer_load_dwordx4 v12, s[12:15], s30 offen offset:1024 lds
    v_mfma_f32_16x16x32_bf16 a[4:7], v[32:35], v[92:95], a[4:7]
    ds_read_b64_tr_b16 v[18:19], v14 offset:8704
    v_mfma_f32_16x16x32_bf16 a[44:47], v[36:39], v[92:95], a[44:47]
    v_mfma_f32_16x16x32_bf16 a[84:87], v[40:43], v[92:95], a[84:87]
    buffer_load_dwordx4 v12, s[12:15], s30 offen offset:2048 lds
    ds_read_b64_tr_b16 v[20:21], v14 offset:8200
    v_mfma_f32_16x16x32_bf16 a[124:127], v[44:47], v[92:95], a[124:127]
    v_mfma_f32_16x16x32_bf16 a[8:11], v[32:35], v[96:99], a[8:11]
    buffer_load_dwordx4 v12, s[12:15], s30 offen offset:3072 lds
    ds_read_b64_tr_b16 v[22:23], v14 offset:8712
    v_mfma_f32_16x16x32_bf16 a[48:51], v[36:39], v[96:99], a[48:51]
    v_mfma_f32_16x16x32_bf16 a[88:91], v[40:43], v[96:99], a[88:91]
    ds_read_b64_tr_b16 v[24:25], v15 offset:8192
    v_mfma_f32_16x16x32_bf16 a[128:131], v[44:47], v[96:99], a[128:131]
    s_mov_b32 s29, 256000
    buffer_load_dwordx4 v[48:51], v2, s[16:19], s29 offen offset:0
    v_mfma_f32_16x16x32_bf16 a[12:15], v[32:35], v[100:103], a[12:15]
    ds_read_b64_tr_b16 v[26:27], v15 offset:8704
    v_mfma_f32_16x16x32_bf16 a[52:55], v[36:39], v[100:103], a[52:55]
    v_mfma_f32_16x16x32_bf16 a[92:95], v[40:43], v[100:103], a[92:95]
    s_mov_b32 s29, 256000
    buffer_load_dwordx4 v[52:55], v2, s[16:19], s29 offen offset:1024
    ds_read_b64_tr_b16 v[28:29], v15 offset:8200
    v_mfma_f32_16x16x32_bf16 a[132:135], v[44:47], v[100:103], a[132:135]
    v_mfma_f32_16x16x32_bf16 a[16:19], v[32:35], v[104:107], a[16:19]
    s_mov_b32 s29, 256000
    buffer_load_dwordx4 v[56:59], v2, s[16:19], s29 offen offset:2048
    ds_read_b64_tr_b16 v[30:31], v15 offset:8712
    v_mfma_f32_16x16x32_bf16 a[56:59], v[36:39], v[104:107], a[56:59]
    v_mfma_f32_16x16x32_bf16 a[96:99], v[40:43], v[104:107], a[96:99]
    v_mfma_f32_16x16x32_bf16 a[136:139], v[44:47], v[104:107], a[136:139]
    s_mov_b32 s29, 256000
    buffer_load_dwordx4 v[60:63], v2, s[16:19], s29 offen offset:3072
    v_mfma_f32_16x16x32_bf16 a[20:23], v[32:35], v[108:111], a[20:23]
    v_mfma_f32_16x16x32_bf16 a[60:63], v[36:39], v[108:111], a[60:63]
    v_mfma_f32_16x16x32_bf16 a[100:103], v[40:43], v[108:111], a[100:103]
    s_mov_b32 s29, 256000
    buffer_load_dwordx4 v[64:67], v3, s[16:19], s29 offen offset:0
    v_mfma_f32_16x16x32_bf16 a[140:143], v[44:47], v[108:111], a[140:143]
    v_mfma_f32_16x16x32_bf16 a[24:27], v[32:35], v[112:115], a[24:27]
    s_mov_b32 s29, 256000
    buffer_load_dwordx4 v[68:71], v3, s[16:19], s29 offen offset:1024
    v_mfma_f32_16x16x32_bf16 a[64:67], v[36:39], v[112:115], a[64:67]
    v_mfma_f32_16x16x32_bf16 a[104:107], v[40:43], v[112:115], a[104:107]
    v_mfma_f32_16x16x32_bf16 a[144:147], v[44:47], v[112:115], a[144:147]
    s_mov_b32 s29, 256000
    buffer_load_dwordx4 v[72:75], v3, s[16:19], s29 offen offset:2048
    v_mfma_f32_16x16x32_bf16 a[28:31], v[32:35], v[116:119], a[28:31]
    v_mfma_f32_16x16x32_bf16 a[68:71], v[36:39], v[116:119], a[68:71]
    v_mfma_f32_16x16x32_bf16 a[108:111], v[40:43], v[116:119], a[108:111]
    s_mov_b32 s29, 256000
    buffer_load_dwordx4 v[76:79], v3, s[16:19], s29 offen offset:3072
    v_mfma_f32_16x16x32_bf16 a[148:151], v[44:47], v[116:119], a[148:151]
    v_mfma_f32_16x16x32_bf16 a[32:35], v[32:35], v[120:123], a[32:35]
    s_mov_b32 s29, 256000
    buffer_load_dwordx4 v[80:83], v4, s[16:19], s29 offen offset:0
    v_mfma_f32_16x16x32_bf16 a[72:75], v[36:39], v[120:123], a[72:75]
    v_mfma_f32_16x16x32_bf16 a[112:115], v[40:43], v[120:123], a[112:115]
    v_mfma_f32_16x16x32_bf16 a[152:155], v[44:47], v[120:123], a[152:155]
    s_mov_b32 s29, 256000
    buffer_load_dwordx4 v[84:87], v4, s[16:19], s29 offen offset:1024
    v_mfma_f32_16x16x32_bf16 a[36:39], v[32:35], v[124:127], a[36:39]
    v_mfma_f32_16x16x32_bf16 a[76:79], v[36:39], v[124:127], a[76:79]
    v_mfma_f32_16x16x32_bf16 a[116:119], v[40:43], v[124:127], a[116:119]
    v_mfma_f32_16x16x32_bf16 a[156:159], v[44:47], v[124:127], a[156:159]
    s_waitcnt vmcnt(38)
    s_waitcnt lgkmcnt(0)
    v_mfma_f32_16x16x32_bf16 a[0:3], v[16:19], v[128:131], a[0:3]
    v_mfma_f32_16x16x32_bf16 a[40:43], v[20:23], v[128:131], a[40:43]
    s_add_u32 m0, s25, 8192
    s_mov_b32 s30, 106496
    buffer_load_dwordx4 v12, s[12:15], s30 offen offset:0 lds
    v_mfma_f32_16x16x32_bf16 a[80:83], v[24:27], v[128:131], a[80:83]
    ds_read_b64_tr_b16 v[32:33], v14 offset:12288
    v_mfma_f32_16x16x32_bf16 a[120:123], v[28:31], v[128:131], a[120:123]
    buffer_load_dwordx4 v12, s[12:15], s30 offen offset:1024 lds
    v_mfma_f32_16x16x32_bf16 a[4:7], v[16:19], v[132:135], a[4:7]
    ds_read_b64_tr_b16 v[34:35], v14 offset:12800
    v_mfma_f32_16x16x32_bf16 a[44:47], v[20:23], v[132:135], a[44:47]
    v_mfma_f32_16x16x32_bf16 a[84:87], v[24:27], v[132:135], a[84:87]
    buffer_load_dwordx4 v12, s[12:15], s30 offen offset:2048 lds
    ds_read_b64_tr_b16 v[36:37], v14 offset:12296
    v_mfma_f32_16x16x32_bf16 a[124:127], v[28:31], v[132:135], a[124:127]
    v_mfma_f32_16x16x32_bf16 a[8:11], v[16:19], v[136:139], a[8:11]
    buffer_load_dwordx4 v12, s[12:15], s30 offen offset:3072 lds
    ds_read_b64_tr_b16 v[38:39], v14 offset:12808
    v_mfma_f32_16x16x32_bf16 a[48:51], v[20:23], v[136:139], a[48:51]
    v_mfma_f32_16x16x32_bf16 a[88:91], v[24:27], v[136:139], a[88:91]
    ds_read_b64_tr_b16 v[40:41], v15 offset:12288
    v_mfma_f32_16x16x32_bf16 a[128:131], v[28:31], v[136:139], a[128:131]
    s_mov_b32 s29, 266240
    buffer_load_dwordx4 v[88:91], v2, s[16:19], s29 offen offset:0
    v_mfma_f32_16x16x32_bf16 a[12:15], v[16:19], v[140:143], a[12:15]
    ds_read_b64_tr_b16 v[42:43], v15 offset:12800
    v_mfma_f32_16x16x32_bf16 a[52:55], v[20:23], v[140:143], a[52:55]
    v_mfma_f32_16x16x32_bf16 a[92:95], v[24:27], v[140:143], a[92:95]
    s_mov_b32 s29, 266240
    buffer_load_dwordx4 v[92:95], v2, s[16:19], s29 offen offset:1024
    ds_read_b64_tr_b16 v[44:45], v15 offset:12296
    v_mfma_f32_16x16x32_bf16 a[132:135], v[28:31], v[140:143], a[132:135]
    v_mfma_f32_16x16x32_bf16 a[16:19], v[16:19], v[144:147], a[16:19]
    s_mov_b32 s29, 266240
    buffer_load_dwordx4 v[96:99], v2, s[16:19], s29 offen offset:2048
    ds_read_b64_tr_b16 v[46:47], v15 offset:12808
    v_mfma_f32_16x16x32_bf16 a[56:59], v[20:23], v[144:147], a[56:59]
    v_mfma_f32_16x16x32_bf16 a[96:99], v[24:27], v[144:147], a[96:99]
    v_mfma_f32_16x16x32_bf16 a[136:139], v[28:31], v[144:147], a[136:139]
    s_mov_b32 s29, 266240
    buffer_load_dwordx4 v[100:103], v2, s[16:19], s29 offen offset:3072
    v_mfma_f32_16x16x32_bf16 a[20:23], v[16:19], v[148:151], a[20:23]
    v_mfma_f32_16x16x32_bf16 a[60:63], v[20:23], v[148:151], a[60:63]
    v_mfma_f32_16x16x32_bf16 a[100:103], v[24:27], v[148:151], a[100:103]
    s_mov_b32 s29, 266240
    buffer_load_dwordx4 v[104:107], v3, s[16:19], s29 offen offset:0
    v_mfma_f32_16x16x32_bf16 a[140:143], v[28:31], v[148:151], a[140:143]
    v_mfma_f32_16x16x32_bf16 a[24:27], v[16:19], v[152:155], a[24:27]
    s_mov_b32 s29, 266240
    buffer_load_dwordx4 v[108:111], v3, s[16:19], s29 offen offset:1024
    v_mfma_f32_16x16x32_bf16 a[64:67], v[20:23], v[152:155], a[64:67]
    v_mfma_f32_16x16x32_bf16 a[104:107], v[24:27], v[152:155], a[104:107]
    v_mfma_f32_16x16x32_bf16 a[144:147], v[28:31], v[152:155], a[144:147]
    s_mov_b32 s29, 266240
    buffer_load_dwordx4 v[112:115], v3, s[16:19], s29 offen offset:2048
    v_mfma_f32_16x16x32_bf16 a[28:31], v[16:19], v[156:159], a[28:31]
    v_mfma_f32_16x16x32_bf16 a[68:71], v[20:23], v[156:159], a[68:71]
    v_mfma_f32_16x16x32_bf16 a[108:111], v[24:27], v[156:159], a[108:111]
    s_mov_b32 s29, 266240
    buffer_load_dwordx4 v[116:119], v3, s[16:19], s29 offen offset:3072
    v_mfma_f32_16x16x32_bf16 a[148:151], v[28:31], v[156:159], a[148:151]
    v_mfma_f32_16x16x32_bf16 a[32:35], v[16:19], v[160:163], a[32:35]
    s_mov_b32 s29, 266240
    buffer_load_dwordx4 v[120:123], v4, s[16:19], s29 offen offset:0
    v_mfma_f32_16x16x32_bf16 a[72:75], v[20:23], v[160:163], a[72:75]
    v_mfma_f32_16x16x32_bf16 a[112:115], v[24:27], v[160:163], a[112:115]
    v_mfma_f32_16x16x32_bf16 a[152:155], v[28:31], v[160:163], a[152:155]
    s_mov_b32 s29, 266240
    buffer_load_dwordx4 v[124:127], v4, s[16:19], s29 offen offset:1024
    v_mfma_f32_16x16x32_bf16 a[36:39], v[16:19], v[164:167], a[36:39]
    v_mfma_f32_16x16x32_bf16 a[76:79], v[20:23], v[164:167], a[76:79]
    v_mfma_f32_16x16x32_bf16 a[116:119], v[24:27], v[164:167], a[116:119]
    v_mfma_f32_16x16x32_bf16 a[156:159], v[28:31], v[164:167], a[156:159]
    s_waitcnt vmcnt(38)
    s_waitcnt lgkmcnt(0)
    v_mfma_f32_16x16x32_bf16 a[0:3], v[32:35], v[168:171], a[0:3]
    v_mfma_f32_16x16x32_bf16 a[40:43], v[36:39], v[168:171], a[40:43]
    s_add_u32 m0, s25, 12288
    s_mov_b32 s30, 110592
    buffer_load_dwordx4 v12, s[12:15], s30 offen offset:0 lds
    v_mfma_f32_16x16x32_bf16 a[80:83], v[40:43], v[168:171], a[80:83]
    ds_read_b64_tr_b16 v[16:17], v14 offset:0
    v_mfma_f32_16x16x32_bf16 a[120:123], v[44:47], v[168:171], a[120:123]
    buffer_load_dwordx4 v12, s[12:15], s30 offen offset:1024 lds
    v_mfma_f32_16x16x32_bf16 a[4:7], v[32:35], v[172:175], a[4:7]
    ds_read_b64_tr_b16 v[18:19], v14 offset:512
    v_mfma_f32_16x16x32_bf16 a[44:47], v[36:39], v[172:175], a[44:47]
    v_mfma_f32_16x16x32_bf16 a[84:87], v[40:43], v[172:175], a[84:87]
    buffer_load_dwordx4 v12, s[12:15], s30 offen offset:2048 lds
    ds_read_b64_tr_b16 v[20:21], v14 offset:8
    v_mfma_f32_16x16x32_bf16 a[124:127], v[44:47], v[172:175], a[124:127]
    v_mfma_f32_16x16x32_bf16 a[8:11], v[32:35], v[176:179], a[8:11]
    buffer_load_dwordx4 v12, s[12:15], s30 offen offset:3072 lds
    ds_read_b64_tr_b16 v[22:23], v14 offset:520
    v_mfma_f32_16x16x32_bf16 a[48:51], v[36:39], v[176:179], a[48:51]
    v_mfma_f32_16x16x32_bf16 a[88:91], v[40:43], v[176:179], a[88:91]
    ds_read_b64_tr_b16 v[24:25], v15 offset:0
    v_mfma_f32_16x16x32_bf16 a[128:131], v[44:47], v[176:179], a[128:131]
    s_mov_b32 s29, 276480
    buffer_load_dwordx4 v[128:131], v2, s[16:19], s29 offen offset:0
    v_mfma_f32_16x16x32_bf16 a[12:15], v[32:35], v[180:183], a[12:15]
    ds_read_b64_tr_b16 v[26:27], v15 offset:512
    v_mfma_f32_16x16x32_bf16 a[52:55], v[36:39], v[180:183], a[52:55]
    v_mfma_f32_16x16x32_bf16 a[92:95], v[40:43], v[180:183], a[92:95]
    s_mov_b32 s29, 276480
    buffer_load_dwordx4 v[132:135], v2, s[16:19], s29 offen offset:1024
    ds_read_b64_tr_b16 v[28:29], v15 offset:8
    v_mfma_f32_16x16x32_bf16 a[132:135], v[44:47], v[180:183], a[132:135]
    v_mfma_f32_16x16x32_bf16 a[16:19], v[32:35], v[184:187], a[16:19]
    s_mov_b32 s29, 276480
    buffer_load_dwordx4 v[136:139], v2, s[16:19], s29 offen offset:2048
    ds_read_b64_tr_b16 v[30:31], v15 offset:520
    v_mfma_f32_16x16x32_bf16 a[56:59], v[36:39], v[184:187], a[56:59]
    v_mfma_f32_16x16x32_bf16 a[96:99], v[40:43], v[184:187], a[96:99]
    v_mfma_f32_16x16x32_bf16 a[136:139], v[44:47], v[184:187], a[136:139]
    s_mov_b32 s29, 276480
    buffer_load_dwordx4 v[140:143], v2, s[16:19], s29 offen offset:3072
    v_mfma_f32_16x16x32_bf16 a[20:23], v[32:35], v[188:191], a[20:23]
    v_mfma_f32_16x16x32_bf16 a[60:63], v[36:39], v[188:191], a[60:63]
    v_mfma_f32_16x16x32_bf16 a[100:103], v[40:43], v[188:191], a[100:103]
    s_mov_b32 s29, 276480
    buffer_load_dwordx4 v[144:147], v3, s[16:19], s29 offen offset:0
    v_mfma_f32_16x16x32_bf16 a[140:143], v[44:47], v[188:191], a[140:143]
    v_mfma_f32_16x16x32_bf16 a[24:27], v[32:35], v[192:195], a[24:27]
    s_mov_b32 s29, 276480
    buffer_load_dwordx4 v[148:151], v3, s[16:19], s29 offen offset:1024
    v_mfma_f32_16x16x32_bf16 a[64:67], v[36:39], v[192:195], a[64:67]
    v_mfma_f32_16x16x32_bf16 a[104:107], v[40:43], v[192:195], a[104:107]
    v_mfma_f32_16x16x32_bf16 a[144:147], v[44:47], v[192:195], a[144:147]
    s_mov_b32 s29, 276480
    buffer_load_dwordx4 v[152:155], v3, s[16:19], s29 offen offset:2048
    v_mfma_f32_16x16x32_bf16 a[28:31], v[32:35], v[196:199], a[28:31]
    v_mfma_f32_16x16x32_bf16 a[68:71], v[36:39], v[196:199], a[68:71]
    v_mfma_f32_16x16x32_bf16 a[108:111], v[40:43], v[196:199], a[108:111]
    s_mov_b32 s29, 276480
    buffer_load_dwordx4 v[156:159], v3, s[16:19], s29 offen offset:3072
    v_mfma_f32_16x16x32_bf16 a[148:151], v[44:47], v[196:199], a[148:151]
    v_mfma_f32_16x16x32_bf16 a[32:35], v[32:35], v[200:203], a[32:35]
    s_mov_b32 s29, 276480
    buffer_load_dwordx4 v[160:163], v4, s[16:19], s29 offen offset:0
    v_mfma_f32_16x16x32_bf16 a[72:75], v[36:39], v[200:203], a[72:75]
    v_mfma_f32_16x16x32_bf16 a[112:115], v[40:43], v[200:203], a[112:115]
    v_mfma_f32_16x16x32_bf16 a[152:155], v[44:47], v[200:203], a[152:155]
    s_mov_b32 s29, 276480
    buffer_load_dwordx4 v[164:167], v4, s[16:19], s29 offen offset:1024
    v_mfma_f32_16x16x32_bf16 a[36:39], v[32:35], v[204:207], a[36:39]
    v_mfma_f32_16x16x32_bf16 a[76:79], v[36:39], v[204:207], a[76:79]
    v_mfma_f32_16x16x32_bf16 a[116:119], v[40:43], v[204:207], a[116:119]
    v_mfma_f32_16x16x32_bf16 a[156:159], v[44:47], v[204:207], a[156:159]
    s_waitcnt vmcnt(38)
    s_waitcnt lgkmcnt(0)
    v_mfma_f32_16x16x32_bf16 a[0:3], v[16:19], v[208:211], a[0:3]
    v_mfma_f32_16x16x32_bf16 a[40:43], v[20:23], v[208:211], a[40:43]
    s_add_u32 m0, s25, 0
    s_mov_b32 s30, 114688
    buffer_load_dwordx4 v12, s[12:15], s30 offen offset:0 lds
    v_mfma_f32_16x16x32_bf16 a[80:83], v[24:27], v[208:211], a[80:83]
    ds_read_b64_tr_b16 v[32:33], v14 offset:4096
    v_mfma_f32_16x16x32_bf16 a[120:123], v[28:31], v[208:211], a[120:123]
    buffer_load_dwordx4 v12, s[12:15], s30 offen offset:1024 lds
    v_mfma_f32_16x16x32_bf16 a[4:7], v[16:19], v[212:215], a[4:7]
    ds_read_b64_tr_b16 v[34:35], v14 offset:4608
    v_mfma_f32_16x16x32_bf16 a[44:47], v[20:23], v[212:215], a[44:47]
    v_mfma_f32_16x16x32_bf16 a[84:87], v[24:27], v[212:215], a[84:87]
    buffer_load_dwordx4 v12, s[12:15], s30 offen offset:2048 lds
    ds_read_b64_tr_b16 v[36:37], v14 offset:4104
    v_mfma_f32_16x16x32_bf16 a[124:127], v[28:31], v[212:215], a[124:127]
    v_mfma_f32_16x16x32_bf16 a[8:11], v[16:19], v[216:219], a[8:11]
    buffer_load_dwordx4 v12, s[12:15], s30 offen offset:3072 lds
    ds_read_b64_tr_b16 v[38:39], v14 offset:4616
    v_mfma_f32_16x16x32_bf16 a[48:51], v[20:23], v[216:219], a[48:51]
    v_mfma_f32_16x16x32_bf16 a[88:91], v[24:27], v[216:219], a[88:91]
    ds_read_b64_tr_b16 v[40:41], v15 offset:4096
    v_mfma_f32_16x16x32_bf16 a[128:131], v[28:31], v[216:219], a[128:131]
    s_mov_b32 s29, 286720
    buffer_load_dwordx4 v[168:171], v2, s[16:19], s29 offen offset:0
    v_mfma_f32_16x16x32_bf16 a[12:15], v[16:19], v[220:223], a[12:15]
    ds_read_b64_tr_b16 v[42:43], v15 offset:4608
    v_mfma_f32_16x16x32_bf16 a[52:55], v[20:23], v[220:223], a[52:55]
    v_mfma_f32_16x16x32_bf16 a[92:95], v[24:27], v[220:223], a[92:95]
    s_mov_b32 s29, 286720
    buffer_load_dwordx4 v[172:175], v2, s[16:19], s29 offen offset:1024
    ds_read_b64_tr_b16 v[44:45], v15 offset:4104
    v_mfma_f32_16x16x32_bf16 a[132:135], v[28:31], v[220:223], a[132:135]
    v_mfma_f32_16x16x32_bf16 a[16:19], v[16:19], v[224:227], a[16:19]
    s_mov_b32 s29, 286720
    buffer_load_dwordx4 v[176:179], v2, s[16:19], s29 offen offset:2048
    ds_read_b64_tr_b16 v[46:47], v15 offset:4616
    v_mfma_f32_16x16x32_bf16 a[56:59], v[20:23], v[224:227], a[56:59]
    v_mfma_f32_16x16x32_bf16 a[96:99], v[24:27], v[224:227], a[96:99]
    v_mfma_f32_16x16x32_bf16 a[136:139], v[28:31], v[224:227], a[136:139]
    s_mov_b32 s29, 286720
    buffer_load_dwordx4 v[180:183], v2, s[16:19], s29 offen offset:3072
    v_mfma_f32_16x16x32_bf16 a[20:23], v[16:19], v[228:231], a[20:23]
    v_mfma_f32_16x16x32_bf16 a[60:63], v[20:23], v[228:231], a[60:63]
    v_mfma_f32_16x16x32_bf16 a[100:103], v[24:27], v[228:231], a[100:103]
    s_mov_b32 s29, 286720
    buffer_load_dwordx4 v[184:187], v3, s[16:19], s29 offen offset:0
    v_mfma_f32_16x16x32_bf16 a[140:143], v[28:31], v[228:231], a[140:143]
    v_mfma_f32_16x16x32_bf16 a[24:27], v[16:19], v[232:235], a[24:27]
    s_mov_b32 s29, 286720
    buffer_load_dwordx4 v[188:191], v3, s[16:19], s29 offen offset:1024
    v_mfma_f32_16x16x32_bf16 a[64:67], v[20:23], v[232:235], a[64:67]
    v_mfma_f32_16x16x32_bf16 a[104:107], v[24:27], v[232:235], a[104:107]
    v_mfma_f32_16x16x32_bf16 a[144:147], v[28:31], v[232:235], a[144:147]
    s_mov_b32 s29, 286720
    buffer_load_dwordx4 v[192:195], v3, s[16:19], s29 offen offset:2048
    v_mfma_f32_16x16x32_bf16 a[28:31], v[16:19], v[236:239], a[28:31]
    v_mfma_f32_16x16x32_bf16 a[68:71], v[20:23], v[236:239], a[68:71]
    v_mfma_f32_16x16x32_bf16 a[108:111], v[24:27], v[236:239], a[108:111]
    s_mov_b32 s29, 286720
    buffer_load_dwordx4 v[196:199], v3, s[16:19], s29 offen offset:3072
    v_mfma_f32_16x16x32_bf16 a[148:151], v[28:31], v[236:239], a[148:151]
    v_mfma_f32_16x16x32_bf16 a[32:35], v[16:19], v[240:243], a[32:35]
    s_mov_b32 s29, 286720
    buffer_load_dwordx4 v[200:203], v4, s[16:19], s29 offen offset:0
    v_mfma_f32_16x16x32_bf16 a[72:75], v[20:23], v[240:243], a[72:75]
    v_mfma_f32_16x16x32_bf16 a[112:115], v[24:27], v[240:243], a[112:115]
    v_mfma_f32_16x16x32_bf16 a[152:155], v[28:31], v[240:243], a[152:155]
    s_mov_b32 s29, 286720
    buffer_load_dwordx4 v[204:207], v4, s[16:19], s29 offen offset:1024
    v_mfma_f32_16x16x32_bf16 a[36:39], v[16:19], v[244:247], a[36:39]
    v_mfma_f32_16x16x32_bf16 a[76:79], v[20:23], v[244:247], a[76:79]
    v_mfma_f32_16x16x32_bf16 a[116:119], v[24:27], v[244:247], a[116:119]
    v_mfma_f32_16x16x32_bf16 a[156:159], v[28:31], v[244:247], a[156:159]
    s_waitcnt vmcnt(38)
    s_waitcnt lgkmcnt(0)
    v_mfma_f32_16x16x32_bf16 a[0:3], v[32:35], v[48:51], a[0:3]
    v_mfma_f32_16x16x32_bf16 a[40:43], v[36:39], v[48:51], a[40:43]
    s_add_u32 m0, s25, 4096
    s_mov_b32 s30, 118784
    buffer_load_dwordx4 v12, s[12:15], s30 offen offset:0 lds
    v_mfma_f32_16x16x32_bf16 a[80:83], v[40:43], v[48:51], a[80:83]
    ds_read_b64_tr_b16 v[16:17], v14 offset:8192
    v_mfma_f32_16x16x32_bf16 a[120:123], v[44:47], v[48:51], a[120:123]
    buffer_load_dwordx4 v12, s[12:15], s30 offen offset:1024 lds
    v_mfma_f32_16x16x32_bf16 a[4:7], v[32:35], v[52:55], a[4:7]
    ds_read_b64_tr_b16 v[18:19], v14 offset:8704
    v_mfma_f32_16x16x32_bf16 a[44:47], v[36:39], v[52:55], a[44:47]
    v_mfma_f32_16x16x32_bf16 a[84:87], v[40:43], v[52:55], a[84:87]
    buffer_load_dwordx4 v12, s[12:15], s30 offen offset:2048 lds
    ds_read_b64_tr_b16 v[20:21], v14 offset:8200
    v_mfma_f32_16x16x32_bf16 a[124:127], v[44:47], v[52:55], a[124:127]
    v_mfma_f32_16x16x32_bf16 a[8:11], v[32:35], v[56:59], a[8:11]
    buffer_load_dwordx4 v12, s[12:15], s30 offen offset:3072 lds
    ds_read_b64_tr_b16 v[22:23], v14 offset:8712
    v_mfma_f32_16x16x32_bf16 a[48:51], v[36:39], v[56:59], a[48:51]
    v_mfma_f32_16x16x32_bf16 a[88:91], v[40:43], v[56:59], a[88:91]
    ds_read_b64_tr_b16 v[24:25], v15 offset:8192
    v_mfma_f32_16x16x32_bf16 a[128:131], v[44:47], v[56:59], a[128:131]
    s_mov_b32 s29, 296960
    buffer_load_dwordx4 v[208:211], v2, s[16:19], s29 offen offset:0
    v_mfma_f32_16x16x32_bf16 a[12:15], v[32:35], v[60:63], a[12:15]
    ds_read_b64_tr_b16 v[26:27], v15 offset:8704
    v_mfma_f32_16x16x32_bf16 a[52:55], v[36:39], v[60:63], a[52:55]
    v_mfma_f32_16x16x32_bf16 a[92:95], v[40:43], v[60:63], a[92:95]
    s_mov_b32 s29, 296960
    buffer_load_dwordx4 v[212:215], v2, s[16:19], s29 offen offset:1024
    ds_read_b64_tr_b16 v[28:29], v15 offset:8200
    v_mfma_f32_16x16x32_bf16 a[132:135], v[44:47], v[60:63], a[132:135]
    v_mfma_f32_16x16x32_bf16 a[16:19], v[32:35], v[64:67], a[16:19]
    s_mov_b32 s29, 296960
    buffer_load_dwordx4 v[216:219], v2, s[16:19], s29 offen offset:2048
    ds_read_b64_tr_b16 v[30:31], v15 offset:8712
    v_mfma_f32_16x16x32_bf16 a[56:59], v[36:39], v[64:67], a[56:59]
    v_mfma_f32_16x16x32_bf16 a[96:99], v[40:43], v[64:67], a[96:99]
    v_mfma_f32_16x16x32_bf16 a[136:139], v[44:47], v[64:67], a[136:139]
    s_mov_b32 s29, 296960
    buffer_load_dwordx4 v[220:223], v2, s[16:19], s29 offen offset:3072
    v_mfma_f32_16x16x32_bf16 a[20:23], v[32:35], v[68:71], a[20:23]
    v_mfma_f32_16x16x32_bf16 a[60:63], v[36:39], v[68:71], a[60:63]
    v_mfma_f32_16x16x32_bf16 a[100:103], v[40:43], v[68:71], a[100:103]
    s_mov_b32 s29, 296960
    buffer_load_dwordx4 v[224:227], v3, s[16:19], s29 offen offset:0
    v_mfma_f32_16x16x32_bf16 a[140:143], v[44:47], v[68:71], a[140:143]
    v_mfma_f32_16x16x32_bf16 a[24:27], v[32:35], v[72:75], a[24:27]
    s_mov_b32 s29, 296960
    buffer_load_dwordx4 v[228:231], v3, s[16:19], s29 offen offset:1024
    v_mfma_f32_16x16x32_bf16 a[64:67], v[36:39], v[72:75], a[64:67]
    v_mfma_f32_16x16x32_bf16 a[104:107], v[40:43], v[72:75], a[104:107]
    v_mfma_f32_16x16x32_bf16 a[144:147], v[44:47], v[72:75], a[144:147]
    s_mov_b32 s29, 296960
    buffer_load_dwordx4 v[232:235], v3, s[16:19], s29 offen offset:2048
    v_mfma_f32_16x16x32_bf16 a[28:31], v[32:35], v[76:79], a[28:31]
    v_mfma_f32_16x16x32_bf16 a[68:71], v[36:39], v[76:79], a[68:71]
    v_mfma_f32_16x16x32_bf16 a[108:111], v[40:43], v[76:79], a[108:111]
    s_mov_b32 s29, 296960
    buffer_load_dwordx4 v[236:239], v3, s[16:19], s29 offen offset:3072
    v_mfma_f32_16x16x32_bf16 a[148:151], v[44:47], v[76:79], a[148:151]
    v_mfma_f32_16x16x32_bf16 a[32:35], v[32:35], v[80:83], a[32:35]
    s_mov_b32 s29, 296960
    buffer_load_dwordx4 v[240:243], v4, s[16:19], s29 offen offset:0
    v_mfma_f32_16x16x32_bf16 a[72:75], v[36:39], v[80:83], a[72:75]
    v_mfma_f32_16x16x32_bf16 a[112:115], v[40:43], v[80:83], a[112:115]
    v_mfma_f32_16x16x32_bf16 a[152:155], v[44:47], v[80:83], a[152:155]
    s_mov_b32 s29, 296960
    buffer_load_dwordx4 v[244:247], v4, s[16:19], s29 offen offset:1024
    v_mfma_f32_16x16x32_bf16 a[36:39], v[32:35], v[84:87], a[36:39]
    v_mfma_f32_16x16x32_bf16 a[76:79], v[36:39], v[84:87], a[76:79]
    v_mfma_f32_16x16x32_bf16 a[116:119], v[40:43], v[84:87], a[116:119]
    v_mfma_f32_16x16x32_bf16 a[156:159], v[44:47], v[84:87], a[156:159]
    s_waitcnt vmcnt(38)
    s_waitcnt lgkmcnt(0)
    v_mfma_f32_16x16x32_bf16 a[0:3], v[16:19], v[88:91], a[0:3]
    v_mfma_f32_16x16x32_bf16 a[40:43], v[20:23], v[88:91], a[40:43]
    s_add_u32 m0, s25, 8192
    s_mov_b32 s30, 122880
    buffer_load_dwordx4 v12, s[12:15], s30 offen offset:0 lds
    v_mfma_f32_16x16x32_bf16 a[80:83], v[24:27], v[88:91], a[80:83]
    ds_read_b64_tr_b16 v[32:33], v14 offset:12288
    v_mfma_f32_16x16x32_bf16 a[120:123], v[28:31], v[88:91], a[120:123]
    buffer_load_dwordx4 v12, s[12:15], s30 offen offset:1024 lds
    v_mfma_f32_16x16x32_bf16 a[4:7], v[16:19], v[92:95], a[4:7]
    ds_read_b64_tr_b16 v[34:35], v14 offset:12800
    v_mfma_f32_16x16x32_bf16 a[44:47], v[20:23], v[92:95], a[44:47]
    v_mfma_f32_16x16x32_bf16 a[84:87], v[24:27], v[92:95], a[84:87]
    buffer_load_dwordx4 v12, s[12:15], s30 offen offset:2048 lds
    ds_read_b64_tr_b16 v[36:37], v14 offset:12296
    v_mfma_f32_16x16x32_bf16 a[124:127], v[28:31], v[92:95], a[124:127]
    v_mfma_f32_16x16x32_bf16 a[8:11], v[16:19], v[96:99], a[8:11]
    buffer_load_dwordx4 v12, s[12:15], s30 offen offset:3072 lds
    ds_read_b64_tr_b16 v[38:39], v14 offset:12808
    v_mfma_f32_16x16x32_bf16 a[48:51], v[20:23], v[96:99], a[48:51]
    v_mfma_f32_16x16x32_bf16 a[88:91], v[24:27], v[96:99], a[88:91]
    ds_read_b64_tr_b16 v[40:41], v15 offset:12288
    v_mfma_f32_16x16x32_bf16 a[128:131], v[28:31], v[96:99], a[128:131]
    s_mov_b32 s29, 307200
    buffer_load_dwordx4 v[48:51], v2, s[16:19], s29 offen offset:0
    v_mfma_f32_16x16x32_bf16 a[12:15], v[16:19], v[100:103], a[12:15]
    ds_read_b64_tr_b16 v[42:43], v15 offset:12800
    v_mfma_f32_16x16x32_bf16 a[52:55], v[20:23], v[100:103], a[52:55]
    v_mfma_f32_16x16x32_bf16 a[92:95], v[24:27], v[100:103], a[92:95]
    s_mov_b32 s29, 307200
    buffer_load_dwordx4 v[52:55], v2, s[16:19], s29 offen offset:1024
    ds_read_b64_tr_b16 v[44:45], v15 offset:12296
    v_mfma_f32_16x16x32_bf16 a[132:135], v[28:31], v[100:103], a[132:135]
    v_mfma_f32_16x16x32_bf16 a[16:19], v[16:19], v[104:107], a[16:19]
    s_mov_b32 s29, 307200
    buffer_load_dwordx4 v[56:59], v2, s[16:19], s29 offen offset:2048
    ds_read_b64_tr_b16 v[46:47], v15 offset:12808
    v_mfma_f32_16x16x32_bf16 a[56:59], v[20:23], v[104:107], a[56:59]
    v_mfma_f32_16x16x32_bf16 a[96:99], v[24:27], v[104:107], a[96:99]
    v_mfma_f32_16x16x32_bf16 a[136:139], v[28:31], v[104:107], a[136:139]
    s_mov_b32 s29, 307200
    buffer_load_dwordx4 v[60:63], v2, s[16:19], s29 offen offset:3072
    v_mfma_f32_16x16x32_bf16 a[20:23], v[16:19], v[108:111], a[20:23]
    v_mfma_f32_16x16x32_bf16 a[60:63], v[20:23], v[108:111], a[60:63]
    v_mfma_f32_16x16x32_bf16 a[100:103], v[24:27], v[108:111], a[100:103]
    s_mov_b32 s29, 307200
    buffer_load_dwordx4 v[64:67], v3, s[16:19], s29 offen offset:0
    v_mfma_f32_16x16x32_bf16 a[140:143], v[28:31], v[108:111], a[140:143]
    v_mfma_f32_16x16x32_bf16 a[24:27], v[16:19], v[112:115], a[24:27]
    s_mov_b32 s29, 307200
    buffer_load_dwordx4 v[68:71], v3, s[16:19], s29 offen offset:1024
    v_mfma_f32_16x16x32_bf16 a[64:67], v[20:23], v[112:115], a[64:67]
    v_mfma_f32_16x16x32_bf16 a[104:107], v[24:27], v[112:115], a[104:107]
    v_mfma_f32_16x16x32_bf16 a[144:147], v[28:31], v[112:115], a[144:147]
    s_mov_b32 s29, 307200
    buffer_load_dwordx4 v[72:75], v3, s[16:19], s29 offen offset:2048
    v_mfma_f32_16x16x32_bf16 a[28:31], v[16:19], v[116:119], a[28:31]
    v_mfma_f32_16x16x32_bf16 a[68:71], v[20:23], v[116:119], a[68:71]
    v_mfma_f32_16x16x32_bf16 a[108:111], v[24:27], v[116:119], a[108:111]
    s_mov_b32 s29, 307200
    buffer_load_dwordx4 v[76:79], v3, s[16:19], s29 offen offset:3072
    v_mfma_f32_16x16x32_bf16 a[148:151], v[28:31], v[116:119], a[148:151]
    v_mfma_f32_16x16x32_bf16 a[32:35], v[16:19], v[120:123], a[32:35]
    s_mov_b32 s29, 307200
    buffer_load_dwordx4 v[80:83], v4, s[16:19], s29 offen offset:0
    v_mfma_f32_16x16x32_bf16 a[72:75], v[20:23], v[120:123], a[72:75]
    v_mfma_f32_16x16x32_bf16 a[112:115], v[24:27], v[120:123], a[112:115]
    v_mfma_f32_16x16x32_bf16 a[152:155], v[28:31], v[120:123], a[152:155]
    s_mov_b32 s29, 307200
    buffer_load_dwordx4 v[84:87], v4, s[16:19], s29 offen offset:1024
    v_mfma_f32_16x16x32_bf16 a[36:39], v[16:19], v[124:127], a[36:39]
    v_mfma_f32_16x16x32_bf16 a[76:79], v[20:23], v[124:127], a[76:79]
    v_mfma_f32_16x16x32_bf16 a[116:119], v[24:27], v[124:127], a[116:119]
    v_mfma_f32_16x16x32_bf16 a[156:159], v[28:31], v[124:127], a[156:159]
    s_waitcnt vmcnt(38)
    s_waitcnt lgkmcnt(0)
    v_mfma_f32_16x16x32_bf16 a[0:3], v[32:35], v[128:131], a[0:3]
    v_mfma_f32_16x16x32_bf16 a[40:43], v[36:39], v[128:131], a[40:43]
    s_add_u32 m0, s25, 12288
    s_mov_b32 s30, 126976
    buffer_load_dwordx4 v12, s[12:15], s30 offen offset:0 lds
    v_mfma_f32_16x16x32_bf16 a[80:83], v[40:43], v[128:131], a[80:83]
    ds_read_b64_tr_b16 v[16:17], v14 offset:0
    v_mfma_f32_16x16x32_bf16 a[120:123], v[44:47], v[128:131], a[120:123]
    buffer_load_dwordx4 v12, s[12:15], s30 offen offset:1024 lds
    v_mfma_f32_16x16x32_bf16 a[4:7], v[32:35], v[132:135], a[4:7]
    ds_read_b64_tr_b16 v[18:19], v14 offset:512
    v_mfma_f32_16x16x32_bf16 a[44:47], v[36:39], v[132:135], a[44:47]
    v_mfma_f32_16x16x32_bf16 a[84:87], v[40:43], v[132:135], a[84:87]
    buffer_load_dwordx4 v12, s[12:15], s30 offen offset:2048 lds
    ds_read_b64_tr_b16 v[20:21], v14 offset:8
    v_mfma_f32_16x16x32_bf16 a[124:127], v[44:47], v[132:135], a[124:127]
    v_mfma_f32_16x16x32_bf16 a[8:11], v[32:35], v[136:139], a[8:11]
    buffer_load_dwordx4 v12, s[12:15], s30 offen offset:3072 lds
    ds_read_b64_tr_b16 v[22:23], v14 offset:520
    v_mfma_f32_16x16x32_bf16 a[48:51], v[36:39], v[136:139], a[48:51]
    v_mfma_f32_16x16x32_bf16 a[88:91], v[40:43], v[136:139], a[88:91]
    ds_read_b64_tr_b16 v[24:25], v15 offset:0
    v_mfma_f32_16x16x32_bf16 a[128:131], v[44:47], v[136:139], a[128:131]
    s_mov_b32 s29, 317440
    buffer_load_dwordx4 v[88:91], v2, s[16:19], s29 offen offset:0
    v_mfma_f32_16x16x32_bf16 a[12:15], v[32:35], v[140:143], a[12:15]
    ds_read_b64_tr_b16 v[26:27], v15 offset:512
    v_mfma_f32_16x16x32_bf16 a[52:55], v[36:39], v[140:143], a[52:55]
    v_mfma_f32_16x16x32_bf16 a[92:95], v[40:43], v[140:143], a[92:95]
    s_mov_b32 s29, 317440
    buffer_load_dwordx4 v[92:95], v2, s[16:19], s29 offen offset:1024
    ds_read_b64_tr_b16 v[28:29], v15 offset:8
    v_mfma_f32_16x16x32_bf16 a[132:135], v[44:47], v[140:143], a[132:135]
    v_mfma_f32_16x16x32_bf16 a[16:19], v[32:35], v[144:147], a[16:19]
    s_mov_b32 s29, 317440
    buffer_load_dwordx4 v[96:99], v2, s[16:19], s29 offen offset:2048
    ds_read_b64_tr_b16 v[30:31], v15 offset:520
    v_mfma_f32_16x16x32_bf16 a[56:59], v[36:39], v[144:147], a[56:59]
    v_mfma_f32_16x16x32_bf16 a[96:99], v[40:43], v[144:147], a[96:99]
    v_mfma_f32_16x16x32_bf16 a[136:139], v[44:47], v[144:147], a[136:139]
    s_mov_b32 s29, 317440
    buffer_load_dwordx4 v[100:103], v2, s[16:19], s29 offen offset:3072
    v_mfma_f32_16x16x32_bf16 a[20:23], v[32:35], v[148:151], a[20:23]
    v_mfma_f32_16x16x32_bf16 a[60:63], v[36:39], v[148:151], a[60:63]
    v_mfma_f32_16x16x32_bf16 a[100:103], v[40:43], v[148:151], a[100:103]
    s_mov_b32 s29, 317440
    buffer_load_dwordx4 v[104:107], v3, s[16:19], s29 offen offset:0
    v_mfma_f32_16x16x32_bf16 a[140:143], v[44:47], v[148:151], a[140:143]
    v_mfma_f32_16x16x32_bf16 a[24:27], v[32:35], v[152:155], a[24:27]
    s_mov_b32 s29, 317440
    buffer_load_dwordx4 v[108:111], v3, s[16:19], s29 offen offset:1024
    v_mfma_f32_16x16x32_bf16 a[64:67], v[36:39], v[152:155], a[64:67]
    v_mfma_f32_16x16x32_bf16 a[104:107], v[40:43], v[152:155], a[104:107]
    v_mfma_f32_16x16x32_bf16 a[144:147], v[44:47], v[152:155], a[144:147]
    s_mov_b32 s29, 317440
    buffer_load_dwordx4 v[112:115], v3, s[16:19], s29 offen offset:2048
    v_mfma_f32_16x16x32_bf16 a[28:31], v[32:35], v[156:159], a[28:31]
    v_mfma_f32_16x16x32_bf16 a[68:71], v[36:39], v[156:159], a[68:71]
    v_mfma_f32_16x16x32_bf16 a[108:111], v[40:43], v[156:159], a[108:111]
    s_mov_b32 s29, 317440
    buffer_load_dwordx4 v[116:119], v3, s[16:19], s29 offen offset:3072
    v_mfma_f32_16x16x32_bf16 a[148:151], v[44:47], v[156:159], a[148:151]
    v_mfma_f32_16x16x32_bf16 a[32:35], v[32:35], v[160:163], a[32:35]
    s_mov_b32 s29, 317440
    buffer_load_dwordx4 v[120:123], v4, s[16:19], s29 offen offset:0
    v_mfma_f32_16x16x32_bf16 a[72:75], v[36:39], v[160:163], a[72:75]
    v_mfma_f32_16x16x32_bf16 a[112:115], v[40:43], v[160:163], a[112:115]
    v_mfma_f32_16x16x32_bf16 a[152:155], v[44:47], v[160:163], a[152:155]
    s_mov_b32 s29, 317440
    buffer_load_dwordx4 v[124:127], v4, s[16:19], s29 offen offset:1024
    v_mfma_f32_16x16x32_bf16 a[36:39], v[32:35], v[164:167], a[36:39]
    v_mfma_f32_16x16x32_bf16 a[76:79], v[36:39], v[164:167], a[76:79]
    v_mfma_f32_16x16x32_bf16 a[116:119], v[40:43], v[164:167], a[116:119]
    v_mfma_f32_16x16x32_bf16 a[156:159], v[44:47], v[164:167], a[156:159]
    s_waitcnt vmcnt(38)
    s_waitcnt lgkmcnt(0)
    v_mfma_f32_16x16x32_bf16 a[0:3], v[16:19], v[168:171], a[0:3]
    v_mfma_f32_16x16x32_bf16 a[40:43], v[20:23], v[168:171], a[40:43]
    v_mfma_f32_16x16x32_bf16 a[80:83], v[24:27], v[168:171], a[80:83]
    ds_read_b64_tr_b16 v[32:33], v14 offset:4096
    v_mfma_f32_16x16x32_bf16 a[120:123], v[28:31], v[168:171], a[120:123]
    v_mfma_f32_16x16x32_bf16 a[4:7], v[16:19], v[172:175], a[4:7]
    ds_read_b64_tr_b16 v[34:35], v14 offset:4608
    v_mfma_f32_16x16x32_bf16 a[44:47], v[20:23], v[172:175], a[44:47]
    v_mfma_f32_16x16x32_bf16 a[84:87], v[24:27], v[172:175], a[84:87]
    ds_read_b64_tr_b16 v[36:37], v14 offset:4104
    v_mfma_f32_16x16x32_bf16 a[124:127], v[28:31], v[172:175], a[124:127]
    v_mfma_f32_16x16x32_bf16 a[8:11], v[16:19], v[176:179], a[8:11]
    ds_read_b64_tr_b16 v[38:39], v14 offset:4616
    v_mfma_f32_16x16x32_bf16 a[48:51], v[20:23], v[176:179], a[48:51]
    v_mfma_f32_16x16x32_bf16 a[88:91], v[24:27], v[176:179], a[88:91]
    ds_read_b64_tr_b16 v[40:41], v15 offset:4096
    v_mfma_f32_16x16x32_bf16 a[128:131], v[28:31], v[176:179], a[128:131]
    v_mfma_f32_16x16x32_bf16 a[12:15], v[16:19], v[180:183], a[12:15]
    ds_read_b64_tr_b16 v[42:43], v15 offset:4608
    v_mfma_f32_16x16x32_bf16 a[52:55], v[20:23], v[180:183], a[52:55]
    v_mfma_f32_16x16x32_bf16 a[92:95], v[24:27], v[180:183], a[92:95]
    ds_read_b64_tr_b16 v[44:45], v15 offset:4104
    v_mfma_f32_16x16x32_bf16 a[132:135], v[28:31], v[180:183], a[132:135]
    v_mfma_f32_16x16x32_bf16 a[16:19], v[16:19], v[184:187], a[16:19]
    ds_read_b64_tr_b16 v[46:47], v15 offset:4616
    v_mfma_f32_16x16x32_bf16 a[56:59], v[20:23], v[184:187], a[56:59]
    v_mfma_f32_16x16x32_bf16 a[96:99], v[24:27], v[184:187], a[96:99]
    v_mfma_f32_16x16x32_bf16 a[136:139], v[28:31], v[184:187], a[136:139]
    v_mfma_f32_16x16x32_bf16 a[20:23], v[16:19], v[188:191], a[20:23]
    v_mfma_f32_16x16x32_bf16 a[60:63], v[20:23], v[188:191], a[60:63]
    v_mfma_f32_16x16x32_bf16 a[100:103], v[24:27], v[188:191], a[100:103]
    v_mfma_f32_16x16x32_bf16 a[140:143], v[28:31], v[188:191], a[140:143]
    v_mfma_f32_16x16x32_bf16 a[24:27], v[16:19], v[192:195], a[24:27]
    v_mfma_f32_16x16x32_bf16 a[64:67], v[20:23], v[192:195], a[64:67]
    v_mfma_f32_16x16x32_bf16 a[104:107], v[24:27], v[192:195], a[104:107]
    v_mfma_f32_16x16x32_bf16 a[144:147], v[28:31], v[192:195], a[144:147]
    v_mfma_f32_16x16x32_bf16 a[28:31], v[16:19], v[196:199], a[28:31]
    v_mfma_f32_16x16x32_bf16 a[68:71], v[20:23], v[196:199], a[68:71]
    v_mfma_f32_16x16x32_bf16 a[108:111], v[24:27], v[196:199], a[108:111]
    v_mfma_f32_16x16x32_bf16 a[148:151], v[28:31], v[196:199], a[148:151]
    v_mfma_f32_16x16x32_bf16 a[32:35], v[16:19], v[200:203], a[32:35]
    v_mfma_f32_16x16x32_bf16 a[72:75], v[20:23], v[200:203], a[72:75]
    v_mfma_f32_16x16x32_bf16 a[112:115], v[24:27], v[200:203], a[112:115]
    v_mfma_f32_16x16x32_bf16 a[152:155], v[28:31], v[200:203], a[152:155]
    v_mfma_f32_16x16x32_bf16 a[36:39], v[16:19], v[204:207], a[36:39]
    v_mfma_f32_16x16x32_bf16 a[76:79], v[20:23], v[204:207], a[76:79]
    v_mfma_f32_16x16x32_bf16 a[116:119], v[24:27], v[204:207], a[116:119]
    v_mfma_f32_16x16x32_bf16 a[156:159], v[28:31], v[204:207], a[156:159]
    s_waitcnt vmcnt(24)
    s_waitcnt lgkmcnt(0)
    v_mfma_f32_16x16x32_bf16 a[0:3], v[32:35], v[208:211], a[0:3]
    v_mfma_f32_16x16x32_bf16 a[40:43], v[36:39], v[208:211], a[40:43]
    v_mfma_f32_16x16x32_bf16 a[80:83], v[40:43], v[208:211], a[80:83]
    ds_read_b64_tr_b16 v[16:17], v14 offset:8192
    v_mfma_f32_16x16x32_bf16 a[120:123], v[44:47], v[208:211], a[120:123]
    v_mfma_f32_16x16x32_bf16 a[4:7], v[32:35], v[212:215], a[4:7]
    ds_read_b64_tr_b16 v[18:19], v14 offset:8704
    v_mfma_f32_16x16x32_bf16 a[44:47], v[36:39], v[212:215], a[44:47]
    v_mfma_f32_16x16x32_bf16 a[84:87], v[40:43], v[212:215], a[84:87]
    ds_read_b64_tr_b16 v[20:21], v14 offset:8200
    v_mfma_f32_16x16x32_bf16 a[124:127], v[44:47], v[212:215], a[124:127]
    v_mfma_f32_16x16x32_bf16 a[8:11], v[32:35], v[216:219], a[8:11]
    ds_read_b64_tr_b16 v[22:23], v14 offset:8712
    v_mfma_f32_16x16x32_bf16 a[48:51], v[36:39], v[216:219], a[48:51]
    v_mfma_f32_16x16x32_bf16 a[88:91], v[40:43], v[216:219], a[88:91]
    ds_read_b64_tr_b16 v[24:25], v15 offset:8192
    v_mfma_f32_16x16x32_bf16 a[128:131], v[44:47], v[216:219], a[128:131]
    v_mfma_f32_16x16x32_bf16 a[12:15], v[32:35], v[220:223], a[12:15]
    ds_read_b64_tr_b16 v[26:27], v15 offset:8704
    v_mfma_f32_16x16x32_bf16 a[52:55], v[36:39], v[220:223], a[52:55]
    v_mfma_f32_16x16x32_bf16 a[92:95], v[40:43], v[220:223], a[92:95]
    ds_read_b64_tr_b16 v[28:29], v15 offset:8200
    v_mfma_f32_16x16x32_bf16 a[132:135], v[44:47], v[220:223], a[132:135]
    v_mfma_f32_16x16x32_bf16 a[16:19], v[32:35], v[224:227], a[16:19]
    ds_read_b64_tr_b16 v[30:31], v15 offset:8712
    v_mfma_f32_16x16x32_bf16 a[56:59], v[36:39], v[224:227], a[56:59]
    v_mfma_f32_16x16x32_bf16 a[96:99], v[40:43], v[224:227], a[96:99]
    v_mfma_f32_16x16x32_bf16 a[136:139], v[44:47], v[224:227], a[136:139]
    v_mfma_f32_16x16x32_bf16 a[20:23], v[32:35], v[228:231], a[20:23]
    v_mfma_f32_16x16x32_bf16 a[60:63], v[36:39], v[228:231], a[60:63]
    v_mfma_f32_16x16x32_bf16 a[100:103], v[40:43], v[228:231], a[100:103]
    v_mfma_f32_16x16x32_bf16 a[140:143], v[44:47], v[228:231], a[140:143]
    v_mfma_f32_16x16x32_bf16 a[24:27], v[32:35], v[232:235], a[24:27]
    v_mfma_f32_16x16x32_bf16 a[64:67], v[36:39], v[232:235], a[64:67]
    v_mfma_f32_16x16x32_bf16 a[104:107], v[40:43], v[232:235], a[104:107]
    v_mfma_f32_16x16x32_bf16 a[144:147], v[44:47], v[232:235], a[144:147]
    v_mfma_f32_16x16x32_bf16 a[28:31], v[32:35], v[236:239], a[28:31]
    v_mfma_f32_16x16x32_bf16 a[68:71], v[36:39], v[236:239], a[68:71]
    v_mfma_f32_16x16x32_bf16 a[108:111], v[40:43], v[236:239], a[108:111]
    v_mfma_f32_16x16x32_bf16 a[148:151], v[44:47], v[236:239], a[148:151]
    v_mfma_f32_16x16x32_bf16 a[32:35], v[32:35], v[240:243], a[32:35]
    v_mfma_f32_16x16x32_bf16 a[72:75], v[36:39], v[240:243], a[72:75]
    v_mfma_f32_16x16x32_bf16 a[112:115], v[40:43], v[240:243], a[112:115]
    v_mfma_f32_16x16x32_bf16 a[152:155], v[44:47], v[240:243], a[152:155]
    v_mfma_f32_16x16x32_bf16 a[36:39], v[32:35], v[244:247], a[36:39]
    v_mfma_f32_16x16x32_bf16 a[76:79], v[36:39], v[244:247], a[76:79]
    v_mfma_f32_16x16x32_bf16 a[116:119], v[40:43], v[244:247], a[116:119]
    v_mfma_f32_16x16x32_bf16 a[156:159], v[44:47], v[244:247], a[156:159]
    s_waitcnt vmcnt(10)
    s_waitcnt lgkmcnt(0)
    v_mfma_f32_16x16x32_bf16 a[0:3], v[16:19], v[48:51], a[0:3]
    v_mfma_f32_16x16x32_bf16 a[40:43], v[20:23], v[48:51], a[40:43]
    v_mfma_f32_16x16x32_bf16 a[80:83], v[24:27], v[48:51], a[80:83]
    ds_read_b64_tr_b16 v[32:33], v14 offset:12288
    v_mfma_f32_16x16x32_bf16 a[120:123], v[28:31], v[48:51], a[120:123]
    v_mfma_f32_16x16x32_bf16 a[4:7], v[16:19], v[52:55], a[4:7]
    ds_read_b64_tr_b16 v[34:35], v14 offset:12800
    v_mfma_f32_16x16x32_bf16 a[44:47], v[20:23], v[52:55], a[44:47]
    v_mfma_f32_16x16x32_bf16 a[84:87], v[24:27], v[52:55], a[84:87]
    ds_read_b64_tr_b16 v[36:37], v14 offset:12296
    v_mfma_f32_16x16x32_bf16 a[124:127], v[28:31], v[52:55], a[124:127]
    v_mfma_f32_16x16x32_bf16 a[8:11], v[16:19], v[56:59], a[8:11]
    ds_read_b64_tr_b16 v[38:39], v14 offset:12808
    v_mfma_f32_16x16x32_bf16 a[48:51], v[20:23], v[56:59], a[48:51]
    v_mfma_f32_16x16x32_bf16 a[88:91], v[24:27], v[56:59], a[88:91]
    ds_read_b64_tr_b16 v[40:41], v15 offset:12288
    v_mfma_f32_16x16x32_bf16 a[128:131], v[28:31], v[56:59], a[128:131]
    v_mfma_f32_16x16x32_bf16 a[12:15], v[16:19], v[60:63], a[12:15]
    ds_read_b64_tr_b16 v[42:43], v15 offset:12800
    v_mfma_f32_16x16x32_bf16 a[52:55], v[20:23], v[60:63], a[52:55]
    v_mfma_f32_16x16x32_bf16 a[92:95], v[24:27], v[60:63], a[92:95]
    ds_read_b64_tr_b16 v[44:45], v15 offset:12296
    v_mfma_f32_16x16x32_bf16 a[132:135], v[28:31], v[60:63], a[132:135]
    v_mfma_f32_16x16x32_bf16 a[16:19], v[16:19], v[64:67], a[16:19]
    ds_read_b64_tr_b16 v[46:47], v15 offset:12808
    v_mfma_f32_16x16x32_bf16 a[56:59], v[20:23], v[64:67], a[56:59]
    v_mfma_f32_16x16x32_bf16 a[96:99], v[24:27], v[64:67], a[96:99]
    v_mfma_f32_16x16x32_bf16 a[136:139], v[28:31], v[64:67], a[136:139]
    v_mfma_f32_16x16x32_bf16 a[20:23], v[16:19], v[68:71], a[20:23]
    v_mfma_f32_16x16x32_bf16 a[60:63], v[20:23], v[68:71], a[60:63]
    v_mfma_f32_16x16x32_bf16 a[100:103], v[24:27], v[68:71], a[100:103]
    v_mfma_f32_16x16x32_bf16 a[140:143], v[28:31], v[68:71], a[140:143]
    v_mfma_f32_16x16x32_bf16 a[24:27], v[16:19], v[72:75], a[24:27]
    v_mfma_f32_16x16x32_bf16 a[64:67], v[20:23], v[72:75], a[64:67]
    v_mfma_f32_16x16x32_bf16 a[104:107], v[24:27], v[72:75], a[104:107]
    v_mfma_f32_16x16x32_bf16 a[144:147], v[28:31], v[72:75], a[144:147]
    v_mfma_f32_16x16x32_bf16 a[28:31], v[16:19], v[76:79], a[28:31]
    v_mfma_f32_16x16x32_bf16 a[68:71], v[20:23], v[76:79], a[68:71]
    v_mfma_f32_16x16x32_bf16 a[108:111], v[24:27], v[76:79], a[108:111]
    v_mfma_f32_16x16x32_bf16 a[148:151], v[28:31], v[76:79], a[148:151]
    v_mfma_f32_16x16x32_bf16 a[32:35], v[16:19], v[80:83], a[32:35]
    v_mfma_f32_16x16x32_bf16 a[72:75], v[20:23], v[80:83], a[72:75]
    v_mfma_f32_16x16x32_bf16 a[112:115], v[24:27], v[80:83], a[112:115]
    v_mfma_f32_16x16x32_bf16 a[152:155], v[28:31], v[80:83], a[152:155]
    v_mfma_f32_16x16x32_bf16 a[36:39], v[16:19], v[84:87], a[36:39]
    v_mfma_f32_16x16x32_bf16 a[76:79], v[20:23], v[84:87], a[76:79]
    v_mfma_f32_16x16x32_bf16 a[116:119], v[24:27], v[84:87], a[116:119]
    v_mfma_f32_16x16x32_bf16 a[156:159], v[28:31], v[84:87], a[156:159]
    s_waitcnt lgkmcnt(0)
    s_waitcnt vmcnt(9)
    v_mfma_f32_16x16x32_bf16 a[0:3], v[32:35], v[88:91], a[0:3]
    v_mfma_f32_16x16x32_bf16 a[40:43], v[36:39], v[88:91], a[40:43]
    v_mfma_f32_16x16x32_bf16 a[80:83], v[40:43], v[88:91], a[80:83]
    v_mfma_f32_16x16x32_bf16 a[120:123], v[44:47], v[88:91], a[120:123]
    s_waitcnt vmcnt(8)
    v_mfma_f32_16x16x32_bf16 a[4:7], v[32:35], v[92:95], a[4:7]
    v_mfma_f32_16x16x32_bf16 a[44:47], v[36:39], v[92:95], a[44:47]
    v_mfma_f32_16x16x32_bf16 a[84:87], v[40:43], v[92:95], a[84:87]
    v_mfma_f32_16x16x32_bf16 a[124:127], v[44:47], v[92:95], a[124:127]
    s_waitcnt vmcnt(7)
    v_mfma_f32_16x16x32_bf16 a[8:11], v[32:35], v[96:99], a[8:11]
    v_mfma_f32_16x16x32_bf16 a[48:51], v[36:39], v[96:99], a[48:51]
    v_mfma_f32_16x16x32_bf16 a[88:91], v[40:43], v[96:99], a[88:91]
    v_mfma_f32_16x16x32_bf16 a[128:131], v[44:47], v[96:99], a[128:131]
    s_waitcnt vmcnt(6)
    v_mfma_f32_16x16x32_bf16 a[12:15], v[32:35], v[100:103], a[12:15]
    v_mfma_f32_16x16x32_bf16 a[52:55], v[36:39], v[100:103], a[52:55]
    v_mfma_f32_16x16x32_bf16 a[92:95], v[40:43], v[100:103], a[92:95]
    v_mfma_f32_16x16x32_bf16 a[132:135], v[44:47], v[100:103], a[132:135]
    s_waitcnt vmcnt(5)
    v_mfma_f32_16x16x32_bf16 a[16:19], v[32:35], v[104:107], a[16:19]
    v_mfma_f32_16x16x32_bf16 a[56:59], v[36:39], v[104:107], a[56:59]
    v_mfma_f32_16x16x32_bf16 a[96:99], v[40:43], v[104:107], a[96:99]
    v_mfma_f32_16x16x32_bf16 a[136:139], v[44:47], v[104:107], a[136:139]
    s_waitcnt vmcnt(4)
    v_mfma_f32_16x16x32_bf16 a[20:23], v[32:35], v[108:111], a[20:23]
    v_mfma_f32_16x16x32_bf16 a[60:63], v[36:39], v[108:111], a[60:63]
    v_mfma_f32_16x16x32_bf16 a[100:103], v[40:43], v[108:111], a[100:103]
    v_mfma_f32_16x16x32_bf16 a[140:143], v[44:47], v[108:111], a[140:143]
    s_waitcnt vmcnt(3)
    v_mfma_f32_16x16x32_bf16 a[24:27], v[32:35], v[112:115], a[24:27]
    v_mfma_f32_16x16x32_bf16 a[64:67], v[36:39], v[112:115], a[64:67]
    v_mfma_f32_16x16x32_bf16 a[104:107], v[40:43], v[112:115], a[104:107]
    v_mfma_f32_16x16x32_bf16 a[144:147], v[44:47], v[112:115], a[144:147]
    s_waitcnt vmcnt(2)
    v_mfma_f32_16x16x32_bf16 a[28:31], v[32:35], v[116:119], a[28:31]
    v_mfma_f32_16x16x32_bf16 a[68:71], v[36:39], v[116:119], a[68:71]
    v_mfma_f32_16x16x32_bf16 a[108:111], v[40:43], v[116:119], a[108:111]
    v_mfma_f32_16x16x32_bf16 a[148:151], v[44:47], v[116:119], a[148:151]
    s_waitcnt vmcnt(1)
    v_mfma_f32_16x16x32_bf16 a[32:35], v[32:35], v[120:123], a[32:35]
    v_mfma_f32_16x16x32_bf16 a[72:75], v[36:39], v[120:123], a[72:75]
    v_mfma_f32_16x16x32_bf16 a[112:115], v[40:43], v[120:123], a[112:115]
    v_mfma_f32_16x16x32_bf16 a[152:155], v[44:47], v[120:123], a[152:155]
    s_waitcnt vmcnt(0)
    v_mfma_f32_16x16x32_bf16 a[36:39], v[32:35], v[124:127], a[36:39]
    v_mfma_f32_16x16x32_bf16 a[76:79], v[36:39], v[124:127], a[76:79]
    v_mfma_f32_16x16x32_bf16 a[116:119], v[40:43], v[124:127], a[116:119]
    v_mfma_f32_16x16x32_bf16 a[156:159], v[44:47], v[124:127], a[156:159]
    s_nop 15
    s_waitcnt vmcnt(0) lgkmcnt(0)
    s_barrier
    v_add_u32 v100, 0, v248
    v_add_u32 v101, 32768, v248
    v_add_u32 v102, 65536, v248
    v_add_u32 v103, 98304, v248
    v_add_u32 v104, 131072, v248
    v_add_u32 v105, 163840, v248
    v_add_u32 v106, 196608, v248
    v_add_u32 v107, 229376, v248
    v_add_u32 v108, 262144, v248
    v_add_u32 v109, 294912, v248
K2_W1:
    s_add_u32 s27, s24, 1
    s_and_b32 s27, s27, 3
    s_mul_i32 s28, s27, 30720
    s_add_u32 s28, s28, 20480
    v_add_u32 v250, s28, v249
    s_cmp_lg_u32 s27, 0
    s_cbranch_scc1 K2_W1_0
    ds_write_b128 v250, a[0:3] offset:0
    ds_write_b128 v250, a[4:7] offset:1024
    ds_write_b128 v250, a[8:11] offset:2048
    ds_write_b128 v250, a[12:15] offset:3072
    ds_write_b128 v250, a[16:19] offset:4096
    ds_write_b128 v250, a[20:23] offset:5120
    ds_write_b128 v250, a[24:27] offset:6144
    ds_write_b128 v250, a[28:31] offset:7168
    ds_write_b128 v250, a[32:35] offset:8192
    ds_write_b128 v250, a[36:39] offset:9216
K2_W1_0:
    s_cmp_lg_u32 s27, 1
    s_cbranch_scc1 K2_W1_1
    ds_write_b128 v250, a[40:43] offset:0
    ds_write_b128 v250, a[44:47] offset:1024
    ds_write_b128 v250, a[48:51] offset:2048
    ds_write_b128 v250, a[52:55] offset:3072
    ds_write_b128 v250, a[56:59] offset:4096
    ds_write_b128 v250, a[60:63] offset:5120
    ds_write_b128 v250, a[64:67] offset:6144
    ds_write_b128 v250, a[68:71] offset:7168
    ds_write_b128 v250, a[72:75] offset:8192
    ds_write_b128 v250, a[76:79] offset:9216
K2_W1_1:
    s_cmp_lg_u32 s27, 2
    s_cbranch_scc1 K2_W1_2
    ds_write_b128 v250, a[80:83] offset:0
    ds_write_b128 v250, a[84:87] offset:1024
    ds_write_b128 v250, a[88:91] offset:2048
    ds_write_b128 v250, a[92:95] offset:3072
    ds_write_b128 v250, a[96:99] offset:4096
    ds_write_b128 v250, a[100:103] offset:5120
    ds_write_b128 v250, a[104:107] offset:6144
    ds_write_b128 v250, a[108:111] offset:7168
    ds_write_b128 v250, a[112:115] offset:8192
    ds_write_b128 v250, a[116:119] offset:9216
K2_W1_2:
    s_cmp_lg_u32 s27, 3
    s_cbranch_scc1 K2_W1_3
    ds_write_b128 v250, a[120:123] offset:0
    ds_write_b128 v250, a[124:127] offset:1024
    ds_write_b128 v250, a[128:131] offset:2048
    ds_write_b128 v250, a[132:135] offset:3072
    ds_write_b128 v250, a[136:139] offset:4096
    ds_write_b128 v250, a[140:143] offset:5120
    ds_write_b128 v250, a[144:147] offset:6144
    ds_write_b128 v250, a[148:151] offset:7168
    ds_write_b128 v250, a[152:155] offset:8192
    ds_write_b128 v250, a[156:159] offset:9216
K2_W1_3:
K2_W2:
    s_add_u32 s27, s24, 2
    s_and_b32 s27, s27, 3
    s_mul_i32 s28, s27, 30720
    s_add_u32 s28, s28, 10240
    v_add_u32 v250, s28, v249
    s_cmp_lg_u32 s27, 0
    s_cbranch_scc1 K2_W2_0
    ds_write_b128 v250, a[0:3] offset:0
    ds_write_b128 v250, a[4:7] offset:1024
    ds_write_b128 v250, a[8:11] offset:2048
    ds_write_b128 v250, a[12:15] offset:3072
    ds_write_b128 v250, a[16:19] offset:4096
    ds_write_b128 v250, a[20:23] offset:5120
    ds_write_b128 v250, a[24:27] offset:6144
    ds_write_b128 v250, a[28:31] offset:7168
    ds_write_b128 v250, a[32:35] offset:8192
    ds_write_b128 v250, a[36:39] offset:9216
K2_W2_0:
    s_cmp_lg_u32 s27, 1
    s_cbranch_scc1 K2_W2_1
    ds_write_b128 v250, a[40:43] offset:0
    ds_write_b128 v250, a[44:47] offset:1024
    ds_write_b128 v250, a[48:51] offset:2048
    ds_write_b128 v250, a[52:55] offset:3072
    ds_write_b128 v250, a[56:59] offset:4096
    ds_write_b128 v250, a[60:63] offset:5120
    ds_write_b128 v250, a[64:67] offset:6144
    ds_write_b128 v250, a[68:71] offset:7168
    ds_write_b128 v250, a[72:75] offset:8192
    ds_write_b128 v250, a[76:79] offset:9216
K2_W2_1:
    s_cmp_lg_u32 s27, 2
    s_cbranch_scc1 K2_W2_2
    ds_write_b128 v250, a[80:83] offset:0
    ds_write_b128 v250, a[84:87] offset:1024
    ds_write_b128 v250, a[88:91] offset:2048
    ds_write_b128 v250, a[92:95] offset:3072
    ds_write_b128 v250, a[96:99] offset:4096
    ds_write_b128 v250, a[100:103] offset:5120
    ds_write_b128 v250, a[104:107] offset:6144
    ds_write_b128 v250, a[108:111] offset:7168
    ds_write_b128 v250, a[112:115] offset:8192
    ds_write_b128 v250, a[116:119] offset:9216
K2_W2_2:
    s_cmp_lg_u32 s27, 3
    s_cbranch_scc1 K2_W2_3
    ds_write_b128 v250, a[120:123] offset:0
    ds_write_b128 v250, a[124:127] offset:1024
    ds_write_b128 v250, a[128:131] offset:2048
    ds_write_b128 v250, a[132:135] offset:3072
    ds_write_b128 v250, a[136:139] offset:4096
    ds_write_b128 v250, a[140:143] offset:5120
    ds_write_b128 v250, a[144:147] offset:6144
    ds_write_b128 v250, a[148:151] offset:7168
    ds_write_b128 v250, a[152:155] offset:8192
    ds_write_b128 v250, a[156:159] offset:9216
K2_W2_3:
K2_W3:
    s_add_u32 s27, s24, 3
    s_and_b32 s27, s27, 3
    s_mul_i32 s28, s27, 30720
    s_add_u32 s28, s28, 0
    v_add_u32 v250, s28, v249
    s_cmp_lg_u32 s27, 0
    s_cbranch_scc1 K2_W3_0
    ds_write_b128 v250, a[0:3] offset:0
    ds_write_b128 v250, a[4:7] offset:1024
    ds_write_b128 v250, a[8:11] offset:2048
    ds_write_b128 v250, a[12:15] offset:3072
    ds_write_b128 v250, a[16:19] offset:4096
    ds_write_b128 v250, a[20:23] offset:5120
    ds_write_b128 v250, a[24:27] offset:6144
    ds_write_b128 v250, a[28:31] offset:7168
    ds_write_b128 v250, a[32:35] offset:8192
    ds_write_b128 v250, a[36:39] offset:9216
K2_W3_0:
    s_cmp_lg_u32 s27, 1
    s_cbranch_scc1 K2_W3_1
    ds_write_b128 v250, a[40:43] offset:0
    ds_write_b128 v250, a[44:47] offset:1024
    ds_write_b128 v250, a[48:51] offset:2048
    ds_write_b128 v250, a[52:55] offset:3072
    ds_write_b128 v250, a[56:59] offset:4096
    ds_write_b128 v250, a[60:63] offset:5120
    ds_write_b128 v250, a[64:67] offset:6144
    ds_write_b128 v250, a[68:71] offset:7168
    ds_write_b128 v250, a[72:75] offset:8192
    ds_write_b128 v250, a[76:79] offset:9216
K2_W3_1:
    s_cmp_lg_u32 s27, 2
    s_cbranch_scc1 K2_W3_2
    ds_write_b128 v250, a[80:83] offset:0
    ds_write_b128 v250, a[84:87] offset:1024
    ds_write_b128 v250, a[88:91] offset:2048
    ds_write_b128 v250, a[92:95] offset:3072
    ds_write_b128 v250, a[96:99] offset:4096
    ds_write_b128 v250, a[100:103] offset:5120
    ds_write_b128 v250, a[104:107] offset:6144
    ds_write_b128 v250, a[108:111] offset:7168
    ds_write_b128 v250, a[112:115] offset:8192
    ds_write_b128 v250, a[116:119] offset:9216
K2_W3_2:
    s_cmp_lg_u32 s27, 3
    s_cbranch_scc1 K2_W3_3
    ds_write_b128 v250, a[120:123] offset:0
    ds_write_b128 v250, a[124:127] offset:1024
    ds_write_b128 v250, a[128:131] offset:2048
    ds_write_b128 v250, a[132:135] offset:3072
    ds_write_b128 v250, a[136:139] offset:4096
    ds_write_b128 v250, a[140:143] offset:5120
    ds_write_b128 v250, a[144:147] offset:6144
    ds_write_b128 v250, a[148:151] offset:7168
    ds_write_b128 v250, a[152:155] offset:8192
    ds_write_b128 v250, a[156:159] offset:9216
K2_W3_3:
    s_waitcnt lgkmcnt(0)
    s_barrier
    s_mul_i32 s28, s24, 30720
    v_add_u32 v250, s28, v249
    s_cmp_lg_u32 s24, 0
    s_cbranch_scc1 K2_R0
    ds_read_b128 v[48:51], v250 offset:0
    ds_read_b128 v[52:55], v250 offset:10240
    ds_read_b128 v[56:59], v250 offset:20480
    v_accvgpr_read_b32 v60, a0
    v_accvgpr_read_b32 v61, a1
    v_accvgpr_read_b32 v62, a2
    v_accvgpr_read_b32 v63, a3
    s_waitcnt lgkmcnt(2)
    v_add_f32 v60, v60, v48
    v_add_f32 v61, v61, v49
    v_add_f32 v62, v62, v50
    v_add_f32 v63, v63, v51
    s_waitcnt lgkmcnt(1)
    v_add_f32 v60, v60, v52
    v_add_f32 v61, v61, v53
    v_add_f32 v62, v62, v54
    v_add_f32 v63, v63, v55
    s_waitcnt lgkmcnt(0)
    v_add_f32 v60, v60, v56
    v_add_f32 v61, v61, v57
    v_add_f32 v62, v62, v58
    v_add_f32 v63, v63, v59
    v_cvt_pk_bf16_f32 v64, v60, v61
    v_cvt_pk_bf16_f32 v65, v62, v63
    buffer_store_dwordx2 v[64:65], v100, s[20:23], 0 offen offset:0
    ds_read_b128 v[68:71], v250 offset:1024
    ds_read_b128 v[72:75], v250 offset:11264
    ds_read_b128 v[76:79], v250 offset:21504
    v_accvgpr_read_b32 v80, a4
    v_accvgpr_read_b32 v81, a5
    v_accvgpr_read_b32 v82, a6
    v_accvgpr_read_b32 v83, a7
    s_waitcnt lgkmcnt(2)
    v_add_f32 v80, v80, v68
    v_add_f32 v81, v81, v69
    v_add_f32 v82, v82, v70
    v_add_f32 v83, v83, v71
    s_waitcnt lgkmcnt(1)
    v_add_f32 v80, v80, v72
    v_add_f32 v81, v81, v73
    v_add_f32 v82, v82, v74
    v_add_f32 v83, v83, v75
    s_waitcnt lgkmcnt(0)
    v_add_f32 v80, v80, v76
    v_add_f32 v81, v81, v77
    v_add_f32 v82, v82, v78
    v_add_f32 v83, v83, v79
    v_cvt_pk_bf16_f32 v84, v80, v81
    v_cvt_pk_bf16_f32 v85, v82, v83
    buffer_store_dwordx2 v[84:85], v101, s[20:23], 0 offen offset:0
    ds_read_b128 v[48:51], v250 offset:2048
    ds_read_b128 v[52:55], v250 offset:12288
    ds_read_b128 v[56:59], v250 offset:22528
    v_accvgpr_read_b32 v60, a8
    v_accvgpr_read_b32 v61, a9
    v_accvgpr_read_b32 v62, a10
    v_accvgpr_read_b32 v63, a11
    s_waitcnt lgkmcnt(2)
    v_add_f32 v60, v60, v48
    v_add_f32 v61, v61, v49
    v_add_f32 v62, v62, v50
    v_add_f32 v63, v63, v51
    s_waitcnt lgkmcnt(1)
    v_add_f32 v60, v60, v52
    v_add_f32 v61, v61, v53
    v_add_f32 v62, v62, v54
    v_add_f32 v63, v63, v55
    s_waitcnt lgkmcnt(0)
    v_add_f32 v60, v60, v56
    v_add_f32 v61, v61, v57
    v_add_f32 v62, v62, v58
    v_add_f32 v63, v63, v59
    v_cvt_pk_bf16_f32 v64, v60, v61
    v_cvt_pk_bf16_f32 v65, v62, v63
    buffer_store_dwordx2 v[64:65], v102, s[20:23], 0 offen offset:0
    ds_read_b128 v[68:71], v250 offset:3072
    ds_read_b128 v[72:75], v250 offset:13312
    ds_read_b128 v[76:79], v250 offset:23552
    v_accvgpr_read_b32 v80, a12
    v_accvgpr_read_b32 v81, a13
    v_accvgpr_read_b32 v82, a14
    v_accvgpr_read_b32 v83, a15
    s_waitcnt lgkmcnt(2)
    v_add_f32 v80, v80, v68
    v_add_f32 v81, v81, v69
    v_add_f32 v82, v82, v70
    v_add_f32 v83, v83, v71
    s_waitcnt lgkmcnt(1)
    v_add_f32 v80, v80, v72
    v_add_f32 v81, v81, v73
    v_add_f32 v82, v82, v74
    v_add_f32 v83, v83, v75
    s_waitcnt lgkmcnt(0)
    v_add_f32 v80, v80, v76
    v_add_f32 v81, v81, v77
    v_add_f32 v82, v82, v78
    v_add_f32 v83, v83, v79
    v_cvt_pk_bf16_f32 v84, v80, v81
    v_cvt_pk_bf16_f32 v85, v82, v83
    buffer_store_dwordx2 v[84:85], v103, s[20:23], 0 offen offset:0
    ds_read_b128 v[48:51], v250 offset:4096
    ds_read_b128 v[52:55], v250 offset:14336
    ds_read_b128 v[56:59], v250 offset:24576
    v_accvgpr_read_b32 v60, a16
    v_accvgpr_read_b32 v61, a17
    v_accvgpr_read_b32 v62, a18
    v_accvgpr_read_b32 v63, a19
    s_waitcnt lgkmcnt(2)
    v_add_f32 v60, v60, v48
    v_add_f32 v61, v61, v49
    v_add_f32 v62, v62, v50
    v_add_f32 v63, v63, v51
    s_waitcnt lgkmcnt(1)
    v_add_f32 v60, v60, v52
    v_add_f32 v61, v61, v53
    v_add_f32 v62, v62, v54
    v_add_f32 v63, v63, v55
    s_waitcnt lgkmcnt(0)
    v_add_f32 v60, v60, v56
    v_add_f32 v61, v61, v57
    v_add_f32 v62, v62, v58
    v_add_f32 v63, v63, v59
    v_cvt_pk_bf16_f32 v64, v60, v61
    v_cvt_pk_bf16_f32 v65, v62, v63
    buffer_store_dwordx2 v[64:65], v104, s[20:23], 0 offen offset:0
    ds_read_b128 v[68:71], v250 offset:5120
    ds_read_b128 v[72:75], v250 offset:15360
    ds_read_b128 v[76:79], v250 offset:25600
    v_accvgpr_read_b32 v80, a20
    v_accvgpr_read_b32 v81, a21
    v_accvgpr_read_b32 v82, a22
    v_accvgpr_read_b32 v83, a23
    s_waitcnt lgkmcnt(2)
    v_add_f32 v80, v80, v68
    v_add_f32 v81, v81, v69
    v_add_f32 v82, v82, v70
    v_add_f32 v83, v83, v71
    s_waitcnt lgkmcnt(1)
    v_add_f32 v80, v80, v72
    v_add_f32 v81, v81, v73
    v_add_f32 v82, v82, v74
    v_add_f32 v83, v83, v75
    s_waitcnt lgkmcnt(0)
    v_add_f32 v80, v80, v76
    v_add_f32 v81, v81, v77
    v_add_f32 v82, v82, v78
    v_add_f32 v83, v83, v79
    v_cvt_pk_bf16_f32 v84, v80, v81
    v_cvt_pk_bf16_f32 v85, v82, v83
    buffer_store_dwordx2 v[84:85], v105, s[20:23], 0 offen offset:0
    ds_read_b128 v[48:51], v250 offset:6144
    ds_read_b128 v[52:55], v250 offset:16384
    ds_read_b128 v[56:59], v250 offset:26624
    v_accvgpr_read_b32 v60, a24
    v_accvgpr_read_b32 v61, a25
    v_accvgpr_read_b32 v62, a26
    v_accvgpr_read_b32 v63, a27
    s_waitcnt lgkmcnt(2)
    v_add_f32 v60, v60, v48
    v_add_f32 v61, v61, v49
    v_add_f32 v62, v62, v50
    v_add_f32 v63, v63, v51
    s_waitcnt lgkmcnt(1)
    v_add_f32 v60, v60, v52
    v_add_f32 v61, v61, v53
    v_add_f32 v62, v62, v54
    v_add_f32 v63, v63, v55
    s_waitcnt lgkmcnt(0)
    v_add_f32 v60, v60, v56
    v_add_f32 v61, v61, v57
    v_add_f32 v62, v62, v58
    v_add_f32 v63, v63, v59
    v_cvt_pk_bf16_f32 v64, v60, v61
    v_cvt_pk_bf16_f32 v65, v62, v63
    buffer_store_dwordx2 v[64:65], v106, s[20:23], 0 offen offset:0
    ds_read_b128 v[68:71], v250 offset:7168
    ds_read_b128 v[72:75], v250 offset:17408
    ds_read_b128 v[76:79], v250 offset:27648
    v_accvgpr_read_b32 v80, a28
    v_accvgpr_read_b32 v81, a29
    v_accvgpr_read_b32 v82, a30
    v_accvgpr_read_b32 v83, a31
    s_waitcnt lgkmcnt(2)
    v_add_f32 v80, v80, v68
    v_add_f32 v81, v81, v69
    v_add_f32 v82, v82, v70
    v_add_f32 v83, v83, v71
    s_waitcnt lgkmcnt(1)
    v_add_f32 v80, v80, v72
    v_add_f32 v81, v81, v73
    v_add_f32 v82, v82, v74
    v_add_f32 v83, v83, v75
    s_waitcnt lgkmcnt(0)
    v_add_f32 v80, v80, v76
    v_add_f32 v81, v81, v77
    v_add_f32 v82, v82, v78
    v_add_f32 v83, v83, v79
    v_cvt_pk_bf16_f32 v84, v80, v81
    v_cvt_pk_bf16_f32 v85, v82, v83
    buffer_store_dwordx2 v[84:85], v107, s[20:23], 0 offen offset:0
    ds_read_b128 v[48:51], v250 offset:8192
    ds_read_b128 v[52:55], v250 offset:18432
    ds_read_b128 v[56:59], v250 offset:28672
    v_accvgpr_read_b32 v60, a32
    v_accvgpr_read_b32 v61, a33
    v_accvgpr_read_b32 v62, a34
    v_accvgpr_read_b32 v63, a35
    s_waitcnt lgkmcnt(2)
    v_add_f32 v60, v60, v48
    v_add_f32 v61, v61, v49
    v_add_f32 v62, v62, v50
    v_add_f32 v63, v63, v51
    s_waitcnt lgkmcnt(1)
    v_add_f32 v60, v60, v52
    v_add_f32 v61, v61, v53
    v_add_f32 v62, v62, v54
    v_add_f32 v63, v63, v55
    s_waitcnt lgkmcnt(0)
    v_add_f32 v60, v60, v56
    v_add_f32 v61, v61, v57
    v_add_f32 v62, v62, v58
    v_add_f32 v63, v63, v59
    v_cvt_pk_bf16_f32 v64, v60, v61
    v_cvt_pk_bf16_f32 v65, v62, v63
    buffer_store_dwordx2 v[64:65], v108, s[20:23], 0 offen offset:0
    ds_read_b128 v[68:71], v250 offset:9216
    ds_read_b128 v[72:75], v250 offset:19456
    ds_read_b128 v[76:79], v250 offset:29696
    v_accvgpr_read_b32 v80, a36
    v_accvgpr_read_b32 v81, a37
    v_accvgpr_read_b32 v82, a38
    v_accvgpr_read_b32 v83, a39
    s_waitcnt lgkmcnt(2)
    v_add_f32 v80, v80, v68
    v_add_f32 v81, v81, v69
    v_add_f32 v82, v82, v70
    v_add_f32 v83, v83, v71
    s_waitcnt lgkmcnt(1)
    v_add_f32 v80, v80, v72
    v_add_f32 v81, v81, v73
    v_add_f32 v82, v82, v74
    v_add_f32 v83, v83, v75
    s_waitcnt lgkmcnt(0)
    v_add_f32 v80, v80, v76
    v_add_f32 v81, v81, v77
    v_add_f32 v82, v82, v78
    v_add_f32 v83, v83, v79
    v_cvt_pk_bf16_f32 v84, v80, v81
    v_cvt_pk_bf16_f32 v85, v82, v83
    buffer_store_dwordx2 v[84:85], v109, s[20:23], 0 offen offset:0
    s_waitcnt vmcnt(0) lgkmcnt(0)
K2_R0:
    s_cmp_lg_u32 s24, 1
    s_cbranch_scc1 K2_R1
    ds_read_b128 v[48:51], v250 offset:0
    ds_read_b128 v[52:55], v250 offset:10240
    ds_read_b128 v[56:59], v250 offset:20480
    v_accvgpr_read_b32 v60, a40
    v_accvgpr_read_b32 v61, a41
    v_accvgpr_read_b32 v62, a42
    v_accvgpr_read_b32 v63, a43
    s_waitcnt lgkmcnt(2)
    v_add_f32 v60, v60, v48
    v_add_f32 v61, v61, v49
    v_add_f32 v62, v62, v50
    v_add_f32 v63, v63, v51
    s_waitcnt lgkmcnt(1)
    v_add_f32 v60, v60, v52
    v_add_f32 v61, v61, v53
    v_add_f32 v62, v62, v54
    v_add_f32 v63, v63, v55
    s_waitcnt lgkmcnt(0)
    v_add_f32 v60, v60, v56
    v_add_f32 v61, v61, v57
    v_add_f32 v62, v62, v58
    v_add_f32 v63, v63, v59
    v_cvt_pk_bf16_f32 v64, v60, v61
    v_cvt_pk_bf16_f32 v65, v62, v63
    buffer_store_dwordx2 v[64:65], v100, s[20:23], 0 offen offset:8
    ds_read_b128 v[68:71], v250 offset:1024
    ds_read_b128 v[72:75], v250 offset:11264
    ds_read_b128 v[76:79], v250 offset:21504
    v_accvgpr_read_b32 v80, a44
    v_accvgpr_read_b32 v81, a45
    v_accvgpr_read_b32 v82, a46
    v_accvgpr_read_b32 v83, a47
    s_waitcnt lgkmcnt(2)
    v_add_f32 v80, v80, v68
    v_add_f32 v81, v81, v69
    v_add_f32 v82, v82, v70
    v_add_f32 v83, v83, v71
    s_waitcnt lgkmcnt(1)
    v_add_f32 v80, v80, v72
    v_add_f32 v81, v81, v73
    v_add_f32 v82, v82, v74
    v_add_f32 v83, v83, v75
    s_waitcnt lgkmcnt(0)
    v_add_f32 v80, v80, v76
    v_add_f32 v81, v81, v77
    v_add_f32 v82, v82, v78
    v_add_f32 v83, v83, v79
    v_cvt_pk_bf16_f32 v84, v80, v81
    v_cvt_pk_bf16_f32 v85, v82, v83
    buffer_store_dwordx2 v[84:85], v101, s[20:23], 0 offen offset:8
    ds_read_b128 v[48:51], v250 offset:2048
    ds_read_b128 v[52:55], v250 offset:12288
    ds_read_b128 v[56:59], v250 offset:22528
    v_accvgpr_read_b32 v60, a48
    v_accvgpr_read_b32 v61, a49
    v_accvgpr_read_b32 v62, a50
    v_accvgpr_read_b32 v63, a51
    s_waitcnt lgkmcnt(2)
    v_add_f32 v60, v60, v48
    v_add_f32 v61, v61, v49
    v_add_f32 v62, v62, v50
    v_add_f32 v63, v63, v51
    s_waitcnt lgkmcnt(1)
    v_add_f32 v60, v60, v52
    v_add_f32 v61, v61, v53
    v_add_f32 v62, v62, v54
    v_add_f32 v63, v63, v55
    s_waitcnt lgkmcnt(0)
    v_add_f32 v60, v60, v56
    v_add_f32 v61, v61, v57
    v_add_f32 v62, v62, v58
    v_add_f32 v63, v63, v59
    v_cvt_pk_bf16_f32 v64, v60, v61
    v_cvt_pk_bf16_f32 v65, v62, v63
    buffer_store_dwordx2 v[64:65], v102, s[20:23], 0 offen offset:8
    ds_read_b128 v[68:71], v250 offset:3072
    ds_read_b128 v[72:75], v250 offset:13312
    ds_read_b128 v[76:79], v250 offset:23552
    v_accvgpr_read_b32 v80, a52
    v_accvgpr_read_b32 v81, a53
    v_accvgpr_read_b32 v82, a54
    v_accvgpr_read_b32 v83, a55
    s_waitcnt lgkmcnt(2)
    v_add_f32 v80, v80, v68
    v_add_f32 v81, v81, v69
    v_add_f32 v82, v82, v70
    v_add_f32 v83, v83, v71
    s_waitcnt lgkmcnt(1)
    v_add_f32 v80, v80, v72
    v_add_f32 v81, v81, v73
    v_add_f32 v82, v82, v74
    v_add_f32 v83, v83, v75
    s_waitcnt lgkmcnt(0)
    v_add_f32 v80, v80, v76
    v_add_f32 v81, v81, v77
    v_add_f32 v82, v82, v78
    v_add_f32 v83, v83, v79
    v_cvt_pk_bf16_f32 v84, v80, v81
    v_cvt_pk_bf16_f32 v85, v82, v83
    buffer_store_dwordx2 v[84:85], v103, s[20:23], 0 offen offset:8
    ds_read_b128 v[48:51], v250 offset:4096
    ds_read_b128 v[52:55], v250 offset:14336
    ds_read_b128 v[56:59], v250 offset:24576
    v_accvgpr_read_b32 v60, a56
    v_accvgpr_read_b32 v61, a57
    v_accvgpr_read_b32 v62, a58
    v_accvgpr_read_b32 v63, a59
    s_waitcnt lgkmcnt(2)
    v_add_f32 v60, v60, v48
    v_add_f32 v61, v61, v49
    v_add_f32 v62, v62, v50
    v_add_f32 v63, v63, v51
    s_waitcnt lgkmcnt(1)
    v_add_f32 v60, v60, v52
    v_add_f32 v61, v61, v53
    v_add_f32 v62, v62, v54
    v_add_f32 v63, v63, v55
    s_waitcnt lgkmcnt(0)
    v_add_f32 v60, v60, v56
    v_add_f32 v61, v61, v57
    v_add_f32 v62, v62, v58
    v_add_f32 v63, v63, v59
    v_cvt_pk_bf16_f32 v64, v60, v61
    v_cvt_pk_bf16_f32 v65, v62, v63
    buffer_store_dwordx2 v[64:65], v104, s[20:23], 0 offen offset:8
    ds_read_b128 v[68:71], v250 offset:5120
    ds_read_b128 v[72:75], v250 offset:15360
    ds_read_b128 v[76:79], v250 offset:25600
    v_accvgpr_read_b32 v80, a60
    v_accvgpr_read_b32 v81, a61
    v_accvgpr_read_b32 v82, a62
    v_accvgpr_read_b32 v83, a63
    s_waitcnt lgkmcnt(2)
    v_add_f32 v80, v80, v68
    v_add_f32 v81, v81, v69
    v_add_f32 v82, v82, v70
    v_add_f32 v83, v83, v71
    s_waitcnt lgkmcnt(1)
    v_add_f32 v80, v80, v72
    v_add_f32 v81, v81, v73
    v_add_f32 v82, v82, v74
    v_add_f32 v83, v83, v75
    s_waitcnt lgkmcnt(0)
    v_add_f32 v80, v80, v76
    v_add_f32 v81, v81, v77
    v_add_f32 v82, v82, v78
    v_add_f32 v83, v83, v79
    v_cvt_pk_bf16_f32 v84, v80, v81
    v_cvt_pk_bf16_f32 v85, v82, v83
    buffer_store_dwordx2 v[84:85], v105, s[20:23], 0 offen offset:8
    ds_read_b128 v[48:51], v250 offset:6144
    ds_read_b128 v[52:55], v250 offset:16384
    ds_read_b128 v[56:59], v250 offset:26624
    v_accvgpr_read_b32 v60, a64
    v_accvgpr_read_b32 v61, a65
    v_accvgpr_read_b32 v62, a66
    v_accvgpr_read_b32 v63, a67
    s_waitcnt lgkmcnt(2)
    v_add_f32 v60, v60, v48
    v_add_f32 v61, v61, v49
    v_add_f32 v62, v62, v50
    v_add_f32 v63, v63, v51
    s_waitcnt lgkmcnt(1)
    v_add_f32 v60, v60, v52
    v_add_f32 v61, v61, v53
    v_add_f32 v62, v62, v54
    v_add_f32 v63, v63, v55
    s_waitcnt lgkmcnt(0)
    v_add_f32 v60, v60, v56
    v_add_f32 v61, v61, v57
    v_add_f32 v62, v62, v58
    v_add_f32 v63, v63, v59
    v_cvt_pk_bf16_f32 v64, v60, v61
    v_cvt_pk_bf16_f32 v65, v62, v63
    buffer_store_dwordx2 v[64:65], v106, s[20:23], 0 offen offset:8
    ds_read_b128 v[68:71], v250 offset:7168
    ds_read_b128 v[72:75], v250 offset:17408
    ds_read_b128 v[76:79], v250 offset:27648
    v_accvgpr_read_b32 v80, a68
    v_accvgpr_read_b32 v81, a69
    v_accvgpr_read_b32 v82, a70
    v_accvgpr_read_b32 v83, a71
    s_waitcnt lgkmcnt(2)
    v_add_f32 v80, v80, v68
    v_add_f32 v81, v81, v69
    v_add_f32 v82, v82, v70
    v_add_f32 v83, v83, v71
    s_waitcnt lgkmcnt(1)
    v_add_f32 v80, v80, v72
    v_add_f32 v81, v81, v73
    v_add_f32 v82, v82, v74
    v_add_f32 v83, v83, v75
    s_waitcnt lgkmcnt(0)
    v_add_f32 v80, v80, v76
    v_add_f32 v81, v81, v77
    v_add_f32 v82, v82, v78
    v_add_f32 v83, v83, v79
    v_cvt_pk_bf16_f32 v84, v80, v81
    v_cvt_pk_bf16_f32 v85, v82, v83
    buffer_store_dwordx2 v[84:85], v107, s[20:23], 0 offen offset:8
    ds_read_b128 v[48:51], v250 offset:8192
    ds_read_b128 v[52:55], v250 offset:18432
    ds_read_b128 v[56:59], v250 offset:28672
    v_accvgpr_read_b32 v60, a72
    v_accvgpr_read_b32 v61, a73
    v_accvgpr_read_b32 v62, a74
    v_accvgpr_read_b32 v63, a75
    s_waitcnt lgkmcnt(2)
    v_add_f32 v60, v60, v48
    v_add_f32 v61, v61, v49
    v_add_f32 v62, v62, v50
    v_add_f32 v63, v63, v51
    s_waitcnt lgkmcnt(1)
    v_add_f32 v60, v60, v52
    v_add_f32 v61, v61, v53
    v_add_f32 v62, v62, v54
    v_add_f32 v63, v63, v55
    s_waitcnt lgkmcnt(0)
    v_add_f32 v60, v60, v56
    v_add_f32 v61, v61, v57
    v_add_f32 v62, v62, v58
    v_add_f32 v63, v63, v59
    v_cvt_pk_bf16_f32 v64, v60, v61
    v_cvt_pk_bf16_f32 v65, v62, v63
    buffer_store_dwordx2 v[64:65], v108, s[20:23], 0 offen offset:8
    ds_read_b128 v[68:71], v250 offset:9216
    ds_read_b128 v[72:75], v250 offset:19456
    ds_read_b128 v[76:79], v250 offset:29696
    v_accvgpr_read_b32 v80, a76
    v_accvgpr_read_b32 v81, a77
    v_accvgpr_read_b32 v82, a78
    v_accvgpr_read_b32 v83, a79
    s_waitcnt lgkmcnt(2)
    v_add_f32 v80, v80, v68
    v_add_f32 v81, v81, v69
    v_add_f32 v82, v82, v70
    v_add_f32 v83, v83, v71
    s_waitcnt lgkmcnt(1)
    v_add_f32 v80, v80, v72
    v_add_f32 v81, v81, v73
    v_add_f32 v82, v82, v74
    v_add_f32 v83, v83, v75
    s_waitcnt lgkmcnt(0)
    v_add_f32 v80, v80, v76
    v_add_f32 v81, v81, v77
    v_add_f32 v82, v82, v78
    v_add_f32 v83, v83, v79
    v_cvt_pk_bf16_f32 v84, v80, v81
    v_cvt_pk_bf16_f32 v85, v82, v83
    buffer_store_dwordx2 v[84:85], v109, s[20:23], 0 offen offset:8
    s_waitcnt vmcnt(0) lgkmcnt(0)
K2_R1:
    s_cmp_lg_u32 s24, 2
    s_cbranch_scc1 K2_R2
    ds_read_b128 v[48:51], v250 offset:0
    ds_read_b128 v[52:55], v250 offset:10240
    ds_read_b128 v[56:59], v250 offset:20480
    v_accvgpr_read_b32 v60, a80
    v_accvgpr_read_b32 v61, a81
    v_accvgpr_read_b32 v62, a82
    v_accvgpr_read_b32 v63, a83
    s_waitcnt lgkmcnt(2)
    v_add_f32 v60, v60, v48
    v_add_f32 v61, v61, v49
    v_add_f32 v62, v62, v50
    v_add_f32 v63, v63, v51
    s_waitcnt lgkmcnt(1)
    v_add_f32 v60, v60, v52
    v_add_f32 v61, v61, v53
    v_add_f32 v62, v62, v54
    v_add_f32 v63, v63, v55
    s_waitcnt lgkmcnt(0)
    v_add_f32 v60, v60, v56
    v_add_f32 v61, v61, v57
    v_add_f32 v62, v62, v58
    v_add_f32 v63, v63, v59
    v_cvt_pk_bf16_f32 v64, v60, v61
    v_cvt_pk_bf16_f32 v65, v62, v63
    buffer_store_dwordx2 v[64:65], v100, s[20:23], 0 offen offset:64
    ds_read_b128 v[68:71], v250 offset:1024
    ds_read_b128 v[72:75], v250 offset:11264
    ds_read_b128 v[76:79], v250 offset:21504
    v_accvgpr_read_b32 v80, a84
    v_accvgpr_read_b32 v81, a85
    v_accvgpr_read_b32 v82, a86
    v_accvgpr_read_b32 v83, a87
    s_waitcnt lgkmcnt(2)
    v_add_f32 v80, v80, v68
    v_add_f32 v81, v81, v69
    v_add_f32 v82, v82, v70
    v_add_f32 v83, v83, v71
    s_waitcnt lgkmcnt(1)
    v_add_f32 v80, v80, v72
    v_add_f32 v81, v81, v73
    v_add_f32 v82, v82, v74
    v_add_f32 v83, v83, v75
    s_waitcnt lgkmcnt(0)
    v_add_f32 v80, v80, v76
    v_add_f32 v81, v81, v77
    v_add_f32 v82, v82, v78
    v_add_f32 v83, v83, v79
    v_cvt_pk_bf16_f32 v84, v80, v81
    v_cvt_pk_bf16_f32 v85, v82, v83
    buffer_store_dwordx2 v[84:85], v101, s[20:23], 0 offen offset:64
    ds_read_b128 v[48:51], v250 offset:2048
    ds_read_b128 v[52:55], v250 offset:12288
    ds_read_b128 v[56:59], v250 offset:22528
    v_accvgpr_read_b32 v60, a88
    v_accvgpr_read_b32 v61, a89
    v_accvgpr_read_b32 v62, a90
    v_accvgpr_read_b32 v63, a91
    s_waitcnt lgkmcnt(2)
    v_add_f32 v60, v60, v48
    v_add_f32 v61, v61, v49
    v_add_f32 v62, v62, v50
    v_add_f32 v63, v63, v51
    s_waitcnt lgkmcnt(1)
    v_add_f32 v60, v60, v52
    v_add_f32 v61, v61, v53
    v_add_f32 v62, v62, v54
    v_add_f32 v63, v63, v55
    s_waitcnt lgkmcnt(0)
    v_add_f32 v60, v60, v56
    v_add_f32 v61, v61, v57
    v_add_f32 v62, v62, v58
    v_add_f32 v63, v63, v59
    v_cvt_pk_bf16_f32 v64, v60, v61
    v_cvt_pk_bf16_f32 v65, v62, v63
    buffer_store_dwordx2 v[64:65], v102, s[20:23], 0 offen offset:64
    ds_read_b128 v[68:71], v250 offset:3072
    ds_read_b128 v[72:75], v250 offset:13312
    ds_read_b128 v[76:79], v250 offset:23552
    v_accvgpr_read_b32 v80, a92
    v_accvgpr_read_b32 v81, a93
    v_accvgpr_read_b32 v82, a94
    v_accvgpr_read_b32 v83, a95
    s_waitcnt lgkmcnt(2)
    v_add_f32 v80, v80, v68
    v_add_f32 v81, v81, v69
    v_add_f32 v82, v82, v70
    v_add_f32 v83, v83, v71
    s_waitcnt lgkmcnt(1)
    v_add_f32 v80, v80, v72
    v_add_f32 v81, v81, v73
    v_add_f32 v82, v82, v74
    v_add_f32 v83, v83, v75
    s_waitcnt lgkmcnt(0)
    v_add_f32 v80, v80, v76
    v_add_f32 v81, v81, v77
    v_add_f32 v82, v82, v78
    v_add_f32 v83, v83, v79
    v_cvt_pk_bf16_f32 v84, v80, v81
    v_cvt_pk_bf16_f32 v85, v82, v83
    buffer_store_dwordx2 v[84:85], v103, s[20:23], 0 offen offset:64
    ds_read_b128 v[48:51], v250 offset:4096
    ds_read_b128 v[52:55], v250 offset:14336
    ds_read_b128 v[56:59], v250 offset:24576
    v_accvgpr_read_b32 v60, a96
    v_accvgpr_read_b32 v61, a97
    v_accvgpr_read_b32 v62, a98
    v_accvgpr_read_b32 v63, a99
    s_waitcnt lgkmcnt(2)
    v_add_f32 v60, v60, v48
    v_add_f32 v61, v61, v49
    v_add_f32 v62, v62, v50
    v_add_f32 v63, v63, v51
    s_waitcnt lgkmcnt(1)
    v_add_f32 v60, v60, v52
    v_add_f32 v61, v61, v53
    v_add_f32 v62, v62, v54
    v_add_f32 v63, v63, v55
    s_waitcnt lgkmcnt(0)
    v_add_f32 v60, v60, v56
    v_add_f32 v61, v61, v57
    v_add_f32 v62, v62, v58
    v_add_f32 v63, v63, v59
    v_cvt_pk_bf16_f32 v64, v60, v61
    v_cvt_pk_bf16_f32 v65, v62, v63
    buffer_store_dwordx2 v[64:65], v104, s[20:23], 0 offen offset:64
    ds_read_b128 v[68:71], v250 offset:5120
    ds_read_b128 v[72:75], v250 offset:15360
    ds_read_b128 v[76:79], v250 offset:25600
    v_accvgpr_read_b32 v80, a100
    v_accvgpr_read_b32 v81, a101
    v_accvgpr_read_b32 v82, a102
    v_accvgpr_read_b32 v83, a103
    s_waitcnt lgkmcnt(2)
    v_add_f32 v80, v80, v68
    v_add_f32 v81, v81, v69
    v_add_f32 v82, v82, v70
    v_add_f32 v83, v83, v71
    s_waitcnt lgkmcnt(1)
    v_add_f32 v80, v80, v72
    v_add_f32 v81, v81, v73
    v_add_f32 v82, v82, v74
    v_add_f32 v83, v83, v75
    s_waitcnt lgkmcnt(0)
    v_add_f32 v80, v80, v76
    v_add_f32 v81, v81, v77
    v_add_f32 v82, v82, v78
    v_add_f32 v83, v83, v79
    v_cvt_pk_bf16_f32 v84, v80, v81
    v_cvt_pk_bf16_f32 v85, v82, v83
    buffer_store_dwordx2 v[84:85], v105, s[20:23], 0 offen offset:64
    ds_read_b128 v[48:51], v250 offset:6144
    ds_read_b128 v[52:55], v250 offset:16384
    ds_read_b128 v[56:59], v250 offset:26624
    v_accvgpr_read_b32 v60, a104
    v_accvgpr_read_b32 v61, a105
    v_accvgpr_read_b32 v62, a106
    v_accvgpr_read_b32 v63, a107
    s_waitcnt lgkmcnt(2)
    v_add_f32 v60, v60, v48
    v_add_f32 v61, v61, v49
    v_add_f32 v62, v62, v50
    v_add_f32 v63, v63, v51
    s_waitcnt lgkmcnt(1)
    v_add_f32 v60, v60, v52
    v_add_f32 v61, v61, v53
    v_add_f32 v62, v62, v54
    v_add_f32 v63, v63, v55
    s_waitcnt lgkmcnt(0)
    v_add_f32 v60, v60, v56
    v_add_f32 v61, v61, v57
    v_add_f32 v62, v62, v58
    v_add_f32 v63, v63, v59
    v_cvt_pk_bf16_f32 v64, v60, v61
    v_cvt_pk_bf16_f32 v65, v62, v63
    buffer_store_dwordx2 v[64:65], v106, s[20:23], 0 offen offset:64
    ds_read_b128 v[68:71], v250 offset:7168
    ds_read_b128 v[72:75], v250 offset:17408
    ds_read_b128 v[76:79], v250 offset:27648
    v_accvgpr_read_b32 v80, a108
    v_accvgpr_read_b32 v81, a109
    v_accvgpr_read_b32 v82, a110
    v_accvgpr_read_b32 v83, a111
    s_waitcnt lgkmcnt(2)
    v_add_f32 v80, v80, v68
    v_add_f32 v81, v81, v69
    v_add_f32 v82, v82, v70
    v_add_f32 v83, v83, v71
    s_waitcnt lgkmcnt(1)
    v_add_f32 v80, v80, v72
    v_add_f32 v81, v81, v73
    v_add_f32 v82, v82, v74
    v_add_f32 v83, v83, v75
    s_waitcnt lgkmcnt(0)
    v_add_f32 v80, v80, v76
    v_add_f32 v81, v81, v77
    v_add_f32 v82, v82, v78
    v_add_f32 v83, v83, v79
    v_cvt_pk_bf16_f32 v84, v80, v81
    v_cvt_pk_bf16_f32 v85, v82, v83
    buffer_store_dwordx2 v[84:85], v107, s[20:23], 0 offen offset:64
    ds_read_b128 v[48:51], v250 offset:8192
    ds_read_b128 v[52:55], v250 offset:18432
    ds_read_b128 v[56:59], v250 offset:28672
    v_accvgpr_read_b32 v60, a112
    v_accvgpr_read_b32 v61, a113
    v_accvgpr_read_b32 v62, a114
    v_accvgpr_read_b32 v63, a115
    s_waitcnt lgkmcnt(2)
    v_add_f32 v60, v60, v48
    v_add_f32 v61, v61, v49
    v_add_f32 v62, v62, v50
    v_add_f32 v63, v63, v51
    s_waitcnt lgkmcnt(1)
    v_add_f32 v60, v60, v52
    v_add_f32 v61, v61, v53
    v_add_f32 v62, v62, v54
    v_add_f32 v63, v63, v55
    s_waitcnt lgkmcnt(0)
    v_add_f32 v60, v60, v56
    v_add_f32 v61, v61, v57
    v_add_f32 v62, v62, v58
    v_add_f32 v63, v63, v59
    v_cvt_pk_bf16_f32 v64, v60, v61
    v_cvt_pk_bf16_f32 v65, v62, v63
    buffer_store_dwordx2 v[64:65], v108, s[20:23], 0 offen offset:64
    ds_read_b128 v[68:71], v250 offset:9216
    ds_read_b128 v[72:75], v250 offset:19456
    ds_read_b128 v[76:79], v250 offset:29696
    v_accvgpr_read_b32 v80, a116
    v_accvgpr_read_b32 v81, a117
    v_accvgpr_read_b32 v82, a118
    v_accvgpr_read_b32 v83, a119
    s_waitcnt lgkmcnt(2)
    v_add_f32 v80, v80, v68
    v_add_f32 v81, v81, v69
    v_add_f32 v82, v82, v70
    v_add_f32 v83, v83, v71
    s_waitcnt lgkmcnt(1)
    v_add_f32 v80, v80, v72
    v_add_f32 v81, v81, v73
    v_add_f32 v82, v82, v74
    v_add_f32 v83, v83, v75
    s_waitcnt lgkmcnt(0)
    v_add_f32 v80, v80, v76
    v_add_f32 v81, v81, v77
    v_add_f32 v82, v82, v78
    v_add_f32 v83, v83, v79
    v_cvt_pk_bf16_f32 v84, v80, v81
    v_cvt_pk_bf16_f32 v85, v82, v83
    buffer_store_dwordx2 v[84:85], v109, s[20:23], 0 offen offset:64
    s_waitcnt vmcnt(0) lgkmcnt(0)
K2_R2:
    s_cmp_lg_u32 s24, 3
    s_cbranch_scc1 K2_R3
    ds_read_b128 v[48:51], v250 offset:0
    ds_read_b128 v[52:55], v250 offset:10240
    ds_read_b128 v[56:59], v250 offset:20480
    v_accvgpr_read_b32 v60, a120
    v_accvgpr_read_b32 v61, a121
    v_accvgpr_read_b32 v62, a122
    v_accvgpr_read_b32 v63, a123
    s_waitcnt lgkmcnt(2)
    v_add_f32 v60, v60, v48
    v_add_f32 v61, v61, v49
    v_add_f32 v62, v62, v50
    v_add_f32 v63, v63, v51
    s_waitcnt lgkmcnt(1)
    v_add_f32 v60, v60, v52
    v_add_f32 v61, v61, v53
    v_add_f32 v62, v62, v54
    v_add_f32 v63, v63, v55
    s_waitcnt lgkmcnt(0)
    v_add_f32 v60, v60, v56
    v_add_f32 v61, v61, v57
    v_add_f32 v62, v62, v58
    v_add_f32 v63, v63, v59
    v_cvt_pk_bf16_f32 v64, v60, v61
    v_cvt_pk_bf16_f32 v65, v62, v63
    buffer_store_dwordx2 v[64:65], v100, s[20:23], 0 offen offset:72
    ds_read_b128 v[68:71], v250 offset:1024
    ds_read_b128 v[72:75], v250 offset:11264
    ds_read_b128 v[76:79], v250 offset:21504
    v_accvgpr_read_b32 v80, a124
    v_accvgpr_read_b32 v81, a125
    v_accvgpr_read_b32 v82, a126
    v_accvgpr_read_b32 v83, a127
    s_waitcnt lgkmcnt(2)
    v_add_f32 v80, v80, v68
    v_add_f32 v81, v81, v69
    v_add_f32 v82, v82, v70
    v_add_f32 v83, v83, v71
    s_waitcnt lgkmcnt(1)
    v_add_f32 v80, v80, v72
    v_add_f32 v81, v81, v73
    v_add_f32 v82, v82, v74
    v_add_f32 v83, v83, v75
    s_waitcnt lgkmcnt(0)
    v_add_f32 v80, v80, v76
    v_add_f32 v81, v81, v77
    v_add_f32 v82, v82, v78
    v_add_f32 v83, v83, v79
    v_cvt_pk_bf16_f32 v84, v80, v81
    v_cvt_pk_bf16_f32 v85, v82, v83
    buffer_store_dwordx2 v[84:85], v101, s[20:23], 0 offen offset:72
    ds_read_b128 v[48:51], v250 offset:2048
    ds_read_b128 v[52:55], v250 offset:12288
    ds_read_b128 v[56:59], v250 offset:22528
    v_accvgpr_read_b32 v60, a128
    v_accvgpr_read_b32 v61, a129
    v_accvgpr_read_b32 v62, a130
    v_accvgpr_read_b32 v63, a131
    s_waitcnt lgkmcnt(2)
    v_add_f32 v60, v60, v48
    v_add_f32 v61, v61, v49
    v_add_f32 v62, v62, v50
    v_add_f32 v63, v63, v51
    s_waitcnt lgkmcnt(1)
    v_add_f32 v60, v60, v52
    v_add_f32 v61, v61, v53
    v_add_f32 v62, v62, v54
    v_add_f32 v63, v63, v55
    s_waitcnt lgkmcnt(0)
    v_add_f32 v60, v60, v56
    v_add_f32 v61, v61, v57
    v_add_f32 v62, v62, v58
    v_add_f32 v63, v63, v59
    v_cvt_pk_bf16_f32 v64, v60, v61
    v_cvt_pk_bf16_f32 v65, v62, v63
    buffer_store_dwordx2 v[64:65], v102, s[20:23], 0 offen offset:72
    ds_read_b128 v[68:71], v250 offset:3072
    ds_read_b128 v[72:75], v250 offset:13312
    ds_read_b128 v[76:79], v250 offset:23552
    v_accvgpr_read_b32 v80, a132
    v_accvgpr_read_b32 v81, a133
    v_accvgpr_read_b32 v82, a134
    v_accvgpr_read_b32 v83, a135
    s_waitcnt lgkmcnt(2)
    v_add_f32 v80, v80, v68
    v_add_f32 v81, v81, v69
    v_add_f32 v82, v82, v70
    v_add_f32 v83, v83, v71
    s_waitcnt lgkmcnt(1)
    v_add_f32 v80, v80, v72
    v_add_f32 v81, v81, v73
    v_add_f32 v82, v82, v74
    v_add_f32 v83, v83, v75
    s_waitcnt lgkmcnt(0)
    v_add_f32 v80, v80, v76
    v_add_f32 v81, v81, v77
    v_add_f32 v82, v82, v78
    v_add_f32 v83, v83, v79
    v_cvt_pk_bf16_f32 v84, v80, v81
    v_cvt_pk_bf16_f32 v85, v82, v83
    buffer_store_dwordx2 v[84:85], v103, s[20:23], 0 offen offset:72
    ds_read_b128 v[48:51], v250 offset:4096
    ds_read_b128 v[52:55], v250 offset:14336
    ds_read_b128 v[56:59], v250 offset:24576
    v_accvgpr_read_b32 v60, a136
    v_accvgpr_read_b32 v61, a137
    v_accvgpr_read_b32 v62, a138
    v_accvgpr_read_b32 v63, a139
    s_waitcnt lgkmcnt(2)
    v_add_f32 v60, v60, v48
    v_add_f32 v61, v61, v49
    v_add_f32 v62, v62, v50
    v_add_f32 v63, v63, v51
    s_waitcnt lgkmcnt(1)
    v_add_f32 v60, v60, v52
    v_add_f32 v61, v61, v53
    v_add_f32 v62, v62, v54
    v_add_f32 v63, v63, v55
    s_waitcnt lgkmcnt(0)
    v_add_f32 v60, v60, v56
    v_add_f32 v61, v61, v57
    v_add_f32 v62, v62, v58
    v_add_f32 v63, v63, v59
    v_cvt_pk_bf16_f32 v64, v60, v61
    v_cvt_pk_bf16_f32 v65, v62, v63
    buffer_store_dwordx2 v[64:65], v104, s[20:23], 0 offen offset:72
    ds_read_b128 v[68:71], v250 offset:5120
    ds_read_b128 v[72:75], v250 offset:15360
    ds_read_b128 v[76:79], v250 offset:25600
    v_accvgpr_read_b32 v80, a140
    v_accvgpr_read_b32 v81, a141
    v_accvgpr_read_b32 v82, a142
    v_accvgpr_read_b32 v83, a143
    s_waitcnt lgkmcnt(2)
    v_add_f32 v80, v80, v68
    v_add_f32 v81, v81, v69
    v_add_f32 v82, v82, v70
    v_add_f32 v83, v83, v71
    s_waitcnt lgkmcnt(1)
    v_add_f32 v80, v80, v72
    v_add_f32 v81, v81, v73
    v_add_f32 v82, v82, v74
    v_add_f32 v83, v83, v75
    s_waitcnt lgkmcnt(0)
    v_add_f32 v80, v80, v76
    v_add_f32 v81, v81, v77
    v_add_f32 v82, v82, v78
    v_add_f32 v83, v83, v79
    v_cvt_pk_bf16_f32 v84, v80, v81
    v_cvt_pk_bf16_f32 v85, v82, v83
    buffer_store_dwordx2 v[84:85], v105, s[20:23], 0 offen offset:72
    ds_read_b128 v[48:51], v250 offset:6144
    ds_read_b128 v[52:55], v250 offset:16384
    ds_read_b128 v[56:59], v250 offset:26624
    v_accvgpr_read_b32 v60, a144
    v_accvgpr_read_b32 v61, a145
    v_accvgpr_read_b32 v62, a146
    v_accvgpr_read_b32 v63, a147
    s_waitcnt lgkmcnt(2)
    v_add_f32 v60, v60, v48
    v_add_f32 v61, v61, v49
    v_add_f32 v62, v62, v50
    v_add_f32 v63, v63, v51
    s_waitcnt lgkmcnt(1)
    v_add_f32 v60, v60, v52
    v_add_f32 v61, v61, v53
    v_add_f32 v62, v62, v54
    v_add_f32 v63, v63, v55
    s_waitcnt lgkmcnt(0)
    v_add_f32 v60, v60, v56
    v_add_f32 v61, v61, v57
    v_add_f32 v62, v62, v58
    v_add_f32 v63, v63, v59
    v_cvt_pk_bf16_f32 v64, v60, v61
    v_cvt_pk_bf16_f32 v65, v62, v63
    buffer_store_dwordx2 v[64:65], v106, s[20:23], 0 offen offset:72
    ds_read_b128 v[68:71], v250 offset:7168
    ds_read_b128 v[72:75], v250 offset:17408
    ds_read_b128 v[76:79], v250 offset:27648
    v_accvgpr_read_b32 v80, a148
    v_accvgpr_read_b32 v81, a149
    v_accvgpr_read_b32 v82, a150
    v_accvgpr_read_b32 v83, a151
    s_waitcnt lgkmcnt(2)
    v_add_f32 v80, v80, v68
    v_add_f32 v81, v81, v69
    v_add_f32 v82, v82, v70
    v_add_f32 v83, v83, v71
    s_waitcnt lgkmcnt(1)
    v_add_f32 v80, v80, v72
    v_add_f32 v81, v81, v73
    v_add_f32 v82, v82, v74
    v_add_f32 v83, v83, v75
    s_waitcnt lgkmcnt(0)
    v_add_f32 v80, v80, v76
    v_add_f32 v81, v81, v77
    v_add_f32 v82, v82, v78
    v_add_f32 v83, v83, v79
    v_cvt_pk_bf16_f32 v84, v80, v81
    v_cvt_pk_bf16_f32 v85, v82, v83
    buffer_store_dwordx2 v[84:85], v107, s[20:23], 0 offen offset:72
    ds_read_b128 v[48:51], v250 offset:8192
    ds_read_b128 v[52:55], v250 offset:18432
    ds_read_b128 v[56:59], v250 offset:28672
    v_accvgpr_read_b32 v60, a152
    v_accvgpr_read_b32 v61, a153
    v_accvgpr_read_b32 v62, a154
    v_accvgpr_read_b32 v63, a155
    s_waitcnt lgkmcnt(2)
    v_add_f32 v60, v60, v48
    v_add_f32 v61, v61, v49
    v_add_f32 v62, v62, v50
    v_add_f32 v63, v63, v51
    s_waitcnt lgkmcnt(1)
    v_add_f32 v60, v60, v52
    v_add_f32 v61, v61, v53
    v_add_f32 v62, v62, v54
    v_add_f32 v63, v63, v55
    s_waitcnt lgkmcnt(0)
    v_add_f32 v60, v60, v56
    v_add_f32 v61, v61, v57
    v_add_f32 v62, v62, v58
    v_add_f32 v63, v63, v59
    v_cvt_pk_bf16_f32 v64, v60, v61
    v_cvt_pk_bf16_f32 v65, v62, v63
    buffer_store_dwordx2 v[64:65], v108, s[20:23], 0 offen offset:72
    ds_read_b128 v[68:71], v250 offset:9216
    ds_read_b128 v[72:75], v250 offset:19456
    ds_read_b128 v[76:79], v250 offset:29696
    v_accvgpr_read_b32 v80, a156
    v_accvgpr_read_b32 v81, a157
    v_accvgpr_read_b32 v82, a158
    v_accvgpr_read_b32 v83, a159
    s_waitcnt lgkmcnt(2)
    v_add_f32 v80, v80, v68
    v_add_f32 v81, v81, v69
    v_add_f32 v82, v82, v70
    v_add_f32 v83, v83, v71
    s_waitcnt lgkmcnt(1)
    v_add_f32 v80, v80, v72
    v_add_f32 v81, v81, v73
    v_add_f32 v82, v82, v74
    v_add_f32 v83, v83, v75
    s_waitcnt lgkmcnt(0)
    v_add_f32 v80, v80, v76
    v_add_f32 v81, v81, v77
    v_add_f32 v82, v82, v78
    v_add_f32 v83, v83, v79
    v_cvt_pk_bf16_f32 v84, v80, v81
    v_cvt_pk_bf16_f32 v85, v82, v83
    buffer_store_dwordx2 v[84:85], v109, s[20:23], 0 offen offset:72
    s_waitcnt vmcnt(0) lgkmcnt(0)
K2_R3:
K2_END:
    s_endpgm
.globl prep_kernel
.p2align 8
.type prep_kernel,@function
prep_kernel:
    s_cmp_ge_u32 s2, 1344
    s_cbranch_scc1 K0_END
    s_load_dwordx2 s[22:23], s[0:1], 96
    s_cmp_ge_u32 s2, 320
    s_cbranch_scc1 K0_W
    s_cmp_ge_u32 s2, 160
    s_cselect_b32 s21, 1, 0
    s_mul_i32 s16, s21, 160
    s_sub_u32 s16, s2, s16
    s_mul_i32 s17, s21, 40
    s_add_u32 s24, s0, s17
    s_addc_u32 s25, s1, 0
    s_load_dwordx2 s[4:5], s[24:25], 0
    s_waitcnt lgkmcnt(0)
    s_lshl_b32 s17, s16, 14
    s_add_u32 s8, s4, s17
    s_addc_u32 s9, s5, 0
    s_and_b32 s9, s9, 65535
    s_mov_b32 s10, 16384
    s_mov_b32 s11, 131072
    s_lshl_b32 s17, s2, 14
    s_add_u32 s17, s17, 67108864
    s_add_u32 s12, s22, s17
    s_addc_u32 s13, s23, 0
    s_and_b32 s13, s13, 65535
    s_mov_b32 s14, 16384
    s_mov_b32 s15, 131072
    v_add_u32 v5, 0, v0
    v_and_b32 v6, 15, v5
    v_lshlrev_b32 v6, 10, v6
    v_lshrrev_b32 v7, 6, v5
    v_lshl_add_u32 v6, v7, 6, v6
    v_bfe_u32 v7, v5, 4, 2
    v_lshl_add_u32 v1, v7, 4, v6
    v_add_u32 v5, 256, v0
    v_and_b32 v6, 15, v5
    v_lshlrev_b32 v6, 10, v6
    v_lshrrev_b32 v7, 6, v5
    v_lshl_add_u32 v6, v7, 6, v6
    v_bfe_u32 v7, v5, 4, 2
    v_lshl_add_u32 v2, v7, 4, v6
    v_add_u32 v5, 512, v0
    v_and_b32 v6, 15, v5
    v_lshlrev_b32 v6, 10, v6
    v_lshrrev_b32 v7, 6, v5
    v_lshl_add_u32 v6, v7, 6, v6
    v_bfe_u32 v7, v5, 4, 2
    v_lshl_add_u32 v3, v7, 4, v6
    v_add_u32 v5, 768, v0
    v_and_b32 v6, 15, v5
    v_lshlrev_b32 v6, 10, v6
    v_lshrrev_b32 v7, 6, v5
    v_lshl_add_u32 v6, v7, 6, v6
    v_bfe_u32 v7, v5, 4, 2
    v_lshl_add_u32 v4, v7, 4, v6
    s_branch K0_COPY
K0_W:
    s_sub_u32 s16, s2, 320
    s_cmp_ge_u32 s16, 512
    s_cbranch_scc1 K0_WO
    s_lshr_b32 s21, s16, 8
    s_mul_i32 s17, s21, 40
    s_add_u32 s24, s0, s17
    s_addc_u32 s25, s1, 0
    s_load_dwordx2 s[4:5], s[24:25], 24
    s_waitcnt lgkmcnt(0)
    s_bfe_u32 s18, s16, 327683
    s_and_b32 s19, s16, 7
    s_lshl_b32 s17, s19, 19
    s_lshl_b32 s20, s18, 8
    s_add_u32 s17, s17, s20
    s_add_u32 s8, s4, s17
    s_addc_u32 s9, s5, 0
    s_and_b32 s9, s9, 65535
    s_sub_u32 s10, 524288, s20
    s_mov_b32 s11, 131072
    s_lshl_b32 s17, s16, 14
    s_add_u32 s17, s17, 83886080
    s_add_u32 s12, s22, s17
    s_addc_u32 s13, s23, 0
    s_and_b32 s13, s13, 65535
    s_mov_b32 s14, 16384
    s_mov_b32 s15, 131072
    v_add_u32 v5, 0, v0
    v_lshrrev_b32 v6, 4, v5
    v_and_b32 v7, 3, v6
    v_lshlrev_b32 v7, 2, v7
    v_and_b32 v8, 15, v5
    v_xor_b32 v7, v7, v8
    v_lshlrev_b32 v7, 4, v7
    v_lshl_add_u32 v1, v6, 13, v7
    v_add_u32 v5, 256, v0
    v_lshrrev_b32 v6, 4, v5
    v_and_b32 v7, 3, v6
    v_lshlrev_b32 v7, 2, v7
    v_and_b32 v8, 15, v5
    v_xor_b32 v7, v7, v8
    v_lshlrev_b32 v7, 4, v7
    v_lshl_add_u32 v2, v6, 13, v7
    v_add_u32 v5, 512, v0
    v_lshrrev_b32 v6, 4, v5
    v_and_b32 v7, 3, v6
    v_lshlrev_b32 v7, 2, v7
    v_and_b32 v8, 15, v5
    v_xor_b32 v7, v7, v8
    v_lshlrev_b32 v7, 4, v7
    v_lshl_add_u32 v3, v6, 13, v7
    v_add_u32 v5, 768, v0
    v_lshrrev_b32 v6, 4, v5
    v_and_b32 v7, 3, v6
    v_lshlrev_b32 v7, 2, v7
    v_and_b32 v8, 15, v5
    v_xor_b32 v7, v7, v8
    v_lshlrev_b32 v7, 4, v7
    v_lshl_add_u32 v4, v6, 13, v7
    s_branch K0_COPY
K0_WO:
    s_sub_u32 s16, s16, 512
    s_lshr_b32 s21, s16, 8
    s_mul_i32 s17, s21, 40
    s_add_u32 s24, s0, s17
    s_addc_u32 s25, s1, 0
    s_load_dwordx2 s[4:5], s[24:25], 32
    s_waitcnt lgkmcnt(0)
    s_bfe_u32 s18, s16, 196613
    s_and_b32 s19, s16, 31
    s_lshl_b32 s17, s19, 17
    s_lshl_b32 s20, s18, 7
    s_add_u32 s17, s17, s20
    s_add_u32 s8, s4, s17
    s_addc_u32 s9, s5, 0
    s_and_b32 s9, s9, 65535
    s_sub_u32 s10, 131072, s20
    s_mov_b32 s11, 131072
    s_lshl_b32 s17, s16, 14
    s_add_u32 s17, s17, 100663296
    s_add_u32 s12, s22, s17
    s_addc_u32 s13, s23, 0
    s_and_b32 s13, s13, 65535
    s_mov_b32 s14, 16384
    s_mov_b32 s15, 131072
    v_add_u32 v5, 0, v0
    v_lshrrev_b32 v6, 3, v5
    v_bfe_u32 v7, v6, 1, 1
    v_lshlrev_b32 v7, 2, v7
    v_and_b32 v8, 7, v5
    v_xor_b32 v7, v7, v8
    v_lshlrev_b32 v7, 4, v7
    v_lshl_add_u32 v1, v6, 10, v7
    v_add_u32 v5, 256, v0
    v_lshrrev_b32 v6, 3, v5
    v_bfe_u32 v7, v6, 1, 1
    v_lshlrev_b32 v7, 2, v7
    v_and_b32 v8, 7, v5
    v_xor_b32 v7, v7, v8
    v_lshlrev_b32 v7, 4, v7
    v_lshl_add_u32 v2, v6, 10, v7
    v_add_u32 v5, 512, v0
    v_lshrrev_b32 v6, 3, v5
    v_bfe_u32 v7, v6, 1, 1
    v_lshlrev_b32 v7, 2, v7
    v_and_b32 v8, 7, v5
    v_xor_b32 v7, v7, v8
    v_lshlrev_b32 v7, 4, v7
    v_lshl_add_u32 v3, v6, 10, v7
    v_add_u32 v5, 768, v0
    v_lshrrev_b32 v6, 3, v5
    v_bfe_u32 v7, v6, 1, 1
    v_lshlrev_b32 v7, 2, v7
    v_and_b32 v8, 7, v5
    v_xor_b32 v7, v7, v8
    v_lshlrev_b32 v7, 4, v7
    v_lshl_add_u32 v4, v6, 10, v7
K0_COPY:
    v_lshlrev_b32 v9, 4, v0
    buffer_load_dwordx4 v[12:15], v1, s[8:11], 0 offen offset:0 nt
    buffer_load_dwordx4 v[16:19], v2, s[8:11], 0 offen offset:0 nt
    buffer_load_dwordx4 v[20:23], v3, s[8:11], 0 offen offset:0 nt
    buffer_load_dwordx4 v[24:27], v4, s[8:11], 0 offen offset:0 nt
    s_mov_b32 s16, 0
    s_waitcnt vmcnt(3)
    buffer_store_dwordx4 v[12:15], v9, s[12:15], s16 offen offset:0
    s_mov_b32 s16, 4096
    s_waitcnt vmcnt(3)
    buffer_store_dwordx4 v[16:19], v9, s[12:15], s16 offen offset:0
    s_mov_b32 s16, 8192
    s_waitcnt vmcnt(3)
    buffer_store_dwordx4 v[20:23], v9, s[12:15], s16 offen offset:0
    s_mov_b32 s16, 12288
    s_waitcnt vmcnt(3)
    buffer_store_dwordx4 v[24:27], v9, s[12:15], s16 offen offset:0
K0_END:
    s_endpgm
.section .rodata,"a"
.p2align 6
.amdhsa_kernel concat_heads__mha_block_cached__gqa_block_cached__near_ridge_kernel
  .amdhsa_next_free_vgpr 512
  .amdhsa_next_free_sgpr 102
  .amdhsa_accum_offset 256
  .amdhsa_group_segment_fixed_size 0
  .amdhsa_kernarg_size 104
  .amdhsa_user_sgpr_count 2
  .amdhsa_user_sgpr_kernarg_segment_ptr 1
  .amdhsa_system_sgpr_workgroup_id_x 1
.end_amdhsa_kernel
.p2align 6
.amdhsa_kernel oproj_kernel
  .amdhsa_next_free_vgpr 512
  .amdhsa_next_free_sgpr 96
  .amdhsa_accum_offset 256
  .amdhsa_group_segment_fixed_size 0
  .amdhsa_kernarg_size 104
  .amdhsa_user_sgpr_count 2
  .amdhsa_user_sgpr_kernarg_segment_ptr 1
  .amdhsa_system_sgpr_workgroup_id_x 1
.end_amdhsa_kernel
.p2align 6
.amdhsa_kernel prep_kernel
  .amdhsa_next_free_vgpr 32
  .amdhsa_next_free_sgpr 32
  .amdhsa_accum_offset 32
  .amdhsa_group_segment_fixed_size 0
  .amdhsa_kernarg_size 104
  .amdhsa_user_sgpr_count 2
  .amdhsa_user_sgpr_kernarg_segment_ptr 1
  .amdhsa_system_sgpr_workgroup_id_x 1
.end_amdhsa_kernel
```
